```python
import torch

def _softmax(x, axis=-1):
    return torch.softmax(x, dim=axis)
def _gelu(x):
    return torch.nn.functional.gelu(x, approximate="tanh")
def _silu(x):
    return torch.nn.functional.silu(x)
def _sigmoid(x):
    return torch.sigmoid(x)
def _layernorm(x, axis=-1, eps=1e-5):
    m = x.mean(dim=axis, keepdim=True)
    v = x.var(dim=axis, keepdim=True, unbiased=False)
    return (x - m) / torch.sqrt(v + eps)
def _scatter_add(tgt, idx, src, axis=0):
    return tgt.clone().index_add_(axis, idx, src)
def _segment_sum(src, seg, n):
    out = torch.zeros((n,) + src.shape[1:], dtype=src.dtype)
    return out.index_add_(0, seg, src)
def _pad(x, pw):
    flat = tuple(v for pair in reversed(pw) for v in pair)
    return torch.nn.functional.pad(x, flat)

kernel_name = 'gated_mix__softmax_full_mha__glu_gated_geglu__prompt'

def setup_inputs():

    _w = (lambda a: (lambda t: t.to(torch.bfloat16) if t.is_floating_point() else t)(torch.as_tensor(a)))
    def _A_setup():
        B, S, D = 1, 2048, 1024
        return {
            "x": _w((lambda *s: torch.randn(*s, dtype=torch.bfloat16) * 0.05)(B, S, D)),
            "wqkv": _w((lambda *s: torch.randn(*s, dtype=torch.bfloat16) * 0.4)(D, 3 * D)),
            "wo": _w((lambda *s: torch.randn(*s, dtype=torch.bfloat16) * 0.05)(D, D)),
        }
    _A_in = _A_setup()

    def _B_setup():
        B, S, Dm, Df = 1, 2048, 1024, 3584
        return {
            "x": _w((lambda *s: torch.randn(*s, dtype=torch.bfloat16) * 0.05)(B, S, Dm)),
            "w_gate": _w((lambda *s: torch.randn(*s, dtype=torch.bfloat16) * 1.6)(Dm, Df) * (Dm ** -0.5)),
            "w_up": _w((lambda *s: torch.randn(*s, dtype=torch.bfloat16) * 1.6)(Dm, Df) * (Dm ** -0.5)),
            "w_down": _w((lambda *s: torch.randn(*s, dtype=torch.bfloat16) * 1.6)(Df, Dm) * (Df ** -0.5)),
        }
    _B_in = _B_setup()

    return {
        "A_x": _A_in["x"],
        "A_wqkv": _A_in["wqkv"],
        "A_wo": _A_in["wo"],
        "B_x": _B_in["x"],
        "B_w_gate": _B_in["w_gate"],
        "B_w_up": _B_in["w_up"],
        "B_w_down": _B_in["w_down"],
        "gate_w": _w((lambda *s: torch.randn(*s, dtype=torch.bfloat16) * 0.05)(1024) * 16.0),
    }

def reference(A_x, A_wqkv, A_wo, B_x, B_w_gate, B_w_up, B_w_down, gate_w):
    def _A_ref(x, wqkv, wo):
        B, S, D = x.shape
        H = 32; Dh = D // H
        qkv = (lambda x, *d: x.permute(*d))((x @ wqkv).reshape(B, S, 3, H, Dh), 2, 0, 3, 1, 4)
        q, k, v = qkv[0], qkv[1], qkv[2]
        scale = Dh ** -0.5
        scores = torch.einsum("bhqd,bhkd->bhqk", q, k) * scale
        p = _softmax(scores, axis=-1)
        o = torch.einsum("bhqk,bhkd->bhqd", p, v)
        return (lambda x, *d: x.permute(*d))(o, 0, 2, 1, 3).reshape(B, S, D) @ wo

    def _B_ref(x, w_gate, w_up, w_down):
        g = torch.einsum("bsd,df->bsf", x, w_gate)
        u = torch.einsum("bsd,df->bsf", x, w_up)
        h = _gelu(g) * u
        return torch.einsum("bsf,fd->bsd", h, w_down)

    x = A_x
    g = _sigmoid((x * gate_w).sum(-1, keepdims=True))
    a = _A_ref(x, A_wqkv, A_wo)
    b = _B_ref(x, B_w_gate, B_w_up, B_w_down)
    return g * a + (1 - g) * b
```

```asm
; @launch grid=(256,1,1) block=(256,1,1) lds=163840
.amdgcn_target "amdgcn-amd-amdhsa--gfx950"
.text
.globl gated_mix__softmax_full_mha__glu_gated_geglu__prompt_kernel
.p2align 8
.type gated_mix__softmax_full_mha__glu_gated_geglu__prompt_kernel,@function
gated_mix__softmax_full_mha__glu_gated_geglu__prompt_kernel:
  s_cmp_ge_u32 s2, 256
  s_cbranch_scc1 L_end
  s_load_dwordx16 s[80:95], s[0:1], 0
  s_load_dwordx4 s[96:99], s[0:1], 64
  s_load_dwordx2 s[100:101], s[0:1], 80
  v_lshrrev_b32 v2, 6, v0
  v_and_b32 v1, 63, v0
  s_and_b32 s6, s2, 7
  v_readfirstlane_b32 s3, v2
  s_lshr_b32 s7, s2, 3
  s_and_b32 s61, s7, 3
  s_lshl_b32 s4, s6, 2
  s_add_u32 s4, s4, s61
  s_lshr_b32 s5, s7, 2
  s_getpc_b64 s[76:77]
L_cpf0:
  s_add_u32 s76, s76, L_pro-L_cpf0
  s_addc_u32 s77, s77, 0
  s_lshl_b32 s64, s3, 13
  s_and_b32 s63, s7, 3
  s_lshl_b32 s63, s63, 15
  s_add_u32 s64, s64, s63
  v_lshl_add_u32 v40, v1, 7, s64
  v_min_u32 v40, L_codeend-L_pro-4, v40
  v_mov_b32 v41, s77
  v_add_co_u32 v40, vcc, s76, v40
  s_nop 1
  v_addc_co_u32 v41, vcc, 0, v41, vcc
  global_load_dword v42, v[40:41], off
L_pro:
  s_and_b32 s61, s7, 3
  s_lshl_b32 s61, s61, 6
  s_lshl_b32 s62, s5, 8
  s_add_u32 s61, s61, s62
  v_add_u32 v27, s61, v1
  v_lshlrev_b32 v27, 11, v27
  s_lshl_b32 s61, s7, 1
  v_cmp_lt_u32 vcc, 6, v1
  v_mov_b32 v31, 0x80000000
  s_nop 0
  v_cndmask_b32 v28, 0, 1, vcc
  v_mul_u32_u24 v29, 7, v28
  v_sub_u32 v29, v1, v29
  v_add_u32 v28, s61, v28
  v_mul_u32_u24 v28, 7168, v28
  v_lshl_add_u32 v28, v29, 7, v28
  s_mul_i32 s62, s6, 896
  v_add_u32 v28, s62, v28
  v_cmp_gt_u32 vcc, 14, v1
  s_nop 1
  v_cndmask_b32 v28, v31, v28, vcc
  v_cmp_lt_u32 vcc, 5, v1
  s_nop 1
  v_cndmask_b32 v29, 0, 1, vcc
  v_mul_u32_u24 v30, 6, v29
  v_sub_u32 v30, v1, v30
  v_add_u32 v29, s61, v29
  v_mul_u32_u24 v29, 6144, v29
  v_lshrrev_b32 v21, 1, v30
  v_lshl_add_u32 v29, v21, 11, v29
  v_and_b32 v30, 1, v30
  v_lshl_add_u32 v29, v30, 7, v29
  s_lshl_b32 s62, s6, 8
  v_add_u32 v29, s62, v29
  v_cmp_gt_u32 vcc, 12, v1
  s_nop 1
  v_cndmask_b32 v29, v31, v29, vcc
  s_cmp_eq_u32 s3, 0
  s_cselect_b64 vcc, -1, 0
  v_cndmask_b32 v20, v28, v27, vcc
  s_cmp_eq_u32 s3, 3
  s_cselect_b64 vcc, -1, 0
  v_cndmask_b32 v20, v20, v29, vcc
  s_waitcnt lgkmcnt(0)
  s_mov_b32 s8, s80
  s_mov_b32 s9, s81
  s_mov_b32 s10, 4194304
  s_mov_b32 s11, 0x20000
  s_mov_b32 s12, s82
  s_mov_b32 s13, s83
  s_mov_b32 s14, 6291456
  s_mov_b32 s15, 0x20000
  s_cmp_lt_u32 s3, 2
  s_cselect_b32 s16, s88, s90
  s_cselect_b32 s17, s89, s91
  s_mov_b32 s18, 7340032
  s_mov_b32 s19, 0x20000
  s_cmp_eq_u32 s3, 0
  s_cselect_b32 s40, s8, s16
  s_cselect_b32 s41, s9, s17
  s_cselect_b32 s42, s10, s18
  s_mov_b32 s52, 458752
  s_cselect_b32 s52, 128, s52
  s_cmp_eq_u32 s3, 3
  s_cselect_b32 s40, s12, s40
  s_cselect_b32 s41, s13, s41
  s_cselect_b32 s42, s14, s42
  s_cselect_b32 s52, 393216, s52
  s_mov_b32 s43, 0x20000
  s_mul_i32 s73, s6, 0
  s_add_u32 s73, s73, 0
  s_and_b32 s73, s73, 15
  s_mul_i32 s51, s52, s73
  buffer_load_dword v21, v20, s[40:43], s51 offen
  s_add_u32 s73, s73, 1
  s_and_b32 s73, s73, 15
  s_mul_i32 s51, s73, s52
  buffer_load_dword v21, v20, s[40:43], s51 offen
  s_add_u32 s73, s73, 1
  s_and_b32 s73, s73, 15
  s_mul_i32 s51, s73, s52
  s_lshl_b32 s61, s5, 8
  s_lshl_b32 s62, s3, 6
  s_add_u32 s61, s61, s62
  v_lshrrev_b32 v27, 3, v1
  v_add_u32 v27, s61, v27
  v_lshlrev_b32 v27, 11, v27
  v_and_b32 v28, 7, v1
  v_lshrrev_b32 v29, 4, v1
  v_xor_b32 v28, v28, v29
  v_lshl_add_u32 v2, v28, 4, v27
  v_xor_b32 v28, 4, v28
  v_lshl_add_u32 v3, v28, 4, v27
  v_add_u32 v3, 15360, v3
  v_add_u32 v4, 30720, v2
  v_add_u32 v5, 30720, v3
  v_add_u32 v6, 65536, v2
  v_add_u32 v7, 65536, v3
  v_add_u32 v8, 96256, v2
  v_add_u32 v9, 96256, v3
  v_lshrrev_b32 v27, 2, v1
  v_and_b32 v28, 3, v27
  v_bfe_u32 v29, v27, 2, 1
  v_lshl_or_b32 v28, v29, 3, v28
  v_bfe_u32 v30, v27, 3, 1
  v_lshl_or_b32 v28, v30, 2, v28
  s_lshl_b32 s61, s3, 4
  v_add_u32 v28, s61, v28
  v_mul_u32_u24 v28, 6144, v28
  v_and_b32 v30, 3, v1
  v_lshlrev_b32 v29, 1, v29
  v_xor_b32 v30, v30, v29
  v_lshl_add_u32 v28, v30, 4, v28
  s_lshl_b32 s61, s4, 6
  v_add_u32 v10, s61, v28
  v_add_u32 v11, 1024, v10
  v_add_u32 v12, 2048, v10
  s_lshl_b32 s54, s3, 13
  s_add_u32 s55, s54, 4096
  s_mul_i32 s56, s3, 3072
  s_add_u32 s56, s56, 32768
  s_mul_i32 s57, s3, 7168
  s_add_u32 s57, s57, 45056
  s_add_u32 s58, s57, 4096
  s_mov_b32 s53, 0
  s_mov_b32 s59, 73728
  s_mul_i32 s72, s6, 0
  s_and_b32 s72, s72, 15
  s_lshl_b32 s48, s72, 7
  s_mul_i32 s49, s72, 393216
  s_mul_i32 s50, s72, 458752
  v_mov_b32 v44, 0
  v_mov_b32 v45, 0
  v_mov_b32 v46, 0
  v_mov_b32 v47, 0
  s_and_b32 s61, s3, 1
  s_mul_i32 s61, s61, 448
  s_mul_i32 s62, s4, 224
  v_add_u32 v31, s61, v1
  v_add_u32 v27, 0, v31
  v_mul_u32_u24 v28, 4682, v27
  v_lshrrev_b32 v28, 16, v28
  v_mul_u32_u24 v29, 14, v28
  v_sub_u32 v27, v27, v29
  v_and_b32_e64 v29, 0x33, v28
  v_bfe_u32 v30, v28, 2, 1
  v_lshl_or_b32 v29, v30, 3, v29
  v_bfe_u32 v30, v28, 3, 1
  v_lshl_or_b32 v29, v30, 2, v29
  v_mul_u32_u24 v29, 7168, v29
  v_lshl_add_u32 v29, v27, 4, v29
  v_mfma_f32_32x32x16_bf16 a[0:15], v[44:47], v[44:47], 0
  v_add_u32 v29, s62, v29
  v_subrev_u32 v13, 0, v29
  v_add_u32 v27, 64, v31
  v_mul_u32_u24 v28, 4682, v27
  v_lshrrev_b32 v28, 16, v28
  v_mul_u32_u24 v29, 14, v28
  v_sub_u32 v27, v27, v29
  v_and_b32_e64 v29, 0x33, v28
  v_bfe_u32 v30, v28, 2, 1
  v_lshl_or_b32 v29, v30, 3, v29
  v_bfe_u32 v30, v28, 3, 1
  v_lshl_or_b32 v29, v30, 2, v29
  v_mul_u32_u24 v29, 7168, v29
  v_lshl_add_u32 v29, v27, 4, v29
  v_add_u32 v29, s62, v29
  v_subrev_u32 v14, 1024, v29
  v_add_u32 v27, 128, v31
  v_mfma_f32_32x32x16_bf16 a[16:31], v[44:47], v[44:47], 0
  v_mul_u32_u24 v28, 4682, v27
  v_lshrrev_b32 v28, 16, v28
  v_mul_u32_u24 v29, 14, v28
  v_sub_u32 v27, v27, v29
  v_and_b32_e64 v29, 0x33, v28
  v_bfe_u32 v30, v28, 2, 1
  v_lshl_or_b32 v29, v30, 3, v29
  v_bfe_u32 v30, v28, 3, 1
  v_lshl_or_b32 v29, v30, 2, v29
  v_mul_u32_u24 v29, 7168, v29
  v_lshl_add_u32 v29, v27, 4, v29
  v_add_u32_e64 v29, s62, v29
  v_subrev_u32 v15, 2048, v29
  v_add_u32 v27, 192, v31
  v_mul_u32_u24 v28, 4682, v27
  v_lshrrev_b32 v28, 16, v28
  v_mul_u32_u24 v29, 14, v28
  v_mfma_f32_32x32x16_bf16 a[32:47], v[44:47], v[44:47], 0
  v_sub_u32 v27, v27, v29
  v_and_b32 v29, 0x33, v28
  v_bfe_u32 v30, v28, 2, 1
  v_lshl_or_b32 v29, v30, 3, v29
  v_bfe_u32 v30, v28, 3, 1
  v_lshl_or_b32 v29, v30, 2, v29
  v_mul_u32_u24 v29, 7168, v29
  v_lshl_add_u32 v29, v27, 4, v29
  v_add_u32_e64 v29, s62, v29
  v_subrev_u32 v16, 3072, v29
  v_add_u32 v27, 256, v31
  v_mul_u32_u24 v28, 4682, v27
  v_lshrrev_b32 v28, 16, v28
  v_mul_u32_u24 v29, 14, v28
  v_sub_u32 v27, v27, v29
  v_and_b32 v29, 0x33, v28
  v_bfe_u32 v30, v28, 2, 1
  v_mfma_f32_32x32x16_bf16 a[48:63], v[44:47], v[44:47], 0
  v_lshl_or_b32 v29, v30, 3, v29
  v_bfe_u32 v30, v28, 3, 1
  v_lshl_or_b32 v29, v30, 2, v29
  v_mul_u32_u24 v29, 7168, v29
  v_lshl_add_u32 v29, v27, 4, v29
  v_add_u32 v29, s62, v29
  v_subrev_u32 v17, 0, v29
  v_add_u32 v27, 320, v31
  v_mul_u32_u24 v28, 4682, v27
  v_lshrrev_b32 v28, 16, v28
  v_mul_u32_u24 v29, 14, v28
  v_sub_u32 v27, v27, v29
  v_and_b32 v29, 0x33, v28
  v_bfe_u32 v30, v28, 2, 1
  v_lshl_or_b32 v29, v30, 3, v29
  v_bfe_u32 v30, v28, 3, 1
  v_lshl_or_b32 v29, v30, 2, v29
  v_mfma_f32_32x32x16_bf16 a[64:79], v[44:47], v[44:47], 0
  v_mul_u32_u24 v29, 7168, v29
  v_lshl_add_u32 v29, v27, 4, v29
  v_add_u32_e64 v29, s62, v29
  v_subrev_u32 v18, 1024, v29
  v_add_u32 v27, 384, v31
  v_mul_u32_u24 v28, 4682, v27
  v_lshrrev_b32 v28, 16, v28
  v_mul_u32_u24 v29, 14, v28
  v_sub_u32 v27, v27, v29
  v_and_b32 v29, 0x33, v28
  v_bfe_u32 v30, v28, 2, 1
  v_lshl_or_b32 v29, v30, 3, v29
  v_bfe_u32 v30, v28, 3, 1
  v_lshl_or_b32 v29, v30, 2, v29
  v_mul_u32_u24 v29, 7168, v29
  v_lshl_add_u32 v29, v27, 4, v29
  v_add_u32 v29, s62, v29
  v_mfma_f32_32x32x16_bf16 a[80:95], v[44:47], v[44:47], 0
  v_subrev_u32 v19, 2048, v29
  v_and_b32 v27, 15, v1
  v_lshrrev_b32 v28, 4, v1
  v_lshrrev_b32 v29, 1, v27
  v_xor_b32 v29, v29, v28
  s_lshl_b32 s61, s3, 13
  v_lshlrev_b32 v30, 7, v27
  v_add_u32 v30, s61, v30
  v_lshl_add_u32 v22, v29, 4, v30
  v_xor_b32 v29, 4, v29
  v_lshl_add_u32 v23, v29, 4, v30
  v_lshrrev_b32 v29, 5, v1
  v_and_b32 v28, 1, v28
  v_lshrrev_b32 v30, 2, v27
  v_lshl_add_u32 v30, v28, 2, v30
  v_and_b32 v27, 3, v27
  v_lshlrev_b32 v27, 3, v27
  v_mfma_f32_32x32x16_bf16 a[96:111], v[44:47], v[44:47], 0
  v_mul_u32_u24 v31, 3072, v29
  v_lshl_add_u32 v31, v30, 6, v31
  v_add_u32 v31, v31, v27
  v_add_u32 v31, 32768, v31
  v_lshl_add_u32 v24, v28, 5, v31
  v_xor_b32 v28, 1, v28
  v_lshl_add_u32 v25, v28, 5, v31
  v_lshl_add_u32 v30, v29, 4, v30
  v_mul_u32_u24 v30, 224, v30
  v_add_u32 v30, v30, v27
  v_add_u32 v26, 45056, v30
  s_mov_b32 s28, s84
  s_mov_b32 s29, s85
  s_mov_b32 s30, 2097152
  s_mov_b32 s31, 0x20000
  s_mov_b32 s24, s92
  s_mov_b32 s25, s93
  v_mfma_f32_32x32x16_bf16 v[48:63], v[44:47], v[44:47], 0
  s_mov_b32 s26, 7340032
  s_mov_b32 s27, 0x20000
  s_mov_b32 s44, s94
  s_mov_b32 s45, s95
  s_mov_b32 s46, 2048
  s_mov_b32 s47, 0x20000
  s_mov_b64 s[78:79], s[96:97]
  s_mov_b32 s36, s98
  s_mov_b32 s37, s99
  s_mov_b32 s38, 256
  s_mov_b32 s39, 0x20000
  s_mov_b32 s20, s100
  s_mov_b32 s21, s101
  s_mov_b32 s22, 41943040
  s_mov_b32 s23, 0x20000
  s_lshl_b32 s65, s4, 3
  s_add_u32 s65, s65, s5
  v_mfma_f32_32x32x16_bf16 v[64:79], v[44:47], v[44:47], 0
  s_and_b32 s68, s6, 1
  s_lshr_b32 s66, s6, 1
  s_lshl_b32 s66, s66, 2
  s_lshr_b32 s61, s7, 3
  s_add_u32 s66, s66, s61
  s_and_b32 s67, s7, 7
  s_lshl_b32 s69, s65, 7
  s_add_u32 s69, s69, 35651584
  s_mov_b32 s94, 35651584
  s_lshl_b32 s61, s5, 8
  s_lshl_b32 s62, s4, 3
  s_add_u32 s61, s61, s62
  s_lshl_b32 s62, s3, 1
  s_add_u32 s61, s61, s62
  s_lshl_b32 s80, s61, 11
  s_lshl_b32 s81, s4, 18
  s_lshl_b32 s61, s5, 15
  v_mfma_f32_32x32x16_bf16 v[80:95], v[44:47], v[44:47], 0
  s_add_u32 s70, s81, s61
  s_add_u32 s71, s70, 4096
  s_mov_b32 s82, s5
  s_lshl_b32 s85, s3, 13
  s_mul_i32 s87, s68, 4194304
  s_lshl_b32 s61, s67, 8
  s_add_u32 s87, s87, s61
  s_add_u32 s88, s87, 32768
  s_add_u32 s89, s85, 65536
  s_lshl_b32 s100, s67, 18
  s_lshl_b32 s62, s3, 17
  s_add_u32 s100, s100, s62
  s_and_b32 s100, s100, 0x1fffff
  s_add_u32 s100, s100, s61
  s_lshl_b32 s62, s68, 7
  s_add_u32 s100, s100, s62
  s_lshl_b32 s61, s66, 2
  v_mfma_f32_32x32x16_bf16 v[96:111], v[44:47], v[44:47], 0
  s_add_u32 s61, s61, s3
  s_lshl_b32 s96, s61, 16
  s_add_u32 s96, s96, 23068672
  s_mul_i32 s90, s61, 224
  s_mul_i32 s62, s68, 128
  s_add_u32 s90, s90, s62
  s_lshl_b32 s90, s90, 10
  s_add_u32 s90, s90, 8388608
  s_lshl_b32 s61, s2, 2
  s_add_u32 s61, s61, s3
  s_lshl_b32 s93, s61, 13
  s_add_u32 s93, s93, 27262976
  s_lshl_b32 s61, s5, 3
  s_lshl_b32 s62, s3, 1
  s_add_u32 s61, s61, s62
  s_lshl_b32 s97, s61, 5
  s_add_u32 s97, s97, s4
  v_mfma_f32_32x32x16_bf16 v[112:127], v[44:47], v[44:47], 0
  s_lshl_b32 s97, s97, 11
  s_add_u32 s97, s97, 23068672
  s_mul_i32 s61, s61, 224
  s_mul_i32 s62, s4, 7
  s_add_u32 s61, s61, s62
  s_lshl_b32 s61, s61, 10
  s_add_u32 s98, s61, 8388608
  v_lshrrev_b32 v32, 4, v1
  v_and_b32 v33, 1, v32
  v_lshlrev_b32 v33, 10, v33
  v_lshrrev_b32_e64 v34, 1, v32
  v_lshl_or_b32 v33, v34, 9, v33
  v_bfe_u32 v34, v1, 3, 1
  v_lshl_or_b32 v33, v34, 8, v33
  v_and_b32 v34, 7, v1
  v_lshl_or_b32 v33, v34, 4, v33
  v_add_u32 v33, s85, v33
  v_mfma_f32_32x32x16_bf16 v[128:143], v[44:47], v[44:47], 0
  v_accvgpr_write_b32 a224, v33
  v_lshrrev_b32 v33, 1, v32
  v_lshlrev_b32 v33, 10, v33
  v_and_b32 v34, 1, v32
  v_lshl_or_b32 v33, v34, 9, v33
  v_and_b32 v34, 15, v1
  v_lshl_or_b32 v33, v34, 4, v33
  v_add_u32 v33, s85, v33
  v_accvgpr_write_b32 a225, v33
  v_and_b32 v33, 6, v1
  v_cmp_eq_u32 vcc, 0, v33
  v_mov_b32 v35, 0x3f803f80
  s_nop 0
  v_cndmask_b32 v36, 0, v35, vcc
  v_cmp_eq_u32 vcc, 4, v33
  v_and_b32_e64 v33, 1, v1
  s_nop 0
  v_cndmask_b32 v37, 0, v35, vcc
  v_cmp_eq_u32 vcc, 0, v33
  v_mfma_f32_32x32x16_bf16 v[144:159], v[44:47], v[44:47], 0
  v_mov_b32 v33, 0xeeeeeeee
  v_mov_b32 v35, 0x44444444
  v_cndmask_b32 v33, v33, v35, vcc
  v_accvgpr_write_b32 a226, v36
  v_accvgpr_write_b32 a227, v37
  v_accvgpr_write_b32 a228, v33
  v_lshrrev_b32 v32, 4, v1
  s_lshl_b32 s61, s3, 5
  v_add_u32 v33, s61, v32
  v_lshlrev_b32 v33, 11, v33
  v_and_b32 v34, 15, v1
  v_lshlrev_b32 v35, 1, v32
  v_xor_b32_e64 v35, v34, v35
  v_lshl_add_u32 v33, v35, 4, v33
  v_xor_b32 v36, 128, v33
  v_accvgpr_write_b32 a229, v33
  v_add_u32 v35, 7168, v33
  v_mfma_f32_32x32x16_bf16 v[160:175], v[44:47], v[44:47], 0
  v_accvgpr_write_b32 a230, v35
  v_add_u32 v35, 14336, v36
  v_accvgpr_write_b32 a231, v35
  v_add_u32 v35, 21504, v36
  v_accvgpr_write_b32 a232, v35
  v_lshrrev_b32 v35, 1, v32
  v_lshlrev_b32 v35, 10, v35
  v_and_b32_e64 v36, 1, v32
  v_lshl_or_b32 v35, v36, 9, v35
  v_lshl_or_b32 v35, v34, 4, v35
  v_accvgpr_write_b32 a233, v35
  v_bfe_u32 v33, v1, 2, 2
  v_lshl_add_u32 v32, v32, 3, v33
  v_and_b32 v34, 3, v1
  v_lshlrev_b32 v34, 3, v34
  v_lshl_add_u32 v35, v32, 8, v34
  v_add_u32 v35, 65536, v35
  v_mfma_f32_32x32x16_bf16 v[176:191], v[44:47], v[44:47], 0
  v_lshl_or_b32 v37, v36, 2, v33
  s_lshl_b32 s61, s68, 2
  s_xor_b32 s61, s61, 4
  v_xor_b32_e64 v37, s61, v37
  v_lshl_add_u32 v37, v37, 5, v35
  v_accvgpr_write_b32 a234, v37
  v_lshl_add_u32 v35, v32, 7, v34
  v_lshrrev_b32_e64 v33, 1, v33
  v_lshl_or_b32 v37, v36, 1, v33
  v_lshl_add_u32 v37, v37, 5, v35
  v_accvgpr_write_b32 a235, v37
  v_lshrrev_b32 v32, 5, v1
  v_bfe_u32 v33, v1, 3, 2
  v_lshl_add_u32 v32, v32, 3, v33
  v_lshlrev_b32 v32, 11, v32
  v_bfe_u32 v33, v1, 4, 1
  v_lshlrev_b32 v33, 1, v33
  v_mfma_f32_32x32x16_bf16 v[192:207], v[44:47], v[44:47], 0
  v_and_b32 v34, 7, v1
  v_xor_b32 v33, v33, v34
  v_lshl_add_u32 v33, v33, 4, v32
  v_xor_b32 v36, 64, v33
  v_accvgpr_write_b32 a236, v33
  v_add_u32 v34, 7168, v36
  v_accvgpr_write_b32 a237, v34
  v_add_u32 v34, 30720, v33
  v_accvgpr_write_b32 a238, v34
  v_add_u32 v34, 37888, v36
  v_accvgpr_write_b32 a239, v34
  v_and_b32 v33, 7, v1
  s_lshl_b32 s61, s4, 3
  v_add_u32 v33, s61, v33
  v_lshlrev_b32 v33, 7, v33
  v_accvgpr_write_b32 a240, v33
  v_and_b32 v33, 31, v1
  v_mfma_f32_32x32x16_bf16 v[208:223], v[44:47], v[44:47], 0
  v_lshlrev_b32 v33, 3, v33
  s_lshr_b32 s61, s66, 1
  v_add_u32 v33, s61, v33
  v_lshlrev_b32 v33, 7, v33
  v_accvgpr_write_b32 a241, v33
  s_lshl_b32 s61, s66, 7
  s_lshl_b32 s62, s3, 5
  s_add_u32 s61, s61, s62
  v_and_b32 v32, 15, v1
  v_add_u32 v32, s61, v32
  v_bfe_u32 v33, v32, 3, 5
  v_lshlrev_b32 v33, 3, v33
  v_lshrrev_b32 v34, 8, v32
  v_add_u32 v33, v33, v34
  v_lshlrev_b32 v33, 7, v33
  v_and_b32 v34, 7, v32
  v_lshl_add_u32 v33, v34, 2, v33
  v_mfma_f32_32x32x16_bf16 v[224:239], v[44:47], v[44:47], 0
  v_accvgpr_write_b32 a242, v33
  v_lshlrev_b32 v32, 11, v32
  v_lshrrev_b32_e64 v33, 5, v1
  v_lshl_add_u32 v33, v33, 4, v32
  v_bfe_u32 v34, v1, 4, 1
  v_lshl_add_u32 v33, v34, 5, v33
  v_accvgpr_write_b32 a243, v33
  s_lshl_b32 s61, s2, 2
  s_add_u32 s61, s61, s3
  s_mul_i32 s95, s61, 7168
  s_lshl_b32 s101, s61, 11
  v_lshlrev_b32 v38, 7, v1
  v_mov_b32 v33, 0x80000000
  v_cmp_gt_u32 vcc, 6, v1
  s_nop 1
  v_cndmask_b32 v38, v33, v38, vcc
  s_mov_b32 s32, s24
  s_mov_b32 s33, s25
  v_mfma_f32_32x32x16_bf16 v[240:255], v[44:47], v[44:47], 0
  s_mov_b32 s34, s26
  s_mov_b32 s35, 0x20000
  v_lshlrev_b32 v34, 7, v1
  v_cmp_gt_u32 vcc, 19, v1
  s_nop 1
  v_cndmask_b32 v34, v33, v34, vcc
  v_accvgpr_write_b32 a244, v34
  v_accvgpr_write_b32 a245, v38
  s_add_u32 m0, s53, s54
  s_nop 0
  buffer_load_dwordx4 v2, s[8:11], s48 offen offset:0 lds
  buffer_load_dwordx4 v3, s[8:11], s48 offen offset:1024 lds
  buffer_load_dwordx4 v4, s[8:11], s48 offen offset:2048 lds
  buffer_load_dwordx4 v5, s[8:11], s48 offen offset:3072 lds
  s_add_u32 m0, s53, s56
  s_nop 0
  buffer_load_dwordx4 v10, s[12:15], s49 offen offset:0 lds
  buffer_load_dwordx4 v11, s[12:15], s49 offen offset:1024 lds
  buffer_load_dwordx4 v12, s[12:15], s49 offen offset:2048 lds
  s_add_u32 m0, s53, s57
  s_nop 0
  buffer_load_dwordx4 v13, s[16:19], s50 offen offset:0 lds
  buffer_load_dwordx4 v14, s[16:19], s50 offen offset:1024 lds
  buffer_load_dwordx4 v15, s[16:19], s50 offen offset:2048 lds
  buffer_load_dwordx4 v16, s[16:19], s50 offen offset:3072 lds
  s_add_u32 m0, s53, s58
  s_nop 0
  buffer_load_dwordx4 v17, s[16:19], s50 offen offset:0 lds
  buffer_load_dwordx4 v18, s[16:19], s50 offen offset:1024 lds
  buffer_load_dwordx4 v19, s[16:19], s50 offen offset:2048 lds
  s_add_u32 m0, s53, s55
  s_nop 0
  buffer_load_dwordx4 v6, s[8:11], s48 offen offset:0 lds
  buffer_load_dwordx4 v7, s[8:11], s48 offen offset:1024 lds
  buffer_load_dwordx4 v8, s[8:11], s48 offen offset:2048 lds
  buffer_load_dwordx4 v9, s[8:11], s48 offen offset:3072 lds
  s_add_u32 s72, s72, 1
  s_and_b32 s72, s72, 15
  s_lshl_b32 s48, s72, 7
  s_mul_i32 s49, s72, 393216
  s_mul_i32 s50, s72, 458752
  s_xor_b32 s53, s53, 73728
  s_mov_b64 exec, 1
  v_mov_b32 v31, 0
  buffer_store_dword v31, off, s[20:23], s69 sc1
  s_mov_b64 exec, -1
  s_mov_b64 exec, 0
  s_cmp_eq_u32 s3, 1
  s_cbranch_scc1 L_tgo1
  s_cmp_eq_u32 s3, 2
  s_cbranch_scc1 L_tgo2
  s_cmp_eq_u32 s3, 3
  s_cbranch_scc1 L_tgo3
L_tgo0:
  s_cmp_eq_u32 s68, 1
  s_branch L_touch0
L_tgo1:
  s_cmp_eq_u32 s68, 1
  s_branch L_touch1
L_tgo2:
  s_cmp_eq_u32 s68, 1
  s_branch L_touch2
L_tgo3:
  s_cmp_eq_u32 s68, 1
  s_branch L_touch3
L_tdisp0:
  s_cbranch_scc1 L_touch14
  s_branch L_touch8
L_tdisp1:
  s_cbranch_scc1 L_touch15
  s_branch L_touch9
L_tdisp2:
  s_cbranch_scc1 L_touch16
  s_branch L_touch10
L_tdisp3:
  s_cbranch_scc1 L_s3b
  s_branch L_touch7
L_tback:
  s_mov_b64 exec, -1
  s_waitcnt vmcnt(1)
  s_barrier
  s_and_b32 s99, s7, 7
  s_sub_u32 s99, 14, s99
  s_cmp_eq_u32 s3, 0
  s_cselect_b32 s99, s99, -1
  s_mov_b32 s60, 15
  ds_read_b64_tr_b16 a[144:145], v24 offset:0
  ds_read_b64_tr_b16 a[146:147], v24 offset:512
  ds_read_b64_tr_b16 a[148:149], v25 offset:0
  ds_read_b64_tr_b16 a[150:151], v25 offset:512
  ds_read_b64_tr_b16 a[152:153], v24 offset:1024
  ds_read_b64_tr_b16 a[154:155], v24 offset:1536
  s_add_u32 m0, s53, s54
  s_nop 0
  buffer_load_dwordx4 v2, s[8:11], s48 offen offset:0 lds
  ds_read_b64_tr_b16 a[156:157], v25 offset:1024
  ds_read_b64_tr_b16 a[158:159], v25 offset:1536
  ds_read_b128 a[112:115], v22 offset:0
  buffer_load_dwordx4 v3, s[8:11], s48 offen offset:1024 lds
  ds_read_b64_tr_b16 a[160:161], v24 offset:2048
  ds_read_b64_tr_b16 a[162:163], v24 offset:2560
  ds_read_b128 a[116:119], v22 offset:2048
  buffer_load_dwordx4 v4, s[8:11], s48 offen offset:2048 lds
  ds_read_b64_tr_b16 a[164:165], v25 offset:2048
  ds_read_b64_tr_b16 a[166:167], v25 offset:2560
  ds_read_b128 a[120:123], v22 offset:4096
  buffer_load_dwordx4 v5, s[8:11], s48 offen offset:3072 lds
  s_waitcnt lgkmcnt(12)
  ds_read_b64_tr_b16 a[168:169], v26 offset:0
  ds_read_b64_tr_b16 a[170:171], v26 offset:1792
  ds_read_b128 a[124:127], v22 offset:6144
  s_add_u32 m0, s53, s56
  s_nop 0
  buffer_load_dwordx4 v10, s[12:15], s49 offen offset:0 lds
  buffer_load_dword v21, v20, s[40:43], s51 offen
  s_add_u32 s73, s73, 1
  s_and_b32 s73, s73, 15
  s_mul_i32 s51, s73, s52
  s_branch L_p1_mid
.p2align 12
L_p1_top:
  s_waitcnt vmcnt(1) lgkmcnt(0)
  s_barrier
  v_mfma_f32_16x16x32_bf16 v[176:179], a[152:155], a[128:131], v[176:179]
  ds_read_b64_tr_b16 a[144:145], v24 offset:0
  v_mfma_f32_16x16x32_bf16 v[180:183], a[152:155], a[132:135], v[180:183]
  ds_read_b64_tr_b16 a[146:147], v24 offset:512
  v_mfma_f32_16x16x32_bf16 v[184:187], a[152:155], a[136:139], v[184:187]
  ds_read_b64_tr_b16 a[148:149], v25 offset:0
  v_mfma_f32_16x16x32_bf16 v[188:191], a[152:155], a[140:143], v[188:191]
  ds_read_b64_tr_b16 a[150:151], v25 offset:512
  v_mfma_f32_16x16x32_bf16 v[192:195], a[156:159], a[128:131], v[192:195]
  ds_read_b64_tr_b16 a[152:153], v24 offset:1024
  v_mfma_f32_16x16x32_bf16 v[196:199], a[156:159], a[132:135], v[196:199]
  ds_read_b64_tr_b16 a[154:155], v24 offset:1536
  v_mfma_f32_16x16x32_bf16 v[200:203], a[156:159], a[136:139], v[200:203]
  s_add_u32 m0, s53, s54
  v_mfma_f32_16x16x32_bf16 v[204:207], a[156:159], a[140:143], v[204:207]
  buffer_load_dwordx4 v2, s[8:11], s48 offen offset:0 lds
  v_mfma_f32_16x16x32_bf16 v[208:211], a[160:163], a[128:131], v[208:211]
  ds_read_b64_tr_b16 a[156:157], v25 offset:1024
  v_mfma_f32_16x16x32_bf16 v[212:215], a[160:163], a[132:135], v[212:215]
  ds_read_b64_tr_b16 a[158:159], v25 offset:1536
  v_mfma_f32_16x16x32_bf16 v[216:219], a[160:163], a[136:139], v[216:219]
  ds_read_b128 a[112:115], v22 offset:0
  v_mfma_f32_16x16x32_bf16 v[220:223], a[160:163], a[140:143], v[220:223]
  buffer_load_dwordx4 v3, s[8:11], s48 offen offset:1024 lds
  v_mfma_f32_16x16x32_bf16 v[224:227], a[164:167], a[128:131], v[224:227]
  ds_read_b64_tr_b16 a[160:161], v24 offset:2048
  v_mfma_f32_16x16x32_bf16 v[228:231], a[164:167], a[132:135], v[228:231]
  ds_read_b64_tr_b16 a[162:163], v24 offset:2560
  v_mfma_f32_16x16x32_bf16 v[232:235], a[164:167], a[136:139], v[232:235]
  ds_read_b128 a[116:119], v22 offset:2048
  v_mfma_f32_16x16x32_bf16 v[236:239], a[164:167], a[140:143], v[236:239]
  buffer_load_dwordx4 v4, s[8:11], s48 offen offset:2048 lds
  v_mfma_f32_16x16x32_bf16 v[240:243], a[168:171], a[128:131], v[240:243]
  ds_read_b64_tr_b16 a[164:165], v25 offset:2048
  v_mfma_f32_16x16x32_bf16 v[244:247], a[168:171], a[132:135], v[244:247]
  ds_read_b64_tr_b16 a[166:167], v25 offset:2560
  v_mfma_f32_16x16x32_bf16 v[248:251], a[168:171], a[136:139], v[248:251]
  ds_read_b128 a[120:123], v22 offset:4096
  v_mfma_f32_16x16x32_bf16 v[252:255], a[168:171], a[140:143], v[252:255]
  buffer_load_dwordx4 v5, s[8:11], s48 offen offset:3072 lds
  v_mfma_f32_16x16x32_bf16 a[0:3], a[172:175], a[128:131], a[0:3]
  s_waitcnt lgkmcnt(12)
  ds_read_b64_tr_b16 a[168:169], v26 offset:0
  v_mfma_f32_16x16x32_bf16 a[4:7], a[172:175], a[132:135], a[4:7]
  ds_read_b64_tr_b16 a[170:171], v26 offset:1792
  v_mfma_f32_16x16x32_bf16 a[8:11], a[172:175], a[136:139], a[8:11]
  ds_read_b128 a[124:127], v22 offset:6144
  s_add_u32 m0, s53, s56
  v_mfma_f32_16x16x32_bf16 a[12:15], a[172:175], a[140:143], a[12:15]
  buffer_load_dwordx4 v10, s[12:15], s49 offen offset:0 lds
L_p1_mid:
  s_waitcnt lgkmcnt(9)
  v_mfma_f32_16x16x32_bf16 a[16:19], a[144:147], a[112:115], a[16:19]
  ds_read_b64_tr_b16 a[172:173], v26 offset:32
  s_waitcnt lgkmcnt(7)
  v_mfma_f32_16x16x32_bf16 a[20:23], a[144:147], a[116:119], a[20:23]
  ds_read_b64_tr_b16 a[174:175], v26 offset:1824
  s_waitcnt lgkmcnt(5)
  v_mfma_f32_16x16x32_bf16 a[24:27], a[144:147], a[120:123], a[24:27]
  s_waitcnt lgkmcnt(2)
  v_mfma_f32_16x16x32_bf16 a[28:31], a[144:147], a[124:127], a[28:31]
  v_mfma_f32_16x16x32_bf16 a[32:35], a[148:151], a[112:115], a[32:35]
  ds_read_b64_tr_b16 a[144:145], v26 offset:64
  v_mfma_f32_16x16x32_bf16 a[36:39], a[148:151], a[116:119], a[36:39]
  ds_read_b64_tr_b16 a[146:147], v26 offset:1856
  v_mfma_f32_16x16x32_bf16 a[40:43], a[148:151], a[120:123], a[40:43]
  buffer_load_dwordx4 v11, s[12:15], s49 offen offset:1024 lds
  v_mfma_f32_16x16x32_bf16 a[44:47], a[148:151], a[124:127], a[44:47]
  v_mfma_f32_16x16x32_bf16 a[48:51], a[152:155], a[112:115], a[48:51]
  ds_read_b64_tr_b16 a[148:149], v26 offset:96
  v_mfma_f32_16x16x32_bf16 a[52:55], a[152:155], a[116:119], a[52:55]
  ds_read_b64_tr_b16 a[150:151], v26 offset:1888
  v_mfma_f32_16x16x32_bf16 a[56:59], a[152:155], a[120:123], a[56:59]
  v_mfma_f32_16x16x32_bf16 a[60:63], a[152:155], a[124:127], a[60:63]
  buffer_load_dwordx4 v12, s[12:15], s49 offen offset:2048 lds
  v_mfma_f32_16x16x32_bf16 a[64:67], a[156:159], a[112:115], a[64:67]
  ds_read_b64_tr_b16 a[152:153], v26 offset:128
  v_mfma_f32_16x16x32_bf16 a[68:71], a[156:159], a[116:119], a[68:71]
  ds_read_b64_tr_b16 a[154:155], v26 offset:1920
  v_mfma_f32_16x16x32_bf16 a[72:75], a[156:159], a[120:123], a[72:75]
  v_mfma_f32_16x16x32_bf16 a[76:79], a[156:159], a[124:127], a[76:79]
  v_mfma_f32_16x16x32_bf16 a[80:83], a[112:115], a[160:163], a[80:83]
  ds_read_b64_tr_b16 a[156:157], v26 offset:160
  v_mfma_f32_16x16x32_bf16 a[84:87], a[116:119], a[160:163], a[84:87]
  ds_read_b64_tr_b16 a[158:159], v26 offset:1952
  s_add_u32 m0, s53, s57
  v_mfma_f32_16x16x32_bf16 a[88:91], a[120:123], a[160:163], a[88:91]
  buffer_load_dwordx4 v13, s[16:19], s50 offen offset:0 lds
  v_mfma_f32_16x16x32_bf16 a[92:95], a[124:127], a[160:163], a[92:95]
  v_mfma_f32_16x16x32_bf16 a[96:99], a[112:115], a[164:167], a[96:99]
  ds_read_b64_tr_b16 a[160:161], v26 offset:192
  v_mfma_f32_16x16x32_bf16 a[100:103], a[116:119], a[164:167], a[100:103]
  ds_read_b64_tr_b16 a[162:163], v26 offset:1984
  v_mfma_f32_16x16x32_bf16 a[104:107], a[120:123], a[164:167], a[104:107]
  v_mfma_f32_16x16x32_bf16 a[108:111], a[124:127], a[164:167], a[108:111]
  buffer_load_dwordx4 v14, s[16:19], s50 offen offset:1024 lds
  v_mfma_f32_16x16x32_bf16 v[48:51], a[168:171], a[112:115], v[48:51]
  ds_read_b64_tr_b16 a[164:165], v26 offset:14336
  v_mfma_f32_16x16x32_bf16 v[52:55], a[168:171], a[116:119], v[52:55]
  ds_read_b64_tr_b16 a[166:167], v26 offset:16128
  v_mfma_f32_16x16x32_bf16 v[56:59], a[168:171], a[120:123], v[56:59]
  v_mfma_f32_16x16x32_bf16 v[60:63], a[168:171], a[124:127], v[60:63]
  s_waitcnt lgkmcnt(12)
  v_mfma_f32_16x16x32_bf16 v[64:67], a[172:175], a[112:115], v[64:67]
  ds_read_b64_tr_b16 a[168:169], v26 offset:14368
  v_mfma_f32_16x16x32_bf16 v[68:71], a[172:175], a[116:119], v[68:71]
  ds_read_b64_tr_b16 a[170:171], v26 offset:16160
  v_mfma_f32_16x16x32_bf16 v[72:75], a[172:175], a[120:123], v[72:75]
  buffer_load_dwordx4 v15, s[16:19], s50 offen offset:2048 lds
  v_mfma_f32_16x16x32_bf16 v[76:79], a[172:175], a[124:127], v[76:79]
  s_waitcnt lgkmcnt(12)
  v_mfma_f32_16x16x32_bf16 v[80:83], a[144:147], a[112:115], v[80:83]
  ds_read_b64_tr_b16 a[172:173], v26 offset:14400
  v_mfma_f32_16x16x32_bf16 v[84:87], a[144:147], a[116:119], v[84:87]
  ds_read_b64_tr_b16 a[174:175], v26 offset:16192
  v_mfma_f32_16x16x32_bf16 v[88:91], a[144:147], a[120:123], v[88:91]
  v_mfma_f32_16x16x32_bf16 v[92:95], a[144:147], a[124:127], v[92:95]
  buffer_load_dwordx4 v16, s[16:19], s50 offen offset:3072 lds
  s_waitcnt lgkmcnt(12)
  v_mfma_f32_16x16x32_bf16 v[96:99], a[148:151], a[112:115], v[96:99]
  ds_read_b64_tr_b16 a[144:145], v26 offset:14432
  v_mfma_f32_16x16x32_bf16 v[100:103], a[148:151], a[116:119], v[100:103]
  ds_read_b64_tr_b16 a[146:147], v26 offset:16224
  v_mfma_f32_16x16x32_bf16 v[104:107], a[148:151], a[120:123], v[104:107]
  v_mfma_f32_16x16x32_bf16 v[108:111], a[148:151], a[124:127], v[108:111]
  s_waitcnt lgkmcnt(12)
  v_mfma_f32_16x16x32_bf16 v[112:115], a[152:155], a[112:115], v[112:115]
  ds_read_b64_tr_b16 a[148:149], v26 offset:14464
  v_mfma_f32_16x16x32_bf16 v[116:119], a[152:155], a[116:119], v[116:119]
  ds_read_b64_tr_b16 a[150:151], v26 offset:16256
  v_mfma_f32_16x16x32_bf16 v[120:123], a[152:155], a[120:123], v[120:123]
  ds_read_b128 a[128:131], v23 offset:0
  s_add_u32 m0, s53, s58
  v_mfma_f32_16x16x32_bf16 v[124:127], a[152:155], a[124:127], v[124:127]
  buffer_load_dwordx4 v17, s[16:19], s50 offen offset:0 lds
  s_waitcnt lgkmcnt(12)
  v_mfma_f32_16x16x32_bf16 v[128:131], a[156:159], a[112:115], v[128:131]
  ds_read_b64_tr_b16 a[152:153], v26 offset:14496
  v_mfma_f32_16x16x32_bf16 v[132:135], a[156:159], a[116:119], v[132:135]
  ds_read_b64_tr_b16 a[154:155], v26 offset:16288
  v_mfma_f32_16x16x32_bf16 v[136:139], a[156:159], a[120:123], v[136:139]
  ds_read_b128 a[132:135], v23 offset:2048
  v_mfma_f32_16x16x32_bf16 v[140:143], a[156:159], a[124:127], v[140:143]
  buffer_load_dwordx4 v18, s[16:19], s50 offen offset:1024 lds
  s_waitcnt lgkmcnt(12)
  v_mfma_f32_16x16x32_bf16 v[144:147], a[160:163], a[112:115], v[144:147]
  ds_read_b64_tr_b16 a[156:157], v26 offset:14528
  v_mfma_f32_16x16x32_bf16 v[148:151], a[160:163], a[116:119], v[148:151]
  ds_read_b64_tr_b16 a[158:159], v26 offset:16320
  v_mfma_f32_16x16x32_bf16 v[152:155], a[160:163], a[120:123], v[152:155]
  ds_read_b128 a[136:139], v23 offset:4096
  v_mfma_f32_16x16x32_bf16 v[156:159], a[160:163], a[124:127], v[156:159]
  v_mfma_f32_16x16x32_bf16 v[160:163], a[164:167], a[112:115], v[160:163]
  s_waitcnt lgkmcnt(12)
  ds_read_b64_tr_b16 a[160:161], v24 offset:6144
  v_mfma_f32_16x16x32_bf16 v[164:167], a[164:167], a[116:119], v[164:167]
  ds_read_b64_tr_b16 a[162:163], v24 offset:6656
  v_mfma_f32_16x16x32_bf16 v[168:171], a[164:167], a[120:123], v[168:171]
  ds_read_b128 a[140:143], v23 offset:6144
  v_mfma_f32_16x16x32_bf16 v[172:175], a[164:167], a[124:127], v[172:175]
  buffer_load_dwordx4 v19, s[16:19], s50 offen offset:2048 lds
  v_mfma_f32_16x16x32_bf16 v[176:179], a[168:171], a[112:115], v[176:179]
  s_waitcnt lgkmcnt(12)
  ds_read_b64_tr_b16 a[164:165], v25 offset:6144
  v_mfma_f32_16x16x32_bf16 v[180:183], a[168:171], a[116:119], v[180:183]
  ds_read_b64_tr_b16 a[166:167], v25 offset:6656
  v_mfma_f32_16x16x32_bf16 v[184:187], a[168:171], a[120:123], v[184:187]
  s_add_u32 m0, s53, s55
  v_mfma_f32_16x16x32_bf16 v[188:191], a[168:171], a[124:127], v[188:191]
  buffer_load_dwordx4 v6, s[8:11], s48 offen offset:0 lds
  v_mfma_f32_16x16x32_bf16 v[192:195], a[172:175], a[112:115], v[192:195]
  ds_read_b64_tr_b16 a[168:169], v24 offset:7168
  v_mfma_f32_16x16x32_bf16 v[196:199], a[172:175], a[116:119], v[196:199]
  s_waitcnt lgkmcnt(12)
  ds_read_b64_tr_b16 a[170:171], v24 offset:7680
  v_mfma_f32_16x16x32_bf16 v[200:203], a[172:175], a[120:123], v[200:203]
  v_mfma_f32_16x16x32_bf16 v[204:207], a[172:175], a[124:127], v[204:207]
  buffer_load_dwordx4 v7, s[8:11], s48 offen offset:1024 lds
  v_mfma_f32_16x16x32_bf16 v[208:211], a[144:147], a[112:115], v[208:211]
  ds_read_b64_tr_b16 a[172:173], v25 offset:7168
  v_mfma_f32_16x16x32_bf16 v[212:215], a[144:147], a[116:119], v[212:215]
  ds_read_b64_tr_b16 a[174:175], v25 offset:7680
  v_mfma_f32_16x16x32_bf16 v[216:219], a[144:147], a[120:123], v[216:219]
  v_mfma_f32_16x16x32_bf16 v[220:223], a[144:147], a[124:127], v[220:223]
  buffer_load_dwordx4 v8, s[8:11], s48 offen offset:2048 lds
  v_mfma_f32_16x16x32_bf16 v[224:227], a[148:151], a[112:115], v[224:227]
  s_waitcnt lgkmcnt(12)
  ds_read_b64_tr_b16 a[144:145], v24 offset:8192
  v_mfma_f32_16x16x32_bf16 v[228:231], a[148:151], a[116:119], v[228:231]
  ds_read_b64_tr_b16 a[146:147], v24 offset:8704
  v_mfma_f32_16x16x32_bf16 v[232:235], a[148:151], a[120:123], v[232:235]
  v_mfma_f32_16x16x32_bf16 v[236:239], a[148:151], a[124:127], v[236:239]
  buffer_load_dwordx4 v9, s[8:11], s48 offen offset:3072 lds
  v_mfma_f32_16x16x32_bf16 v[240:243], a[152:155], a[112:115], v[240:243]
  ds_read_b64_tr_b16 a[148:149], v25 offset:8192
  v_mfma_f32_16x16x32_bf16 v[244:247], a[152:155], a[116:119], v[244:247]
  s_waitcnt lgkmcnt(12)
  ds_read_b64_tr_b16 a[150:151], v25 offset:8704
  s_cmp_eq_u32 s60, s99
  v_mfma_f32_16x16x32_bf16 v[248:251], a[152:155], a[120:123], v[248:251]
  s_cbranch_scc1 L_ann
L_annret:
  v_mfma_f32_16x16x32_bf16 v[252:255], a[152:155], a[124:127], v[252:255]
  buffer_load_dword v21, v20, s[40:43], s51 offen
  v_mfma_f32_16x16x32_bf16 a[0:3], a[156:159], a[112:115], a[0:3]
  ds_read_b64_tr_b16 a[152:153], v26 offset:7168
  v_mfma_f32_16x16x32_bf16 a[4:7], a[156:159], a[116:119], a[4:7]
  ds_read_b64_tr_b16 a[154:155], v26 offset:8960
  v_mfma_f32_16x16x32_bf16 a[8:11], a[156:159], a[120:123], a[8:11]
  s_add_u32 s72, s72, 1
  v_mfma_f32_16x16x32_bf16 a[12:15], a[156:159], a[124:127], a[12:15]
  s_and_b32 s72, s72, 15
  s_waitcnt lgkmcnt(12)
  v_mfma_f32_16x16x32_bf16 a[16:19], a[160:163], a[128:131], a[16:19]
  ds_read_b64_tr_b16 a[156:157], v26 offset:7200
  v_mfma_f32_16x16x32_bf16 a[20:23], a[160:163], a[132:135], a[20:23]
  ds_read_b64_tr_b16 a[158:159], v26 offset:8992
  v_mfma_f32_16x16x32_bf16 a[24:27], a[160:163], a[136:139], a[24:27]
  s_lshl_b32 s48, s72, 7
  v_mfma_f32_16x16x32_bf16 a[28:31], a[160:163], a[140:143], a[28:31]
  s_mul_i32 s49, s72, 393216
  s_waitcnt lgkmcnt(12)
  v_mfma_f32_16x16x32_bf16 a[32:35], a[164:167], a[128:131], a[32:35]
  ds_read_b64_tr_b16 a[160:161], v26 offset:7232
  v_mfma_f32_16x16x32_bf16 a[36:39], a[164:167], a[132:135], a[36:39]
  ds_read_b64_tr_b16 a[162:163], v26 offset:9024
  v_mfma_f32_16x16x32_bf16 a[40:43], a[164:167], a[136:139], a[40:43]
  s_mul_i32 s50, s72, 458752
  v_mfma_f32_16x16x32_bf16 a[44:47], a[164:167], a[140:143], a[44:47]
  s_xor_b32 s53, s53, 73728
  s_waitcnt lgkmcnt(12)
  v_mfma_f32_16x16x32_bf16 a[48:51], a[168:171], a[128:131], a[48:51]
  ds_read_b64_tr_b16 a[164:165], v26 offset:7264
  v_mfma_f32_16x16x32_bf16 a[52:55], a[168:171], a[132:135], a[52:55]
  ds_read_b64_tr_b16 a[166:167], v26 offset:9056
  v_mfma_f32_16x16x32_bf16 a[56:59], a[168:171], a[136:139], a[56:59]
  s_add_u32 s73, s73, 1
  v_mfma_f32_16x16x32_bf16 a[60:63], a[168:171], a[140:143], a[60:63]
  s_and_b32 s73, s73, 15
  s_waitcnt lgkmcnt(12)
  v_mfma_f32_16x16x32_bf16 a[64:67], a[172:175], a[128:131], a[64:67]
  ds_read_b64_tr_b16 a[168:169], v26 offset:7296
  v_mfma_f32_16x16x32_bf16 a[68:71], a[172:175], a[132:135], a[68:71]
  ds_read_b64_tr_b16 a[170:171], v26 offset:9088
  v_mfma_f32_16x16x32_bf16 a[72:75], a[172:175], a[136:139], a[72:75]
  s_mul_i32 s51, s73, s52
  v_mfma_f32_16x16x32_bf16 a[76:79], a[172:175], a[140:143], a[76:79]
  s_waitcnt lgkmcnt(12)
  v_mfma_f32_16x16x32_bf16 a[80:83], a[128:131], a[144:147], a[80:83]
  ds_read_b64_tr_b16 a[172:173], v26 offset:7328
  v_mfma_f32_16x16x32_bf16 a[84:87], a[132:135], a[144:147], a[84:87]
  ds_read_b64_tr_b16 a[174:175], v26 offset:9120
  v_mfma_f32_16x16x32_bf16 a[88:91], a[136:139], a[144:147], a[88:91]
  v_mfma_f32_16x16x32_bf16 a[92:95], a[140:143], a[144:147], a[92:95]
  s_waitcnt lgkmcnt(12)
  v_mfma_f32_16x16x32_bf16 a[96:99], a[128:131], a[148:151], a[96:99]
  ds_read_b64_tr_b16 a[144:145], v26 offset:7360
  v_mfma_f32_16x16x32_bf16 a[100:103], a[132:135], a[148:151], a[100:103]
  ds_read_b64_tr_b16 a[146:147], v26 offset:9152
  v_mfma_f32_16x16x32_bf16 a[104:107], a[136:139], a[148:151], a[104:107]
  v_mfma_f32_16x16x32_bf16 a[108:111], a[140:143], a[148:151], a[108:111]
  s_waitcnt lgkmcnt(12)
  v_mfma_f32_16x16x32_bf16 v[48:51], a[152:155], a[128:131], v[48:51]
  ds_read_b64_tr_b16 a[148:149], v26 offset:21504
  v_mfma_f32_16x16x32_bf16 v[52:55], a[152:155], a[132:135], v[52:55]
  ds_read_b64_tr_b16 a[150:151], v26 offset:23296
  v_mfma_f32_16x16x32_bf16 v[56:59], a[152:155], a[136:139], v[56:59]
  v_mfma_f32_16x16x32_bf16 v[60:63], a[152:155], a[140:143], v[60:63]
  s_waitcnt lgkmcnt(12)
  v_mfma_f32_16x16x32_bf16 v[64:67], a[156:159], a[128:131], v[64:67]
  ds_read_b64_tr_b16 a[152:153], v26 offset:21536
  v_mfma_f32_16x16x32_bf16 v[68:71], a[156:159], a[132:135], v[68:71]
  ds_read_b64_tr_b16 a[154:155], v26 offset:23328
  v_mfma_f32_16x16x32_bf16 v[72:75], a[156:159], a[136:139], v[72:75]
  v_mfma_f32_16x16x32_bf16 v[76:79], a[156:159], a[140:143], v[76:79]
  s_waitcnt lgkmcnt(12)
  v_mfma_f32_16x16x32_bf16 v[80:83], a[160:163], a[128:131], v[80:83]
  ds_read_b64_tr_b16 a[156:157], v26 offset:21568
  v_mfma_f32_16x16x32_bf16 v[84:87], a[160:163], a[132:135], v[84:87]
  ds_read_b64_tr_b16 a[158:159], v26 offset:23360
  v_mfma_f32_16x16x32_bf16 v[88:91], a[160:163], a[136:139], v[88:91]
  v_mfma_f32_16x16x32_bf16 v[92:95], a[160:163], a[140:143], v[92:95]
  s_waitcnt lgkmcnt(12)
  v_mfma_f32_16x16x32_bf16 v[96:99], a[164:167], a[128:131], v[96:99]
  ds_read_b64_tr_b16 a[160:161], v26 offset:21600
  v_mfma_f32_16x16x32_bf16 v[100:103], a[164:167], a[132:135], v[100:103]
  ds_read_b64_tr_b16 a[162:163], v26 offset:23392
  v_mfma_f32_16x16x32_bf16 v[104:107], a[164:167], a[136:139], v[104:107]
  v_mfma_f32_16x16x32_bf16 v[108:111], a[164:167], a[140:143], v[108:111]
  s_waitcnt lgkmcnt(12)
  v_mfma_f32_16x16x32_bf16 v[112:115], a[168:171], a[128:131], v[112:115]
  ds_read_b64_tr_b16 a[164:165], v26 offset:21632
  v_mfma_f32_16x16x32_bf16 v[116:119], a[168:171], a[132:135], v[116:119]
  ds_read_b64_tr_b16 a[166:167], v26 offset:23424
  v_mfma_f32_16x16x32_bf16 v[120:123], a[168:171], a[136:139], v[120:123]
  v_mfma_f32_16x16x32_bf16 v[124:127], a[168:171], a[140:143], v[124:127]
  s_waitcnt lgkmcnt(12)
  v_mfma_f32_16x16x32_bf16 v[128:131], a[172:175], a[128:131], v[128:131]
  ds_read_b64_tr_b16 a[168:169], v26 offset:21664
  v_mfma_f32_16x16x32_bf16 v[132:135], a[172:175], a[132:135], v[132:135]
  ds_read_b64_tr_b16 a[170:171], v26 offset:23456
  v_mfma_f32_16x16x32_bf16 v[136:139], a[172:175], a[136:139], v[136:139]
  v_mfma_f32_16x16x32_bf16 v[140:143], a[172:175], a[140:143], v[140:143]
  s_waitcnt lgkmcnt(12)
  v_mfma_f32_16x16x32_bf16 v[144:147], a[144:147], a[128:131], v[144:147]
  ds_read_b64_tr_b16 a[172:173], v26 offset:21696
  v_mfma_f32_16x16x32_bf16 v[148:151], a[144:147], a[132:135], v[148:151]
  ds_read_b64_tr_b16 a[174:175], v26 offset:23488
  v_mfma_f32_16x16x32_bf16 v[152:155], a[144:147], a[136:139], v[152:155]
  s_sub_u32 s60, s60, 1
  v_mfma_f32_16x16x32_bf16 v[156:159], a[144:147], a[140:143], v[156:159]
  s_waitcnt lgkmcnt(12)
  v_mfma_f32_16x16x32_bf16 v[160:163], a[148:151], a[128:131], v[160:163]
  v_add_u32 v22, s59, v22
  v_mfma_f32_16x16x32_bf16 v[164:167], a[148:151], a[132:135], v[164:167]
  v_add_u32 v23, s59, v23
  v_mfma_f32_16x16x32_bf16 v[168:171], a[148:151], a[136:139], v[168:171]
  v_add_u32 v24, s59, v24
  v_mfma_f32_16x16x32_bf16 v[172:175], a[148:151], a[140:143], v[172:175]
  v_add_u32 v25, s59, v25
  v_add_u32 v26, s59, v26
  s_sub_u32 s59, 0, s59
  s_cmp_lg_u32 s60, 0
  s_cbranch_scc1 L_p1_top
L_p1_last:
  s_waitcnt vmcnt(1)
  s_waitcnt lgkmcnt(0)
  s_barrier
  v_mfma_f32_16x16x32_bf16 v[176:179], a[152:155], a[128:131], v[176:179]
  ds_read_b64_tr_b16 a[144:145], v24 offset:0
  v_mfma_f32_16x16x32_bf16 v[180:183], a[152:155], a[132:135], v[180:183]
  ds_read_b64_tr_b16 a[146:147], v24 offset:512
  v_mfma_f32_16x16x32_bf16 v[184:187], a[152:155], a[136:139], v[184:187]
  ds_read_b64_tr_b16 a[148:149], v25 offset:0
  v_mfma_f32_16x16x32_bf16 v[188:191], a[152:155], a[140:143], v[188:191]
  ds_read_b64_tr_b16 a[150:151], v25 offset:512
  v_mfma_f32_16x16x32_bf16 v[192:195], a[156:159], a[128:131], v[192:195]
  ds_read_b64_tr_b16 a[152:153], v24 offset:1024
  v_mfma_f32_16x16x32_bf16 v[196:199], a[156:159], a[132:135], v[196:199]
  ds_read_b64_tr_b16 a[154:155], v24 offset:1536
  v_mfma_f32_16x16x32_bf16 v[200:203], a[156:159], a[136:139], v[200:203]
  v_mfma_f32_16x16x32_bf16 v[204:207], a[156:159], a[140:143], v[204:207]
  s_getpc_b64 s[76:77]
L_cpf1:
  s_add_u32 s76, s76, L_epi-L_cpf1
  s_addc_u32 s77, s77, 0
  v_mfma_f32_16x16x32_bf16 v[208:211], a[160:163], a[128:131], v[208:211]
  ds_read_b64_tr_b16 a[156:157], v25 offset:1024
  v_mfma_f32_16x16x32_bf16 v[212:215], a[160:163], a[132:135], v[212:215]
  ds_read_b64_tr_b16 a[158:159], v25 offset:1536
  v_mfma_f32_16x16x32_bf16 v[216:219], a[160:163], a[136:139], v[216:219]
  ds_read_b128 a[112:115], v22 offset:0
  v_mfma_f32_16x16x32_bf16 v[220:223], a[160:163], a[140:143], v[220:223]
  s_lshl_b32 s64, s3, 13
  v_mfma_f32_16x16x32_bf16 v[224:227], a[164:167], a[128:131], v[224:227]
  ds_read_b64_tr_b16 a[160:161], v24 offset:2048
  v_mfma_f32_16x16x32_bf16 v[228:231], a[164:167], a[132:135], v[228:231]
  ds_read_b64_tr_b16 a[162:163], v24 offset:2560
  v_mfma_f32_16x16x32_bf16 v[232:235], a[164:167], a[136:139], v[232:235]
  ds_read_b128 a[116:119], v22 offset:2048
  v_mfma_f32_16x16x32_bf16 v[236:239], a[164:167], a[140:143], v[236:239]
  v_lshl_add_u32 v28, v1, 7, s64
  v_mfma_f32_16x16x32_bf16 v[240:243], a[168:171], a[128:131], v[240:243]
  ds_read_b64_tr_b16 a[164:165], v25 offset:2048
  v_mfma_f32_16x16x32_bf16 v[244:247], a[168:171], a[132:135], v[244:247]
  ds_read_b64_tr_b16 a[166:167], v25 offset:2560
  v_mfma_f32_16x16x32_bf16 v[248:251], a[168:171], a[136:139], v[248:251]
  ds_read_b128 a[120:123], v22 offset:4096
  v_mfma_f32_16x16x32_bf16 v[252:255], a[168:171], a[140:143], v[252:255]
  v_min_u32 v28, L_codeend-L_epi-4, v28
  v_mfma_f32_16x16x32_bf16 a[0:3], a[172:175], a[128:131], a[0:3]
  s_waitcnt lgkmcnt(12)
  ds_read_b64_tr_b16 a[168:169], v24 offset:6144
  v_mfma_f32_16x16x32_bf16 a[4:7], a[172:175], a[132:135], a[4:7]
  ds_read_b64_tr_b16 a[170:171], v24 offset:6656
  v_mfma_f32_16x16x32_bf16 a[8:11], a[172:175], a[136:139], a[8:11]
  ds_read_b128 a[124:127], v22 offset:6144
  v_mfma_f32_16x16x32_bf16 a[12:15], a[172:175], a[140:143], a[12:15]
  v_mov_b32 v29, s77
  s_waitcnt lgkmcnt(9)
  v_mfma_f32_16x16x32_bf16 a[16:19], a[144:147], a[112:115], a[16:19]
  ds_read_b64_tr_b16 a[172:173], v25 offset:6144
  s_waitcnt lgkmcnt(7)
  v_mfma_f32_16x16x32_bf16 a[20:23], a[144:147], a[116:119], a[20:23]
  ds_read_b64_tr_b16 a[174:175], v25 offset:6656
  s_waitcnt lgkmcnt(5)
  v_mfma_f32_16x16x32_bf16 a[24:27], a[144:147], a[120:123], a[24:27]
  ds_read_b128 a[128:131], v23 offset:0
  s_waitcnt lgkmcnt(3)
  v_mfma_f32_16x16x32_bf16 a[28:31], a[144:147], a[124:127], a[28:31]
  v_add_co_u32 v28, vcc, s76, v28
  v_mfma_f32_16x16x32_bf16 a[32:35], a[148:151], a[112:115], a[32:35]
  ds_read_b64_tr_b16 a[144:145], v24 offset:7168
  v_mfma_f32_16x16x32_bf16 a[36:39], a[148:151], a[116:119], a[36:39]
  ds_read_b64_tr_b16 a[146:147], v24 offset:7680
  v_mfma_f32_16x16x32_bf16 a[40:43], a[148:151], a[120:123], a[40:43]
  ds_read_b128 a[132:135], v23 offset:2048
  v_mfma_f32_16x16x32_bf16 a[44:47], a[148:151], a[124:127], a[44:47]
  v_addc_co_u32 v29, vcc, 0, v29, vcc
  v_mfma_f32_16x16x32_bf16 a[48:51], a[152:155], a[112:115], a[48:51]
  ds_read_b64_tr_b16 a[148:149], v25 offset:7168
  v_mfma_f32_16x16x32_bf16 a[52:55], a[152:155], a[116:119], a[52:55]
  ds_read_b64_tr_b16 a[150:151], v25 offset:7680
  v_mfma_f32_16x16x32_bf16 a[56:59], a[152:155], a[120:123], a[56:59]
  ds_read_b128 a[136:139], v23 offset:4096
  v_mfma_f32_16x16x32_bf16 a[60:63], a[152:155], a[124:127], a[60:63]
  global_load_dword v27, v[28:29], off
  v_mfma_f32_16x16x32_bf16 a[64:67], a[156:159], a[112:115], a[64:67]
  ds_read_b64_tr_b16 a[152:153], v24 offset:8192
  v_mfma_f32_16x16x32_bf16 a[68:71], a[156:159], a[116:119], a[68:71]
  ds_read_b64_tr_b16 a[154:155], v24 offset:8704
  v_mfma_f32_16x16x32_bf16 a[72:75], a[156:159], a[120:123], a[72:75]
  ds_read_b128 a[140:143], v23 offset:6144
  v_mfma_f32_16x16x32_bf16 a[76:79], a[156:159], a[124:127], a[76:79]
  v_lshlrev_b32 v31, 5, v1
  v_mfma_f32_16x16x32_bf16 a[80:83], a[112:115], a[160:163], a[80:83]
  ds_read_b64_tr_b16 a[156:157], v25 offset:8192
  v_mfma_f32_16x16x32_bf16 a[84:87], a[116:119], a[160:163], a[84:87]
  ds_read_b64_tr_b16 a[158:159], v25 offset:8704
  v_mfma_f32_16x16x32_bf16 a[88:91], a[120:123], a[160:163], a[88:91]
  buffer_load_dwordx4 v[6:9], v31, s[44:47], 0 offen
  v_mfma_f32_16x16x32_bf16 a[92:95], a[124:127], a[160:163], a[92:95]
  buffer_load_dwordx4 v[10:13], v31, s[44:47], 0 offen offset:16
  v_mfma_f32_16x16x32_bf16 a[96:99], a[112:115], a[164:167], a[96:99]
  ds_read_b64_tr_b16 a[160:161], v26 offset:0
  v_mfma_f32_16x16x32_bf16 a[100:103], a[116:119], a[164:167], a[100:103]
  s_waitcnt lgkmcnt(12)
  ds_read_b64_tr_b16 a[162:163], v26 offset:1792
  v_mfma_f32_16x16x32_bf16 a[104:107], a[120:123], a[164:167], a[104:107]
  buffer_load_dwordx4 v[32:35], v31, s[8:11], s80 offen
  v_mfma_f32_16x16x32_bf16 a[108:111], a[124:127], a[164:167], a[108:111]
  buffer_load_dwordx4 v[36:39], v31, s[8:11], s80 offen offset:16
  v_mfma_f32_16x16x32_bf16 a[16:19], a[168:171], a[128:131], a[16:19]
  ds_read_b64_tr_b16 a[164:165], v26 offset:32
  s_waitcnt lgkmcnt(11)
  v_mfma_f32_16x16x32_bf16 a[20:23], a[168:171], a[132:135], a[20:23]
  ds_read_b64_tr_b16 a[166:167], v26 offset:1824
  s_waitcnt lgkmcnt(9)
  v_mfma_f32_16x16x32_bf16 a[24:27], a[168:171], a[136:139], a[24:27]
  buffer_load_dwordx4 v[40:43], v31, s[8:11], s80 offen offset:2048
  s_waitcnt lgkmcnt(6)
  v_mfma_f32_16x16x32_bf16 a[28:31], a[168:171], a[140:143], a[28:31]
  buffer_load_dwordx4 v[44:47], v31, s[8:11], s80 offen offset:2064
  v_mfma_f32_16x16x32_bf16 a[32:35], a[172:175], a[128:131], a[32:35]
  ds_read_b64_tr_b16 a[168:169], v26 offset:64
  v_mfma_f32_16x16x32_bf16 a[36:39], a[172:175], a[132:135], a[36:39]
  ds_read_b64_tr_b16 a[170:171], v26 offset:1856
  v_mfma_f32_16x16x32_bf16 a[40:43], a[172:175], a[136:139], a[40:43]
  buffer_load_dword v5, off, s[36:39], 0 offset:252 sc1
  v_mfma_f32_16x16x32_bf16 a[44:47], a[172:175], a[140:143], a[44:47]
  v_accvgpr_read_b32 v2, a224
  v_mfma_f32_16x16x32_bf16 a[48:51], a[144:147], a[128:131], a[48:51]
  ds_read_b64_tr_b16 a[172:173], v26 offset:96
  v_mfma_f32_16x16x32_bf16 a[52:55], a[144:147], a[132:135], a[52:55]
  ds_read_b64_tr_b16 a[174:175], v26 offset:1888
  v_mfma_f32_16x16x32_bf16 a[56:59], a[144:147], a[136:139], a[56:59]
  v_accvgpr_read_b32 v3, a225
  v_mfma_f32_16x16x32_bf16 a[60:63], a[144:147], a[140:143], a[60:63]
  v_lshlrev_b32 v4, 4, v1
  v_mfma_f32_16x16x32_bf16 a[64:67], a[148:151], a[128:131], a[64:67]
  ds_read_b64_tr_b16 a[144:145], v26 offset:128
  v_mfma_f32_16x16x32_bf16 a[68:71], a[148:151], a[132:135], a[68:71]
  ds_read_b64_tr_b16 a[146:147], v26 offset:1920
  v_mfma_f32_16x16x32_bf16 a[72:75], a[148:151], a[136:139], a[72:75]
  v_mfma_f32_16x16x32_bf16 a[76:79], a[148:151], a[140:143], a[76:79]
  v_mfma_f32_16x16x32_bf16 a[80:83], a[128:131], a[152:155], a[80:83]
  ds_read_b64_tr_b16 a[148:149], v26 offset:160
  v_mfma_f32_16x16x32_bf16 a[84:87], a[132:135], a[152:155], a[84:87]
  ds_read_b64_tr_b16 a[150:151], v26 offset:1952
  v_mfma_f32_16x16x32_bf16 a[88:91], a[136:139], a[152:155], a[88:91]
  v_mfma_f32_16x16x32_bf16 a[92:95], a[140:143], a[152:155], a[92:95]
  s_waitcnt lgkmcnt(12)
  v_mfma_f32_16x16x32_bf16 a[96:99], a[128:131], a[156:159], a[96:99]
  ds_read_b64_tr_b16 a[152:153], v26 offset:192
  v_mfma_f32_16x16x32_bf16 a[100:103], a[132:135], a[156:159], a[100:103]
  ds_read_b64_tr_b16 a[154:155], v26 offset:1984
  v_mfma_f32_16x16x32_bf16 a[104:107], a[136:139], a[156:159], a[104:107]
  v_mfma_f32_16x16x32_bf16 a[108:111], a[140:143], a[156:159], a[108:111]
  s_waitcnt lgkmcnt(12)
  v_mfma_f32_16x16x32_bf16 v[48:51], a[160:163], a[112:115], v[48:51]
  ds_read_b64_tr_b16 a[156:157], v26 offset:14336
  v_mfma_f32_16x16x32_bf16 v[52:55], a[160:163], a[116:119], v[52:55]
  ds_read_b64_tr_b16 a[158:159], v26 offset:16128
  v_mfma_f32_16x16x32_bf16 v[56:59], a[160:163], a[120:123], v[56:59]
  v_mfma_f32_16x16x32_bf16 v[60:63], a[160:163], a[124:127], v[60:63]
  s_waitcnt lgkmcnt(12)
  v_mfma_f32_16x16x32_bf16 v[64:67], a[164:167], a[112:115], v[64:67]
  ds_read_b64_tr_b16 a[160:161], v26 offset:14368
  v_mfma_f32_16x16x32_bf16 v[68:71], a[164:167], a[116:119], v[68:71]
  ds_read_b64_tr_b16 a[162:163], v26 offset:16160
  v_mfma_f32_16x16x32_bf16 v[72:75], a[164:167], a[120:123], v[72:75]
  v_mfma_f32_16x16x32_bf16 v[76:79], a[164:167], a[124:127], v[76:79]
  s_waitcnt lgkmcnt(12)
  v_mfma_f32_16x16x32_bf16 v[80:83], a[168:171], a[112:115], v[80:83]
  ds_read_b64_tr_b16 a[164:165], v26 offset:14400
  v_accvgpr_read_b32 v18, a48
  v_mfma_f32_16x16x32_bf16 v[84:87], a[168:171], a[116:119], v[84:87]
  ds_read_b64_tr_b16 a[166:167], v26 offset:16192
  v_accvgpr_read_b32 v19, a49
  v_mfma_f32_16x16x32_bf16 v[88:91], a[168:171], a[120:123], v[88:91]
  v_accvgpr_read_b32 v20, a50
  s_waitcnt vmcnt(8)
  v_accvgpr_read_b32 v21, a51
  v_mfma_f32_16x16x32_bf16 v[92:95], a[168:171], a[124:127], v[92:95]
  v_cvt_pk_bf16_f32 v14, v18, v19
  v_cvt_pk_bf16_f32 v15, v20, v21
  s_waitcnt lgkmcnt(12)
  v_mfma_f32_16x16x32_bf16 v[96:99], a[172:175], a[112:115], v[96:99]
  ds_read_b64_tr_b16 a[168:169], v26 offset:14432
  v_accvgpr_read_b32 v18, a64
  v_mfma_f32_16x16x32_bf16 v[100:103], a[172:175], a[116:119], v[100:103]
  ds_read_b64_tr_b16 a[170:171], v26 offset:16224
  v_accvgpr_read_b32 v19, a65
  v_mfma_f32_16x16x32_bf16 v[104:107], a[172:175], a[120:123], v[104:107]
  v_accvgpr_read_b32 v20, a66
  v_accvgpr_read_b32 v21, a67
  v_mfma_f32_16x16x32_bf16 v[108:111], a[172:175], a[124:127], v[108:111]
  v_cvt_pk_bf16_f32 v16, v18, v19
  v_cvt_pk_bf16_f32 v17, v20, v21
  s_waitcnt lgkmcnt(12)
  v_mfma_f32_16x16x32_bf16 v[112:115], a[144:147], a[112:115], v[112:115]
  ds_read_b64_tr_b16 a[172:173], v26 offset:14464
  v_mfma_f32_16x16x32_bf16 v[116:119], a[144:147], a[116:119], v[116:119]
  ds_read_b64_tr_b16 a[174:175], v26 offset:16256
  v_mfma_f32_16x16x32_bf16 v[120:123], a[144:147], a[120:123], v[120:123]
  buffer_store_dwordx4 v[14:17], v2, s[20:23], s70 offen offset:0 sc1
  v_mfma_f32_16x16x32_bf16 v[124:127], a[144:147], a[124:127], v[124:127]
  ds_write_b128 v2, v[14:17] offset:0
  s_waitcnt lgkmcnt(12)
  v_mfma_f32_16x16x32_bf16 v[128:131], a[148:151], a[112:115], v[128:131]
  ds_read_b64_tr_b16 a[144:145], v26 offset:14496
  v_accvgpr_read_b32 v18, a52
  v_mfma_f32_16x16x32_bf16 v[132:135], a[148:151], a[116:119], v[132:135]
  ds_read_b64_tr_b16 a[146:147], v26 offset:16288
  v_accvgpr_read_b32 v19, a53
  v_mfma_f32_16x16x32_bf16 v[136:139], a[148:151], a[120:123], v[136:139]
  v_accvgpr_read_b32 v20, a54
  v_accvgpr_read_b32 v21, a55
  v_mfma_f32_16x16x32_bf16 v[140:143], a[148:151], a[124:127], v[140:143]
  v_cvt_pk_bf16_f32 v28, v18, v19
  v_cvt_pk_bf16_f32 v29, v20, v21
  s_waitcnt lgkmcnt(12)
  v_mfma_f32_16x16x32_bf16 v[144:147], a[152:155], a[112:115], v[144:147]
  ds_read_b64_tr_b16 a[148:149], v26 offset:14528
  v_accvgpr_read_b32 v18, a68
  v_mfma_f32_16x16x32_bf16 v[148:151], a[152:155], a[116:119], v[148:151]
  ds_read_b64_tr_b16 a[150:151], v26 offset:16320
  v_accvgpr_read_b32 v19, a69
  v_mfma_f32_16x16x32_bf16 v[152:155], a[152:155], a[120:123], v[152:155]
  v_accvgpr_read_b32 v20, a70
  v_accvgpr_read_b32 v21, a71
  v_mfma_f32_16x16x32_bf16 v[156:159], a[152:155], a[124:127], v[156:159]
  v_cvt_pk_bf16_f32 v30, v18, v19
  v_cvt_pk_bf16_f32 v31, v20, v21
  s_waitcnt lgkmcnt(12)
  v_mfma_f32_16x16x32_bf16 v[160:163], a[156:159], a[112:115], v[160:163]
L_touch0:
  s_cbranch_execz L_touch4
  ds_read_b64_tr_b16 a[152:153], v26 offset:7168
  v_mfma_f32_16x16x32_bf16 v[164:167], a[156:159], a[116:119], v[164:167]
  ds_read_b64_tr_b16 a[154:155], v26 offset:8960
  v_mfma_f32_16x16x32_bf16 v[168:171], a[156:159], a[120:123], v[168:171]
  buffer_store_dwordx4 v[28:31], v2, s[20:23], s70 offen offset:128 sc1
  v_mfma_f32_16x16x32_bf16 v[172:175], a[156:159], a[124:127], v[172:175]
  ds_write_b128 v2, v[28:31] offset:128
  s_waitcnt lgkmcnt(12)
  v_mfma_f32_16x16x32_bf16 v[176:179], a[160:163], a[112:115], v[176:179]
  ds_read_b64_tr_b16 a[156:157], v26 offset:7200
  v_accvgpr_read_b32 v18, a56
  v_mfma_f32_16x16x32_bf16 v[180:183], a[160:163], a[116:119], v[180:183]
  ds_read_b64_tr_b16 a[158:159], v26 offset:8992
  v_accvgpr_read_b32 v19, a57
  v_mfma_f32_16x16x32_bf16 v[184:187], a[160:163], a[120:123], v[184:187]
  v_accvgpr_read_b32 v20, a58
  v_accvgpr_read_b32 v21, a59
  v_mfma_f32_16x16x32_bf16 v[188:191], a[160:163], a[124:127], v[188:191]
  v_cvt_pk_bf16_f32 v14, v18, v19
  v_cvt_pk_bf16_f32 v15, v20, v21
  v_mfma_f32_16x16x32_bf16 v[192:195], a[164:167], a[112:115], v[192:195]
  ds_read_b64_tr_b16 a[160:161], v26 offset:7232
  v_accvgpr_read_b32 v18, a72
  v_mfma_f32_16x16x32_bf16 v[196:199], a[164:167], a[116:119], v[196:199]
  s_waitcnt lgkmcnt(12)
  ds_read_b64_tr_b16 a[162:163], v26 offset:9024
  v_accvgpr_read_b32 v19, a73
  v_mfma_f32_16x16x32_bf16 v[200:203], a[164:167], a[120:123], v[200:203]
  v_accvgpr_read_b32 v20, a74
  v_accvgpr_read_b32 v21, a75
  v_mfma_f32_16x16x32_bf16 v[204:207], a[164:167], a[124:127], v[204:207]
  v_cvt_pk_bf16_f32 v16, v18, v19
  v_cvt_pk_bf16_f32 v17, v20, v21
  v_mfma_f32_16x16x32_bf16 v[208:211], a[168:171], a[112:115], v[208:211]
  ds_read_b64_tr_b16 a[164:165], v26 offset:7264
  v_mfma_f32_16x16x32_bf16 v[212:215], a[168:171], a[116:119], v[212:215]
  ds_read_b64_tr_b16 a[166:167], v26 offset:9056
  v_mfma_f32_16x16x32_bf16 v[216:219], a[168:171], a[120:123], v[216:219]
  buffer_store_dwordx4 v[14:17], v2, s[20:23], s71 offen offset:0 sc1
  v_mfma_f32_16x16x32_bf16 v[220:223], a[168:171], a[124:127], v[220:223]
  s_waitcnt lgkmcnt(12)
  ds_write_b128 v2, v[14:17] offset:4096
  v_mfma_f32_16x16x32_bf16 v[224:227], a[172:175], a[112:115], v[224:227]
  ds_read_b64_tr_b16 a[168:169], v26 offset:7296
  v_accvgpr_read_b32 v18, a60
  v_mfma_f32_16x16x32_bf16 v[228:231], a[172:175], a[116:119], v[228:231]
  ds_read_b64_tr_b16 a[170:171], v26 offset:9088
  v_accvgpr_read_b32 v19, a61
  v_mfma_f32_16x16x32_bf16 v[232:235], a[172:175], a[120:123], v[232:235]
  v_accvgpr_read_b32 v20, a62
  v_accvgpr_read_b32 v21, a63
  v_mfma_f32_16x16x32_bf16 v[236:239], a[172:175], a[124:127], v[236:239]
  v_cvt_pk_bf16_f32 v28, v18, v19
  v_cvt_pk_bf16_f32 v29, v20, v21
  s_waitcnt lgkmcnt(12)
  v_mfma_f32_16x16x32_bf16 v[240:243], a[144:147], a[112:115], v[240:243]
  ds_read_b64_tr_b16 a[172:173], v26 offset:7328
  v_accvgpr_read_b32 v18, a76
  v_mfma_f32_16x16x32_bf16 v[244:247], a[144:147], a[116:119], v[244:247]
  ds_read_b64_tr_b16 a[174:175], v26 offset:9120
  v_accvgpr_read_b32 v19, a77
  v_mfma_f32_16x16x32_bf16 v[248:251], a[144:147], a[120:123], v[248:251]
  v_accvgpr_read_b32 v20, a78
  v_accvgpr_read_b32 v21, a79
  v_mfma_f32_16x16x32_bf16 v[252:255], a[144:147], a[124:127], v[252:255]
  v_cvt_pk_bf16_f32 v30, v18, v19
  v_cvt_pk_bf16_f32 v31, v20, v21
  v_mfma_f32_16x16x32_bf16 a[0:3], a[148:151], a[112:115], a[0:3]
  ds_read_b64_tr_b16 a[144:145], v26 offset:7360
  v_mfma_f32_16x16x32_bf16 a[4:7], a[148:151], a[116:119], a[4:7]
  s_waitcnt lgkmcnt(12)
  ds_read_b64_tr_b16 a[146:147], v26 offset:9152
  v_mfma_f32_16x16x32_bf16 a[8:11], a[148:151], a[120:123], a[8:11]
  buffer_store_dwordx4 v[28:31], v2, s[20:23], s71 offen offset:128 sc1
  v_mfma_f32_16x16x32_bf16 a[12:15], a[148:151], a[124:127], a[12:15]
  ds_write_b128 v2, v[28:31] offset:4224
  v_mfma_f32_16x16x32_bf16 v[48:51], a[152:155], a[128:131], v[48:51]
  ds_read_b64_tr_b16 a[148:149], v26 offset:21504
  v_accvgpr_read_b32 v18, a80
  v_mfma_f32_16x16x32_bf16 v[52:55], a[152:155], a[132:135], v[52:55]
  s_waitcnt lgkmcnt(12)
  ds_read_b64_tr_b16 a[150:151], v26 offset:23296
  v_accvgpr_read_b32 v19, a81
  v_mfma_f32_16x16x32_bf16 v[56:59], a[152:155], a[136:139], v[56:59]
  v_accvgpr_read_b32 v20, a82
  v_accvgpr_read_b32 v21, a83
  v_mfma_f32_16x16x32_bf16 v[60:63], a[152:155], a[140:143], v[60:63]
  v_cvt_pk_bf16_f32 v14, v18, v19
  v_cvt_pk_bf16_f32 v15, v20, v21
  v_mfma_f32_16x16x32_bf16 v[64:67], a[156:159], a[128:131], v[64:67]
  ds_read_b64_tr_b16 a[152:153], v26 offset:21536
  v_accvgpr_read_b32 v18, a84
  v_mfma_f32_16x16x32_bf16 v[68:71], a[156:159], a[132:135], v[68:71]
  ds_read_b64_tr_b16 a[154:155], v26 offset:23328
  v_accvgpr_read_b32 v19, a85
  v_mfma_f32_16x16x32_bf16 v[72:75], a[156:159], a[136:139], v[72:75]
  v_accvgpr_read_b32 v20, a86
  v_accvgpr_read_b32 v21, a87
  v_mfma_f32_16x16x32_bf16 v[76:79], a[156:159], a[140:143], v[76:79]
  v_cvt_pk_bf16_f32 v16, v18, v19
  v_cvt_pk_bf16_f32 v17, v20, v21
  s_waitcnt lgkmcnt(12)
  v_mfma_f32_16x16x32_bf16 v[80:83], a[160:163], a[128:131], v[80:83]
  ds_read_b64_tr_b16 a[156:157], v26 offset:21568
  v_mfma_f32_16x16x32_bf16 v[84:87], a[160:163], a[132:135], v[84:87]
  ds_read_b64_tr_b16 a[158:159], v26 offset:23360
  v_mfma_f32_16x16x32_bf16 v[88:91], a[160:163], a[136:139], v[88:91]
  buffer_store_dwordx4 v[14:17], v3, s[20:23], s70 offen offset:2048 sc1
  v_mfma_f32_16x16x32_bf16 v[92:95], a[160:163], a[140:143], v[92:95]
  ds_write_b128 v3, v[14:17] offset:2048
  v_mfma_f32_16x16x32_bf16 v[96:99], a[164:167], a[128:131], v[96:99]
  s_waitcnt lgkmcnt(12)
  ds_read_b64_tr_b16 a[160:161], v26 offset:21600
  v_accvgpr_read_b32 v18, a96
  v_mfma_f32_16x16x32_bf16 v[100:103], a[164:167], a[132:135], v[100:103]
  ds_read_b64_tr_b16 a[162:163], v26 offset:23392
  v_accvgpr_read_b32 v19, a97
  v_mfma_f32_16x16x32_bf16 v[104:107], a[164:167], a[136:139], v[104:107]
  v_accvgpr_read_b32 v20, a98
  v_accvgpr_read_b32 v21, a99
  v_mfma_f32_16x16x32_bf16 v[108:111], a[164:167], a[140:143], v[108:111]
  v_cvt_pk_bf16_f32 v28, v18, v19
  v_cvt_pk_bf16_f32 v29, v20, v21
  v_mfma_f32_16x16x32_bf16 v[112:115], a[168:171], a[128:131], v[112:115]
  ds_read_b64_tr_b16 a[164:165], v26 offset:21632
  v_accvgpr_read_b32 v18, a100
  v_mfma_f32_16x16x32_bf16 v[116:119], a[168:171], a[132:135], v[116:119]
  s_waitcnt lgkmcnt(12)
  ds_read_b64_tr_b16 a[166:167], v26 offset:23424
  v_accvgpr_read_b32 v19, a101
  v_mfma_f32_16x16x32_bf16 v[120:123], a[168:171], a[136:139], v[120:123]
  v_accvgpr_read_b32 v20, a102
  v_accvgpr_read_b32 v21, a103
  v_mfma_f32_16x16x32_bf16 v[124:127], a[168:171], a[140:143], v[124:127]
  v_cvt_pk_bf16_f32 v30, v18, v19
  v_cvt_pk_bf16_f32 v31, v20, v21
  v_mfma_f32_16x16x32_bf16 v[128:131], a[172:175], a[128:131], v[128:131]
  ds_read_b64_tr_b16 a[168:169], v26 offset:21664
  v_mfma_f32_16x16x32_bf16 v[132:135], a[172:175], a[132:135], v[132:135]
  ds_read_b64_tr_b16 a[170:171], v26 offset:23456
  v_mfma_f32_16x16x32_bf16 v[136:139], a[172:175], a[136:139], v[136:139]
  buffer_store_dwordx4 v[28:31], v3, s[20:23], s70 offen offset:2304 sc1
  v_mfma_f32_16x16x32_bf16 v[140:143], a[172:175], a[140:143], v[140:143]
  s_waitcnt lgkmcnt(12)
  ds_write_b128 v3, v[28:31] offset:2304
  v_mfma_f32_16x16x32_bf16 v[144:147], a[144:147], a[128:131], v[144:147]
  ds_read_b64_tr_b16 a[172:173], v26 offset:21696
  v_accvgpr_read_b32 v18, a88
  v_mfma_f32_16x16x32_bf16 v[148:151], a[144:147], a[132:135], v[148:151]
  ds_read_b64_tr_b16 a[174:175], v26 offset:23488
  v_accvgpr_read_b32 v19, a89
  v_mfma_f32_16x16x32_bf16 v[152:155], a[144:147], a[136:139], v[152:155]
  v_accvgpr_read_b32 v20, a90
  v_accvgpr_read_b32 v21, a91
  v_mfma_f32_16x16x32_bf16 v[156:159], a[144:147], a[140:143], v[156:159]
  v_cvt_pk_bf16_f32 v14, v18, v19
  v_cvt_pk_bf16_f32 v15, v20, v21
  s_waitcnt lgkmcnt(12)
  v_mfma_f32_16x16x32_bf16 v[160:163], a[148:151], a[128:131], v[160:163]
  v_accvgpr_read_b32 v18, a92
  v_accvgpr_read_b32 v19, a93
  v_mfma_f32_16x16x32_bf16 v[164:167], a[148:151], a[132:135], v[164:167]
  v_accvgpr_read_b32 v20, a94
  v_accvgpr_read_b32 v21, a95
  v_mfma_f32_16x16x32_bf16 v[168:171], a[148:151], a[136:139], v[168:171]
  v_cvt_pk_bf16_f32 v16, v18, v19
  v_cvt_pk_bf16_f32 v17, v20, v21
  v_mfma_f32_16x16x32_bf16 v[172:175], a[148:151], a[140:143], v[172:175]
  buffer_store_dwordx4 v[14:17], v3, s[20:23], s71 offen offset:2048 sc1
  v_mfma_f32_16x16x32_bf16 v[176:179], a[152:155], a[128:131], v[176:179]
  ds_write_b128 v3, v[14:17] offset:6144
  v_mfma_f32_16x16x32_bf16 v[180:183], a[152:155], a[132:135], v[180:183]
  v_accvgpr_read_b32 v18, a104
  v_accvgpr_read_b32 v19, a105
  v_mfma_f32_16x16x32_bf16 v[184:187], a[152:155], a[136:139], v[184:187]
  v_accvgpr_read_b32 v20, a106
  v_accvgpr_read_b32 v21, a107
  v_mfma_f32_16x16x32_bf16 v[188:191], a[152:155], a[140:143], v[188:191]
  v_cvt_pk_bf16_f32 v28, v18, v19
  v_cvt_pk_bf16_f32 v29, v20, v21
  s_waitcnt lgkmcnt(11)
  v_mfma_f32_16x16x32_bf16 v[192:195], a[156:159], a[128:131], v[192:195]
  v_accvgpr_read_b32 v18, a108
  v_accvgpr_read_b32 v19, a109
  v_mfma_f32_16x16x32_bf16 v[196:199], a[156:159], a[132:135], v[196:199]
  v_accvgpr_read_b32 v20, a110
  v_accvgpr_read_b32 v21, a111
  v_mfma_f32_16x16x32_bf16 v[200:203], a[156:159], a[136:139], v[200:203]
  v_cvt_pk_bf16_f32 v30, v18, v19
  v_cvt_pk_bf16_f32 v31, v20, v21
  v_mfma_f32_16x16x32_bf16 v[204:207], a[156:159], a[140:143], v[204:207]
  buffer_store_dwordx4 v[28:31], v3, s[20:23], s71 offen offset:2304 sc1
  s_waitcnt lgkmcnt(8)
  v_mfma_f32_16x16x32_bf16 v[208:211], a[160:163], a[128:131], v[208:211]
  ds_write_b128 v3, v[28:31] offset:6400
  v_mfma_f32_16x16x32_bf16 v[212:215], a[160:163], a[132:135], v[212:215]
  s_waitcnt vmcnt(12)
  v_dot2_f32_bf16 v14, v32, v6, 0
  s_waitcnt vmcnt(10)
  v_dot2_f32_bf16 v15, v40, v6, 0
  v_mfma_f32_16x16x32_bf16 v[216:219], a[160:163], a[136:139], v[216:219]
  v_dot2_f32_bf16 v14, v33, v7, v14
  v_dot2_f32_bf16 v15, v41, v7, v15
  v_mfma_f32_16x16x32_bf16 v[220:223], a[160:163], a[140:143], v[220:223]
  v_dot2_f32_bf16 v14, v34, v8, v14
  v_dot2_f32_bf16 v15, v42, v8, v15
  s_waitcnt lgkmcnt(7)
  v_mfma_f32_16x16x32_bf16 v[224:227], a[164:167], a[128:131], v[224:227]
  v_dot2_f32_bf16 v14, v35, v9, v14
  v_dot2_f32_bf16 v15, v43, v9, v15
  v_mfma_f32_16x16x32_bf16 v[228:231], a[164:167], a[132:135], v[228:231]
  v_dot2_f32_bf16 v14, v36, v10, v14
  s_waitcnt vmcnt(9)
  v_dot2_f32_bf16 v15, v44, v10, v15
  v_mfma_f32_16x16x32_bf16 v[232:235], a[164:167], a[136:139], v[232:235]
  v_dot2_f32_bf16 v14, v37, v11, v14
  v_dot2_f32_bf16 v15, v45, v11, v15
  v_mfma_f32_16x16x32_bf16 v[236:239], a[164:167], a[140:143], v[236:239]
  v_dot2_f32_bf16 v14, v38, v12, v14
  v_dot2_f32_bf16 v15, v46, v12, v15
  s_waitcnt lgkmcnt(5)
  v_mfma_f32_16x16x32_bf16 v[240:243], a[168:171], a[128:131], v[240:243]
  v_dot2_f32_bf16 v14, v39, v13, v14
  v_dot2_f32_bf16 v15, v47, v13, v15
  v_mfma_f32_16x16x32_bf16 v[244:247], a[168:171], a[132:135], v[244:247]
  s_nop 2
  v_add_f32 v14, v14, v14 row_shr:1 row_mask:0xf bank_mask:0xf bound_ctrl:1
  v_mfma_f32_16x16x32_bf16 v[248:251], a[168:171], a[136:139], v[248:251]
  v_add_f32 v15, v15, v15 row_shr:1 row_mask:0xf bank_mask:0xf bound_ctrl:1
  v_add_f32 v14, v14, v14 row_shr:2 row_mask:0xf bank_mask:0xf bound_ctrl:1
  v_mfma_f32_16x16x32_bf16 v[252:255], a[168:171], a[140:143], v[252:255]
  v_add_f32 v15, v15, v15 row_shr:2 row_mask:0xf bank_mask:0xf bound_ctrl:1
  v_add_f32 v14, v14, v14 row_shr:4 row_mask:0xf bank_mask:0xf bound_ctrl:1
  s_waitcnt lgkmcnt(2)
  v_mfma_f32_16x16x32_bf16 a[0:3], a[172:175], a[128:131], a[0:3]
  v_add_f32 v15, v15, v15 row_shr:4 row_mask:0xf bank_mask:0xf bound_ctrl:1
  v_add_f32 v14, v14, v14 row_shr:8 row_mask:0xf bank_mask:0xf bound_ctrl:1
  v_mfma_f32_16x16x32_bf16 a[4:7], a[172:175], a[132:135], a[4:7]
  v_add_f32 v15, v15, v15 row_shr:8 row_mask:0xf bank_mask:0xf bound_ctrl:1
  v_add_f32 v14, v14, v14 row_bcast:15 row_mask:0xa bank_mask:0xf bound_ctrl:1
  v_mfma_f32_16x16x32_bf16 a[8:11], a[172:175], a[136:139], a[8:11]
  v_add_f32 v15, v15, v15 row_bcast:15 row_mask:0xa bank_mask:0xf bound_ctrl:1
  v_add_f32 v14, v14, v14 row_bcast:31 row_mask:0xc bank_mask:0xf bound_ctrl:1
  v_mfma_f32_16x16x32_bf16 a[12:15], a[172:175], a[140:143], a[12:15]
  v_add_f32 v15, v15, v15 row_bcast:31 row_mask:0xc bank_mask:0xf bound_ctrl:1
  v_cvt_pk_bf16_f32 v14, v14, v15
  v_and_b32 v15, 0xffff0000, v14
  v_lshlrev_b32 v14, 16, v14
  v_mul_f32 v14, 0xbfb8aa3b, v14
  v_mul_f32 v15, 0xbfb8aa3b, v15
  v_exp_f32 v14, v14
  v_exp_f32 v15, v15
  v_add_f32 v14, 1.0, v14
  v_add_f32 v15, 1.0, v15
  v_rcp_f32 v14, v14
  v_rcp_f32 v15, v15
  s_lshl_b32 s61, s3, 3
  s_add_u32 s61, s61, s69
  v_cvt_pk_bf16_f32 v14, v14, v15
  v_and_b32 v15, 0xffff0000, v14
  v_lshlrev_b32 v14, 16, v14
  s_mov_b32 exec_lo, 0
  s_mov_b32 exec_hi, 0x80000000
  buffer_store_dwordx2 v[14:15], off, s[20:23], s61 offset:32 sc1
  s_mov_b64 exec, -1
  s_mov_b32 s61, 0x3e8293ee
  v_accvgpr_read_b32 v18, a16
  v_accvgpr_read_b32 v19, a17
  v_accvgpr_read_b32 v20, a18
  v_accvgpr_read_b32 v21, a19
  v_mul_f32 v18, s61, v18
  v_mul_f32 v19, s61, v19
  v_mul_f32 v20, s61, v20
  v_mul_f32 v21, s61, v21
  v_cvt_pk_bf16_f32 v32, v18, v19
  v_cvt_pk_bf16_f32 v33, v20, v21
  v_accvgpr_read_b32 v18, a32
  v_accvgpr_read_b32 v19, a33
  v_accvgpr_read_b32 v20, a34
  v_accvgpr_read_b32 v21, a35
  v_mul_f32 v18, s61, v18
  v_mul_f32 v19, s61, v19
  v_mul_f32 v20, s61, v20
  v_mul_f32 v21, s61, v21
  v_cvt_pk_bf16_f32 v34, v18, v19
  v_cvt_pk_bf16_f32 v35, v20, v21
  v_accvgpr_read_b32 v18, a20
  v_accvgpr_read_b32 v19, a21
  v_accvgpr_read_b32 v20, a22
  v_accvgpr_read_b32 v21, a23
  v_mul_f32 v18, s61, v18
  v_mul_f32 v19, s61, v19
  v_mul_f32 v20, s61, v20
  v_mul_f32 v21, s61, v21
  v_cvt_pk_bf16_f32 v36, v18, v19
  v_cvt_pk_bf16_f32 v37, v20, v21
  v_accvgpr_read_b32 v18, a36
  v_accvgpr_read_b32 v19, a37
  v_accvgpr_read_b32 v20, a38
  v_accvgpr_read_b32 v21, a39
  v_mul_f32 v18, s61, v18
  v_mul_f32 v19, s61, v19
  v_mul_f32 v20, s61, v20
  v_mul_f32 v21, s61, v21
  v_cvt_pk_bf16_f32 v38, v18, v19
  v_cvt_pk_bf16_f32 v39, v20, v21
  v_accvgpr_read_b32 v18, a24
  v_accvgpr_read_b32 v19, a25
  v_accvgpr_read_b32 v20, a26
  v_accvgpr_read_b32 v21, a27
  v_mul_f32 v18, s61, v18
  v_mul_f32 v19, s61, v19
  v_mul_f32 v20, s61, v20
  v_mul_f32 v21, s61, v21
  v_cvt_pk_bf16_f32 v40, v18, v19
  v_cvt_pk_bf16_f32 v41, v20, v21
  v_accvgpr_read_b32 v18, a40
  v_accvgpr_read_b32 v19, a41
  v_accvgpr_read_b32 v20, a42
  v_accvgpr_read_b32 v21, a43
  v_mul_f32 v18, s61, v18
  v_mul_f32 v19, s61, v19
  v_mul_f32 v20, s61, v20
  v_mul_f32 v21, s61, v21
  v_cvt_pk_bf16_f32 v42, v18, v19
  v_cvt_pk_bf16_f32 v43, v20, v21
  v_accvgpr_read_b32 v18, a28
  v_accvgpr_read_b32 v19, a29
  v_accvgpr_read_b32 v20, a30
  v_accvgpr_read_b32 v21, a31
  v_mul_f32 v18, s61, v18
  v_mul_f32 v19, s61, v19
  v_mul_f32 v20, s61, v20
  v_mul_f32 v21, s61, v21
  v_cvt_pk_bf16_f32 v44, v18, v19
  v_cvt_pk_bf16_f32 v45, v20, v21
  v_accvgpr_read_b32 v18, a44
  v_accvgpr_read_b32 v19, a45
  v_accvgpr_read_b32 v20, a46
  v_accvgpr_read_b32 v21, a47
  v_mul_f32 v18, s61, v18
  v_mul_f32 v19, s61, v19
  v_mul_f32 v20, s61, v20
  v_mul_f32 v21, s61, v21
  v_cvt_pk_bf16_f32 v46, v18, v19
  v_cvt_pk_bf16_f32 v47, v20, v21
  v_permlane16_swap_b32 v32, v36
  v_permlane16_swap_b32 v33, v37
  v_permlane16_swap_b32 v34, v38
  v_permlane16_swap_b32 v35, v39
  v_permlane16_swap_b32 v40, v44
  v_permlane16_swap_b32 v41, v45
  v_permlane16_swap_b32 v42, v46
  v_permlane16_swap_b32 v43, v47
L_epi:
  s_mov_b32 s32, s78
  s_mov_b32 s33, s79
  s_mov_b32 s34, 4194304
  s_mov_b32 s35, 0x20000
  s_waitcnt vmcnt(9)
  v_cmp_gt_u32 vcc, 0x100, v5
  s_nop 0
  s_cbranch_vccnz L_retry0
L_cont0:
  s_mov_b32 s76, 0xbdd2d3e8
  s_mov_b32 s77, 0xbdd2d3e8
  v_mov_b32 v6, 0xc0135761
  v_mov_b32 v7, 0xc0135761
  s_mov_b32 s70, s98
  s_add_u32 s71, s70, 4096
  s_add_u32 s72, s70, 229376
  s_add_u32 s73, s72, 4096
  v_pk_mul_f32 v[8:9], v[136:137], v[136:137]
  v_pk_mul_f32 v[10:11], v[138:139], v[138:139]
  v_pk_mul_f32 v[12:13], v[140:141], v[140:141]
  v_pk_mul_f32 v[14:15], v[142:143], v[142:143]
  v_pk_fma_f32 v[8:9], v[8:9], s[76:77], v[6:7]
  v_pk_fma_f32 v[10:11], v[10:11], s[76:77], v[6:7]
  v_pk_fma_f32 v[12:13], v[12:13], s[76:77], v[6:7]
  v_pk_fma_f32 v[14:15], v[14:15], s[76:77], v[6:7]
  v_pk_mul_f32 v[8:9], v[8:9], v[136:137]
  v_pk_mul_f32 v[10:11], v[10:11], v[138:139]
  v_pk_mul_f32 v[12:13], v[12:13], v[140:141]
  v_pk_mul_f32 v[14:15], v[14:15], v[142:143]
  v_exp_f32 v8, v8
  v_pk_mul_f32 v[136:137], v[136:137], v[248:249]
  v_pk_mul_f32 v[138:139], v[138:139], v[250:251]
  v_exp_f32 v9, v9
  v_pk_mul_f32 v[140:141], v[140:141], v[252:253]
  v_pk_mul_f32 v[142:143], v[142:143], v[254:255]
  v_exp_f32 v10, v10
  v_exp_f32 v11, v11
  v_exp_f32 v12, v12
  v_exp_f32 v13, v13
  v_exp_f32 v14, v14
  v_exp_f32 v15, v15
  v_pk_add_f32 v[8:9], v[8:9], 1.0 op_sel_hi:[1,0]
  v_pk_add_f32 v[10:11], v[10:11], 1.0 op_sel_hi:[1,0]
  v_rcp_f32 v8, v8
  v_pk_add_f32 v[12:13], v[12:13], 1.0 op_sel_hi:[1,0]
  v_pk_add_f32 v[14:15], v[14:15], 1.0 op_sel_hi:[1,0]
  v_rcp_f32 v9, v9
  v_pk_mul_f32 v[16:17], v[128:129], v[128:129]
  v_pk_mul_f32 v[18:19], v[130:131], v[130:131]
  v_rcp_f32 v10, v10
  v_pk_mul_f32 v[20:21], v[132:133], v[132:133]
  v_pk_mul_f32 v[22:23], v[134:135], v[134:135]
  v_rcp_f32 v11, v11
  v_pk_fma_f32 v[16:17], v[16:17], s[76:77], v[6:7]
  v_pk_fma_f32 v[18:19], v[18:19], s[76:77], v[6:7]
  v_rcp_f32 v12, v12
  v_pk_fma_f32 v[20:21], v[20:21], s[76:77], v[6:7]
  v_pk_fma_f32 v[22:23], v[22:23], s[76:77], v[6:7]
  v_rcp_f32 v13, v13
  v_pk_mul_f32 v[16:17], v[16:17], v[128:129]
  v_pk_mul_f32 v[18:19], v[18:19], v[130:131]
  v_rcp_f32 v14, v14
  v_pk_mul_f32 v[20:21], v[20:21], v[132:133]
  v_pk_mul_f32 v[22:23], v[22:23], v[134:135]
  v_rcp_f32 v15, v15
  v_exp_f32 v16, v16
  v_pk_mul_f32 v[136:137], v[136:137], v[8:9]
  v_pk_mul_f32 v[138:139], v[138:139], v[10:11]
  v_exp_f32 v17, v17
  v_pk_mul_f32 v[140:141], v[140:141], v[12:13]
  v_pk_mul_f32 v[142:143], v[142:143], v[14:15]
  v_exp_f32 v18, v18
  v_cvt_pk_bf16_f32 v252, v136, v137
  v_cvt_pk_bf16_f32 v253, v138, v139
  v_exp_f32 v19, v19
  v_cvt_pk_bf16_f32 v254, v140, v141
  v_cvt_pk_bf16_f32 v255, v142, v143
  v_exp_f32 v20, v20
  v_pk_mul_f32 v[128:129], v[128:129], v[240:241]
  v_pk_mul_f32 v[130:131], v[130:131], v[242:243]
  v_exp_f32 v21, v21
  v_pk_mul_f32 v[132:133], v[132:133], v[244:245]
  v_pk_mul_f32 v[134:135], v[134:135], v[246:247]
  v_exp_f32 v22, v22
  v_permlane16_swap_b32 v252, v254
  v_permlane16_swap_b32 v253, v255
  v_exp_f32 v23, v23
  v_pk_add_f32 v[16:17], v[16:17], 1.0 op_sel_hi:[1,0]
  v_pk_add_f32 v[18:19], v[18:19], 1.0 op_sel_hi:[1,0]
  v_rcp_f32 v16, v16
  v_pk_add_f32 v[20:21], v[20:21], 1.0 op_sel_hi:[1,0]
  v_pk_add_f32 v[22:23], v[22:23], 1.0 op_sel_hi:[1,0]
  v_rcp_f32 v17, v17
  v_pk_mul_f32 v[8:9], v[120:121], v[120:121]
  v_pk_mul_f32 v[10:11], v[122:123], v[122:123]
  v_rcp_f32 v18, v18
  v_pk_mul_f32 v[12:13], v[124:125], v[124:125]
  v_pk_mul_f32 v[14:15], v[126:127], v[126:127]
  v_rcp_f32 v19, v19
  v_pk_fma_f32 v[8:9], v[8:9], s[76:77], v[6:7]
  v_pk_fma_f32 v[10:11], v[10:11], s[76:77], v[6:7]
  v_rcp_f32 v20, v20
  v_pk_fma_f32 v[12:13], v[12:13], s[76:77], v[6:7]
  v_pk_fma_f32 v[14:15], v[14:15], s[76:77], v[6:7]
  v_rcp_f32 v21, v21
  v_pk_mul_f32 v[8:9], v[8:9], v[120:121]
  v_pk_mul_f32 v[10:11], v[10:11], v[122:123]
  v_rcp_f32 v22, v22
  v_pk_mul_f32 v[12:13], v[12:13], v[124:125]
  v_pk_mul_f32 v[14:15], v[14:15], v[126:127]
  v_rcp_f32 v23, v23
  v_exp_f32 v8, v8
  v_pk_mul_f32 v[128:129], v[128:129], v[16:17]
  v_pk_mul_f32 v[130:131], v[130:131], v[18:19]
  v_exp_f32 v9, v9
  v_pk_mul_f32 v[132:133], v[132:133], v[20:21]
  v_pk_mul_f32 v[134:135], v[134:135], v[22:23]
  v_exp_f32 v10, v10
  v_cvt_pk_bf16_f32 v248, v128, v129
  v_cvt_pk_bf16_f32 v249, v130, v131
  v_exp_f32 v11, v11
  v_cvt_pk_bf16_f32 v250, v132, v133
  v_cvt_pk_bf16_f32 v251, v134, v135
  v_exp_f32 v12, v12
  v_pk_mul_f32 v[120:121], v[120:121], v[232:233]
  v_pk_mul_f32 v[122:123], v[122:123], v[234:235]
  v_exp_f32 v13, v13
  v_pk_mul_f32 v[124:125], v[124:125], v[236:237]
  v_pk_mul_f32 v[126:127], v[126:127], v[238:239]
  v_exp_f32 v14, v14
  v_permlane16_swap_b32 v248, v250
  v_permlane16_swap_b32 v249, v251
  v_exp_f32 v15, v15
  v_pk_add_f32 v[8:9], v[8:9], 1.0 op_sel_hi:[1,0]
  v_pk_add_f32 v[10:11], v[10:11], 1.0 op_sel_hi:[1,0]
  v_rcp_f32 v8, v8
  v_pk_add_f32 v[12:13], v[12:13], 1.0 op_sel_hi:[1,0]
  v_pk_add_f32 v[14:15], v[14:15], 1.0 op_sel_hi:[1,0]
  v_rcp_f32 v9, v9
  v_pk_mul_f32 v[16:17], v[112:113], v[112:113]
  v_pk_mul_f32 v[18:19], v[114:115], v[114:115]
  v_rcp_f32 v10, v10
  v_pk_mul_f32 v[20:21], v[116:117], v[116:117]
  v_pk_mul_f32 v[22:23], v[118:119], v[118:119]
  v_rcp_f32 v11, v11
  v_pk_fma_f32 v[16:17], v[16:17], s[76:77], v[6:7]
  v_pk_fma_f32 v[18:19], v[18:19], s[76:77], v[6:7]
  v_rcp_f32 v12, v12
  v_pk_fma_f32 v[20:21], v[20:21], s[76:77], v[6:7]
  v_pk_fma_f32 v[22:23], v[22:23], s[76:77], v[6:7]
  v_rcp_f32 v13, v13
  v_pk_mul_f32 v[16:17], v[16:17], v[112:113]
  v_pk_mul_f32 v[18:19], v[18:19], v[114:115]
  v_rcp_f32 v14, v14
  v_pk_mul_f32 v[20:21], v[20:21], v[116:117]
  v_pk_mul_f32 v[22:23], v[22:23], v[118:119]
  v_rcp_f32 v15, v15
  s_waitcnt vmcnt(0) lgkmcnt(0)
  s_barrier
  s_cmp_lg_u32 s3, 0
  s_cbranch_scc1 L_sig6
  s_mov_b64 exec, 1
  v_mov_b32 v5, 1
  buffer_store_dword v5, off, s[20:23], s69 sc1
  s_mov_b64 exec, -1
L_sig6:
  v_exp_f32 v16, v16
  v_pk_mul_f32 v[120:121], v[120:121], v[8:9]
  v_pk_mul_f32 v[122:123], v[122:123], v[10:11]
  v_exp_f32 v17, v17
  v_pk_mul_f32 v[124:125], v[124:125], v[12:13]
  v_pk_mul_f32 v[126:127], v[126:127], v[14:15]
  v_exp_f32 v18, v18
  v_cvt_pk_bf16_f32 v244, v120, v121
  v_cvt_pk_bf16_f32 v245, v122, v123
  v_exp_f32 v19, v19
  v_cvt_pk_bf16_f32 v246, v124, v125
  v_cvt_pk_bf16_f32 v247, v126, v127
  v_exp_f32 v20, v20
  v_pk_mul_f32 v[112:113], v[112:113], v[224:225]
  v_pk_mul_f32 v[114:115], v[114:115], v[226:227]
  v_exp_f32 v21, v21
  v_pk_mul_f32 v[116:117], v[116:117], v[228:229]
  v_pk_mul_f32 v[118:119], v[118:119], v[230:231]
  v_exp_f32 v22, v22
  v_permlane16_swap_b32 v244, v246
  v_permlane16_swap_b32 v245, v247
  v_exp_f32 v23, v23
  v_pk_add_f32 v[16:17], v[16:17], 1.0 op_sel_hi:[1,0]
  v_pk_add_f32 v[18:19], v[18:19], 1.0 op_sel_hi:[1,0]
  v_rcp_f32 v16, v16
  v_pk_add_f32 v[20:21], v[20:21], 1.0 op_sel_hi:[1,0]
  v_pk_add_f32 v[22:23], v[22:23], 1.0 op_sel_hi:[1,0]
  v_rcp_f32 v17, v17
  v_pk_mul_f32 v[8:9], v[104:105], v[104:105]
  v_pk_mul_f32 v[10:11], v[106:107], v[106:107]
  v_rcp_f32 v18, v18
  v_pk_mul_f32 v[12:13], v[108:109], v[108:109]
  v_pk_mul_f32 v[14:15], v[110:111], v[110:111]
  v_rcp_f32 v19, v19
  v_pk_fma_f32 v[8:9], v[8:9], s[76:77], v[6:7]
  v_pk_fma_f32 v[10:11], v[10:11], s[76:77], v[6:7]
  v_rcp_f32 v20, v20
  v_pk_fma_f32 v[12:13], v[12:13], s[76:77], v[6:7]
  v_pk_fma_f32 v[14:15], v[14:15], s[76:77], v[6:7]
  v_rcp_f32 v21, v21
  v_pk_mul_f32 v[8:9], v[8:9], v[104:105]
  v_pk_mul_f32 v[10:11], v[10:11], v[106:107]
  v_rcp_f32 v22, v22
  v_pk_mul_f32 v[12:13], v[12:13], v[108:109]
  v_pk_mul_f32 v[14:15], v[14:15], v[110:111]
  v_rcp_f32 v23, v23
  v_exp_f32 v8, v8
  v_pk_mul_f32 v[112:113], v[112:113], v[16:17]
  v_pk_mul_f32 v[114:115], v[114:115], v[18:19]
  v_exp_f32 v9, v9
  v_pk_mul_f32 v[116:117], v[116:117], v[20:21]
  v_pk_mul_f32 v[118:119], v[118:119], v[22:23]
  v_exp_f32 v10, v10
  v_cvt_pk_bf16_f32 v240, v112, v113
  v_cvt_pk_bf16_f32 v241, v114, v115
  v_exp_f32 v11, v11
  v_cvt_pk_bf16_f32 v242, v116, v117
  v_cvt_pk_bf16_f32 v243, v118, v119
  v_exp_f32 v12, v12
  v_pk_mul_f32 v[104:105], v[104:105], v[216:217]
  v_pk_mul_f32 v[106:107], v[106:107], v[218:219]
  v_exp_f32 v13, v13
  v_pk_mul_f32 v[108:109], v[108:109], v[220:221]
  v_pk_mul_f32 v[110:111], v[110:111], v[222:223]
  v_exp_f32 v14, v14
  v_permlane16_swap_b32 v240, v242
  v_permlane16_swap_b32 v241, v243
  v_exp_f32 v15, v15
  v_pk_add_f32 v[8:9], v[8:9], 1.0 op_sel_hi:[1,0]
  v_pk_add_f32 v[10:11], v[10:11], 1.0 op_sel_hi:[1,0]
  v_rcp_f32 v8, v8
  v_pk_add_f32 v[12:13], v[12:13], 1.0 op_sel_hi:[1,0]
  v_pk_add_f32 v[14:15], v[14:15], 1.0 op_sel_hi:[1,0]
  v_rcp_f32 v9, v9
  v_pk_mul_f32 v[16:17], v[96:97], v[96:97]
  v_pk_mul_f32 v[18:19], v[98:99], v[98:99]
  v_rcp_f32 v10, v10
  v_pk_mul_f32 v[20:21], v[100:101], v[100:101]
L_touch1:
  s_cbranch_execz L_touch5
  v_pk_mul_f32 v[22:23], v[102:103], v[102:103]
  v_rcp_f32 v11, v11
  v_pk_fma_f32 v[16:17], v[16:17], s[76:77], v[6:7]
  v_pk_fma_f32 v[18:19], v[18:19], s[76:77], v[6:7]
  v_rcp_f32 v12, v12
  v_pk_fma_f32 v[20:21], v[20:21], s[76:77], v[6:7]
  v_pk_fma_f32 v[22:23], v[22:23], s[76:77], v[6:7]
  v_rcp_f32 v13, v13
  v_pk_mul_f32 v[16:17], v[16:17], v[96:97]
  v_pk_mul_f32 v[18:19], v[18:19], v[98:99]
  v_rcp_f32 v14, v14
  v_pk_mul_f32 v[20:21], v[20:21], v[100:101]
  v_pk_mul_f32 v[22:23], v[22:23], v[102:103]
  v_rcp_f32 v15, v15
  v_exp_f32 v16, v16
  v_pk_mul_f32 v[104:105], v[104:105], v[8:9]
  v_pk_mul_f32 v[106:107], v[106:107], v[10:11]
  v_exp_f32 v17, v17
  v_pk_mul_f32 v[108:109], v[108:109], v[12:13]
  v_pk_mul_f32 v[110:111], v[110:111], v[14:15]
  v_exp_f32 v18, v18
  v_cvt_pk_bf16_f32 v236, v104, v105
  v_cvt_pk_bf16_f32 v237, v106, v107
  v_exp_f32 v19, v19
  v_cvt_pk_bf16_f32 v238, v108, v109
  v_cvt_pk_bf16_f32 v239, v110, v111
  v_exp_f32 v20, v20
  v_pk_mul_f32 v[96:97], v[96:97], v[208:209]
  v_pk_mul_f32 v[98:99], v[98:99], v[210:211]
  v_exp_f32 v21, v21
  v_pk_mul_f32 v[100:101], v[100:101], v[212:213]
  v_pk_mul_f32 v[102:103], v[102:103], v[214:215]
  v_exp_f32 v22, v22
  v_permlane16_swap_b32 v236, v238
  v_permlane16_swap_b32 v237, v239
  v_exp_f32 v23, v23
  v_pk_add_f32 v[16:17], v[16:17], 1.0 op_sel_hi:[1,0]
  v_pk_add_f32 v[18:19], v[18:19], 1.0 op_sel_hi:[1,0]
  v_rcp_f32 v16, v16
  v_pk_add_f32 v[20:21], v[20:21], 1.0 op_sel_hi:[1,0]
  v_pk_add_f32 v[22:23], v[22:23], 1.0 op_sel_hi:[1,0]
  v_rcp_f32 v17, v17
  v_pk_mul_f32 v[8:9], v[88:89], v[88:89]
  v_pk_mul_f32 v[10:11], v[90:91], v[90:91]
  v_rcp_f32 v18, v18
  v_pk_mul_f32 v[12:13], v[92:93], v[92:93]
  v_pk_mul_f32 v[14:15], v[94:95], v[94:95]
  v_rcp_f32 v19, v19
  v_pk_fma_f32 v[8:9], v[8:9], s[76:77], v[6:7]
  v_pk_fma_f32 v[10:11], v[10:11], s[76:77], v[6:7]
  v_rcp_f32 v20, v20
  v_pk_fma_f32 v[12:13], v[12:13], s[76:77], v[6:7]
  v_pk_fma_f32 v[14:15], v[14:15], s[76:77], v[6:7]
  v_rcp_f32 v21, v21
  v_pk_mul_f32 v[8:9], v[8:9], v[88:89]
  v_pk_mul_f32 v[10:11], v[10:11], v[90:91]
  v_rcp_f32 v22, v22
  v_pk_mul_f32 v[12:13], v[12:13], v[92:93]
  v_pk_mul_f32 v[14:15], v[14:15], v[94:95]
  v_rcp_f32 v23, v23
  v_exp_f32 v8, v8
  v_pk_mul_f32 v[96:97], v[96:97], v[16:17]
  v_pk_mul_f32 v[98:99], v[98:99], v[18:19]
  v_exp_f32 v9, v9
  v_pk_mul_f32 v[100:101], v[100:101], v[20:21]
  v_pk_mul_f32 v[102:103], v[102:103], v[22:23]
  v_exp_f32 v10, v10
  v_cvt_pk_bf16_f32 v232, v96, v97
  v_cvt_pk_bf16_f32 v233, v98, v99
  v_exp_f32 v11, v11
  v_cvt_pk_bf16_f32 v234, v100, v101
  v_cvt_pk_bf16_f32 v235, v102, v103
  v_exp_f32 v12, v12
  v_pk_mul_f32 v[88:89], v[88:89], v[200:201]
  v_pk_mul_f32 v[90:91], v[90:91], v[202:203]
  v_exp_f32 v13, v13
  v_pk_mul_f32 v[92:93], v[92:93], v[204:205]
  v_pk_mul_f32 v[94:95], v[94:95], v[206:207]
  v_exp_f32 v14, v14
  v_permlane16_swap_b32 v232, v234
  v_permlane16_swap_b32 v233, v235
  v_exp_f32 v15, v15
  v_pk_add_f32 v[8:9], v[8:9], 1.0 op_sel_hi:[1,0]
  v_pk_add_f32 v[10:11], v[10:11], 1.0 op_sel_hi:[1,0]
  v_rcp_f32 v8, v8
  v_pk_add_f32 v[12:13], v[12:13], 1.0 op_sel_hi:[1,0]
  v_pk_add_f32 v[14:15], v[14:15], 1.0 op_sel_hi:[1,0]
  v_rcp_f32 v9, v9
  v_pk_mul_f32 v[16:17], v[80:81], v[80:81]
  v_pk_mul_f32 v[18:19], v[82:83], v[82:83]
  v_rcp_f32 v10, v10
  v_pk_mul_f32 v[20:21], v[84:85], v[84:85]
  v_pk_mul_f32 v[22:23], v[86:87], v[86:87]
  v_rcp_f32 v11, v11
  v_pk_fma_f32 v[16:17], v[16:17], s[76:77], v[6:7]
  v_pk_fma_f32 v[18:19], v[18:19], s[76:77], v[6:7]
  v_rcp_f32 v12, v12
  v_pk_fma_f32 v[20:21], v[20:21], s[76:77], v[6:7]
  v_pk_fma_f32 v[22:23], v[22:23], s[76:77], v[6:7]
  v_rcp_f32 v13, v13
  v_pk_mul_f32 v[16:17], v[16:17], v[80:81]
  v_pk_mul_f32 v[18:19], v[18:19], v[82:83]
  v_rcp_f32 v14, v14
  v_pk_mul_f32 v[20:21], v[20:21], v[84:85]
  v_pk_mul_f32 v[22:23], v[22:23], v[86:87]
  v_rcp_f32 v15, v15
  v_exp_f32 v16, v16
  v_pk_mul_f32 v[88:89], v[88:89], v[8:9]
  v_pk_mul_f32 v[90:91], v[90:91], v[10:11]
  v_exp_f32 v17, v17
  v_pk_mul_f32 v[92:93], v[92:93], v[12:13]
  v_pk_mul_f32 v[94:95], v[94:95], v[14:15]
  v_exp_f32 v18, v18
  v_cvt_pk_bf16_f32 v228, v88, v89
  v_cvt_pk_bf16_f32 v229, v90, v91
  v_exp_f32 v19, v19
  v_cvt_pk_bf16_f32 v230, v92, v93
  v_cvt_pk_bf16_f32 v231, v94, v95
  v_exp_f32 v20, v20
  v_pk_mul_f32 v[80:81], v[80:81], v[192:193]
  v_pk_mul_f32 v[82:83], v[82:83], v[194:195]
  v_exp_f32 v21, v21
  v_pk_mul_f32 v[84:85], v[84:85], v[196:197]
  v_pk_mul_f32 v[86:87], v[86:87], v[198:199]
  v_exp_f32 v22, v22
  v_permlane16_swap_b32 v228, v230
  v_permlane16_swap_b32 v229, v231
  v_exp_f32 v23, v23
  v_pk_add_f32 v[16:17], v[16:17], 1.0 op_sel_hi:[1,0]
  v_pk_add_f32 v[18:19], v[18:19], 1.0 op_sel_hi:[1,0]
  v_rcp_f32 v16, v16
  v_pk_add_f32 v[20:21], v[20:21], 1.0 op_sel_hi:[1,0]
  v_pk_add_f32 v[22:23], v[22:23], 1.0 op_sel_hi:[1,0]
  v_rcp_f32 v17, v17
  v_pk_mul_f32 v[8:9], v[72:73], v[72:73]
  v_pk_mul_f32 v[10:11], v[74:75], v[74:75]
  v_rcp_f32 v18, v18
  v_pk_mul_f32 v[12:13], v[76:77], v[76:77]
  v_pk_mul_f32 v[14:15], v[78:79], v[78:79]
  v_rcp_f32 v19, v19
  v_pk_fma_f32 v[8:9], v[8:9], s[76:77], v[6:7]
  v_pk_fma_f32 v[10:11], v[10:11], s[76:77], v[6:7]
  v_rcp_f32 v20, v20
  v_pk_fma_f32 v[12:13], v[12:13], s[76:77], v[6:7]
  v_pk_fma_f32 v[14:15], v[14:15], s[76:77], v[6:7]
  v_rcp_f32 v21, v21
  v_pk_mul_f32 v[8:9], v[8:9], v[72:73]
  v_pk_mul_f32 v[10:11], v[10:11], v[74:75]
  v_rcp_f32 v22, v22
  v_pk_mul_f32 v[12:13], v[12:13], v[76:77]
  v_pk_mul_f32 v[14:15], v[14:15], v[78:79]
  v_rcp_f32 v23, v23
  v_exp_f32 v8, v8
  v_pk_mul_f32 v[80:81], v[80:81], v[16:17]
  v_pk_mul_f32 v[82:83], v[82:83], v[18:19]
  v_exp_f32 v9, v9
  v_pk_mul_f32 v[84:85], v[84:85], v[20:21]
  v_pk_mul_f32 v[86:87], v[86:87], v[22:23]
  v_exp_f32 v10, v10
  v_cvt_pk_bf16_f32 v224, v80, v81
  v_cvt_pk_bf16_f32 v225, v82, v83
  v_exp_f32 v11, v11
  v_cvt_pk_bf16_f32 v226, v84, v85
  v_cvt_pk_bf16_f32 v227, v86, v87
  v_exp_f32 v12, v12
  v_pk_mul_f32 v[72:73], v[72:73], v[184:185]
  v_pk_mul_f32 v[74:75], v[74:75], v[186:187]
  v_exp_f32 v13, v13
  v_pk_mul_f32 v[76:77], v[76:77], v[188:189]
  v_pk_mul_f32 v[78:79], v[78:79], v[190:191]
  v_exp_f32 v14, v14
  v_permlane16_swap_b32 v224, v226
  v_permlane16_swap_b32 v225, v227
  v_exp_f32 v15, v15
  v_pk_add_f32 v[8:9], v[8:9], 1.0 op_sel_hi:[1,0]
  v_pk_add_f32 v[10:11], v[10:11], 1.0 op_sel_hi:[1,0]
  v_rcp_f32 v8, v8
  v_pk_add_f32 v[12:13], v[12:13], 1.0 op_sel_hi:[1,0]
  v_pk_add_f32 v[14:15], v[14:15], 1.0 op_sel_hi:[1,0]
  v_rcp_f32 v9, v9
  v_pk_mul_f32 v[16:17], v[64:65], v[64:65]
  v_pk_mul_f32 v[18:19], v[66:67], v[66:67]
  v_rcp_f32 v10, v10
  v_pk_mul_f32 v[20:21], v[68:69], v[68:69]
  v_pk_mul_f32 v[22:23], v[70:71], v[70:71]
  v_rcp_f32 v11, v11
  v_pk_fma_f32 v[16:17], v[16:17], s[76:77], v[6:7]
  v_pk_fma_f32 v[18:19], v[18:19], s[76:77], v[6:7]
  v_rcp_f32 v12, v12
  v_pk_fma_f32 v[20:21], v[20:21], s[76:77], v[6:7]
  v_pk_fma_f32 v[22:23], v[22:23], s[76:77], v[6:7]
  v_rcp_f32 v13, v13
  v_pk_mul_f32 v[16:17], v[16:17], v[64:65]
  v_pk_mul_f32 v[18:19], v[18:19], v[66:67]
  v_rcp_f32 v14, v14
  v_pk_mul_f32 v[20:21], v[20:21], v[68:69]
  v_pk_mul_f32 v[22:23], v[22:23], v[70:71]
  v_rcp_f32 v15, v15
  v_exp_f32 v16, v16
  v_pk_mul_f32 v[72:73], v[72:73], v[8:9]
  v_pk_mul_f32 v[74:75], v[74:75], v[10:11]
  v_exp_f32 v17, v17
  v_pk_mul_f32 v[76:77], v[76:77], v[12:13]
  v_pk_mul_f32 v[78:79], v[78:79], v[14:15]
  v_exp_f32 v18, v18
  v_cvt_pk_bf16_f32 v220, v72, v73
  v_cvt_pk_bf16_f32 v221, v74, v75
  v_exp_f32 v19, v19
  v_cvt_pk_bf16_f32 v222, v76, v77
  v_cvt_pk_bf16_f32 v223, v78, v79
  v_exp_f32 v20, v20
  v_pk_mul_f32 v[64:65], v[64:65], v[176:177]
  v_pk_mul_f32 v[66:67], v[66:67], v[178:179]
  v_exp_f32 v21, v21
  v_pk_mul_f32 v[68:69], v[68:69], v[180:181]
  v_pk_mul_f32 v[70:71], v[70:71], v[182:183]
  v_exp_f32 v22, v22
  v_permlane16_swap_b32 v220, v222
  v_permlane16_swap_b32 v221, v223
  v_exp_f32 v23, v23
  v_pk_add_f32 v[16:17], v[16:17], 1.0 op_sel_hi:[1,0]
  v_pk_add_f32 v[18:19], v[18:19], 1.0 op_sel_hi:[1,0]
  v_rcp_f32 v16, v16
  v_pk_add_f32 v[20:21], v[20:21], 1.0 op_sel_hi:[1,0]
  v_pk_add_f32 v[22:23], v[22:23], 1.0 op_sel_hi:[1,0]
  v_rcp_f32 v17, v17
  v_pk_mul_f32 v[8:9], v[56:57], v[56:57]
  v_pk_mul_f32 v[10:11], v[58:59], v[58:59]
  v_rcp_f32 v18, v18
  v_pk_mul_f32 v[12:13], v[60:61], v[60:61]
  v_pk_mul_f32 v[14:15], v[62:63], v[62:63]
  v_rcp_f32 v19, v19
  v_pk_fma_f32 v[8:9], v[8:9], s[76:77], v[6:7]
  v_pk_fma_f32 v[10:11], v[10:11], s[76:77], v[6:7]
  v_rcp_f32 v20, v20
  v_pk_fma_f32 v[12:13], v[12:13], s[76:77], v[6:7]
  v_pk_fma_f32 v[14:15], v[14:15], s[76:77], v[6:7]
  v_rcp_f32 v21, v21
  v_pk_mul_f32 v[8:9], v[8:9], v[56:57]
  v_pk_mul_f32 v[10:11], v[10:11], v[58:59]
  v_rcp_f32 v22, v22
  v_pk_mul_f32 v[12:13], v[12:13], v[60:61]
  v_pk_mul_f32 v[14:15], v[14:15], v[62:63]
  v_rcp_f32 v23, v23
  v_exp_f32 v8, v8
  v_pk_mul_f32 v[64:65], v[64:65], v[16:17]
  v_pk_mul_f32 v[66:67], v[66:67], v[18:19]
  v_exp_f32 v9, v9
  v_pk_mul_f32 v[68:69], v[68:69], v[20:21]
  v_pk_mul_f32 v[70:71], v[70:71], v[22:23]
  v_exp_f32 v10, v10
  v_cvt_pk_bf16_f32 v216, v64, v65
  v_cvt_pk_bf16_f32 v217, v66, v67
  v_exp_f32 v11, v11
  v_cvt_pk_bf16_f32 v218, v68, v69
  v_cvt_pk_bf16_f32 v219, v70, v71
  v_exp_f32 v12, v12
  v_pk_mul_f32 v[56:57], v[56:57], v[168:169]
  v_pk_mul_f32 v[58:59], v[58:59], v[170:171]
  v_exp_f32 v13, v13
  v_pk_mul_f32 v[60:61], v[60:61], v[172:173]
  v_pk_mul_f32 v[62:63], v[62:63], v[174:175]
  v_exp_f32 v14, v14
  v_permlane16_swap_b32 v216, v218
  v_permlane16_swap_b32 v217, v219
  v_exp_f32 v15, v15
  v_pk_add_f32 v[8:9], v[8:9], 1.0 op_sel_hi:[1,0]
  v_pk_add_f32 v[10:11], v[10:11], 1.0 op_sel_hi:[1,0]
  v_rcp_f32 v8, v8
  v_pk_add_f32 v[12:13], v[12:13], 1.0 op_sel_hi:[1,0]
  v_pk_add_f32 v[14:15], v[14:15], 1.0 op_sel_hi:[1,0]
  v_rcp_f32 v9, v9
  v_pk_mul_f32 v[16:17], v[48:49], v[48:49]
  v_pk_mul_f32 v[18:19], v[50:51], v[50:51]
  v_rcp_f32 v10, v10
  v_pk_mul_f32 v[20:21], v[52:53], v[52:53]
  v_pk_mul_f32 v[22:23], v[54:55], v[54:55]
  v_rcp_f32 v11, v11
  v_pk_fma_f32 v[16:17], v[16:17], s[76:77], v[6:7]
  v_pk_fma_f32 v[18:19], v[18:19], s[76:77], v[6:7]
  v_rcp_f32 v12, v12
  v_pk_fma_f32 v[20:21], v[20:21], s[76:77], v[6:7]
  v_pk_fma_f32 v[22:23], v[22:23], s[76:77], v[6:7]
  v_rcp_f32 v13, v13
  v_pk_mul_f32 v[16:17], v[16:17], v[48:49]
  v_pk_mul_f32 v[18:19], v[18:19], v[50:51]
  v_rcp_f32 v14, v14
  v_pk_mul_f32 v[20:21], v[20:21], v[52:53]
  v_pk_mul_f32 v[22:23], v[22:23], v[54:55]
  v_rcp_f32 v15, v15
  v_exp_f32 v16, v16
  v_pk_mul_f32 v[56:57], v[56:57], v[8:9]
  v_pk_mul_f32 v[58:59], v[58:59], v[10:11]
  v_exp_f32 v17, v17
  v_pk_mul_f32 v[60:61], v[60:61], v[12:13]
  v_pk_mul_f32 v[62:63], v[62:63], v[14:15]
  v_exp_f32 v18, v18
  v_cvt_pk_bf16_f32 v212, v56, v57
  v_cvt_pk_bf16_f32 v213, v58, v59
  v_exp_f32 v19, v19
  v_cvt_pk_bf16_f32 v214, v60, v61
  v_cvt_pk_bf16_f32 v215, v62, v63
  v_exp_f32 v20, v20
  v_pk_mul_f32 v[48:49], v[48:49], v[160:161]
  v_pk_mul_f32 v[50:51], v[50:51], v[162:163]
  v_exp_f32 v21, v21
  v_pk_mul_f32 v[52:53], v[52:53], v[164:165]
  v_pk_mul_f32 v[54:55], v[54:55], v[166:167]
  v_exp_f32 v22, v22
  v_permlane16_swap_b32 v212, v214
  v_permlane16_swap_b32 v213, v215
  v_exp_f32 v23, v23
  v_pk_add_f32 v[16:17], v[16:17], 1.0 op_sel_hi:[1,0]
  v_pk_add_f32 v[18:19], v[18:19], 1.0 op_sel_hi:[1,0]
  v_rcp_f32 v16, v16
  v_pk_add_f32 v[20:21], v[20:21], 1.0 op_sel_hi:[1,0]
  v_pk_add_f32 v[22:23], v[22:23], 1.0 op_sel_hi:[1,0]
  v_rcp_f32 v17, v17
  v_pk_mul_f32 v[8:9], v[152:153], v[152:153]
  v_pk_mul_f32 v[10:11], v[154:155], v[154:155]
  v_rcp_f32 v18, v18
  v_pk_mul_f32 v[12:13], v[156:157], v[156:157]
  v_pk_mul_f32 v[14:15], v[158:159], v[158:159]
  v_rcp_f32 v19, v19
  v_pk_fma_f32 v[8:9], v[8:9], s[76:77], v[6:7]
  v_pk_fma_f32 v[10:11], v[10:11], s[76:77], v[6:7]
  v_rcp_f32 v20, v20
  v_pk_fma_f32 v[12:13], v[12:13], s[76:77], v[6:7]
  v_pk_fma_f32 v[14:15], v[14:15], s[76:77], v[6:7]
  v_rcp_f32 v21, v21
  v_pk_mul_f32 v[8:9], v[8:9], v[152:153]
  v_pk_mul_f32 v[10:11], v[10:11], v[154:155]
  v_rcp_f32 v22, v22
  v_pk_mul_f32 v[12:13], v[12:13], v[156:157]
  v_pk_mul_f32 v[14:15], v[14:15], v[158:159]
  v_rcp_f32_e64 v23, v23
  v_accvgpr_read_b32 v136, a8
  v_accvgpr_read_b32 v137, a9
  v_accvgpr_read_b32 v138, a10
  v_accvgpr_read_b32 v139, a11
  v_accvgpr_read_b32 v140, a12
  v_accvgpr_read_b32 v141, a13
  v_accvgpr_read_b32 v142, a14
  v_accvgpr_read_b32 v143, a15
  v_accvgpr_read_b32 v24, a240
  buffer_load_dword v25, v24, s[20:23], s94 offen sc1
  v_exp_f32 v8, v8
  v_pk_mul_f32 v[48:49], v[48:49], v[16:17]
  v_pk_mul_f32 v[50:51], v[50:51], v[18:19]
  v_exp_f32 v9, v9
  v_pk_mul_f32 v[52:53], v[52:53], v[20:21]
  v_pk_mul_f32 v[54:55], v[54:55], v[22:23]
  v_exp_f32 v10, v10
  v_cvt_pk_bf16_f32 v208, v48, v49
  v_cvt_pk_bf16_f32 v209, v50, v51
  v_exp_f32 v11, v11
  v_cvt_pk_bf16_f32 v210, v52, v53
  v_cvt_pk_bf16_f32 v211, v54, v55
  v_exp_f32 v12, v12
  v_pk_mul_f32 v[152:153], v[152:153], v[136:137]
  v_pk_mul_f32 v[154:155], v[154:155], v[138:139]
  v_exp_f32 v13, v13
  v_pk_mul_f32 v[156:157], v[156:157], v[140:141]
  v_pk_mul_f32 v[158:159], v[158:159], v[142:143]
  v_exp_f32 v14, v14
  v_permlane16_swap_b32 v208, v210
  v_permlane16_swap_b32 v209, v211
  v_exp_f32 v15, v15
  v_pk_add_f32 v[8:9], v[8:9], 1.0 op_sel_hi:[1,0]
  v_pk_add_f32 v[10:11], v[10:11], 1.0 op_sel_hi:[1,0]
  v_rcp_f32 v8, v8
  v_pk_add_f32 v[12:13], v[12:13], 1.0 op_sel_hi:[1,0]
  v_pk_add_f32 v[14:15], v[14:15], 1.0 op_sel_hi:[1,0]
  v_rcp_f32 v9, v9
  v_pk_mul_f32 v[16:17], v[144:145], v[144:145]
  v_pk_mul_f32 v[18:19], v[146:147], v[146:147]
  v_rcp_f32 v10, v10
  v_pk_mul_f32 v[20:21], v[148:149], v[148:149]
  v_pk_mul_f32 v[22:23], v[150:151], v[150:151]
  v_rcp_f32 v11, v11
  v_pk_fma_f32 v[16:17], v[16:17], s[76:77], v[6:7]
  v_pk_fma_f32 v[18:19], v[18:19], s[76:77], v[6:7]
  v_rcp_f32 v12, v12
  v_pk_fma_f32 v[20:21], v[20:21], s[76:77], v[6:7]
  v_pk_fma_f32 v[22:23], v[22:23], s[76:77], v[6:7]
  v_rcp_f32 v13, v13
  v_pk_mul_f32 v[16:17], v[16:17], v[144:145]
  v_pk_mul_f32 v[18:19], v[18:19], v[146:147]
  v_rcp_f32 v14, v14
  v_pk_mul_f32 v[20:21], v[20:21], v[148:149]
  v_pk_mul_f32 v[22:23], v[22:23], v[150:151]
  v_rcp_f32 v15, v15
  v_accvgpr_read_b32 v128, a0
  v_accvgpr_read_b32 v129, a1
  v_accvgpr_read_b32 v130, a2
  v_accvgpr_read_b32 v131, a3
  v_accvgpr_read_b32 v132, a4
  v_accvgpr_read_b32 v133, a5
  v_accvgpr_read_b32 v134, a6
  v_accvgpr_read_b32 v135, a7
  v_exp_f32 v16, v16
  v_pk_mul_f32 v[152:153], v[152:153], v[8:9]
  v_pk_mul_f32 v[154:155], v[154:155], v[10:11]
  v_exp_f32 v17, v17
  v_pk_mul_f32 v[156:157], v[156:157], v[12:13]
  v_pk_mul_f32 v[158:159], v[158:159], v[14:15]
  v_exp_f32 v18, v18
  v_cvt_pk_bf16_f32 v204, v152, v153
  v_cvt_pk_bf16_f32 v205, v154, v155
  v_exp_f32 v19, v19
  v_cvt_pk_bf16_f32 v206, v156, v157
  v_cvt_pk_bf16_f32 v207, v158, v159
  v_exp_f32 v20, v20
  v_pk_mul_f32 v[144:145], v[144:145], v[128:129]
  v_pk_mul_f32 v[146:147], v[146:147], v[130:131]
  v_exp_f32 v21, v21
  v_pk_mul_f32 v[148:149], v[148:149], v[132:133]
  v_pk_mul_f32 v[150:151], v[150:151], v[134:135]
  v_exp_f32 v22, v22
  v_permlane16_swap_b32 v204, v206
  v_permlane16_swap_b32 v205, v207
  v_exp_f32 v23, v23
  v_pk_add_f32 v[16:17], v[16:17], 1.0 op_sel_hi:[1,0]
  v_pk_add_f32 v[18:19], v[18:19], 1.0 op_sel_hi:[1,0]
  v_rcp_f32 v16, v16
  v_pk_add_f32 v[20:21], v[20:21], 1.0 op_sel_hi:[1,0]
  v_pk_add_f32 v[22:23], v[22:23], 1.0 op_sel_hi:[1,0]
  v_rcp_f32 v17, v17
  v_rcp_f32 v18, v18
  v_rcp_f32 v19, v19
  v_rcp_f32 v20, v20
  v_rcp_f32 v21, v21
  v_rcp_f32 v22, v22
  v_rcp_f32 v23, v23
  v_pk_mul_f32 v[144:145], v[144:145], v[16:17]
  v_pk_mul_f32 v[146:147], v[146:147], v[18:19]
  v_pk_mul_f32 v[148:149], v[148:149], v[20:21]
  v_pk_mul_f32 v[150:151], v[150:151], v[22:23]
  v_cvt_pk_bf16_f32 v200, v144, v145
  v_cvt_pk_bf16_f32 v201, v146, v147
  v_cvt_pk_bf16_f32 v202, v148, v149
  v_cvt_pk_bf16_f32 v203, v150, v151
  s_nop 0
  v_permlane16_swap_b32 v200, v202
  v_permlane16_swap_b32 v201, v203
  ds_read_b128 v[160:163], v4 offset:0
  ds_read_b128 v[164:167], v4 offset:1024
  ds_read_b128 v[176:179], v4 offset:2048
  ds_read_b128 v[180:183], v4 offset:3072
  v_mov_b32 v2, v4
  v_add_u32_e64 v3, s85, v4
  s_xor_b32 s85, s85, 32768
  s_add_u32 s82, s82, 1
  s_and_b32 s82, s82, 7
  s_lshl_b32 s83, s82, 15
  s_add_u32 s83, s83, s81
  v_accvgpr_read_b32 v16, a226
  v_accvgpr_read_b32 v17, a226
  v_accvgpr_read_b32 v18, a227
  v_accvgpr_read_b32 v19, a227
  v_mov_b32 v192, 0
  v_mov_b32 v193, 0
  v_mov_b32 v194, 0
  v_mov_b32 v195, 0
  v_mov_b32 v196, 0
  v_mov_b32 v197, 0
  v_mov_b32 v198, 0
  v_mov_b32 v199, 0
  s_waitcnt lgkmcnt(3)
  v_mfma_f32_32x32x16_bf16 v[80:95], v[160:163], v[32:35], 0
  s_waitcnt lgkmcnt(2)
  v_mfma_f32_32x32x16_bf16 v[80:95], v[164:167], v[36:39], v[80:95]
  v_accvgpr_read_b32 v8, a229
  v_accvgpr_read_b32 v9, a230
  v_mfma_f32_32x32x16_bf16 v[96:111], v[160:163], v[40:43], 0
  v_mfma_f32_32x32x16_bf16 v[96:111], v[164:167], v[44:47], v[96:111]
  v_accvgpr_read_b32 v10, a231
  v_accvgpr_read_b32 v11, a232
  s_nop 5
  v_max3_f32 v12, v81, v82, v80
  s_nop 2
  v_max3_f32 v13, v97, v98, v96
  v_max3_f32 v12, v83, v84, v12
  v_max3_f32 v13, v99, v100, v13
  v_max3_f32 v12, v85, v86, v12
  v_max3_f32 v13, v101, v102, v13
  v_max3_f32 v12, v87, v88, v12
  v_max3_f32 v13, v103, v104, v13
  v_max3_f32 v12, v89, v90, v12
  v_max3_f32 v13, v105, v106, v13
  v_max3_f32 v12, v91, v92, v12
  v_max3_f32 v13, v107, v108, v13
  v_max3_f32 v12, v93, v94, v12
  v_max3_f32 v13, v109, v110, v13
  v_max_f32 v12, v95, v12
  v_max_f32 v13, v111, v13
  v_mov_b32 v14, v12
  v_mov_b32 v15, v13
  s_nop 0
  v_permlane32_swap_b32 v12, v14
  v_permlane32_swap_b32 v13, v15
  v_max_f32 v12, v12, v14
  v_max_f32 v13, v13, v15
  v_sub_f32 v48, 0, v12
  v_sub_f32 v49, 0, v12
  v_sub_f32 v50, 0, v12
  v_sub_f32 v51, 0, v12
  v_sub_f32 v52, 0, v12
  v_sub_f32 v53, 0, v12
  v_sub_f32 v54, 0, v12
  v_sub_f32 v55, 0, v12
  v_sub_f32 v56, 0, v12
  v_sub_f32 v57, 0, v12
  v_sub_f32 v58, 0, v12
  v_sub_f32 v59, 0, v12
  v_sub_f32 v60, 0, v12
  v_sub_f32 v61, 0, v12
  v_sub_f32 v62, 0, v12
  v_sub_f32 v63, 0, v12
  v_sub_f32 v64, 0, v13
  v_sub_f32 v65, 0, v13
  v_sub_f32 v66, 0, v13
  v_sub_f32 v67, 0, v13
  v_sub_f32 v68, 0, v13
  v_sub_f32 v69, 0, v13
  v_sub_f32 v70, 0, v13
  v_sub_f32 v71, 0, v13
  v_sub_f32 v72, 0, v13
  v_sub_f32 v73, 0, v13
  v_sub_f32 v74, 0, v13
  v_sub_f32 v75, 0, v13
  v_sub_f32 v76, 0, v13
  v_sub_f32 v77, 0, v13
  v_sub_f32 v78, 0, v13
  v_sub_f32 v79, 0, v13
  v_accvgpr_read_b32 v13, a228
  v_mfma_f32_32x32x16_bf16 v[80:95], v[160:163], v[32:35], v[48:63]
  v_mfma_f32_32x32x16_bf16 v[80:95], v[164:167], v[36:39], v[80:95]
  v_mfma_f32_32x32x16_bf16 v[96:111], v[160:163], v[40:43], v[64:79]
  ds_read_b128 v[168:171], v2 offset:4096
  s_nop 9
  v_exp_f32 v80, v80
  v_exp_f32 v81, v81
  v_exp_f32 v82, v82
  ds_read_b128 v[172:175], v2 offset:5120
  v_cvt_pk_bf16_f32 v144, v80, v81
  v_exp_f32 v83, v83
  v_exp_f32 v84, v84
  v_cvt_pk_bf16_f32 v145, v82, v83
  v_exp_f32 v85, v85
  v_mfma_f32_32x32x16_bf16 v[96:111], v[164:167], v[44:47], v[96:111]
  v_exp_f32 v86, v86
  v_cvt_pk_bf16_f32 v146, v84, v85
  v_exp_f32 v87, v87
  v_exp_f32 v88, v88
  v_cvt_pk_bf16_f32 v147, v86, v87
  v_exp_f32 v89, v89
  v_exp_f32 v90, v90
  s_waitcnt lgkmcnt(3)
  v_mfma_f32_32x32x16_bf16 v[112:127], v[176:179], v[144:147], 0
  s_waitcnt lgkmcnt(0)
  v_cvt_pk_bf16_f32 v148, v88, v89
  v_exp_f32 v91, v91
  v_exp_f32 v92, v92
  v_cvt_pk_bf16_f32 v149, v90, v91
  v_exp_f32 v93, v93
  v_exp_f32 v94, v94
  v_exp_f32 v95, v95
  v_cvt_pk_bf16_f32 v150, v92, v93
  v_cvt_pk_bf16_f32 v151, v94, v95
  s_waitcnt vmcnt(0)
  v_cmp_gt_u32 vcc, 1, v25
  s_nop 0
  s_cbranch_vccnz L_retry1
L_cont1:
  v_mfma_f32_32x32x16_bf16 v[80:95], v[168:171], v[32:35], v[48:63]
  ds_read_b128 v[184:187], v2 offset:6144
  v_exp_f32 v96, v96
  v_exp_f32 v97, v97
  v_exp_f32 v98, v98
  v_mfma_f32_32x32x16_bf16 v[112:127], v[180:183], v[148:151], v[112:127]
  ds_read_b128 v[188:191], v2 offset:7168
  v_cvt_pk_bf16_f32 v152, v96, v97
  v_exp_f32 v99, v99
  v_exp_f32 v100, v100
  v_cvt_pk_bf16_f32 v153, v98, v99
  v_smfmac_f32_16x16x64_bf16 v[192:195], v[16:19], v[144:151], v13
  s_mov_b32 m0, s85
  v_exp_f32 v101, v101
  v_mfma_f32_32x32x16_bf16 v[80:95], v[172:175], v[36:39], v[80:95]
  buffer_load_dwordx4 v3, s[20:23], s83 offen offset:0 sc1 lds
  v_exp_f32 v102, v102
  v_cvt_pk_bf16_f32 v154, v100, v101
  v_exp_f32 v103, v103
  v_exp_f32 v104, v104
  v_cvt_pk_bf16_f32 v155, v102, v103
  v_exp_f32 v105, v105
  v_exp_f32 v106, v106
  v_mfma_f32_32x32x16_bf16 v[128:143], v[176:179], v[152:155], 0
  s_waitcnt lgkmcnt(0)
  buffer_load_dwordx4 v3, s[20:23], s83 offen offset:1024 sc1 lds
  v_cvt_pk_bf16_f32 v156, v104, v105
  v_exp_f32 v107, v107
  v_exp_f32 v108, v108
  v_cvt_pk_bf16_f32 v157, v106, v107
  v_exp_f32 v109, v109
  v_exp_f32 v110, v110
  v_exp_f32 v111, v111
  v_cvt_pk_bf16_f32 v158, v108, v109
  v_cvt_pk_bf16_f32 v159, v110, v111
  v_mfma_f32_32x32x16_bf16 v[96:111], v[168:171], v[40:43], v[64:79]
  ds_read_b128 v[160:163], v2 offset:8192
  v_exp_f32 v80, v80
  v_exp_f32 v81, v81
  v_exp_f32 v82, v82
  v_mfma_f32_32x32x16_bf16 v[128:143], v[180:183], v[156:159], v[128:143]
  ds_read_b128 v[164:167], v2 offset:9216
  v_cvt_pk_bf16_f32 v144, v80, v81
  v_exp_f32 v83, v83
  v_exp_f32 v84, v84
  v_cvt_pk_bf16_f32 v145, v82, v83
  v_smfmac_f32_16x16x64_bf16 v[196:199], v[16:19], v[152:159], v13
  s_add_u32 s84, s83, 4096
  v_exp_f32 v85, v85
  v_mfma_f32_32x32x16_bf16 v[96:111], v[172:175], v[44:47], v[96:111]
  buffer_load_dwordx4 v3, s[20:23], s83 offen offset:2048 sc1 lds
  v_exp_f32 v86, v86
  v_cvt_pk_bf16_f32 v146, v84, v85
  v_exp_f32 v87, v87
  v_exp_f32 v88, v88
  v_cvt_pk_bf16_f32 v147, v86, v87
  v_exp_f32 v89, v89
  v_exp_f32 v90, v90
  v_mfma_f32_32x32x16_bf16 v[112:127], v[184:187], v[144:147], v[112:127]
  s_waitcnt lgkmcnt(0)
  buffer_load_dwordx4 v3, s[20:23], s83 offen offset:3072 sc1 lds
  v_cvt_pk_bf16_f32 v148, v88, v89
  v_exp_f32 v91, v91
  v_exp_f32 v92, v92
  v_cvt_pk_bf16_f32 v149, v90, v91
  v_exp_f32 v93, v93
  v_exp_f32 v94, v94
  v_exp_f32 v95, v95
  v_cvt_pk_bf16_f32 v150, v92, v93
  v_cvt_pk_bf16_f32 v151, v94, v95
  v_mfma_f32_32x32x16_bf16 v[80:95], v[160:163], v[32:35], v[48:63]
  ds_read_b128 v[176:179], v2 offset:10240
  v_exp_f32 v96, v96
  v_exp_f32 v97, v97
  v_exp_f32 v98, v98
  v_mfma_f32_32x32x16_bf16 v[112:127], v[188:191], v[148:151], v[112:127]
  ds_read_b128 v[180:183], v2 offset:11264
  v_cvt_pk_bf16_f32 v152, v96, v97
  v_exp_f32 v99, v99
  v_exp_f32 v100, v100
  v_cvt_pk_bf16_f32 v153, v98, v99
  v_smfmac_f32_16x16x64_bf16 v[192:195], v[16:19], v[144:151], v13
L_touch2:
  s_cbranch_execz L_touch6
  s_add_u32 m0, s85, 4096
  v_exp_f32 v101, v101
  v_mfma_f32_32x32x16_bf16 v[80:95], v[164:167], v[36:39], v[80:95]
  buffer_load_dwordx4 v3, s[20:23], s84 offen offset:0 sc1 lds
  v_exp_f32 v102, v102
  v_cvt_pk_bf16_f32 v154, v100, v101
  v_exp_f32 v103, v103
  v_exp_f32 v104, v104
  v_cvt_pk_bf16_f32 v155, v102, v103
  v_exp_f32 v105, v105
  v_exp_f32 v106, v106
  v_mfma_f32_32x32x16_bf16 v[128:143], v[184:187], v[152:155], v[128:143]
  s_waitcnt lgkmcnt(0)
  buffer_load_dwordx4 v3, s[20:23], s84 offen offset:1024 sc1 lds
  v_cvt_pk_bf16_f32 v156, v104, v105
  v_exp_f32 v107, v107
  v_exp_f32 v108, v108
  v_cvt_pk_bf16_f32 v157, v106, v107
  v_exp_f32 v109, v109
  v_exp_f32 v110, v110
  v_exp_f32 v111, v111
  v_cvt_pk_bf16_f32 v158, v108, v109
  v_cvt_pk_bf16_f32 v159, v110, v111
  v_mfma_f32_32x32x16_bf16 v[96:111], v[160:163], v[40:43], v[64:79]
  ds_read_b128 v[168:171], v2 offset:12288
  v_exp_f32 v80, v80
  v_exp_f32 v81, v81
  v_exp_f32 v82, v82
  v_mfma_f32_32x32x16_bf16 v[128:143], v[188:191], v[156:159], v[128:143]
  ds_read_b128 v[172:175], v2 offset:13312
  v_cvt_pk_bf16_f32 v144, v80, v81
  v_exp_f32 v83, v83
  v_exp_f32 v84, v84
  v_cvt_pk_bf16_f32 v145, v82, v83
  v_smfmac_f32_16x16x64_bf16 v[196:199], v[16:19], v[152:159], v13
  v_exp_f32 v85, v85
  v_mfma_f32_32x32x16_bf16 v[96:111], v[164:167], v[44:47], v[96:111]
  buffer_load_dwordx4 v3, s[20:23], s84 offen offset:2048 sc1 lds
  v_exp_f32 v86, v86
  v_cvt_pk_bf16_f32 v146, v84, v85
  v_exp_f32 v87, v87
  v_exp_f32 v88, v88
  v_cvt_pk_bf16_f32 v147, v86, v87
  v_exp_f32 v89, v89
  v_exp_f32 v90, v90
  v_mfma_f32_32x32x16_bf16 v[112:127], v[176:179], v[144:147], v[112:127]
  s_waitcnt lgkmcnt(0)
  buffer_load_dwordx4 v3, s[20:23], s84 offen offset:3072 sc1 lds
  v_cvt_pk_bf16_f32 v148, v88, v89
  v_exp_f32 v91, v91
  v_exp_f32 v92, v92
  v_cvt_pk_bf16_f32 v149, v90, v91
  v_exp_f32 v93, v93
  v_exp_f32 v94, v94
  v_exp_f32 v95, v95
  v_cvt_pk_bf16_f32 v150, v92, v93
  v_cvt_pk_bf16_f32 v151, v94, v95
  v_mfma_f32_32x32x16_bf16 v[80:95], v[168:171], v[32:35], v[48:63]
  ds_read_b128 v[184:187], v2 offset:14336
  v_exp_f32 v96, v96
  v_exp_f32 v97, v97
  v_exp_f32 v98, v98
  v_mfma_f32_32x32x16_bf16 v[112:127], v[180:183], v[148:151], v[112:127]
  ds_read_b128 v[188:191], v2 offset:15360
  v_cvt_pk_bf16_f32 v152, v96, v97
  v_exp_f32 v99, v99
  v_exp_f32 v100, v100
  v_cvt_pk_bf16_f32 v153, v98, v99
  v_smfmac_f32_16x16x64_bf16 v[192:195], v[16:19], v[144:151], v13
  s_xor_b32 s85, s85, 32768
  v_exp_f32 v101, v101
  v_mfma_f32_32x32x16_bf16 v[80:95], v[172:175], v[36:39], v[80:95]
  v_exp_f32 v102, v102
  v_cvt_pk_bf16_f32 v154, v100, v101
  v_exp_f32 v103, v103
  v_exp_f32 v104, v104
  v_cvt_pk_bf16_f32 v155, v102, v103
  v_exp_f32 v105, v105
  v_exp_f32 v106, v106
  v_mfma_f32_32x32x16_bf16 v[128:143], v[176:179], v[152:155], v[128:143]
  s_waitcnt lgkmcnt(0)
  v_cvt_pk_bf16_f32 v156, v104, v105
  v_exp_f32 v107, v107
  v_exp_f32 v108, v108
  v_cvt_pk_bf16_f32 v157, v106, v107
  v_exp_f32 v109, v109
  v_exp_f32 v110, v110
  v_exp_f32 v111, v111
  v_cvt_pk_bf16_f32 v158, v108, v109
  v_cvt_pk_bf16_f32 v159, v110, v111
  v_mfma_f32_32x32x16_bf16 v[96:111], v[168:171], v[40:43], v[64:79]
  ds_read_b128 v[160:163], v2 offset:16384
  v_exp_f32 v80, v80
  v_exp_f32 v81, v81
  v_exp_f32 v82, v82
  v_mfma_f32_32x32x16_bf16 v[128:143], v[180:183], v[156:159], v[128:143]
  ds_read_b128 v[164:167], v2 offset:17408
  v_cvt_pk_bf16_f32 v144, v80, v81
  v_exp_f32 v83, v83
  v_exp_f32 v84, v84
  v_cvt_pk_bf16_f32 v145, v82, v83
  v_smfmac_f32_16x16x64_bf16 v[196:199], v[16:19], v[152:159], v13
  v_exp_f32 v85, v85
  v_mfma_f32_32x32x16_bf16 v[96:111], v[172:175], v[44:47], v[96:111]
  buffer_store_dwordx4 v[252:255], v4, s[20:23], s73 offen offset:1024 sc1
  v_exp_f32 v86, v86
  v_cvt_pk_bf16_f32 v146, v84, v85
  v_exp_f32 v87, v87
  v_exp_f32 v88, v88
  v_cvt_pk_bf16_f32 v147, v86, v87
  v_exp_f32 v89, v89
  v_exp_f32 v90, v90
  v_mfma_f32_32x32x16_bf16 v[112:127], v[184:187], v[144:147], v[112:127]
  s_waitcnt lgkmcnt(0)
  v_cvt_pk_bf16_f32 v148, v88, v89
  v_exp_f32 v91, v91
  v_exp_f32 v92, v92
  v_cvt_pk_bf16_f32 v149, v90, v91
  v_exp_f32 v93, v93
  v_exp_f32 v94, v94
  v_exp_f32 v95, v95
  v_cvt_pk_bf16_f32 v150, v92, v93
  v_cvt_pk_bf16_f32 v151, v94, v95
  v_mfma_f32_32x32x16_bf16 v[80:95], v[160:163], v[32:35], v[48:63]
  ds_read_b128 v[176:179], v2 offset:18432
  v_exp_f32 v96, v96
  v_exp_f32 v97, v97
  v_exp_f32 v98, v98
  v_mfma_f32_32x32x16_bf16 v[112:127], v[188:191], v[148:151], v[112:127]
  ds_read_b128 v[180:183], v2 offset:19456
  v_cvt_pk_bf16_f32 v152, v96, v97
  v_exp_f32 v99, v99
  v_exp_f32 v100, v100
  v_cvt_pk_bf16_f32 v153, v98, v99
  v_smfmac_f32_16x16x64_bf16 v[192:195], v[16:19], v[144:151], v13
  v_exp_f32 v101, v101
  v_mfma_f32_32x32x16_bf16 v[80:95], v[164:167], v[36:39], v[80:95]
  buffer_store_dwordx4 v[248:251], v4, s[20:23], s71 offen offset:1024 sc1
  v_exp_f32 v102, v102
  v_cvt_pk_bf16_f32 v154, v100, v101
  v_exp_f32 v103, v103
  v_exp_f32 v104, v104
  v_cvt_pk_bf16_f32 v155, v102, v103
  v_exp_f32 v105, v105
  v_exp_f32 v106, v106
  v_mfma_f32_32x32x16_bf16 v[128:143], v[184:187], v[152:155], v[128:143]
  s_waitcnt lgkmcnt(0)
  v_cvt_pk_bf16_f32 v156, v104, v105
  v_exp_f32 v107, v107
  v_exp_f32 v108, v108
  v_cvt_pk_bf16_f32 v157, v106, v107
  v_exp_f32 v109, v109
  v_exp_f32 v110, v110
  v_exp_f32 v111, v111
  v_cvt_pk_bf16_f32 v158, v108, v109
  v_cvt_pk_bf16_f32 v159, v110, v111
  v_mfma_f32_32x32x16_bf16 v[96:111], v[160:163], v[40:43], v[64:79]
  ds_read_b128 v[168:171], v2 offset:20480
  v_exp_f32 v80, v80
  v_exp_f32 v81, v81
  v_exp_f32 v82, v82
  v_mfma_f32_32x32x16_bf16 v[128:143], v[188:191], v[156:159], v[128:143]
  ds_read_b128 v[172:175], v2 offset:21504
  v_cvt_pk_bf16_f32 v144, v80, v81
  v_exp_f32 v83, v83
  v_exp_f32 v84, v84
  v_cvt_pk_bf16_f32 v145, v82, v83
  v_smfmac_f32_16x16x64_bf16 v[196:199], v[16:19], v[152:159], v13
  v_exp_f32 v85, v85
  v_mfma_f32_32x32x16_bf16 v[96:111], v[164:167], v[44:47], v[96:111]
  buffer_store_dwordx4 v[244:247], v4, s[20:23], s73 offen offset:0 sc1
  v_exp_f32 v86, v86
  v_cvt_pk_bf16_f32 v146, v84, v85
  v_exp_f32 v87, v87
  v_exp_f32 v88, v88
  v_cvt_pk_bf16_f32 v147, v86, v87
  v_exp_f32 v89, v89
  v_exp_f32 v90, v90
  v_mfma_f32_32x32x16_bf16 v[112:127], v[176:179], v[144:147], v[112:127]
  s_waitcnt lgkmcnt(0)
  v_cvt_pk_bf16_f32 v148, v88, v89
  v_exp_f32 v91, v91
  v_exp_f32 v92, v92
  v_cvt_pk_bf16_f32 v149, v90, v91
  v_exp_f32 v93, v93
  v_exp_f32 v94, v94
  v_exp_f32 v95, v95
  v_cvt_pk_bf16_f32 v150, v92, v93
  v_cvt_pk_bf16_f32 v151, v94, v95
  v_mfma_f32_32x32x16_bf16 v[80:95], v[168:171], v[32:35], v[48:63]
  ds_read_b128 v[184:187], v2 offset:22528
  v_exp_f32 v96, v96
  v_exp_f32 v97, v97
  v_exp_f32 v98, v98
  v_mfma_f32_32x32x16_bf16 v[112:127], v[180:183], v[148:151], v[112:127]
  ds_read_b128 v[188:191], v2 offset:23552
  v_cvt_pk_bf16_f32 v152, v96, v97
  v_exp_f32 v99, v99
  v_exp_f32 v100, v100
  v_cvt_pk_bf16_f32 v153, v98, v99
  v_smfmac_f32_16x16x64_bf16 v[192:195], v[16:19], v[144:151], v13
  v_exp_f32 v101, v101
  v_mfma_f32_32x32x16_bf16 v[80:95], v[172:175], v[36:39], v[80:95]
  buffer_store_dwordx4 v[240:243], v4, s[20:23], s71 offen offset:0 sc1
  v_exp_f32 v102, v102
  v_cvt_pk_bf16_f32 v154, v100, v101
  v_exp_f32 v103, v103
  v_exp_f32 v104, v104
  v_cvt_pk_bf16_f32 v155, v102, v103
  v_exp_f32 v105, v105
  v_exp_f32 v106, v106
  v_mfma_f32_32x32x16_bf16 v[128:143], v[176:179], v[152:155], v[128:143]
  s_waitcnt lgkmcnt(0)
  v_cvt_pk_bf16_f32 v156, v104, v105
  v_exp_f32 v107, v107
  v_exp_f32 v108, v108
  v_cvt_pk_bf16_f32 v157, v106, v107
  v_exp_f32 v109, v109
  v_exp_f32 v110, v110
  v_exp_f32 v111, v111
  v_cvt_pk_bf16_f32 v158, v108, v109
  v_cvt_pk_bf16_f32 v159, v110, v111
  v_mfma_f32_32x32x16_bf16 v[96:111], v[168:171], v[40:43], v[64:79]
  ds_read_b128 v[160:163], v2 offset:24576
  v_exp_f32 v80, v80
  v_exp_f32 v81, v81
  v_exp_f32 v82, v82
  v_mfma_f32_32x32x16_bf16 v[128:143], v[180:183], v[156:159], v[128:143]
  ds_read_b128 v[164:167], v2 offset:25600
  v_cvt_pk_bf16_f32 v144, v80, v81
  v_exp_f32 v83, v83
  v_exp_f32 v84, v84
  v_cvt_pk_bf16_f32 v145, v82, v83
  v_smfmac_f32_16x16x64_bf16 v[196:199], v[16:19], v[152:159], v13
  v_exp_f32 v85, v85
  v_mfma_f32_32x32x16_bf16 v[96:111], v[172:175], v[44:47], v[96:111]
  buffer_store_dwordx4 v[236:239], v4, s[20:23], s72 offen offset:3072 sc1
  v_exp_f32 v86, v86
  v_cvt_pk_bf16_f32 v146, v84, v85
  v_exp_f32 v87, v87
  v_exp_f32 v88, v88
  v_cvt_pk_bf16_f32 v147, v86, v87
  v_exp_f32 v89, v89
  v_exp_f32 v90, v90
  v_mfma_f32_32x32x16_bf16 v[112:127], v[184:187], v[144:147], v[112:127]
  s_waitcnt lgkmcnt(0)
  v_cvt_pk_bf16_f32 v148, v88, v89
  v_exp_f32 v91, v91
  v_exp_f32 v92, v92
  v_cvt_pk_bf16_f32 v149, v90, v91
  v_exp_f32 v93, v93
  v_exp_f32 v94, v94
  v_exp_f32 v95, v95
  v_cvt_pk_bf16_f32 v150, v92, v93
  v_cvt_pk_bf16_f32 v151, v94, v95
  v_mfma_f32_32x32x16_bf16 v[80:95], v[160:163], v[32:35], v[48:63]
  ds_read_b128 v[176:179], v2 offset:26624
  v_exp_f32 v96, v96
  v_exp_f32 v97, v97
  v_exp_f32 v98, v98
  v_mfma_f32_32x32x16_bf16 v[112:127], v[188:191], v[148:151], v[112:127]
  ds_read_b128 v[180:183], v2 offset:27648
  v_cvt_pk_bf16_f32 v152, v96, v97
  v_exp_f32 v99, v99
  v_exp_f32 v100, v100
  v_cvt_pk_bf16_f32 v153, v98, v99
  v_smfmac_f32_16x16x64_bf16 v[192:195], v[16:19], v[144:151], v13
  v_exp_f32 v101, v101
  v_mfma_f32_32x32x16_bf16 v[80:95], v[164:167], v[36:39], v[80:95]
  buffer_store_dwordx4 v[232:235], v4, s[20:23], s70 offen offset:3072 sc1
  v_exp_f32 v102, v102
  v_cvt_pk_bf16_f32 v154, v100, v101
  v_exp_f32 v103, v103
  v_exp_f32 v104, v104
  v_cvt_pk_bf16_f32 v155, v102, v103
  v_exp_f32 v105, v105
  v_exp_f32 v106, v106
  v_mfma_f32_32x32x16_bf16 v[128:143], v[184:187], v[152:155], v[128:143]
  s_waitcnt lgkmcnt(0)
  v_cvt_pk_bf16_f32 v156, v104, v105
  v_exp_f32 v107, v107
  v_exp_f32 v108, v108
  v_cvt_pk_bf16_f32 v157, v106, v107
  v_exp_f32 v109, v109
  v_exp_f32 v110, v110
  v_exp_f32 v111, v111
  v_cvt_pk_bf16_f32 v158, v108, v109
  v_cvt_pk_bf16_f32 v159, v110, v111
  v_mfma_f32_32x32x16_bf16 v[96:111], v[160:163], v[40:43], v[64:79]
  ds_read_b128 v[168:171], v2 offset:28672
  v_exp_f32 v80, v80
  v_exp_f32 v81, v81
  v_exp_f32 v82, v82
  v_mfma_f32_32x32x16_bf16 v[128:143], v[188:191], v[156:159], v[128:143]
  ds_read_b128 v[172:175], v2 offset:29696
  v_cvt_pk_bf16_f32 v144, v80, v81
  v_exp_f32 v83, v83
  v_exp_f32 v84, v84
  v_cvt_pk_bf16_f32 v145, v82, v83
  v_smfmac_f32_16x16x64_bf16 v[196:199], v[16:19], v[152:159], v13
  s_add_u32 s82, s82, 1
  v_exp_f32 v85, v85
  v_mfma_f32_32x32x16_bf16 v[96:111], v[164:167], v[44:47], v[96:111]
  buffer_store_dwordx4 v[228:231], v4, s[20:23], s72 offen offset:2048 sc1
  v_exp_f32 v86, v86
  v_cvt_pk_bf16_f32 v146, v84, v85
  v_exp_f32 v87, v87
  v_exp_f32 v88, v88
  v_cvt_pk_bf16_f32 v147, v86, v87
  v_exp_f32 v89, v89
  v_exp_f32 v90, v90
  v_mfma_f32_32x32x16_bf16 v[112:127], v[176:179], v[144:147], v[112:127]
  s_waitcnt lgkmcnt(0)
  v_cvt_pk_bf16_f32 v148, v88, v89
  v_exp_f32 v91, v91
  v_exp_f32 v92, v92
  v_cvt_pk_bf16_f32 v149, v90, v91
  v_exp_f32 v93, v93
  v_exp_f32 v94, v94
  v_exp_f32 v95, v95
  v_cvt_pk_bf16_f32 v150, v92, v93
  v_cvt_pk_bf16_f32 v151, v94, v95
  v_mfma_f32_32x32x16_bf16 v[80:95], v[168:171], v[32:35], v[48:63]
  ds_read_b128 v[184:187], v2 offset:30720
  v_exp_f32 v96, v96
  v_exp_f32 v97, v97
  v_exp_f32 v98, v98
  v_mfma_f32_32x32x16_bf16 v[112:127], v[180:183], v[148:151], v[112:127]
  ds_read_b128 v[188:191], v2 offset:31744
  v_cvt_pk_bf16_f32 v152, v96, v97
  v_exp_f32 v99, v99
  v_exp_f32 v100, v100
  v_cvt_pk_bf16_f32 v153, v98, v99
  v_smfmac_f32_16x16x64_bf16 v[192:195], v[16:19], v[144:151], v13
  s_and_b32 s82, s82, 7
  v_exp_f32 v101, v101
  v_mfma_f32_32x32x16_bf16 v[80:95], v[172:175], v[36:39], v[80:95]
  v_xor_b32 v2, 32768, v2
  v_exp_f32 v102, v102
  v_cvt_pk_bf16_f32 v154, v100, v101
  v_exp_f32 v103, v103
  v_exp_f32 v104, v104
  v_cvt_pk_bf16_f32 v155, v102, v103
  v_exp_f32 v105, v105
  v_exp_f32 v106, v106
  v_mfma_f32_32x32x16_bf16 v[128:143], v[176:179], v[152:155], v[128:143]
  s_waitcnt lgkmcnt(0)
  v_cvt_pk_bf16_f32 v156, v104, v105
  v_exp_f32 v107, v107
  v_exp_f32 v108, v108
  v_cvt_pk_bf16_f32 v157, v106, v107
  v_exp_f32 v109, v109
  v_exp_f32 v110, v110
  v_exp_f32 v111, v111
  v_cvt_pk_bf16_f32 v158, v108, v109
  v_cvt_pk_bf16_f32 v159, v110, v111
  s_waitcnt vmcnt(7) lgkmcnt(0)
  s_barrier
  v_mfma_f32_32x32x16_bf16 v[96:111], v[168:171], v[40:43], v[64:79]
  ds_read_b128 v[160:163], v2 offset:0
  v_exp_f32 v80, v80
  v_exp_f32 v81, v81
  v_exp_f32 v82, v82
  v_mfma_f32_32x32x16_bf16 v[128:143], v[180:183], v[156:159], v[128:143]
  ds_read_b128 v[164:167], v2 offset:1024
  v_cvt_pk_bf16_f32 v144, v80, v81
  v_exp_f32 v83, v83
  v_exp_f32 v84, v84
  v_cvt_pk_bf16_f32 v145, v82, v83
  v_smfmac_f32_16x16x64_bf16 v[196:199], v[16:19], v[152:159], v13
  s_lshl_b32 s83, s82, 15
  v_exp_f32 v85, v85
  v_mfma_f32_32x32x16_bf16 v[96:111], v[172:175], v[44:47], v[96:111]
  s_add_u32 s83, s83, s81
  v_exp_f32 v86, v86
  v_cvt_pk_bf16_f32 v146, v84, v85
  v_exp_f32 v87, v87
  v_exp_f32 v88, v88
  v_cvt_pk_bf16_f32 v147, v86, v87
  v_exp_f32 v89, v89
  v_exp_f32 v90, v90
  v_mfma_f32_32x32x16_bf16 v[112:127], v[184:187], v[144:147], v[112:127]
  s_waitcnt lgkmcnt(0)
  v_cvt_pk_bf16_f32 v148, v88, v89
  v_exp_f32 v91, v91
  v_exp_f32 v92, v92
  v_cvt_pk_bf16_f32 v149, v90, v91
  v_exp_f32 v93, v93
  v_exp_f32 v94, v94
  v_exp_f32 v95, v95
  v_cvt_pk_bf16_f32 v150, v92, v93
  v_cvt_pk_bf16_f32 v151, v94, v95
  v_mfma_f32_32x32x16_bf16 v[80:95], v[160:163], v[32:35], v[48:63]
  ds_read_b128 v[176:179], v2 offset:2048
  v_exp_f32 v96, v96
  v_exp_f32 v97, v97
  v_exp_f32 v98, v98
  v_mfma_f32_32x32x16_bf16 v[112:127], v[188:191], v[148:151], v[112:127]
  ds_read_b128 v[180:183], v2 offset:3072
  v_cvt_pk_bf16_f32 v152, v96, v97
  v_exp_f32 v99, v99
  v_exp_f32 v100, v100
  v_cvt_pk_bf16_f32 v153, v98, v99
  v_smfmac_f32_16x16x64_bf16 v[192:195], v[16:19], v[144:151], v13
  v_exp_f32 v101, v101
  v_mfma_f32_32x32x16_bf16 v[80:95], v[164:167], v[36:39], v[80:95]
  v_exp_f32 v102, v102
  v_cvt_pk_bf16_f32 v154, v100, v101
  v_exp_f32 v103, v103
  v_exp_f32 v104, v104
  v_cvt_pk_bf16_f32 v155, v102, v103
  v_exp_f32 v105, v105
  v_exp_f32 v106, v106
  v_mfma_f32_32x32x16_bf16 v[128:143], v[184:187], v[152:155], v[128:143]
  s_waitcnt lgkmcnt(0)
  v_cvt_pk_bf16_f32 v156, v104, v105
  v_exp_f32 v107, v107
  v_exp_f32 v108, v108
  v_cvt_pk_bf16_f32 v157, v106, v107
  v_exp_f32 v109, v109
  v_exp_f32 v110, v110
  v_exp_f32 v111, v111
  v_cvt_pk_bf16_f32 v158, v108, v109
  v_cvt_pk_bf16_f32 v159, v110, v111
  v_mfma_f32_32x32x16_bf16 v[96:111], v[160:163], v[40:43], v[64:79]
  ds_read_b128 v[168:171], v2 offset:4096
  v_exp_f32 v80, v80
  v_exp_f32 v81, v81
  v_exp_f32 v82, v82
  v_mfma_f32_32x32x16_bf16 v[128:143], v[188:191], v[156:159], v[128:143]
  ds_read_b128 v[172:175], v2 offset:5120
  v_cvt_pk_bf16_f32 v144, v80, v81
  v_exp_f32 v83, v83
  v_exp_f32 v84, v84
  v_cvt_pk_bf16_f32 v145, v82, v83
  v_smfmac_f32_16x16x64_bf16 v[196:199], v[16:19], v[152:159], v13
  v_exp_f32 v85, v85
  v_mfma_f32_32x32x16_bf16 v[96:111], v[164:167], v[44:47], v[96:111]
  v_exp_f32 v86, v86
  v_cvt_pk_bf16_f32 v146, v84, v85
  v_exp_f32 v87, v87
  v_exp_f32 v88, v88
  v_cvt_pk_bf16_f32 v147, v86, v87
  v_exp_f32 v89, v89
  v_exp_f32 v90, v90
  v_mfma_f32_32x32x16_bf16 v[112:127], v[176:179], v[144:147], v[112:127]
  s_waitcnt lgkmcnt(0)
  v_cvt_pk_bf16_f32 v148, v88, v89
  v_exp_f32 v91, v91
  v_exp_f32 v92, v92
  v_cvt_pk_bf16_f32 v149, v90, v91
  v_exp_f32 v93, v93
  v_exp_f32 v94, v94
  v_exp_f32 v95, v95
  v_cvt_pk_bf16_f32 v150, v92, v93
  v_cvt_pk_bf16_f32 v151, v94, v95
  v_mfma_f32_32x32x16_bf16 v[80:95], v[168:171], v[32:35], v[48:63]
  ds_read_b128 v[184:187], v2 offset:6144
  v_exp_f32 v96, v96
  v_exp_f32 v97, v97
  v_exp_f32 v98, v98
  v_mfma_f32_32x32x16_bf16 v[112:127], v[180:183], v[148:151], v[112:127]
  ds_read_b128 v[188:191], v2 offset:7168
  v_cvt_pk_bf16_f32 v152, v96, v97
  v_exp_f32 v99, v99
  v_exp_f32 v100, v100
  v_cvt_pk_bf16_f32 v153, v98, v99
  v_smfmac_f32_16x16x64_bf16 v[192:195], v[16:19], v[144:151], v13
  s_mov_b32 m0, s85
  v_exp_f32 v101, v101
  v_mfma_f32_32x32x16_bf16 v[80:95], v[172:175], v[36:39], v[80:95]
  buffer_load_dwordx4 v3, s[20:23], s83 offen offset:0 sc1 lds
  v_exp_f32 v102, v102
  v_cvt_pk_bf16_f32 v154, v100, v101
  v_exp_f32 v103, v103
  v_exp_f32 v104, v104
  v_cvt_pk_bf16_f32 v155, v102, v103
  v_exp_f32 v105, v105
  v_exp_f32 v106, v106
  v_mfma_f32_32x32x16_bf16 v[128:143], v[176:179], v[152:155], v[128:143]
  s_waitcnt lgkmcnt(0)
  buffer_load_dwordx4 v3, s[20:23], s83 offen offset:1024 sc1 lds
  v_cvt_pk_bf16_f32 v156, v104, v105
  v_exp_f32 v107, v107
  v_exp_f32 v108, v108
  v_cvt_pk_bf16_f32 v157, v106, v107
  v_exp_f32 v109, v109
  v_exp_f32 v110, v110
  v_exp_f32 v111, v111
  v_cvt_pk_bf16_f32 v158, v108, v109
  v_cvt_pk_bf16_f32 v159, v110, v111
  v_mfma_f32_32x32x16_bf16 v[96:111], v[168:171], v[40:43], v[64:79]
  ds_read_b128 v[160:163], v2 offset:8192
  v_exp_f32 v80, v80
  v_exp_f32 v81, v81
  v_exp_f32 v82, v82
  v_mfma_f32_32x32x16_bf16 v[128:143], v[180:183], v[156:159], v[128:143]
  ds_read_b128 v[164:167], v2 offset:9216
  v_cvt_pk_bf16_f32 v144, v80, v81
  v_exp_f32 v83, v83
  v_exp_f32 v84, v84
  v_cvt_pk_bf16_f32 v145, v82, v83
  v_smfmac_f32_16x16x64_bf16 v[196:199], v[16:19], v[152:159], v13
  s_add_u32 s84, s83, 4096
  v_exp_f32 v85, v85
  v_mfma_f32_32x32x16_bf16 v[96:111], v[172:175], v[44:47], v[96:111]
  buffer_load_dwordx4 v3, s[20:23], s83 offen offset:2048 sc1 lds
  v_exp_f32 v86, v86
  v_cvt_pk_bf16_f32 v146, v84, v85
  v_exp_f32 v87, v87
  v_exp_f32 v88, v88
  v_cvt_pk_bf16_f32 v147, v86, v87
  v_exp_f32 v89, v89
  v_exp_f32 v90, v90
  v_mfma_f32_32x32x16_bf16 v[112:127], v[184:187], v[144:147], v[112:127]
  s_waitcnt lgkmcnt(0)
  buffer_load_dwordx4 v3, s[20:23], s83 offen offset:3072 sc1 lds
  v_cvt_pk_bf16_f32 v148, v88, v89
  v_exp_f32 v91, v91
  v_exp_f32 v92, v92
  v_cvt_pk_bf16_f32 v149, v90, v91
  v_exp_f32 v93, v93
  v_exp_f32 v94, v94
  v_exp_f32 v95, v95
  v_cvt_pk_bf16_f32 v150, v92, v93
  v_cvt_pk_bf16_f32 v151, v94, v95
  v_mfma_f32_32x32x16_bf16 v[80:95], v[160:163], v[32:35], v[48:63]
  ds_read_b128 v[176:179], v2 offset:10240
  v_exp_f32 v96, v96
  v_exp_f32 v97, v97
  v_exp_f32 v98, v98
  v_mfma_f32_32x32x16_bf16 v[112:127], v[188:191], v[148:151], v[112:127]
  ds_read_b128 v[180:183], v2 offset:11264
  v_cvt_pk_bf16_f32 v152, v96, v97
  v_exp_f32 v99, v99
  v_exp_f32 v100, v100
  v_cvt_pk_bf16_f32 v153, v98, v99
  v_smfmac_f32_16x16x64_bf16 v[192:195], v[16:19], v[144:151], v13
  s_add_u32 m0, s85, 4096
  v_exp_f32 v101, v101
  v_mfma_f32_32x32x16_bf16 v[80:95], v[164:167], v[36:39], v[80:95]
  buffer_load_dwordx4 v3, s[20:23], s84 offen offset:0 sc1 lds
  v_exp_f32 v102, v102
  v_cvt_pk_bf16_f32 v154, v100, v101
  v_exp_f32 v103, v103
  v_exp_f32 v104, v104
  v_cvt_pk_bf16_f32 v155, v102, v103
  v_exp_f32 v105, v105
  v_exp_f32 v106, v106
  v_mfma_f32_32x32x16_bf16 v[128:143], v[184:187], v[152:155], v[128:143]
  s_waitcnt lgkmcnt(0)
  buffer_load_dwordx4 v3, s[20:23], s84 offen offset:1024 sc1 lds
  v_cvt_pk_bf16_f32 v156, v104, v105
  v_exp_f32 v107, v107
  v_exp_f32 v108, v108
  v_cvt_pk_bf16_f32 v157, v106, v107
  v_exp_f32 v109, v109
  v_exp_f32 v110, v110
  v_exp_f32 v111, v111
  v_cvt_pk_bf16_f32 v158, v108, v109
  v_cvt_pk_bf16_f32 v159, v110, v111
  v_mfma_f32_32x32x16_bf16 v[96:111], v[160:163], v[40:43], v[64:79]
  ds_read_b128 v[168:171], v2 offset:12288
  v_exp_f32 v80, v80
  v_exp_f32 v81, v81
  v_exp_f32 v82, v82
  v_mfma_f32_32x32x16_bf16 v[128:143], v[188:191], v[156:159], v[128:143]
  ds_read_b128 v[172:175], v2 offset:13312
  v_cvt_pk_bf16_f32 v144, v80, v81
  v_exp_f32 v83, v83
  v_exp_f32 v84, v84
  v_cvt_pk_bf16_f32 v145, v82, v83
  v_smfmac_f32_16x16x64_bf16 v[196:199], v[16:19], v[152:159], v13
  v_exp_f32 v85, v85
  v_mfma_f32_32x32x16_bf16 v[96:111], v[164:167], v[44:47], v[96:111]
  buffer_load_dwordx4 v3, s[20:23], s84 offen offset:2048 sc1 lds
  v_exp_f32 v86, v86
  v_cvt_pk_bf16_f32 v146, v84, v85
  v_exp_f32 v87, v87
  v_exp_f32 v88, v88
  v_cvt_pk_bf16_f32 v147, v86, v87
  v_exp_f32 v89, v89
  v_exp_f32 v90, v90
  v_mfma_f32_32x32x16_bf16 v[112:127], v[176:179], v[144:147], v[112:127]
  s_waitcnt lgkmcnt(0)
  buffer_load_dwordx4 v3, s[20:23], s84 offen offset:3072 sc1 lds
  v_cvt_pk_bf16_f32 v148, v88, v89
  v_exp_f32 v91, v91
  v_exp_f32 v92, v92
  v_cvt_pk_bf16_f32 v149, v90, v91
  v_exp_f32 v93, v93
  v_exp_f32 v94, v94
  v_exp_f32 v95, v95
  v_cvt_pk_bf16_f32 v150, v92, v93
  v_cvt_pk_bf16_f32 v151, v94, v95
  v_mfma_f32_32x32x16_bf16 v[80:95], v[168:171], v[32:35], v[48:63]
  ds_read_b128 v[184:187], v2 offset:14336
  v_exp_f32 v96, v96
  v_exp_f32 v97, v97
  v_exp_f32 v98, v98
  v_mfma_f32_32x32x16_bf16 v[112:127], v[180:183], v[148:151], v[112:127]
  ds_read_b128 v[188:191], v2 offset:15360
  v_cvt_pk_bf16_f32 v152, v96, v97
  v_exp_f32 v99, v99
  v_exp_f32 v100, v100
  v_cvt_pk_bf16_f32 v153, v98, v99
  v_smfmac_f32_16x16x64_bf16 v[192:195], v[16:19], v[144:151], v13
  s_xor_b32 s85, s85, 32768
  v_exp_f32 v101, v101
  v_mfma_f32_32x32x16_bf16 v[80:95], v[172:175], v[36:39], v[80:95]
  buffer_store_dwordx4 v[224:227], v4, s[20:23], s70 offen offset:2048 sc1
  v_exp_f32 v102, v102
  v_cvt_pk_bf16_f32 v154, v100, v101
  v_exp_f32 v103, v103
  v_exp_f32 v104, v104
  v_cvt_pk_bf16_f32 v155, v102, v103
  v_exp_f32 v105, v105
  v_exp_f32 v106, v106
  v_mfma_f32_32x32x16_bf16 v[128:143], v[176:179], v[152:155], v[128:143]
  s_waitcnt lgkmcnt(0)
  v_cvt_pk_bf16_f32 v156, v104, v105
  v_exp_f32 v107, v107
  v_exp_f32 v108, v108
  v_cvt_pk_bf16_f32 v157, v106, v107
  v_exp_f32 v109, v109
  v_exp_f32 v110, v110
  v_exp_f32 v111, v111
  v_cvt_pk_bf16_f32 v158, v108, v109
  v_cvt_pk_bf16_f32 v159, v110, v111
  v_mfma_f32_32x32x16_bf16 v[96:111], v[168:171], v[40:43], v[64:79]
  ds_read_b128 v[160:163], v2 offset:16384
  v_exp_f32 v80, v80
  v_exp_f32 v81, v81
  v_exp_f32 v82, v82
  v_mfma_f32_32x32x16_bf16 v[128:143], v[180:183], v[156:159], v[128:143]
  ds_read_b128 v[164:167], v2 offset:17408
  v_cvt_pk_bf16_f32 v144, v80, v81
  v_exp_f32 v83, v83
  v_exp_f32 v84, v84
  v_cvt_pk_bf16_f32 v145, v82, v83
  v_smfmac_f32_16x16x64_bf16 v[196:199], v[16:19], v[152:159], v13
  v_exp_f32 v85, v85
  v_mfma_f32_32x32x16_bf16 v[96:111], v[172:175], v[44:47], v[96:111]
  buffer_store_dwordx4 v[220:223], v4, s[20:23], s72 offen offset:1024 sc1
  v_exp_f32 v86, v86
  v_cvt_pk_bf16_f32 v146, v84, v85
  v_exp_f32 v87, v87
  v_exp_f32 v88, v88
  v_cvt_pk_bf16_f32 v147, v86, v87
  v_exp_f32 v89, v89
  v_exp_f32 v90, v90
  v_mfma_f32_32x32x16_bf16 v[112:127], v[184:187], v[144:147], v[112:127]
  s_waitcnt lgkmcnt(0)
  v_cvt_pk_bf16_f32 v148, v88, v89
  v_exp_f32 v91, v91
  v_exp_f32 v92, v92
  v_cvt_pk_bf16_f32 v149, v90, v91
  v_exp_f32 v93, v93
  v_exp_f32 v94, v94
  v_exp_f32 v95, v95
  v_cvt_pk_bf16_f32 v150, v92, v93
  v_cvt_pk_bf16_f32 v151, v94, v95
  v_mfma_f32_32x32x16_bf16 v[80:95], v[160:163], v[32:35], v[48:63]
  ds_read_b128 v[176:179], v2 offset:18432
  v_exp_f32 v96, v96
  v_exp_f32 v97, v97
  v_exp_f32 v98, v98
  v_mfma_f32_32x32x16_bf16 v[112:127], v[188:191], v[148:151], v[112:127]
  ds_read_b128 v[180:183], v2 offset:19456
  v_cvt_pk_bf16_f32 v152, v96, v97
  v_exp_f32 v99, v99
  v_exp_f32 v100, v100
  v_cvt_pk_bf16_f32 v153, v98, v99
  v_smfmac_f32_16x16x64_bf16 v[192:195], v[16:19], v[144:151], v13
  v_exp_f32 v101, v101
  v_mfma_f32_32x32x16_bf16 v[80:95], v[164:167], v[36:39], v[80:95]
  buffer_store_dwordx4 v[216:219], v4, s[20:23], s70 offen offset:1024 sc1
  v_exp_f32 v102, v102
  v_cvt_pk_bf16_f32 v154, v100, v101
  v_exp_f32 v103, v103
  v_exp_f32 v104, v104
  v_cvt_pk_bf16_f32 v155, v102, v103
  v_exp_f32 v105, v105
  v_exp_f32 v106, v106
  v_mfma_f32_32x32x16_bf16 v[128:143], v[184:187], v[152:155], v[128:143]
  s_waitcnt lgkmcnt(0)
  v_cvt_pk_bf16_f32 v156, v104, v105
  v_exp_f32 v107, v107
  v_exp_f32 v108, v108
  v_cvt_pk_bf16_f32 v157, v106, v107
L_touch3:
  s_cbranch_execz L_tdisp3
  v_exp_f32 v109, v109
  v_exp_f32 v110, v110
  v_exp_f32 v111, v111
  v_cvt_pk_bf16_f32 v158, v108, v109
  v_cvt_pk_bf16_f32 v159, v110, v111
  v_mfma_f32_32x32x16_bf16 v[96:111], v[160:163], v[40:43], v[64:79]
  ds_read_b128 v[168:171], v2 offset:20480
  v_exp_f32 v80, v80
  v_exp_f32 v81, v81
  v_exp_f32 v82, v82
  v_mfma_f32_32x32x16_bf16 v[128:143], v[188:191], v[156:159], v[128:143]
  ds_read_b128 v[172:175], v2 offset:21504
  v_cvt_pk_bf16_f32 v144, v80, v81
  v_exp_f32 v83, v83
  v_exp_f32 v84, v84
  v_cvt_pk_bf16_f32 v145, v82, v83
  v_smfmac_f32_16x16x64_bf16 v[196:199], v[16:19], v[152:159], v13
  v_exp_f32 v85, v85
  v_mfma_f32_32x32x16_bf16 v[96:111], v[164:167], v[44:47], v[96:111]
  buffer_store_dwordx4 v[212:215], v4, s[20:23], s72 offen offset:0 sc1
  v_exp_f32 v86, v86
  v_cvt_pk_bf16_f32 v146, v84, v85
  v_exp_f32 v87, v87
  v_exp_f32 v88, v88
  v_cvt_pk_bf16_f32 v147, v86, v87
  v_exp_f32 v89, v89
  v_exp_f32 v90, v90
  v_mfma_f32_32x32x16_bf16 v[112:127], v[176:179], v[144:147], v[112:127]
  s_waitcnt lgkmcnt(0)
  v_cvt_pk_bf16_f32 v148, v88, v89
  v_exp_f32 v91, v91
  v_exp_f32 v92, v92
  v_cvt_pk_bf16_f32 v149, v90, v91
  v_exp_f32 v93, v93
  v_exp_f32 v94, v94
  v_exp_f32 v95, v95
  v_cvt_pk_bf16_f32 v150, v92, v93
  v_cvt_pk_bf16_f32 v151, v94, v95
  v_mfma_f32_32x32x16_bf16 v[80:95], v[168:171], v[32:35], v[48:63]
  ds_read_b128 v[184:187], v2 offset:22528
  v_exp_f32 v96, v96
  v_exp_f32 v97, v97
  v_exp_f32 v98, v98
  v_mfma_f32_32x32x16_bf16 v[112:127], v[180:183], v[148:151], v[112:127]
  ds_read_b128 v[188:191], v2 offset:23552
  v_cvt_pk_bf16_f32 v152, v96, v97
  v_exp_f32 v99, v99
  v_exp_f32 v100, v100
  v_cvt_pk_bf16_f32 v153, v98, v99
  v_smfmac_f32_16x16x64_bf16 v[192:195], v[16:19], v[144:151], v13
  v_exp_f32 v101, v101
  v_mfma_f32_32x32x16_bf16 v[80:95], v[172:175], v[36:39], v[80:95]
  buffer_store_dwordx4 v[208:211], v4, s[20:23], s70 offen offset:0 sc1
  v_exp_f32 v102, v102
  v_cvt_pk_bf16_f32 v154, v100, v101
  v_exp_f32 v103, v103
  v_exp_f32 v104, v104
  v_cvt_pk_bf16_f32 v155, v102, v103
  v_exp_f32 v105, v105
  v_exp_f32 v106, v106
  v_mfma_f32_32x32x16_bf16 v[128:143], v[176:179], v[152:155], v[128:143]
  s_waitcnt lgkmcnt(0)
  v_cvt_pk_bf16_f32 v156, v104, v105
  v_exp_f32 v107, v107
  v_exp_f32 v108, v108
  v_cvt_pk_bf16_f32 v157, v106, v107
  v_exp_f32 v109, v109
  v_exp_f32 v110, v110
  v_exp_f32 v111, v111
  v_cvt_pk_bf16_f32 v158, v108, v109
  v_cvt_pk_bf16_f32 v159, v110, v111
  v_mfma_f32_32x32x16_bf16 v[96:111], v[168:171], v[40:43], v[64:79]
  ds_read_b128 v[160:163], v2 offset:24576
  v_exp_f32 v80, v80
  v_exp_f32 v81, v81
  v_exp_f32 v82, v82
  v_mfma_f32_32x32x16_bf16 v[128:143], v[180:183], v[156:159], v[128:143]
  ds_read_b128 v[164:167], v2 offset:25600
  v_cvt_pk_bf16_f32 v144, v80, v81
  v_exp_f32 v83, v83
  v_exp_f32 v84, v84
  v_cvt_pk_bf16_f32 v145, v82, v83
  v_smfmac_f32_16x16x64_bf16 v[196:199], v[16:19], v[152:159], v13
  v_exp_f32 v85, v85
  v_mfma_f32_32x32x16_bf16 v[96:111], v[172:175], v[44:47], v[96:111]
  buffer_store_dwordx4 v[204:207], v4, s[20:23], s73 offen offset:2048 sc1
  v_exp_f32 v86, v86
  v_cvt_pk_bf16_f32 v146, v84, v85
  v_exp_f32 v87, v87
  v_exp_f32 v88, v88
  v_cvt_pk_bf16_f32 v147, v86, v87
  v_exp_f32 v89, v89
  v_exp_f32 v90, v90
  v_mfma_f32_32x32x16_bf16 v[112:127], v[184:187], v[144:147], v[112:127]
  s_waitcnt lgkmcnt(0)
  v_cvt_pk_bf16_f32 v148, v88, v89
  v_exp_f32 v91, v91
  v_exp_f32 v92, v92
  v_cvt_pk_bf16_f32 v149, v90, v91
  v_exp_f32 v93, v93
  v_exp_f32 v94, v94
  v_exp_f32 v95, v95
  v_cvt_pk_bf16_f32 v150, v92, v93
  v_cvt_pk_bf16_f32 v151, v94, v95
  v_mfma_f32_32x32x16_bf16 v[80:95], v[160:163], v[32:35], v[48:63]
  ds_read_b128 v[176:179], v2 offset:26624
  v_exp_f32 v96, v96
  v_exp_f32 v97, v97
  v_exp_f32 v98, v98
  v_mfma_f32_32x32x16_bf16 v[112:127], v[188:191], v[148:151], v[112:127]
  ds_read_b128 v[180:183], v2 offset:27648
  v_cvt_pk_bf16_f32 v152, v96, v97
  v_exp_f32 v99, v99
  v_exp_f32 v100, v100
  v_cvt_pk_bf16_f32 v153, v98, v99
  v_smfmac_f32_16x16x64_bf16 v[192:195], v[16:19], v[144:151], v13
  v_exp_f32 v101, v101
  v_mfma_f32_32x32x16_bf16 v[80:95], v[164:167], v[36:39], v[80:95]
  buffer_store_dwordx4 v[200:203], v4, s[20:23], s71 offen offset:2048 sc1
  v_exp_f32 v102, v102
  v_cvt_pk_bf16_f32 v154, v100, v101
  v_exp_f32 v103, v103
  v_exp_f32 v104, v104
  v_cvt_pk_bf16_f32 v155, v102, v103
  v_exp_f32 v105, v105
  v_exp_f32 v106, v106
  v_mfma_f32_32x32x16_bf16 v[128:143], v[184:187], v[152:155], v[128:143]
  s_waitcnt lgkmcnt(0)
  v_cvt_pk_bf16_f32 v156, v104, v105
  v_exp_f32 v107, v107
  v_exp_f32 v108, v108
  v_cvt_pk_bf16_f32 v157, v106, v107
  v_exp_f32 v109, v109
  v_exp_f32 v110, v110
  v_exp_f32 v111, v111
  v_cvt_pk_bf16_f32 v158, v108, v109
  v_cvt_pk_bf16_f32 v159, v110, v111
  v_mfma_f32_32x32x16_bf16 v[96:111], v[160:163], v[40:43], v[64:79]
  ds_read_b128 v[168:171], v2 offset:28672
  v_exp_f32 v80, v80
  v_exp_f32 v81, v81
  v_exp_f32 v82, v82
  v_mfma_f32_32x32x16_bf16 v[128:143], v[188:191], v[156:159], v[128:143]
  ds_read_b128 v[172:175], v2 offset:29696
  v_cvt_pk_bf16_f32 v144, v80, v81
  v_exp_f32 v83, v83
  v_exp_f32 v84, v84
  v_cvt_pk_bf16_f32 v145, v82, v83
  v_smfmac_f32_16x16x64_bf16 v[196:199], v[16:19], v[152:159], v13
  s_add_u32 s82, s82, 1
  v_exp_f32 v85, v85
  v_mfma_f32_32x32x16_bf16 v[96:111], v[164:167], v[44:47], v[96:111]
  v_exp_f32 v86, v86
  v_cvt_pk_bf16_f32 v146, v84, v85
  v_exp_f32 v87, v87
  v_exp_f32 v88, v88
  v_cvt_pk_bf16_f32 v147, v86, v87
  v_exp_f32 v89, v89
  v_exp_f32 v90, v90
  v_mfma_f32_32x32x16_bf16 v[112:127], v[176:179], v[144:147], v[112:127]
  s_waitcnt lgkmcnt(0)
  v_cvt_pk_bf16_f32 v148, v88, v89
  v_exp_f32 v91, v91
  v_exp_f32 v92, v92
  v_cvt_pk_bf16_f32 v149, v90, v91
  v_exp_f32 v93, v93
  v_exp_f32 v94, v94
  v_exp_f32 v95, v95
  v_cvt_pk_bf16_f32 v150, v92, v93
  v_cvt_pk_bf16_f32 v151, v94, v95
  v_mfma_f32_32x32x16_bf16 v[80:95], v[168:171], v[32:35], v[48:63]
  ds_read_b128 v[184:187], v2 offset:30720
  v_exp_f32 v96, v96
  v_exp_f32 v97, v97
  v_exp_f32 v98, v98
  v_mfma_f32_32x32x16_bf16 v[112:127], v[180:183], v[148:151], v[112:127]
  ds_read_b128 v[188:191], v2 offset:31744
  v_cvt_pk_bf16_f32 v152, v96, v97
  v_exp_f32 v99, v99
  v_exp_f32 v100, v100
  v_cvt_pk_bf16_f32 v153, v98, v99
  v_smfmac_f32_16x16x64_bf16 v[192:195], v[16:19], v[144:151], v13
  s_and_b32 s82, s82, 7
  v_exp_f32 v101, v101
  v_mfma_f32_32x32x16_bf16 v[80:95], v[172:175], v[36:39], v[80:95]
  v_xor_b32 v2, 32768, v2
  v_exp_f32 v102, v102
  v_cvt_pk_bf16_f32 v154, v100, v101
  v_exp_f32 v103, v103
  v_exp_f32 v104, v104
  v_cvt_pk_bf16_f32 v155, v102, v103
  v_exp_f32 v105, v105
  v_exp_f32 v106, v106
  v_mfma_f32_32x32x16_bf16 v[128:143], v[176:179], v[152:155], v[128:143]
  s_waitcnt lgkmcnt(0)
  v_cvt_pk_bf16_f32 v156, v104, v105
  v_exp_f32 v107, v107
  v_exp_f32 v108, v108
  v_cvt_pk_bf16_f32 v157, v106, v107
  v_exp_f32 v109, v109
  v_exp_f32 v110, v110
  v_exp_f32 v111, v111
  v_cvt_pk_bf16_f32 v158, v108, v109
  v_cvt_pk_bf16_f32 v159, v110, v111
  s_waitcnt vmcnt(0) lgkmcnt(0)
  s_barrier
  s_cmp_lg_u32 s3, 0
  s_cbranch_scc1 L_sig11
  s_mov_b64 exec, 1
  v_mov_b32 v5, 3
  buffer_store_dword v5, off, s[20:23], s69 sc1
  s_mov_b64 exec, -1
L_sig11:
  v_mfma_f32_32x32x16_bf16 v[96:111], v[168:171], v[40:43], v[64:79]
  ds_read_b128 v[160:163], v2 offset:0
  v_exp_f32 v80, v80
  v_exp_f32 v81, v81
  v_exp_f32 v82, v82
  v_mfma_f32_32x32x16_bf16 v[128:143], v[180:183], v[156:159], v[128:143]
  ds_read_b128 v[164:167], v2 offset:1024
  v_cvt_pk_bf16_f32 v144, v80, v81
  v_exp_f32 v83, v83
  v_exp_f32 v84, v84
  v_cvt_pk_bf16_f32 v145, v82, v83
  v_smfmac_f32_16x16x64_bf16 v[196:199], v[16:19], v[152:159], v13
  s_mov_b32 s86, 3
  s_lshl_b32 s83, s82, 15
  v_exp_f32 v85, v85
  v_mfma_f32_32x32x16_bf16 v[96:111], v[172:175], v[44:47], v[96:111]
  s_add_u32 s83, s83, s81
  v_exp_f32 v86, v86
  v_cvt_pk_bf16_f32 v146, v84, v85
  v_exp_f32 v87, v87
  v_exp_f32 v88, v88
  v_cvt_pk_bf16_f32 v147, v86, v87
  v_exp_f32 v89, v89
  v_exp_f32 v90, v90
  v_mfma_f32_32x32x16_bf16 v[112:127], v[184:187], v[144:147], v[112:127]
  s_waitcnt lgkmcnt(0)
  v_cvt_pk_bf16_f32 v148, v88, v89
  v_exp_f32 v91, v91
  v_exp_f32 v92, v92
  v_cvt_pk_bf16_f32 v149, v90, v91
  v_exp_f32 v93, v93
  v_exp_f32 v94, v94
  v_exp_f32 v95, v95
  v_cvt_pk_bf16_f32 v150, v92, v93
  v_cvt_pk_bf16_f32 v151, v94, v95
  v_mfma_f32_32x32x16_bf16 v[80:95], v[160:163], v[32:35], v[48:63]
  ds_read_b128 v[176:179], v2 offset:2048
  v_exp_f32 v96, v96
  v_exp_f32 v97, v97
  v_exp_f32 v98, v98
  v_mfma_f32_32x32x16_bf16 v[112:127], v[188:191], v[148:151], v[112:127]
  ds_read_b128 v[180:183], v2 offset:3072
  v_cvt_pk_bf16_f32 v152, v96, v97
  v_exp_f32 v99, v99
  v_exp_f32 v100, v100
  v_cvt_pk_bf16_f32 v153, v98, v99
  v_smfmac_f32_16x16x64_bf16 v[192:195], v[16:19], v[144:151], v13
  v_accvgpr_read_b32 v7, a244
  v_exp_f32 v101, v101
  v_mfma_f32_32x32x16_bf16 v[80:95], v[164:167], v[36:39], v[80:95]
  v_accvgpr_read_b32 v14, a245
  v_exp_f32 v102, v102
  v_cvt_pk_bf16_f32 v154, v100, v101
  v_exp_f32 v103, v103
  v_exp_f32 v104, v104
  v_cvt_pk_bf16_f32 v155, v102, v103
  v_exp_f32 v105, v105
  v_exp_f32 v106, v106
  v_mfma_f32_32x32x16_bf16 v[128:143], v[184:187], v[152:155], v[128:143]
  s_waitcnt lgkmcnt(0)
  v_cvt_pk_bf16_f32 v156, v104, v105
  v_exp_f32 v107, v107
  v_exp_f32 v108, v108
  v_cvt_pk_bf16_f32 v157, v106, v107
  v_exp_f32 v109, v109
  v_exp_f32 v110, v110
  v_exp_f32 v111, v111
  v_cvt_pk_bf16_f32 v158, v108, v109
  v_cvt_pk_bf16_f32 v159, v110, v111
.p2align 3
L_att2:
  v_mfma_f32_32x32x16_bf16 v[96:111], v[160:163], v[40:43], v[64:79]
  ds_read_b128 v[168:171], v2 offset:4096
  v_exp_f32 v80, v80
  v_exp_f32 v81, v81
  v_exp_f32 v82, v82
  v_mfma_f32_32x32x16_bf16 v[128:143], v[188:191], v[156:159], v[128:143]
  ds_read_b128 v[172:175], v2 offset:5120
  v_cvt_pk_bf16_f32 v144, v80, v81
  v_exp_f32 v83, v83
  v_exp_f32 v84, v84
  v_cvt_pk_bf16_f32 v145, v82, v83
  v_smfmac_f32_16x16x64_bf16 v[196:199], v[16:19], v[152:159], v13
  v_exp_f32 v85, v85
  v_mfma_f32_32x32x16_bf16 v[96:111], v[164:167], v[44:47], v[96:111]
  v_exp_f32 v86, v86
  v_cvt_pk_bf16_f32 v146, v84, v85
  v_exp_f32 v87, v87
  v_exp_f32 v88, v88
  v_cvt_pk_bf16_f32 v147, v86, v87
  v_exp_f32 v89, v89
  v_exp_f32 v90, v90
  v_mfma_f32_32x32x16_bf16 v[112:127], v[176:179], v[144:147], v[112:127]
  s_waitcnt lgkmcnt(0)
  v_cvt_pk_bf16_f32 v148, v88, v89
  v_exp_f32 v91, v91
  v_exp_f32 v92, v92
  v_cvt_pk_bf16_f32 v149, v90, v91
  v_exp_f32 v93, v93
  v_exp_f32 v94, v94
  v_exp_f32 v95, v95
  v_cvt_pk_bf16_f32 v150, v92, v93
  v_cvt_pk_bf16_f32 v151, v94, v95
  v_mfma_f32_32x32x16_bf16 v[80:95], v[168:171], v[32:35], v[48:63]
  ds_read_b128 v[184:187], v2 offset:6144
  v_exp_f32 v96, v96
  v_exp_f32 v97, v97
  v_exp_f32 v98, v98
  v_mfma_f32_32x32x16_bf16 v[112:127], v[180:183], v[148:151], v[112:127]
  ds_read_b128 v[188:191], v2 offset:7168
  v_cvt_pk_bf16_f32 v152, v96, v97
  v_exp_f32 v99, v99
  v_exp_f32 v100, v100
  v_cvt_pk_bf16_f32 v153, v98, v99
  v_smfmac_f32_16x16x64_bf16 v[192:195], v[16:19], v[144:151], v13
  s_mov_b32 m0, s85
  v_exp_f32 v101, v101
  v_mfma_f32_32x32x16_bf16 v[80:95], v[172:175], v[36:39], v[80:95]
  buffer_load_dwordx4 v3, s[20:23], s83 offen offset:0 sc1 lds
  v_exp_f32 v102, v102
  v_cvt_pk_bf16_f32 v154, v100, v101
  v_exp_f32 v103, v103
  v_exp_f32 v104, v104
  v_cvt_pk_bf16_f32 v155, v102, v103
  v_exp_f32 v105, v105
  v_exp_f32 v106, v106
  v_mfma_f32_32x32x16_bf16 v[128:143], v[176:179], v[152:155], v[128:143]
  s_waitcnt lgkmcnt(0)
  buffer_load_dwordx4 v3, s[20:23], s83 offen offset:1024 sc1 lds
  v_cvt_pk_bf16_f32 v156, v104, v105
  v_exp_f32 v107, v107
  v_exp_f32 v108, v108
  v_cvt_pk_bf16_f32 v157, v106, v107
  v_exp_f32 v109, v109
  v_exp_f32 v110, v110
  v_exp_f32 v111, v111
  v_cvt_pk_bf16_f32 v158, v108, v109
  v_cvt_pk_bf16_f32 v159, v110, v111
  v_mfma_f32_32x32x16_bf16 v[96:111], v[168:171], v[40:43], v[64:79]
  ds_read_b128 v[160:163], v2 offset:8192
  v_exp_f32 v80, v80
  v_exp_f32 v81, v81
  v_exp_f32 v82, v82
  v_mfma_f32_32x32x16_bf16 v[128:143], v[180:183], v[156:159], v[128:143]
  ds_read_b128 v[164:167], v2 offset:9216
  v_cvt_pk_bf16_f32 v144, v80, v81
  v_exp_f32 v83, v83
  v_exp_f32 v84, v84
  v_cvt_pk_bf16_f32 v145, v82, v83
  v_smfmac_f32_16x16x64_bf16 v[196:199], v[16:19], v[152:159], v13
  s_add_u32 s84, s83, 4096
  v_exp_f32 v85, v85
  v_mfma_f32_32x32x16_bf16 v[96:111], v[172:175], v[44:47], v[96:111]
  buffer_load_dwordx4 v3, s[20:23], s83 offen offset:2048 sc1 lds
  v_exp_f32 v86, v86
  v_cvt_pk_bf16_f32 v146, v84, v85
  v_exp_f32 v87, v87
  v_exp_f32 v88, v88
  v_cvt_pk_bf16_f32 v147, v86, v87
  v_exp_f32 v89, v89
  v_exp_f32 v90, v90
  v_mfma_f32_32x32x16_bf16 v[112:127], v[184:187], v[144:147], v[112:127]
  s_waitcnt lgkmcnt(0)
  buffer_load_dwordx4 v3, s[20:23], s83 offen offset:3072 sc1 lds
  v_cvt_pk_bf16_f32 v148, v88, v89
  v_exp_f32 v91, v91
  v_exp_f32 v92, v92
  v_cvt_pk_bf16_f32 v149, v90, v91
  v_exp_f32 v93, v93
  v_exp_f32 v94, v94
  v_exp_f32 v95, v95
  v_cvt_pk_bf16_f32 v150, v92, v93
  v_cvt_pk_bf16_f32 v151, v94, v95
  v_mfma_f32_32x32x16_bf16 v[80:95], v[160:163], v[32:35], v[48:63]
  ds_read_b128 v[176:179], v2 offset:10240
  v_exp_f32 v96, v96
  v_exp_f32 v97, v97
  v_exp_f32 v98, v98
  v_mfma_f32_32x32x16_bf16 v[112:127], v[188:191], v[148:151], v[112:127]
  ds_read_b128 v[180:183], v2 offset:11264
  v_cvt_pk_bf16_f32 v152, v96, v97
  v_exp_f32 v99, v99
  v_exp_f32 v100, v100
  v_cvt_pk_bf16_f32 v153, v98, v99
  v_smfmac_f32_16x16x64_bf16 v[192:195], v[16:19], v[144:151], v13
  s_add_u32 m0, s85, 4096
  v_exp_f32 v101, v101
  v_mfma_f32_32x32x16_bf16 v[80:95], v[164:167], v[36:39], v[80:95]
  buffer_load_dwordx4 v3, s[20:23], s84 offen offset:0 sc1 lds
  v_exp_f32 v102, v102
  v_cvt_pk_bf16_f32 v154, v100, v101
  v_exp_f32 v103, v103
  v_exp_f32 v104, v104
  v_cvt_pk_bf16_f32 v155, v102, v103
  v_exp_f32 v105, v105
  v_exp_f32 v106, v106
  v_mfma_f32_32x32x16_bf16 v[128:143], v[184:187], v[152:155], v[128:143]
  s_waitcnt lgkmcnt(0)
  buffer_load_dwordx4 v3, s[20:23], s84 offen offset:1024 sc1 lds
  v_cvt_pk_bf16_f32 v156, v104, v105
  v_exp_f32 v107, v107
  v_exp_f32 v108, v108
  v_cvt_pk_bf16_f32 v157, v106, v107
  v_exp_f32 v109, v109
  v_exp_f32 v110, v110
  v_exp_f32 v111, v111
  v_cvt_pk_bf16_f32 v158, v108, v109
  v_cvt_pk_bf16_f32 v159, v110, v111
  v_mfma_f32_32x32x16_bf16 v[96:111], v[160:163], v[40:43], v[64:79]
  ds_read_b128 v[168:171], v2 offset:12288
  v_exp_f32 v80, v80
  v_exp_f32 v81, v81
  v_exp_f32 v82, v82
  v_mfma_f32_32x32x16_bf16 v[128:143], v[188:191], v[156:159], v[128:143]
  ds_read_b128 v[172:175], v2 offset:13312
  v_cvt_pk_bf16_f32 v144, v80, v81
  v_exp_f32 v83, v83
  v_exp_f32 v84, v84
  v_cvt_pk_bf16_f32 v145, v82, v83
  v_smfmac_f32_16x16x64_bf16 v[196:199], v[16:19], v[152:159], v13
  v_exp_f32 v85, v85
  v_mfma_f32_32x32x16_bf16 v[96:111], v[164:167], v[44:47], v[96:111]
  buffer_load_dwordx4 v3, s[20:23], s84 offen offset:2048 sc1 lds
  v_exp_f32 v86, v86
  v_cvt_pk_bf16_f32 v146, v84, v85
  v_exp_f32 v87, v87
  v_exp_f32 v88, v88
  v_cvt_pk_bf16_f32 v147, v86, v87
  v_exp_f32 v89, v89
  v_exp_f32 v90, v90
  v_mfma_f32_32x32x16_bf16 v[112:127], v[176:179], v[144:147], v[112:127]
  s_waitcnt lgkmcnt(0)
  buffer_load_dwordx4 v3, s[20:23], s84 offen offset:3072 sc1 lds
  v_cvt_pk_bf16_f32 v148, v88, v89
  v_exp_f32 v91, v91
  v_exp_f32 v92, v92
  v_cvt_pk_bf16_f32 v149, v90, v91
  v_exp_f32 v93, v93
  v_exp_f32 v94, v94
  v_exp_f32 v95, v95
  v_cvt_pk_bf16_f32 v150, v92, v93
  v_cvt_pk_bf16_f32 v151, v94, v95
  v_mfma_f32_32x32x16_bf16 v[80:95], v[168:171], v[32:35], v[48:63]
  ds_read_b128 v[184:187], v2 offset:14336
  v_exp_f32 v96, v96
  v_exp_f32 v97, v97
  v_exp_f32 v98, v98
  v_mfma_f32_32x32x16_bf16 v[112:127], v[180:183], v[148:151], v[112:127]
  ds_read_b128 v[188:191], v2 offset:15360
  v_cvt_pk_bf16_f32 v152, v96, v97
  v_exp_f32 v99, v99
  v_exp_f32 v100, v100
  v_cvt_pk_bf16_f32 v153, v98, v99
  v_smfmac_f32_16x16x64_bf16 v[192:195], v[16:19], v[144:151], v13
  s_xor_b32 s85, s85, 32768
  v_exp_f32 v101, v101
  v_mfma_f32_32x32x16_bf16 v[80:95], v[172:175], v[36:39], v[80:95]
  buffer_load_dword v15, v7, s[24:27], s95 offen
  v_exp_f32 v102, v102
  v_cvt_pk_bf16_f32 v154, v100, v101
  v_exp_f32 v103, v103
  v_exp_f32 v104, v104
  v_cvt_pk_bf16_f32 v155, v102, v103
  v_exp_f32 v105, v105
  v_exp_f32 v106, v106
  v_mfma_f32_32x32x16_bf16 v[128:143], v[176:179], v[152:155], v[128:143]
  s_waitcnt lgkmcnt(0)
  buffer_load_dword v15, v14, s[28:31], s101 offen
  v_cvt_pk_bf16_f32 v156, v104, v105
  v_exp_f32 v107, v107
  v_exp_f32 v108, v108
  v_cvt_pk_bf16_f32 v157, v106, v107
  v_exp_f32 v109, v109
  v_exp_f32 v110, v110
  v_exp_f32 v111, v111
  v_cvt_pk_bf16_f32 v158, v108, v109
  v_cvt_pk_bf16_f32 v159, v110, v111
  v_mfma_f32_32x32x16_bf16 v[96:111], v[168:171], v[40:43], v[64:79]
  ds_read_b128 v[160:163], v2 offset:16384
  v_exp_f32 v80, v80
  v_exp_f32 v81, v81
  v_exp_f32 v82, v82
  v_mfma_f32_32x32x16_bf16 v[128:143], v[180:183], v[156:159], v[128:143]
  ds_read_b128 v[164:167], v2 offset:17408
  v_cvt_pk_bf16_f32 v144, v80, v81
  v_exp_f32 v83, v83
  v_exp_f32 v84, v84
  v_cvt_pk_bf16_f32 v145, v82, v83
  v_smfmac_f32_16x16x64_bf16 v[196:199], v[16:19], v[152:159], v13
  s_mov_b32 m0, s89
  s_add_u32 s95, s95, 2432
  v_exp_f32 v85, v85
  v_mfma_f32_32x32x16_bf16 v[96:111], v[172:175], v[44:47], v[96:111]
  buffer_load_dwordx4 v8, s[24:27], s87 offen offset:0 lds
  s_add_u32 s101, s101, 768
  v_exp_f32 v86, v86
  v_cvt_pk_bf16_f32 v146, v84, v85
  v_exp_f32 v87, v87
  v_exp_f32 v88, v88
  v_cvt_pk_bf16_f32 v147, v86, v87
  v_exp_f32 v89, v89
  v_exp_f32 v90, v90
  v_mfma_f32_32x32x16_bf16 v[112:127], v[184:187], v[144:147], v[112:127]
  s_waitcnt lgkmcnt(0)
  buffer_load_dwordx4 v9, s[24:27], s87 offen offset:1024 lds
  v_cvt_pk_bf16_f32 v148, v88, v89
  v_exp_f32 v91, v91
  v_exp_f32 v92, v92
  v_cvt_pk_bf16_f32 v149, v90, v91
  v_exp_f32 v93, v93
  v_exp_f32 v94, v94
  v_exp_f32 v95, v95
  v_cvt_pk_bf16_f32 v150, v92, v93
  v_cvt_pk_bf16_f32 v151, v94, v95
  v_mfma_f32_32x32x16_bf16 v[80:95], v[160:163], v[32:35], v[48:63]
  ds_read_b128 v[176:179], v2 offset:18432
  v_exp_f32 v96, v96
  v_exp_f32 v97, v97
  v_exp_f32 v98, v98
  v_mfma_f32_32x32x16_bf16 v[112:127], v[188:191], v[148:151], v[112:127]
  ds_read_b128 v[180:183], v2 offset:19456
  v_cvt_pk_bf16_f32 v152, v96, v97
  v_exp_f32 v99, v99
  v_exp_f32 v100, v100
  v_cvt_pk_bf16_f32 v153, v98, v99
  v_smfmac_f32_16x16x64_bf16 v[192:195], v[16:19], v[144:151], v13
  v_exp_f32 v101, v101
  v_mfma_f32_32x32x16_bf16 v[80:95], v[164:167], v[36:39], v[80:95]
  buffer_load_dwordx4 v10, s[24:27], s87 offen offset:2048 lds
  v_exp_f32 v102, v102
  v_cvt_pk_bf16_f32 v154, v100, v101
  v_exp_f32 v103, v103
  v_exp_f32 v104, v104
  v_cvt_pk_bf16_f32 v155, v102, v103
  v_exp_f32 v105, v105
  v_exp_f32 v106, v106
  v_mfma_f32_32x32x16_bf16 v[128:143], v[184:187], v[152:155], v[128:143]
  s_waitcnt lgkmcnt(0)
  buffer_load_dwordx4 v11, s[24:27], s87 offen offset:3072 lds
  v_cvt_pk_bf16_f32 v156, v104, v105
  v_exp_f32 v107, v107
  v_exp_f32 v108, v108
  v_cvt_pk_bf16_f32 v157, v106, v107
  v_exp_f32 v109, v109
  v_exp_f32 v110, v110
  v_exp_f32 v111, v111
  v_cvt_pk_bf16_f32 v158, v108, v109
  v_cvt_pk_bf16_f32 v159, v110, v111
  v_mfma_f32_32x32x16_bf16 v[96:111], v[160:163], v[40:43], v[64:79]
  ds_read_b128 v[168:171], v2 offset:20480
  v_exp_f32 v80, v80
  v_exp_f32 v81, v81
  v_exp_f32 v82, v82
  v_mfma_f32_32x32x16_bf16 v[128:143], v[188:191], v[156:159], v[128:143]
  ds_read_b128 v[172:175], v2 offset:21504
  v_cvt_pk_bf16_f32 v144, v80, v81
  v_exp_f32 v83, v83
  v_exp_f32 v84, v84
  v_cvt_pk_bf16_f32 v145, v82, v83
  v_smfmac_f32_16x16x64_bf16 v[196:199], v[16:19], v[152:159], v13
  s_add_u32 m0, s89, 4096
  v_exp_f32 v85, v85
  v_mfma_f32_32x32x16_bf16 v[96:111], v[164:167], v[44:47], v[96:111]
  buffer_load_dwordx4 v8, s[24:27], s88 offen offset:0 lds
  v_exp_f32 v86, v86
  v_cvt_pk_bf16_f32 v146, v84, v85
  v_exp_f32 v87, v87
  v_exp_f32 v88, v88
  v_cvt_pk_bf16_f32 v147, v86, v87
  v_exp_f32 v89, v89
  v_exp_f32 v90, v90
  v_mfma_f32_32x32x16_bf16 v[112:127], v[176:179], v[144:147], v[112:127]
  s_waitcnt lgkmcnt(0)
  buffer_load_dwordx4 v9, s[24:27], s88 offen offset:1024 lds
  v_cvt_pk_bf16_f32 v148, v88, v89
  v_exp_f32 v91, v91
  v_exp_f32 v92, v92
  v_cvt_pk_bf16_f32 v149, v90, v91
  v_exp_f32 v93, v93
  v_exp_f32 v94, v94
  v_exp_f32 v95, v95
  v_cvt_pk_bf16_f32 v150, v92, v93
  v_cvt_pk_bf16_f32 v151, v94, v95
  v_mfma_f32_32x32x16_bf16 v[80:95], v[168:171], v[32:35], v[48:63]
  ds_read_b128 v[184:187], v2 offset:22528
  v_exp_f32 v96, v96
  v_exp_f32 v97, v97
  v_exp_f32 v98, v98
  v_mfma_f32_32x32x16_bf16 v[112:127], v[180:183], v[148:151], v[112:127]
  ds_read_b128 v[188:191], v2 offset:23552
  v_cvt_pk_bf16_f32 v152, v96, v97
  v_exp_f32 v99, v99
  v_exp_f32 v100, v100
  v_cvt_pk_bf16_f32 v153, v98, v99
  v_smfmac_f32_16x16x64_bf16 v[192:195], v[16:19], v[144:151], v13
  v_exp_f32 v101, v101
  v_mfma_f32_32x32x16_bf16 v[80:95], v[172:175], v[36:39], v[80:95]
  buffer_load_dwordx4 v10, s[24:27], s88 offen offset:2048 lds
  v_exp_f32 v102, v102
  v_cvt_pk_bf16_f32 v154, v100, v101
  v_exp_f32 v103, v103
  v_exp_f32 v104, v104
  v_cvt_pk_bf16_f32 v155, v102, v103
  v_exp_f32 v105, v105
  v_exp_f32 v106, v106
  v_mfma_f32_32x32x16_bf16 v[128:143], v[176:179], v[152:155], v[128:143]
  s_waitcnt lgkmcnt(0)
  buffer_load_dwordx4 v11, s[24:27], s88 offen offset:3072 lds
  v_cvt_pk_bf16_f32 v156, v104, v105
  v_exp_f32 v107, v107
  v_exp_f32 v108, v108
  v_cvt_pk_bf16_f32 v157, v106, v107
  v_exp_f32 v109, v109
  v_exp_f32 v110, v110
  v_exp_f32 v111, v111
  v_cvt_pk_bf16_f32 v158, v108, v109
  v_cvt_pk_bf16_f32 v159, v110, v111
  v_mfma_f32_32x32x16_bf16 v[96:111], v[168:171], v[40:43], v[64:79]
  ds_read_b128 v[160:163], v2 offset:24576
  v_exp_f32 v80, v80
  v_exp_f32 v81, v81
  v_exp_f32 v82, v82
  v_mfma_f32_32x32x16_bf16 v[128:143], v[180:183], v[156:159], v[128:143]
  ds_read_b128 v[164:167], v2 offset:25600
  v_cvt_pk_bf16_f32 v144, v80, v81
  v_exp_f32 v83, v83
  v_exp_f32 v84, v84
  v_cvt_pk_bf16_f32 v145, v82, v83
  v_smfmac_f32_16x16x64_bf16 v[196:199], v[16:19], v[152:159], v13
  s_add_u32 s87, s87, 262144
  v_exp_f32 v85, v85
  v_mfma_f32_32x32x16_bf16 v[96:111], v[172:175], v[44:47], v[96:111]
  s_add_u32 s88, s88, 262144
  v_exp_f32 v86, v86
  v_cvt_pk_bf16_f32 v146, v84, v85
  v_exp_f32 v87, v87
  v_exp_f32 v88, v88
  v_cvt_pk_bf16_f32 v147, v86, v87
  v_exp_f32 v89, v89
  v_exp_f32 v90, v90
  v_mfma_f32_32x32x16_bf16 v[112:127], v[184:187], v[144:147], v[112:127]
  s_waitcnt lgkmcnt(0)
  v_cvt_pk_bf16_f32 v148, v88, v89
  v_exp_f32 v91, v91
  v_exp_f32 v92, v92
  v_cvt_pk_bf16_f32 v149, v90, v91
  v_exp_f32 v93, v93
  v_exp_f32 v94, v94
  v_exp_f32 v95, v95
  v_cvt_pk_bf16_f32 v150, v92, v93
  v_cvt_pk_bf16_f32 v151, v94, v95
  v_mfma_f32_32x32x16_bf16 v[80:95], v[160:163], v[32:35], v[48:63]
  ds_read_b128 v[176:179], v2 offset:26624
  v_exp_f32 v96, v96
  v_exp_f32 v97, v97
  v_exp_f32 v98, v98
  v_mfma_f32_32x32x16_bf16 v[112:127], v[188:191], v[148:151], v[112:127]
  ds_read_b128 v[180:183], v2 offset:27648
  v_cvt_pk_bf16_f32 v152, v96, v97
  v_exp_f32 v99, v99
  v_exp_f32 v100, v100
  v_cvt_pk_bf16_f32 v153, v98, v99
  v_smfmac_f32_16x16x64_bf16 v[192:195], v[16:19], v[144:151], v13
  s_add_u32 s89, s89, 32768
  v_exp_f32 v101, v101
  v_mfma_f32_32x32x16_bf16 v[80:95], v[164:167], v[36:39], v[80:95]
  v_exp_f32 v102, v102
  v_cvt_pk_bf16_f32 v154, v100, v101
  v_exp_f32 v103, v103
  v_exp_f32 v104, v104
  v_cvt_pk_bf16_f32 v155, v102, v103
  v_exp_f32 v105, v105
  v_exp_f32 v106, v106
  v_mfma_f32_32x32x16_bf16 v[128:143], v[184:187], v[152:155], v[128:143]
  s_waitcnt lgkmcnt(0)
  v_cvt_pk_bf16_f32 v156, v104, v105
  v_exp_f32 v107, v107
L_touch4:
  s_cbranch_execz L_tdisp0
  v_exp_f32 v108, v108
  v_cvt_pk_bf16_f32 v157, v106, v107
  v_exp_f32 v109, v109
  v_exp_f32 v110, v110
  v_exp_f32 v111, v111
  v_cvt_pk_bf16_f32 v158, v108, v109
  v_cvt_pk_bf16_f32 v159, v110, v111
  v_mfma_f32_32x32x16_bf16 v[96:111], v[160:163], v[40:43], v[64:79]
  ds_read_b128 v[168:171], v2 offset:28672
  v_exp_f32 v80, v80
  v_exp_f32 v81, v81
  v_exp_f32 v82, v82
  v_mfma_f32_32x32x16_bf16 v[128:143], v[188:191], v[156:159], v[128:143]
  ds_read_b128 v[172:175], v2 offset:29696
  v_cvt_pk_bf16_f32 v144, v80, v81
  v_exp_f32 v83, v83
  v_exp_f32 v84, v84
  v_cvt_pk_bf16_f32 v145, v82, v83
  v_smfmac_f32_16x16x64_bf16 v[196:199], v[16:19], v[152:159], v13
  s_add_u32 s82, s82, 1
  v_exp_f32 v85, v85
  v_mfma_f32_32x32x16_bf16 v[96:111], v[164:167], v[44:47], v[96:111]
  v_exp_f32 v86, v86
  v_cvt_pk_bf16_f32 v146, v84, v85
  v_exp_f32 v87, v87
  v_exp_f32 v88, v88
  v_cvt_pk_bf16_f32 v147, v86, v87
  v_exp_f32 v89, v89
  v_exp_f32 v90, v90
  v_mfma_f32_32x32x16_bf16 v[112:127], v[176:179], v[144:147], v[112:127]
  s_waitcnt lgkmcnt(0)
  v_cvt_pk_bf16_f32 v148, v88, v89
  v_exp_f32 v91, v91
  v_exp_f32 v92, v92
  v_cvt_pk_bf16_f32 v149, v90, v91
  v_exp_f32 v93, v93
  v_exp_f32 v94, v94
  v_exp_f32 v95, v95
  v_cvt_pk_bf16_f32 v150, v92, v93
  v_cvt_pk_bf16_f32 v151, v94, v95
  v_mfma_f32_32x32x16_bf16 v[80:95], v[168:171], v[32:35], v[48:63]
  ds_read_b128 v[184:187], v2 offset:30720
  v_exp_f32 v96, v96
  v_exp_f32 v97, v97
  v_exp_f32 v98, v98
  v_mfma_f32_32x32x16_bf16 v[112:127], v[180:183], v[148:151], v[112:127]
  ds_read_b128 v[188:191], v2 offset:31744
  v_cvt_pk_bf16_f32 v152, v96, v97
  v_exp_f32 v99, v99
  v_exp_f32 v100, v100
  v_cvt_pk_bf16_f32 v153, v98, v99
  v_smfmac_f32_16x16x64_bf16 v[192:195], v[16:19], v[144:151], v13
  s_and_b32 s82, s82, 7
  v_exp_f32 v101, v101
  v_mfma_f32_32x32x16_bf16 v[80:95], v[172:175], v[36:39], v[80:95]
  v_xor_b32 v2, 32768, v2
  v_exp_f32 v102, v102
  v_cvt_pk_bf16_f32 v154, v100, v101
  v_exp_f32 v103, v103
  v_exp_f32 v104, v104
  v_cvt_pk_bf16_f32 v155, v102, v103
  v_exp_f32 v105, v105
  v_exp_f32 v106, v106
  v_mfma_f32_32x32x16_bf16 v[128:143], v[176:179], v[152:155], v[128:143]
  s_waitcnt lgkmcnt(0)
  v_cvt_pk_bf16_f32 v156, v104, v105
  v_exp_f32 v107, v107
  v_exp_f32 v108, v108
  v_cvt_pk_bf16_f32 v157, v106, v107
  v_exp_f32 v109, v109
  v_exp_f32 v110, v110
  v_exp_f32 v111, v111
  v_cvt_pk_bf16_f32 v158, v108, v109
  v_cvt_pk_bf16_f32 v159, v110, v111
  s_waitcnt vmcnt(10) lgkmcnt(0)
  s_barrier
  v_mfma_f32_32x32x16_bf16 v[96:111], v[168:171], v[40:43], v[64:79]
  ds_read_b128 v[160:163], v2 offset:0
  v_exp_f32 v80, v80
  v_exp_f32 v81, v81
  v_exp_f32 v82, v82
  v_mfma_f32_32x32x16_bf16 v[128:143], v[180:183], v[156:159], v[128:143]
  ds_read_b128 v[164:167], v2 offset:1024
  v_cvt_pk_bf16_f32 v144, v80, v81
  v_exp_f32 v83, v83
  v_exp_f32 v84, v84
  v_cvt_pk_bf16_f32 v145, v82, v83
  v_smfmac_f32_16x16x64_bf16 v[196:199], v[16:19], v[152:159], v13
  s_lshl_b32 s83, s82, 15
  v_exp_f32 v85, v85
  v_mfma_f32_32x32x16_bf16 v[96:111], v[172:175], v[44:47], v[96:111]
  s_add_u32 s83, s83, s81
  v_exp_f32 v86, v86
  v_cvt_pk_bf16_f32 v146, v84, v85
  v_exp_f32 v87, v87
  v_exp_f32 v88, v88
  v_cvt_pk_bf16_f32 v147, v86, v87
  v_exp_f32 v89, v89
  v_exp_f32 v90, v90
  v_mfma_f32_32x32x16_bf16 v[112:127], v[184:187], v[144:147], v[112:127]
  s_waitcnt lgkmcnt(0)
  v_cvt_pk_bf16_f32 v148, v88, v89
  v_exp_f32 v91, v91
  v_exp_f32 v92, v92
  v_cvt_pk_bf16_f32 v149, v90, v91
  v_exp_f32 v93, v93
  v_exp_f32 v94, v94
  v_exp_f32 v95, v95
  v_cvt_pk_bf16_f32 v150, v92, v93
  v_cvt_pk_bf16_f32 v151, v94, v95
  v_mfma_f32_32x32x16_bf16 v[80:95], v[160:163], v[32:35], v[48:63]
  ds_read_b128 v[176:179], v2 offset:2048
  v_exp_f32 v96, v96
  v_exp_f32 v97, v97
  v_exp_f32 v98, v98
  v_mfma_f32_32x32x16_bf16 v[112:127], v[188:191], v[148:151], v[112:127]
  ds_read_b128 v[180:183], v2 offset:3072
  v_cvt_pk_bf16_f32 v152, v96, v97
  v_exp_f32 v99, v99
  v_exp_f32 v100, v100
  v_cvt_pk_bf16_f32 v153, v98, v99
  v_smfmac_f32_16x16x64_bf16 v[192:195], v[16:19], v[144:151], v13
  s_sub_u32 s86, s86, 1
  v_exp_f32 v101, v101
  v_mfma_f32_32x32x16_bf16 v[80:95], v[164:167], v[36:39], v[80:95]
  s_cmp_lg_u32 s86, 0
  v_exp_f32 v102, v102
  v_cvt_pk_bf16_f32 v154, v100, v101
  v_exp_f32 v103, v103
  v_exp_f32 v104, v104
  v_cvt_pk_bf16_f32 v155, v102, v103
  v_exp_f32 v105, v105
  v_exp_f32 v106, v106
  v_mfma_f32_32x32x16_bf16 v[128:143], v[184:187], v[152:155], v[128:143]
  s_waitcnt lgkmcnt(0)
  v_cvt_pk_bf16_f32 v156, v104, v105
  v_exp_f32 v107, v107
  v_exp_f32 v108, v108
  v_cvt_pk_bf16_f32 v157, v106, v107
  v_exp_f32 v109, v109
  v_exp_f32 v110, v110
  v_exp_f32 v111, v111
  v_cvt_pk_bf16_f32 v158, v108, v109
  v_cvt_pk_bf16_f32 v159, v110, v111
  s_cbranch_scc1 L_att2
  v_accvgpr_read_b32 v24, a241
  buffer_load_dword v25, v24, s[20:23], s94 offen sc1
  v_accvgpr_read_b32 v30, a233
  v_mfma_f32_32x32x16_bf16 v[96:111], v[160:163], v[40:43], v[64:79]
  ds_read_b128 v[168:171], v2 offset:4096
  v_exp_f32 v80, v80
  v_exp_f32 v81, v81
  v_exp_f32 v82, v82
  v_mfma_f32_32x32x16_bf16 v[128:143], v[188:191], v[156:159], v[128:143]
  ds_read_b128 v[172:175], v2 offset:5120
  v_cvt_pk_bf16_f32 v144, v80, v81
  v_exp_f32 v83, v83
  v_exp_f32 v84, v84
  v_cvt_pk_bf16_f32 v145, v82, v83
  v_smfmac_f32_16x16x64_bf16 v[196:199], v[16:19], v[152:159], v13
  v_exp_f32 v85, v85
  v_mfma_f32_32x32x16_bf16 v[96:111], v[164:167], v[44:47], v[96:111]
  v_exp_f32 v86, v86
  v_cvt_pk_bf16_f32 v146, v84, v85
  v_exp_f32 v87, v87
  v_exp_f32 v88, v88
  v_cvt_pk_bf16_f32 v147, v86, v87
  v_exp_f32 v89, v89
  v_exp_f32 v90, v90
  v_mfma_f32_32x32x16_bf16 v[112:127], v[176:179], v[144:147], v[112:127]
  s_waitcnt lgkmcnt(0)
  v_cvt_pk_bf16_f32 v148, v88, v89
  v_exp_f32 v91, v91
  v_exp_f32 v92, v92
  v_cvt_pk_bf16_f32 v149, v90, v91
  v_exp_f32 v93, v93
  v_exp_f32 v94, v94
  v_exp_f32 v95, v95
  v_cvt_pk_bf16_f32 v150, v92, v93
  v_cvt_pk_bf16_f32 v151, v94, v95
  v_mfma_f32_32x32x16_bf16 v[80:95], v[168:171], v[32:35], v[48:63]
  ds_read_b128 v[184:187], v2 offset:6144
  v_exp_f32 v96, v96
  v_exp_f32 v97, v97
  v_exp_f32 v98, v98
  v_mfma_f32_32x32x16_bf16 v[112:127], v[180:183], v[148:151], v[112:127]
  ds_read_b128 v[188:191], v2 offset:7168
  v_cvt_pk_bf16_f32 v152, v96, v97
  v_exp_f32 v99, v99
  v_exp_f32 v100, v100
  v_cvt_pk_bf16_f32 v153, v98, v99
  v_smfmac_f32_16x16x64_bf16 v[192:195], v[16:19], v[144:151], v13
  s_mov_b32 m0, s85
  v_exp_f32 v101, v101
  v_mfma_f32_32x32x16_bf16 v[80:95], v[172:175], v[36:39], v[80:95]
  buffer_load_dwordx4 v3, s[20:23], s83 offen offset:0 sc1 lds
  v_exp_f32 v102, v102
  v_cvt_pk_bf16_f32 v154, v100, v101
  v_exp_f32 v103, v103
  v_exp_f32 v104, v104
  v_cvt_pk_bf16_f32 v155, v102, v103
  v_exp_f32 v105, v105
  v_exp_f32 v106, v106
  v_mfma_f32_32x32x16_bf16 v[128:143], v[176:179], v[152:155], v[128:143]
  s_waitcnt lgkmcnt(0)
  buffer_load_dwordx4 v3, s[20:23], s83 offen offset:1024 sc1 lds
  v_cvt_pk_bf16_f32 v156, v104, v105
  v_exp_f32 v107, v107
  v_exp_f32 v108, v108
  v_cvt_pk_bf16_f32 v157, v106, v107
  v_exp_f32 v109, v109
  v_exp_f32 v110, v110
  v_exp_f32 v111, v111
  v_cvt_pk_bf16_f32 v158, v108, v109
  v_cvt_pk_bf16_f32 v159, v110, v111
  v_mfma_f32_32x32x16_bf16 v[96:111], v[168:171], v[40:43], v[64:79]
  ds_read_b128 v[160:163], v2 offset:8192
  v_exp_f32 v80, v80
  v_exp_f32 v81, v81
  v_exp_f32 v82, v82
  v_mfma_f32_32x32x16_bf16 v[128:143], v[180:183], v[156:159], v[128:143]
  ds_read_b128 v[164:167], v2 offset:9216
  v_cvt_pk_bf16_f32 v144, v80, v81
  v_exp_f32 v83, v83
  v_exp_f32 v84, v84
  v_cvt_pk_bf16_f32 v145, v82, v83
  v_smfmac_f32_16x16x64_bf16 v[196:199], v[16:19], v[152:159], v13
  s_add_u32 s84, s83, 4096
  v_exp_f32 v85, v85
  v_mfma_f32_32x32x16_bf16 v[96:111], v[172:175], v[44:47], v[96:111]
  buffer_load_dwordx4 v3, s[20:23], s83 offen offset:2048 sc1 lds
  v_exp_f32 v86, v86
  v_cvt_pk_bf16_f32 v146, v84, v85
  v_exp_f32 v87, v87
  v_exp_f32 v88, v88
  v_cvt_pk_bf16_f32 v147, v86, v87
  v_exp_f32 v89, v89
  v_exp_f32 v90, v90
  v_mfma_f32_32x32x16_bf16 v[112:127], v[184:187], v[144:147], v[112:127]
  s_waitcnt lgkmcnt(0)
  buffer_load_dwordx4 v3, s[20:23], s83 offen offset:3072 sc1 lds
  v_cvt_pk_bf16_f32 v148, v88, v89
  v_exp_f32 v91, v91
  v_exp_f32 v92, v92
  v_cvt_pk_bf16_f32 v149, v90, v91
  v_exp_f32 v93, v93
  v_exp_f32 v94, v94
  v_exp_f32 v95, v95
  v_cvt_pk_bf16_f32 v150, v92, v93
  v_cvt_pk_bf16_f32 v151, v94, v95
  v_mfma_f32_32x32x16_bf16 v[80:95], v[160:163], v[32:35], v[48:63]
  ds_read_b128 v[176:179], v2 offset:10240
  v_exp_f32 v96, v96
  v_exp_f32 v97, v97
  v_exp_f32 v98, v98
  v_mfma_f32_32x32x16_bf16 v[112:127], v[188:191], v[148:151], v[112:127]
  ds_read_b128 v[180:183], v2 offset:11264
  v_cvt_pk_bf16_f32 v152, v96, v97
  v_exp_f32 v99, v99
  v_exp_f32 v100, v100
  v_cvt_pk_bf16_f32 v153, v98, v99
  v_smfmac_f32_16x16x64_bf16 v[192:195], v[16:19], v[144:151], v13
  s_add_u32 m0, s85, 4096
  v_exp_f32 v101, v101
  v_mfma_f32_32x32x16_bf16 v[80:95], v[164:167], v[36:39], v[80:95]
  buffer_load_dwordx4 v3, s[20:23], s84 offen offset:0 sc1 lds
  v_exp_f32 v102, v102
  v_cvt_pk_bf16_f32 v154, v100, v101
  v_exp_f32 v103, v103
  v_exp_f32 v104, v104
  v_cvt_pk_bf16_f32 v155, v102, v103
  v_exp_f32 v105, v105
  v_exp_f32 v106, v106
  v_mfma_f32_32x32x16_bf16 v[128:143], v[184:187], v[152:155], v[128:143]
  s_waitcnt lgkmcnt(0)
  buffer_load_dwordx4 v3, s[20:23], s84 offen offset:1024 sc1 lds
  v_cvt_pk_bf16_f32 v156, v104, v105
  v_exp_f32 v107, v107
  v_exp_f32 v108, v108
  v_cvt_pk_bf16_f32 v157, v106, v107
  v_exp_f32 v109, v109
  v_exp_f32 v110, v110
  v_exp_f32 v111, v111
  v_cvt_pk_bf16_f32 v158, v108, v109
  v_cvt_pk_bf16_f32 v159, v110, v111
  v_mfma_f32_32x32x16_bf16 v[96:111], v[160:163], v[40:43], v[64:79]
  ds_read_b128 v[168:171], v2 offset:12288
  v_exp_f32 v80, v80
  v_exp_f32 v81, v81
  v_exp_f32 v82, v82
  v_mfma_f32_32x32x16_bf16 v[128:143], v[188:191], v[156:159], v[128:143]
  ds_read_b128 v[172:175], v2 offset:13312
  v_cvt_pk_bf16_f32 v144, v80, v81
  v_exp_f32 v83, v83
  v_exp_f32 v84, v84
  v_cvt_pk_bf16_f32 v145, v82, v83
  v_smfmac_f32_16x16x64_bf16 v[196:199], v[16:19], v[152:159], v13
  v_exp_f32 v85, v85
  v_mfma_f32_32x32x16_bf16 v[96:111], v[164:167], v[44:47], v[96:111]
  buffer_load_dwordx4 v3, s[20:23], s84 offen offset:2048 sc1 lds
  v_exp_f32 v86, v86
  v_cvt_pk_bf16_f32 v146, v84, v85
  v_exp_f32 v87, v87
  v_exp_f32 v88, v88
  v_cvt_pk_bf16_f32 v147, v86, v87
  v_exp_f32 v89, v89
  v_exp_f32 v90, v90
  v_mfma_f32_32x32x16_bf16 v[112:127], v[176:179], v[144:147], v[112:127]
  s_waitcnt lgkmcnt(0)
  buffer_load_dwordx4 v3, s[20:23], s84 offen offset:3072 sc1 lds
  v_cvt_pk_bf16_f32 v148, v88, v89
  v_exp_f32 v91, v91
  v_exp_f32 v92, v92
  v_cvt_pk_bf16_f32 v149, v90, v91
  v_exp_f32 v93, v93
  v_exp_f32 v94, v94
  v_exp_f32 v95, v95
  v_cvt_pk_bf16_f32 v150, v92, v93
  v_cvt_pk_bf16_f32 v151, v94, v95
  v_mfma_f32_32x32x16_bf16 v[80:95], v[168:171], v[32:35], v[48:63]
  ds_read_b128 v[184:187], v2 offset:14336
  v_exp_f32 v96, v96
  v_exp_f32 v97, v97
  v_exp_f32 v98, v98
  v_mfma_f32_32x32x16_bf16 v[112:127], v[180:183], v[148:151], v[112:127]
  ds_read_b128 v[188:191], v2 offset:15360
  v_cvt_pk_bf16_f32 v152, v96, v97
  v_exp_f32 v99, v99
  v_exp_f32 v100, v100
  v_cvt_pk_bf16_f32 v153, v98, v99
  v_smfmac_f32_16x16x64_bf16 v[192:195], v[16:19], v[144:151], v13
  s_xor_b32 s85, s85, 32768
  v_exp_f32 v101, v101
  v_mfma_f32_32x32x16_bf16 v[80:95], v[172:175], v[36:39], v[80:95]
  v_exp_f32 v102, v102
  v_cvt_pk_bf16_f32 v154, v100, v101
  v_exp_f32 v103, v103
  v_exp_f32 v104, v104
  v_cvt_pk_bf16_f32 v155, v102, v103
  v_exp_f32 v105, v105
  v_exp_f32 v106, v106
  v_mfma_f32_32x32x16_bf16 v[128:143], v[176:179], v[152:155], v[128:143]
  s_waitcnt lgkmcnt(0)
  v_cvt_pk_bf16_f32 v156, v104, v105
  v_exp_f32 v107, v107
  v_exp_f32 v108, v108
  v_cvt_pk_bf16_f32 v157, v106, v107
  v_exp_f32 v109, v109
  v_exp_f32 v110, v110
  v_exp_f32 v111, v111
  v_cvt_pk_bf16_f32 v158, v108, v109
  v_cvt_pk_bf16_f32 v159, v110, v111
  v_mfma_f32_32x32x16_bf16 v[96:111], v[168:171], v[40:43], v[64:79]
  ds_read_b128 v[160:163], v2 offset:16384
  v_exp_f32 v80, v80
  v_exp_f32 v81, v81
  v_exp_f32 v82, v82
  v_mfma_f32_32x32x16_bf16 v[128:143], v[180:183], v[156:159], v[128:143]
  ds_read_b128 v[164:167], v2 offset:17408
  v_cvt_pk_bf16_f32 v144, v80, v81
  v_exp_f32 v83, v83
  v_exp_f32 v84, v84
  v_cvt_pk_bf16_f32 v145, v82, v83
  v_smfmac_f32_16x16x64_bf16 v[196:199], v[16:19], v[152:159], v13
  v_exp_f32 v85, v85
  v_mfma_f32_32x32x16_bf16 v[96:111], v[172:175], v[44:47], v[96:111]
  v_exp_f32 v86, v86
  v_cvt_pk_bf16_f32 v146, v84, v85
  v_exp_f32 v87, v87
  v_exp_f32 v88, v88
  v_cvt_pk_bf16_f32 v147, v86, v87
  v_exp_f32 v89, v89
  v_exp_f32 v90, v90
  v_mfma_f32_32x32x16_bf16 v[112:127], v[184:187], v[144:147], v[112:127]
  s_waitcnt lgkmcnt(0)
  v_cvt_pk_bf16_f32 v148, v88, v89
  v_exp_f32 v91, v91
  v_exp_f32 v92, v92
  v_cvt_pk_bf16_f32 v149, v90, v91
  v_exp_f32 v93, v93
  v_exp_f32 v94, v94
  v_exp_f32 v95, v95
  v_cvt_pk_bf16_f32 v150, v92, v93
  v_cvt_pk_bf16_f32 v151, v94, v95
  v_mfma_f32_32x32x16_bf16 v[80:95], v[160:163], v[32:35], v[48:63]
  ds_read_b128 v[176:179], v2 offset:18432
  v_exp_f32 v96, v96
  v_exp_f32 v97, v97
  v_exp_f32 v98, v98
  v_mfma_f32_32x32x16_bf16 v[112:127], v[188:191], v[148:151], v[112:127]
  ds_read_b128 v[180:183], v2 offset:19456
  v_cvt_pk_bf16_f32 v152, v96, v97
  v_exp_f32 v99, v99
  v_exp_f32 v100, v100
  v_cvt_pk_bf16_f32 v153, v98, v99
  v_smfmac_f32_16x16x64_bf16 v[192:195], v[16:19], v[144:151], v13
  v_exp_f32 v101, v101
  v_mfma_f32_32x32x16_bf16 v[80:95], v[164:167], v[36:39], v[80:95]
  v_exp_f32 v102, v102
  v_cvt_pk_bf16_f32 v154, v100, v101
  v_exp_f32 v103, v103
  v_exp_f32 v104, v104
  v_cvt_pk_bf16_f32 v155, v102, v103
  v_exp_f32 v105, v105
  v_exp_f32 v106, v106
  v_mfma_f32_32x32x16_bf16 v[128:143], v[184:187], v[152:155], v[128:143]
  s_waitcnt lgkmcnt(0)
  v_cvt_pk_bf16_f32 v156, v104, v105
  v_exp_f32 v107, v107
  v_exp_f32 v108, v108
  v_cvt_pk_bf16_f32 v157, v106, v107
  v_exp_f32 v109, v109
  v_exp_f32 v110, v110
  v_exp_f32 v111, v111
  v_cvt_pk_bf16_f32 v158, v108, v109
  v_cvt_pk_bf16_f32 v159, v110, v111
  s_waitcnt vmcnt(8)
  v_cmp_gt_u32 vcc, 3, v25
  s_nop 0
  s_cbranch_vccnz L_retry2
L_cont2:
  v_mfma_f32_32x32x16_bf16 v[96:111], v[160:163], v[40:43], v[64:79]
  ds_read_b128 v[168:171], v2 offset:20480
  v_exp_f32 v80, v80
  v_exp_f32 v81, v81
  v_exp_f32 v82, v82
  v_mfma_f32_32x32x16_bf16 v[128:143], v[188:191], v[156:159], v[128:143]
  ds_read_b128 v[172:175], v2 offset:21504
  v_cvt_pk_bf16_f32 v144, v80, v81
  v_exp_f32 v83, v83
  v_exp_f32 v84, v84
  v_cvt_pk_bf16_f32 v145, v82, v83
  v_smfmac_f32_16x16x64_bf16 v[196:199], v[16:19], v[152:159], v13
  v_exp_f32 v85, v85
  v_mfma_f32_32x32x16_bf16 v[96:111], v[164:167], v[44:47], v[96:111]
  buffer_load_dwordx4 a[0:3], v30, s[20:23], s90 offen offset:0 sc1
  v_exp_f32 v86, v86
  v_cvt_pk_bf16_f32 v146, v84, v85
  v_exp_f32 v87, v87
  v_exp_f32 v88, v88
  v_cvt_pk_bf16_f32 v147, v86, v87
  v_exp_f32 v89, v89
  v_exp_f32 v90, v90
  v_mfma_f32_32x32x16_bf16 v[112:127], v[176:179], v[144:147], v[112:127]
  s_waitcnt lgkmcnt(0)
  buffer_load_dwordx4 a[4:7], v30, s[20:23], s90 offen offset:256 sc1
  v_cvt_pk_bf16_f32 v148, v88, v89
  v_exp_f32 v91, v91
  v_exp_f32 v92, v92
  v_cvt_pk_bf16_f32 v149, v90, v91
  v_exp_f32 v93, v93
  v_exp_f32 v94, v94
  v_exp_f32 v95, v95
  v_cvt_pk_bf16_f32 v150, v92, v93
  v_cvt_pk_bf16_f32 v151, v94, v95
  v_mfma_f32_32x32x16_bf16 v[80:95], v[168:171], v[32:35], v[48:63]
  ds_read_b128 v[184:187], v2 offset:22528
  v_exp_f32 v96, v96
  v_exp_f32 v97, v97
  v_exp_f32 v98, v98
  v_mfma_f32_32x32x16_bf16 v[112:127], v[180:183], v[148:151], v[112:127]
  ds_read_b128 v[188:191], v2 offset:23552
  v_cvt_pk_bf16_f32 v152, v96, v97
  v_exp_f32 v99, v99
  v_exp_f32 v100, v100
  v_cvt_pk_bf16_f32 v153, v98, v99
  v_smfmac_f32_16x16x64_bf16 v[192:195], v[16:19], v[144:151], v13
  v_exp_f32 v101, v101
  v_mfma_f32_32x32x16_bf16 v[80:95], v[172:175], v[36:39], v[80:95]
  buffer_load_dwordx4 a[8:11], v30, s[20:23], s90 offen offset:2048 sc1
  v_exp_f32 v102, v102
  v_cvt_pk_bf16_f32 v154, v100, v101
  v_exp_f32 v103, v103
  v_exp_f32 v104, v104
  v_cvt_pk_bf16_f32 v155, v102, v103
  v_exp_f32 v105, v105
  v_exp_f32 v106, v106
  v_mfma_f32_32x32x16_bf16 v[128:143], v[176:179], v[152:155], v[128:143]
  s_waitcnt lgkmcnt(0)
  buffer_load_dwordx4 a[12:15], v30, s[20:23], s90 offen offset:2304 sc1
  s_add_u32 s90, s90, 4096
  v_cvt_pk_bf16_f32 v156, v104, v105
  v_exp_f32 v107, v107
  v_exp_f32 v108, v108
  v_cvt_pk_bf16_f32 v157, v106, v107
  v_exp_f32 v109, v109
  v_exp_f32 v110, v110
  v_exp_f32 v111, v111
  v_cvt_pk_bf16_f32 v158, v108, v109
  v_cvt_pk_bf16_f32 v159, v110, v111
  v_mfma_f32_32x32x16_bf16 v[96:111], v[168:171], v[40:43], v[64:79]
  ds_read_b128 v[160:163], v2 offset:24576
  v_exp_f32 v80, v80
  v_exp_f32 v81, v81
  v_exp_f32 v82, v82
  v_mfma_f32_32x32x16_bf16 v[128:143], v[180:183], v[156:159], v[128:143]
  ds_read_b128 v[164:167], v2 offset:25600
  v_cvt_pk_bf16_f32 v144, v80, v81
  v_exp_f32 v83, v83
  v_exp_f32 v84, v84
  v_cvt_pk_bf16_f32 v145, v82, v83
  v_smfmac_f32_16x16x64_bf16 v[196:199], v[16:19], v[152:159], v13
  v_exp_f32 v85, v85
  v_mfma_f32_32x32x16_bf16 v[96:111], v[172:175], v[44:47], v[96:111]
  buffer_load_dwordx4 a[16:19], v30, s[20:23], s90 offen offset:0 sc1
  v_exp_f32 v86, v86
  v_cvt_pk_bf16_f32 v146, v84, v85
  v_exp_f32 v87, v87
  v_exp_f32 v88, v88
  v_cvt_pk_bf16_f32 v147, v86, v87
  v_exp_f32 v89, v89
  v_exp_f32 v90, v90
  v_mfma_f32_32x32x16_bf16 v[112:127], v[184:187], v[144:147], v[112:127]
  s_waitcnt lgkmcnt(0)
  buffer_load_dwordx4 a[20:23], v30, s[20:23], s90 offen offset:256 sc1
  v_cvt_pk_bf16_f32 v148, v88, v89
  v_exp_f32 v91, v91
  v_exp_f32 v92, v92
  v_cvt_pk_bf16_f32 v149, v90, v91
  v_exp_f32 v93, v93
  v_exp_f32 v94, v94
  v_exp_f32 v95, v95
  v_cvt_pk_bf16_f32 v150, v92, v93
  v_cvt_pk_bf16_f32 v151, v94, v95
  v_mfma_f32_32x32x16_bf16 v[80:95], v[160:163], v[32:35], v[48:63]
  ds_read_b128 v[176:179], v2 offset:26624
  v_exp_f32 v96, v96
  v_exp_f32 v97, v97
  v_exp_f32 v98, v98
  v_mfma_f32_32x32x16_bf16 v[112:127], v[188:191], v[148:151], v[112:127]
  ds_read_b128 v[180:183], v2 offset:27648
  v_cvt_pk_bf16_f32 v152, v96, v97
  v_exp_f32 v99, v99
  v_exp_f32 v100, v100
  v_cvt_pk_bf16_f32 v153, v98, v99
  v_smfmac_f32_16x16x64_bf16 v[192:195], v[16:19], v[144:151], v13
  v_exp_f32 v101, v101
  v_mfma_f32_32x32x16_bf16 v[80:95], v[164:167], v[36:39], v[80:95]
  buffer_load_dwordx4 a[24:27], v30, s[20:23], s90 offen offset:2048 sc1
  v_exp_f32 v102, v102
  v_cvt_pk_bf16_f32 v154, v100, v101
  v_exp_f32 v103, v103
  v_exp_f32 v104, v104
  v_cvt_pk_bf16_f32 v155, v102, v103
  v_exp_f32 v105, v105
  v_exp_f32 v106, v106
  v_mfma_f32_32x32x16_bf16 v[128:143], v[184:187], v[152:155], v[128:143]
  s_waitcnt lgkmcnt(0)
  buffer_load_dwordx4 a[28:31], v30, s[20:23], s90 offen offset:2304 sc1
  s_add_u32 s90, s90, 4096
  v_cvt_pk_bf16_f32 v156, v104, v105
  v_exp_f32 v107, v107
  v_exp_f32 v108, v108
  v_cvt_pk_bf16_f32 v157, v106, v107
  v_exp_f32 v109, v109
  v_exp_f32 v110, v110
  v_exp_f32 v111, v111
  v_cvt_pk_bf16_f32 v158, v108, v109
  v_cvt_pk_bf16_f32 v159, v110, v111
  v_mfma_f32_32x32x16_bf16 v[96:111], v[160:163], v[40:43], v[64:79]
  ds_read_b128 v[168:171], v2 offset:28672
  v_exp_f32 v80, v80
  v_exp_f32 v81, v81
  v_exp_f32 v82, v82
  v_mfma_f32_32x32x16_bf16 v[128:143], v[188:191], v[156:159], v[128:143]
  ds_read_b128 v[172:175], v2 offset:29696
  v_cvt_pk_bf16_f32 v144, v80, v81
  v_exp_f32 v83, v83
  v_exp_f32 v84, v84
  v_cvt_pk_bf16_f32 v145, v82, v83
  v_smfmac_f32_16x16x64_bf16 v[196:199], v[16:19], v[152:159], v13
  s_add_u32 s82, s82, 1
  v_exp_f32 v85, v85
  v_mfma_f32_32x32x16_bf16 v[96:111], v[164:167], v[44:47], v[96:111]
  buffer_load_dwordx4 a[32:35], v30, s[20:23], s90 offen offset:0 sc1
  v_exp_f32 v86, v86
  v_cvt_pk_bf16_f32 v146, v84, v85
  v_exp_f32 v87, v87
  v_exp_f32 v88, v88
  v_cvt_pk_bf16_f32 v147, v86, v87
  v_exp_f32 v89, v89
  v_exp_f32 v90, v90
  v_mfma_f32_32x32x16_bf16 v[112:127], v[176:179], v[144:147], v[112:127]
  s_waitcnt lgkmcnt(0)
  buffer_load_dwordx4 a[36:39], v30, s[20:23], s90 offen offset:256 sc1
  v_cvt_pk_bf16_f32 v148, v88, v89
  v_exp_f32 v91, v91
  v_exp_f32 v92, v92
  v_cvt_pk_bf16_f32 v149, v90, v91
  v_exp_f32 v93, v93
  v_exp_f32 v94, v94
  v_exp_f32 v95, v95
  v_cvt_pk_bf16_f32 v150, v92, v93
  v_cvt_pk_bf16_f32 v151, v94, v95
  v_mfma_f32_32x32x16_bf16 v[80:95], v[168:171], v[32:35], v[48:63]
  ds_read_b128 v[184:187], v2 offset:30720
  v_exp_f32 v96, v96
  v_exp_f32 v97, v97
  v_exp_f32 v98, v98
  v_mfma_f32_32x32x16_bf16 v[112:127], v[180:183], v[148:151], v[112:127]
  ds_read_b128 v[188:191], v2 offset:31744
  v_cvt_pk_bf16_f32 v152, v96, v97
  v_exp_f32 v99, v99
  v_exp_f32 v100, v100
  v_cvt_pk_bf16_f32 v153, v98, v99
  v_smfmac_f32_16x16x64_bf16 v[192:195], v[16:19], v[144:151], v13
  s_and_b32 s82, s82, 7
  v_exp_f32 v101, v101
  v_mfma_f32_32x32x16_bf16 v[80:95], v[172:175], v[36:39], v[80:95]
  buffer_load_dwordx4 a[40:43], v30, s[20:23], s90 offen offset:2048 sc1
  v_xor_b32 v2, 32768, v2
  v_exp_f32 v102, v102
  v_cvt_pk_bf16_f32 v154, v100, v101
  v_exp_f32 v103, v103
  v_exp_f32 v104, v104
  v_cvt_pk_bf16_f32 v155, v102, v103
  v_exp_f32 v105, v105
  v_exp_f32 v106, v106
  v_mfma_f32_32x32x16_bf16 v[128:143], v[176:179], v[152:155], v[128:143]
  s_waitcnt lgkmcnt(0)
  buffer_load_dwordx4 a[44:47], v30, s[20:23], s90 offen offset:2304 sc1
  s_add_u32 s90, s90, 4096
  v_cvt_pk_bf16_f32 v156, v104, v105
  v_exp_f32 v107, v107
  v_exp_f32 v108, v108
  v_cvt_pk_bf16_f32 v157, v106, v107
  v_exp_f32 v109, v109
  v_exp_f32 v110, v110
  v_exp_f32 v111, v111
  v_cvt_pk_bf16_f32 v158, v108, v109
  v_cvt_pk_bf16_f32 v159, v110, v111
  s_waitcnt vmcnt(12) lgkmcnt(0)
  s_barrier
  v_mfma_f32_32x32x16_bf16 v[96:111], v[168:171], v[40:43], v[64:79]
  ds_read_b128 v[160:163], v2 offset:0
  v_exp_f32 v80, v80
  v_exp_f32 v81, v81
  v_exp_f32 v82, v82
  v_mfma_f32_32x32x16_bf16 v[128:143], v[180:183], v[156:159], v[128:143]
  ds_read_b128 v[164:167], v2 offset:1024
  v_cvt_pk_bf16_f32 v144, v80, v81
  v_exp_f32 v83, v83
  v_exp_f32 v84, v84
  v_cvt_pk_bf16_f32 v145, v82, v83
  v_smfmac_f32_16x16x64_bf16 v[196:199], v[16:19], v[152:159], v13
  s_lshl_b32 s83, s82, 15
  v_exp_f32 v85, v85
  v_mfma_f32_32x32x16_bf16 v[96:111], v[172:175], v[44:47], v[96:111]
  buffer_load_dwordx4 a[48:51], v30, s[20:23], s90 offen offset:0 sc1
  s_add_u32 s83, s83, s81
  v_exp_f32 v86, v86
  v_cvt_pk_bf16_f32 v146, v84, v85
  v_exp_f32 v87, v87
  v_exp_f32 v88, v88
  v_cvt_pk_bf16_f32 v147, v86, v87
  v_exp_f32 v89, v89
  v_exp_f32 v90, v90
  v_mfma_f32_32x32x16_bf16 v[112:127], v[184:187], v[144:147], v[112:127]
  s_waitcnt lgkmcnt(0)
  buffer_load_dwordx4 a[52:55], v30, s[20:23], s90 offen offset:256 sc1
  v_cvt_pk_bf16_f32 v148, v88, v89
  v_exp_f32 v91, v91
  v_exp_f32 v92, v92
  v_cvt_pk_bf16_f32 v149, v90, v91
  v_exp_f32 v93, v93
  v_exp_f32 v94, v94
  v_exp_f32 v95, v95
  v_cvt_pk_bf16_f32 v150, v92, v93
  v_cvt_pk_bf16_f32 v151, v94, v95
  v_mfma_f32_32x32x16_bf16 v[80:95], v[160:163], v[32:35], v[48:63]
  ds_read_b128 v[176:179], v2 offset:2048
  v_exp_f32 v96, v96
  v_exp_f32 v97, v97
  v_exp_f32 v98, v98
  v_mfma_f32_32x32x16_bf16 v[112:127], v[188:191], v[148:151], v[112:127]
  ds_read_b128 v[180:183], v2 offset:3072
  v_cvt_pk_bf16_f32 v152, v96, v97
  v_exp_f32 v99, v99
  v_exp_f32 v100, v100
  v_cvt_pk_bf16_f32 v153, v98, v99
  v_smfmac_f32_16x16x64_bf16 v[192:195], v[16:19], v[144:151], v13
  v_exp_f32 v101, v101
  v_mfma_f32_32x32x16_bf16 v[80:95], v[164:167], v[36:39], v[80:95]
  buffer_load_dwordx4 a[56:59], v30, s[20:23], s90 offen offset:2048 sc1
  v_exp_f32 v102, v102
  v_cvt_pk_bf16_f32 v154, v100, v101
  v_exp_f32 v103, v103
  v_exp_f32 v104, v104
  v_cvt_pk_bf16_f32 v155, v102, v103
  v_exp_f32 v105, v105
  v_exp_f32 v106, v106
  v_mfma_f32_32x32x16_bf16 v[128:143], v[184:187], v[152:155], v[128:143]
L_touch5:
  s_cbranch_execz L_tdisp1
  s_waitcnt lgkmcnt(0)
  buffer_load_dwordx4 a[60:63], v30, s[20:23], s90 offen offset:2304 sc1
  s_add_u32 s90, s90, 4096
  v_cvt_pk_bf16_f32 v156, v104, v105
  v_exp_f32 v107, v107
  v_exp_f32 v108, v108
  v_cvt_pk_bf16_f32 v157, v106, v107
  v_exp_f32 v109, v109
  v_exp_f32 v110, v110
  v_exp_f32 v111, v111
  v_cvt_pk_bf16_f32 v158, v108, v109
  v_cvt_pk_bf16_f32 v159, v110, v111
  v_mfma_f32_32x32x16_bf16 v[96:111], v[160:163], v[40:43], v[64:79]
  ds_read_b128 v[168:171], v2 offset:4096
  s_getpc_b64 s[76:77]
L_cpf2:
  s_add_u32 s76, s76, L_norm-L_cpf2
  s_addc_u32 s77, s77, 0
  v_exp_f32 v80, v80
  v_exp_f32 v81, v81
  v_exp_f32 v82, v82
  v_mfma_f32_32x32x16_bf16 v[128:143], v[188:191], v[156:159], v[128:143]
  ds_read_b128 v[172:175], v2 offset:5120
  s_lshl_b32 s64, s3, 13
  s_mul_i32 s63, s68, L_s3b-L_norm
  s_add_u32 s64, s64, s63
  v_cvt_pk_bf16_f32 v144, v80, v81
  v_exp_f32 v83, v83
  v_exp_f32 v84, v84
  v_cvt_pk_bf16_f32 v145, v82, v83
  v_smfmac_f32_16x16x64_bf16 v[196:199], v[16:19], v[152:159], v13
  v_lshl_add_u32 v20, v1, 7, s64
  v_exp_f32 v85, v85
  v_mfma_f32_32x32x16_bf16 v[96:111], v[164:167], v[44:47], v[96:111]
  v_exp_f32 v86, v86
  v_cvt_pk_bf16_f32 v146, v84, v85
  v_exp_f32 v87, v87
  v_exp_f32 v88, v88
  v_cvt_pk_bf16_f32 v147, v86, v87
  v_exp_f32 v89, v89
  v_exp_f32 v90, v90
  v_mfma_f32_32x32x16_bf16 v[112:127], v[176:179], v[144:147], v[112:127]
  s_waitcnt lgkmcnt(0)
  v_cvt_pk_bf16_f32 v148, v88, v89
  v_exp_f32 v91, v91
  v_exp_f32 v92, v92
  v_cvt_pk_bf16_f32 v149, v90, v91
  v_exp_f32 v93, v93
  v_exp_f32 v94, v94
  v_exp_f32 v95, v95
  v_cvt_pk_bf16_f32 v150, v92, v93
  v_cvt_pk_bf16_f32 v151, v94, v95
  v_mfma_f32_32x32x16_bf16 v[80:95], v[168:171], v[32:35], v[48:63]
  ds_read_b128 v[184:187], v2 offset:6144
  v_min_u32 v20, L_codeend-L_norm-4, v20
  v_exp_f32 v96, v96
  v_exp_f32 v97, v97
  v_exp_f32 v98, v98
  v_mfma_f32_32x32x16_bf16 v[112:127], v[180:183], v[148:151], v[112:127]
  ds_read_b128 v[188:191], v2 offset:7168
  v_mov_b32 v21, s77
  v_cvt_pk_bf16_f32 v152, v96, v97
  v_exp_f32 v99, v99
  v_exp_f32 v100, v100
  v_cvt_pk_bf16_f32 v153, v98, v99
  v_smfmac_f32_16x16x64_bf16 v[192:195], v[16:19], v[144:151], v13
  v_add_co_u32 v20, vcc, s76, v20
  s_mov_b32 m0, s85
  v_exp_f32 v101, v101
  v_mfma_f32_32x32x16_bf16 v[80:95], v[172:175], v[36:39], v[80:95]
  buffer_load_dwordx4 v3, s[20:23], s83 offen offset:0 sc1 lds
  v_exp_f32 v102, v102
  v_cvt_pk_bf16_f32 v154, v100, v101
  v_exp_f32 v103, v103
  v_exp_f32 v104, v104
  v_cvt_pk_bf16_f32 v155, v102, v103
  v_exp_f32 v105, v105
  v_exp_f32 v106, v106
  v_mfma_f32_32x32x16_bf16 v[128:143], v[176:179], v[152:155], v[128:143]
  s_waitcnt lgkmcnt(0)
  buffer_load_dwordx4 v3, s[20:23], s83 offen offset:1024 sc1 lds
  v_cvt_pk_bf16_f32 v156, v104, v105
  v_exp_f32 v107, v107
  v_exp_f32 v108, v108
  v_cvt_pk_bf16_f32 v157, v106, v107
  v_exp_f32 v109, v109
  v_exp_f32 v110, v110
  v_exp_f32 v111, v111
  v_cvt_pk_bf16_f32 v158, v108, v109
  v_cvt_pk_bf16_f32 v159, v110, v111
  v_mfma_f32_32x32x16_bf16 v[96:111], v[168:171], v[40:43], v[64:79]
  ds_read_b128 v[160:163], v2 offset:8192
  v_addc_co_u32 v21, vcc, 0, v21, vcc
  v_exp_f32 v80, v80
  v_exp_f32 v81, v81
  v_exp_f32 v82, v82
  v_mfma_f32_32x32x16_bf16 v[128:143], v[180:183], v[156:159], v[128:143]
  ds_read_b128 v[164:167], v2 offset:9216
  global_load_dword v22, v[20:21], off
  v_cvt_pk_bf16_f32 v144, v80, v81
  v_exp_f32 v83, v83
  v_exp_f32 v84, v84
  v_cvt_pk_bf16_f32 v145, v82, v83
  v_smfmac_f32_16x16x64_bf16 v[196:199], v[16:19], v[152:159], v13
  s_add_u32 s84, s83, 4096
  v_exp_f32 v85, v85
  v_mfma_f32_32x32x16_bf16 v[96:111], v[172:175], v[44:47], v[96:111]
  buffer_load_dwordx4 v3, s[20:23], s83 offen offset:2048 sc1 lds
  v_exp_f32 v86, v86
  v_cvt_pk_bf16_f32 v146, v84, v85
  v_exp_f32 v87, v87
  v_exp_f32 v88, v88
  v_cvt_pk_bf16_f32 v147, v86, v87
  v_exp_f32 v89, v89
  v_exp_f32 v90, v90
  v_mfma_f32_32x32x16_bf16 v[112:127], v[184:187], v[144:147], v[112:127]
  s_waitcnt lgkmcnt(0)
  buffer_load_dwordx4 v3, s[20:23], s83 offen offset:3072 sc1 lds
  v_cvt_pk_bf16_f32 v148, v88, v89
  v_exp_f32 v91, v91
  v_exp_f32 v92, v92
  v_cvt_pk_bf16_f32 v149, v90, v91
  v_exp_f32 v93, v93
  v_exp_f32 v94, v94
  v_exp_f32 v95, v95
  v_cvt_pk_bf16_f32 v150, v92, v93
  v_cvt_pk_bf16_f32 v151, v94, v95
  v_mfma_f32_32x32x16_bf16 v[80:95], v[160:163], v[32:35], v[48:63]
  ds_read_b128 v[176:179], v2 offset:10240
  v_exp_f32 v96, v96
  v_exp_f32 v97, v97
  v_exp_f32 v98, v98
  v_mfma_f32_32x32x16_bf16 v[112:127], v[188:191], v[148:151], v[112:127]
  ds_read_b128 v[180:183], v2 offset:11264
  v_cvt_pk_bf16_f32 v152, v96, v97
  v_exp_f32 v99, v99
  v_exp_f32 v100, v100
  v_cvt_pk_bf16_f32 v153, v98, v99
  v_smfmac_f32_16x16x64_bf16 v[192:195], v[16:19], v[144:151], v13
  s_add_u32 m0, s85, 4096
  v_exp_f32 v101, v101
  v_mfma_f32_32x32x16_bf16 v[80:95], v[164:167], v[36:39], v[80:95]
  buffer_load_dwordx4 v3, s[20:23], s84 offen offset:0 sc1 lds
  v_exp_f32 v102, v102
  v_cvt_pk_bf16_f32 v154, v100, v101
  v_exp_f32 v103, v103
  v_exp_f32 v104, v104
  v_cvt_pk_bf16_f32 v155, v102, v103
  v_exp_f32 v105, v105
  v_exp_f32 v106, v106
  v_mfma_f32_32x32x16_bf16 v[128:143], v[184:187], v[152:155], v[128:143]
  s_waitcnt lgkmcnt(0)
  buffer_load_dwordx4 v3, s[20:23], s84 offen offset:1024 sc1 lds
  v_cvt_pk_bf16_f32 v156, v104, v105
  v_exp_f32 v107, v107
  v_exp_f32 v108, v108
  v_cvt_pk_bf16_f32 v157, v106, v107
  v_exp_f32 v109, v109
  v_exp_f32 v110, v110
  v_exp_f32 v111, v111
  v_cvt_pk_bf16_f32 v158, v108, v109
  v_cvt_pk_bf16_f32 v159, v110, v111
  v_mfma_f32_32x32x16_bf16 v[96:111], v[160:163], v[40:43], v[64:79]
  ds_read_b128 v[168:171], v2 offset:12288
  v_accvgpr_read_b32 v14, a242
  v_exp_f32 v80, v80
  v_exp_f32 v81, v81
  v_exp_f32 v82, v82
  v_mfma_f32_32x32x16_bf16 v[128:143], v[188:191], v[156:159], v[128:143]
  ds_read_b128 v[172:175], v2 offset:13312
  buffer_load_dword v6, v14, s[20:23], s94 offen offset:32 sc1
  v_cvt_pk_bf16_f32 v144, v80, v81
  v_exp_f32 v83, v83
  v_exp_f32 v84, v84
  v_cvt_pk_bf16_f32 v145, v82, v83
  v_smfmac_f32_16x16x64_bf16 v[196:199], v[16:19], v[152:159], v13
  buffer_load_dword v31, v14, s[20:23], s94 offen offset:2080 sc1
  v_exp_f32 v85, v85
  v_mfma_f32_32x32x16_bf16 v[96:111], v[164:167], v[44:47], v[96:111]
  buffer_load_dwordx4 v3, s[20:23], s84 offen offset:2048 sc1 lds
  v_exp_f32 v86, v86
  v_cvt_pk_bf16_f32 v146, v84, v85
  v_exp_f32 v87, v87
  v_exp_f32 v88, v88
  v_cvt_pk_bf16_f32 v147, v86, v87
  v_exp_f32 v89, v89
  v_exp_f32 v90, v90
  v_mfma_f32_32x32x16_bf16 v[112:127], v[176:179], v[144:147], v[112:127]
  s_waitcnt lgkmcnt(0)
  buffer_load_dwordx4 v3, s[20:23], s84 offen offset:3072 sc1 lds
  v_cvt_pk_bf16_f32 v148, v88, v89
  v_exp_f32 v91, v91
  v_exp_f32 v92, v92
  v_cvt_pk_bf16_f32 v149, v90, v91
  v_exp_f32 v93, v93
  v_exp_f32 v94, v94
  v_exp_f32 v95, v95
  v_cvt_pk_bf16_f32 v150, v92, v93
  v_cvt_pk_bf16_f32 v151, v94, v95
  v_mfma_f32_32x32x16_bf16 v[80:95], v[168:171], v[32:35], v[48:63]
  ds_read_b128 v[184:187], v2 offset:14336
  v_exp_f32 v96, v96
  v_exp_f32 v97, v97
  v_exp_f32 v98, v98
  v_mfma_f32_32x32x16_bf16 v[112:127], v[180:183], v[148:151], v[112:127]
  ds_read_b128 v[188:191], v2 offset:15360
  v_cvt_pk_bf16_f32 v152, v96, v97
  v_exp_f32 v99, v99
  v_exp_f32 v100, v100
  v_cvt_pk_bf16_f32 v153, v98, v99
  v_smfmac_f32_16x16x64_bf16 v[192:195], v[16:19], v[144:151], v13
  s_xor_b32 s85, s85, 32768
  v_exp_f32 v101, v101
  v_mfma_f32_32x32x16_bf16 v[80:95], v[172:175], v[36:39], v[80:95]
  buffer_load_dwordx4 a[64:67], v30, s[20:23], s90 offen offset:0 sc1
  v_exp_f32 v102, v102
  v_cvt_pk_bf16_f32 v154, v100, v101
  v_exp_f32 v103, v103
  v_exp_f32 v104, v104
  v_cvt_pk_bf16_f32 v155, v102, v103
  v_exp_f32 v105, v105
  v_exp_f32 v106, v106
  v_mfma_f32_32x32x16_bf16 v[128:143], v[176:179], v[152:155], v[128:143]
  s_waitcnt lgkmcnt(0)
  buffer_load_dwordx4 a[68:71], v30, s[20:23], s90 offen offset:256 sc1
  v_cvt_pk_bf16_f32 v156, v104, v105
  v_exp_f32 v107, v107
  v_exp_f32 v108, v108
  v_cvt_pk_bf16_f32 v157, v106, v107
  v_exp_f32 v109, v109
  v_exp_f32 v110, v110
  v_exp_f32 v111, v111
  v_cvt_pk_bf16_f32 v158, v108, v109
  v_cvt_pk_bf16_f32 v159, v110, v111
  v_mfma_f32_32x32x16_bf16 v[96:111], v[168:171], v[40:43], v[64:79]
  ds_read_b128 v[160:163], v2 offset:16384
  v_exp_f32 v80, v80
  v_exp_f32 v81, v81
  v_exp_f32 v82, v82
  v_mfma_f32_32x32x16_bf16 v[128:143], v[180:183], v[156:159], v[128:143]
  ds_read_b128 v[164:167], v2 offset:17408
  v_cvt_pk_bf16_f32 v144, v80, v81
  v_exp_f32 v83, v83
  v_exp_f32 v84, v84
  v_cvt_pk_bf16_f32 v145, v82, v83
  v_smfmac_f32_16x16x64_bf16 v[196:199], v[16:19], v[152:159], v13
  v_exp_f32 v85, v85
  v_mfma_f32_32x32x16_bf16 v[96:111], v[172:175], v[44:47], v[96:111]
  buffer_load_dwordx4 a[72:75], v30, s[20:23], s90 offen offset:2048 sc1
  v_exp_f32 v86, v86
  v_cvt_pk_bf16_f32 v146, v84, v85
  v_exp_f32 v87, v87
  v_exp_f32 v88, v88
  v_cvt_pk_bf16_f32 v147, v86, v87
  v_exp_f32 v89, v89
  v_exp_f32 v90, v90
  v_mfma_f32_32x32x16_bf16 v[112:127], v[184:187], v[144:147], v[112:127]
  s_waitcnt lgkmcnt(0)
  buffer_load_dwordx4 a[76:79], v30, s[20:23], s90 offen offset:2304 sc1
  s_add_u32 s90, s90, 4096
  v_cvt_pk_bf16_f32 v148, v88, v89
  v_exp_f32 v91, v91
  v_exp_f32 v92, v92
  v_cvt_pk_bf16_f32 v149, v90, v91
  v_exp_f32 v93, v93
  v_exp_f32 v94, v94
  v_exp_f32 v95, v95
  v_cvt_pk_bf16_f32 v150, v92, v93
  v_cvt_pk_bf16_f32 v151, v94, v95
  v_mfma_f32_32x32x16_bf16 v[80:95], v[160:163], v[32:35], v[48:63]
  ds_read_b128 v[176:179], v2 offset:18432
  v_exp_f32 v96, v96
  v_exp_f32 v97, v97
  v_exp_f32 v98, v98
  v_mfma_f32_32x32x16_bf16 v[112:127], v[188:191], v[148:151], v[112:127]
  ds_read_b128 v[180:183], v2 offset:19456
  v_cvt_pk_bf16_f32 v152, v96, v97
  v_exp_f32 v99, v99
  v_exp_f32 v100, v100
  v_cvt_pk_bf16_f32 v153, v98, v99
  v_smfmac_f32_16x16x64_bf16 v[192:195], v[16:19], v[144:151], v13
  v_exp_f32 v101, v101
  v_mfma_f32_32x32x16_bf16 v[80:95], v[164:167], v[36:39], v[80:95]
  buffer_load_dwordx4 a[80:83], v30, s[20:23], s90 offen offset:0 sc1
  v_exp_f32 v102, v102
  v_cvt_pk_bf16_f32 v154, v100, v101
  v_exp_f32 v103, v103
  v_exp_f32 v104, v104
  v_cvt_pk_bf16_f32 v155, v102, v103
  v_exp_f32 v105, v105
  v_exp_f32 v106, v106
  v_mfma_f32_32x32x16_bf16 v[128:143], v[184:187], v[152:155], v[128:143]
  s_waitcnt lgkmcnt(0)
  buffer_load_dwordx4 a[84:87], v30, s[20:23], s90 offen offset:256 sc1
  v_cvt_pk_bf16_f32 v156, v104, v105
  v_exp_f32 v107, v107
  v_exp_f32 v108, v108
  v_cvt_pk_bf16_f32 v157, v106, v107
  v_exp_f32 v109, v109
  v_exp_f32 v110, v110
  v_exp_f32 v111, v111
  v_cvt_pk_bf16_f32 v158, v108, v109
  v_cvt_pk_bf16_f32 v159, v110, v111
  v_mfma_f32_32x32x16_bf16 v[96:111], v[160:163], v[40:43], v[64:79]
  ds_read_b128 v[168:171], v2 offset:20480
  v_exp_f32 v80, v80
  v_exp_f32 v81, v81
  v_exp_f32 v82, v82
  v_mfma_f32_32x32x16_bf16 v[128:143], v[188:191], v[156:159], v[128:143]
  ds_read_b128 v[172:175], v2 offset:21504
  v_cvt_pk_bf16_f32 v144, v80, v81
  v_exp_f32 v83, v83
  v_exp_f32 v84, v84
  v_cvt_pk_bf16_f32 v145, v82, v83
  v_smfmac_f32_16x16x64_bf16 v[196:199], v[16:19], v[152:159], v13
  v_exp_f32 v85, v85
  v_mfma_f32_32x32x16_bf16 v[96:111], v[164:167], v[44:47], v[96:111]
  buffer_load_dwordx4 a[88:91], v30, s[20:23], s90 offen offset:2048 sc1
  v_exp_f32 v86, v86
  v_cvt_pk_bf16_f32 v146, v84, v85
  v_exp_f32 v87, v87
  v_exp_f32 v88, v88
  v_cvt_pk_bf16_f32 v147, v86, v87
  v_exp_f32 v89, v89
  v_exp_f32 v90, v90
  v_mfma_f32_32x32x16_bf16 v[112:127], v[176:179], v[144:147], v[112:127]
  s_waitcnt lgkmcnt(0)
  buffer_load_dwordx4 a[92:95], v30, s[20:23], s90 offen offset:2304 sc1
  s_add_u32 s90, s90, 4096
  v_cvt_pk_bf16_f32 v148, v88, v89
  v_exp_f32 v91, v91
  v_exp_f32 v92, v92
  v_cvt_pk_bf16_f32 v149, v90, v91
  v_exp_f32 v93, v93
  v_exp_f32 v94, v94
  v_exp_f32 v95, v95
  v_cvt_pk_bf16_f32 v150, v92, v93
  v_cvt_pk_bf16_f32 v151, v94, v95
  v_mfma_f32_32x32x16_bf16 v[80:95], v[168:171], v[32:35], v[48:63]
  ds_read_b128 v[184:187], v2 offset:22528
  v_exp_f32 v96, v96
  v_exp_f32 v97, v97
  v_exp_f32 v98, v98
  v_mfma_f32_32x32x16_bf16 v[112:127], v[180:183], v[148:151], v[112:127]
  ds_read_b128 v[188:191], v2 offset:23552
  v_cvt_pk_bf16_f32 v152, v96, v97
  v_exp_f32 v99, v99
  v_exp_f32 v100, v100
  v_cvt_pk_bf16_f32 v153, v98, v99
  v_smfmac_f32_16x16x64_bf16 v[192:195], v[16:19], v[144:151], v13
  v_exp_f32 v101, v101
  v_mfma_f32_32x32x16_bf16 v[80:95], v[172:175], v[36:39], v[80:95]
  buffer_load_dwordx4 a[96:99], v30, s[20:23], s90 offen offset:0 sc1
  v_exp_f32 v102, v102
  v_cvt_pk_bf16_f32 v154, v100, v101
  v_exp_f32 v103, v103
  v_exp_f32 v104, v104
  v_cvt_pk_bf16_f32 v155, v102, v103
  v_exp_f32 v105, v105
  v_exp_f32 v106, v106
  v_mfma_f32_32x32x16_bf16 v[128:143], v[176:179], v[152:155], v[128:143]
  s_waitcnt lgkmcnt(0)
  buffer_load_dwordx4 a[100:103], v30, s[20:23], s90 offen offset:256 sc1
  v_cvt_pk_bf16_f32 v156, v104, v105
  v_exp_f32 v107, v107
  v_exp_f32 v108, v108
  v_cvt_pk_bf16_f32 v157, v106, v107
  v_exp_f32 v109, v109
  v_exp_f32 v110, v110
  v_exp_f32 v111, v111
  v_cvt_pk_bf16_f32 v158, v108, v109
  v_cvt_pk_bf16_f32 v159, v110, v111
  v_mfma_f32_32x32x16_bf16 v[96:111], v[168:171], v[40:43], v[64:79]
  ds_read_b128 v[160:163], v2 offset:24576
  v_exp_f32 v80, v80
  v_exp_f32 v81, v81
  v_exp_f32 v82, v82
  v_mfma_f32_32x32x16_bf16 v[128:143], v[180:183], v[156:159], v[128:143]
  ds_read_b128 v[164:167], v2 offset:25600
  v_cvt_pk_bf16_f32 v144, v80, v81
  v_exp_f32 v83, v83
  v_exp_f32 v84, v84
  v_cvt_pk_bf16_f32 v145, v82, v83
  v_smfmac_f32_16x16x64_bf16 v[196:199], v[16:19], v[152:159], v13
  v_exp_f32 v85, v85
  v_mfma_f32_32x32x16_bf16 v[96:111], v[172:175], v[44:47], v[96:111]
  buffer_load_dwordx4 a[104:107], v30, s[20:23], s90 offen offset:2048 sc1
  v_exp_f32 v86, v86
  v_cvt_pk_bf16_f32 v146, v84, v85
  v_exp_f32 v87, v87
  v_exp_f32 v88, v88
  v_cvt_pk_bf16_f32 v147, v86, v87
  v_exp_f32 v89, v89
  v_exp_f32 v90, v90
  v_mfma_f32_32x32x16_bf16 v[112:127], v[184:187], v[144:147], v[112:127]
  s_waitcnt lgkmcnt(0)
  buffer_load_dwordx4 a[108:111], v30, s[20:23], s90 offen offset:2304 sc1
  s_add_u32 s90, s90, 4096
  v_cvt_pk_bf16_f32 v148, v88, v89
  v_exp_f32 v91, v91
  v_exp_f32 v92, v92
  v_cvt_pk_bf16_f32 v149, v90, v91
  v_exp_f32 v93, v93
  v_exp_f32 v94, v94
  v_exp_f32 v95, v95
  v_cvt_pk_bf16_f32 v150, v92, v93
  v_cvt_pk_bf16_f32 v151, v94, v95
  v_mfma_f32_32x32x16_bf16 v[80:95], v[160:163], v[32:35], v[48:63]
  ds_read_b128 v[176:179], v2 offset:26624
  v_exp_f32 v96, v96
  v_exp_f32 v97, v97
  v_exp_f32 v98, v98
  v_mfma_f32_32x32x16_bf16 v[112:127], v[188:191], v[148:151], v[112:127]
  ds_read_b128 v[180:183], v2 offset:27648
  v_cvt_pk_bf16_f32 v152, v96, v97
  v_exp_f32 v99, v99
  v_exp_f32 v100, v100
  v_cvt_pk_bf16_f32 v153, v98, v99
  v_smfmac_f32_16x16x64_bf16 v[192:195], v[16:19], v[144:151], v13
  v_exp_f32 v101, v101
  v_mfma_f32_32x32x16_bf16 v[80:95], v[164:167], v[36:39], v[80:95]
  buffer_load_dwordx4 a[112:115], v30, s[20:23], s90 offen offset:0 sc1
  v_exp_f32 v102, v102
  v_cvt_pk_bf16_f32 v154, v100, v101
  v_exp_f32 v103, v103
  v_exp_f32 v104, v104
  v_cvt_pk_bf16_f32 v155, v102, v103
  v_exp_f32 v105, v105
  v_exp_f32 v106, v106
  v_mfma_f32_32x32x16_bf16 v[128:143], v[184:187], v[152:155], v[128:143]
  s_waitcnt lgkmcnt(0)
  buffer_load_dwordx4 a[116:119], v30, s[20:23], s90 offen offset:256 sc1
  v_cvt_pk_bf16_f32 v156, v104, v105
  v_exp_f32 v107, v107
  v_exp_f32 v108, v108
  v_cvt_pk_bf16_f32 v157, v106, v107
  v_exp_f32 v109, v109
  v_exp_f32 v110, v110
  v_exp_f32 v111, v111
  v_cvt_pk_bf16_f32 v158, v108, v109
  v_cvt_pk_bf16_f32 v159, v110, v111
  v_mfma_f32_32x32x16_bf16 v[96:111], v[160:163], v[40:43], v[64:79]
  ds_read_b128 v[168:171], v2 offset:28672
  v_exp_f32 v80, v80
  v_exp_f32 v81, v81
  v_exp_f32 v82, v82
  v_mfma_f32_32x32x16_bf16 v[128:143], v[188:191], v[156:159], v[128:143]
  ds_read_b128 v[172:175], v2 offset:29696
  v_cvt_pk_bf16_f32 v144, v80, v81
  v_exp_f32 v83, v83
  v_exp_f32 v84, v84
  v_cvt_pk_bf16_f32 v145, v82, v83
  v_smfmac_f32_16x16x64_bf16 v[196:199], v[16:19], v[152:159], v13
  s_add_u32 s82, s82, 1
  v_exp_f32 v85, v85
  v_mfma_f32_32x32x16_bf16 v[96:111], v[164:167], v[44:47], v[96:111]
  buffer_load_dwordx4 a[120:123], v30, s[20:23], s90 offen offset:2048 sc1
  v_exp_f32 v86, v86
  v_cvt_pk_bf16_f32 v146, v84, v85
  v_exp_f32 v87, v87
  v_exp_f32 v88, v88
  v_cvt_pk_bf16_f32 v147, v86, v87
  v_exp_f32 v89, v89
  v_exp_f32 v90, v90
  v_mfma_f32_32x32x16_bf16 v[112:127], v[176:179], v[144:147], v[112:127]
  s_waitcnt lgkmcnt(0)
  buffer_load_dwordx4 a[124:127], v30, s[20:23], s90 offen offset:2304 sc1
  s_add_u32 s90, s90, 4096
  v_cvt_pk_bf16_f32 v148, v88, v89
  v_exp_f32 v91, v91
  v_exp_f32 v92, v92
  v_cvt_pk_bf16_f32 v149, v90, v91
  v_exp_f32 v93, v93
  v_exp_f32 v94, v94
  v_exp_f32 v95, v95
  v_cvt_pk_bf16_f32 v150, v92, v93
  v_cvt_pk_bf16_f32 v151, v94, v95
  v_mfma_f32_32x32x16_bf16 v[80:95], v[168:171], v[32:35], v[48:63]
  ds_read_b128 v[184:187], v2 offset:30720
  v_exp_f32 v96, v96
  v_exp_f32 v97, v97
  v_exp_f32 v98, v98
  v_mfma_f32_32x32x16_bf16 v[112:127], v[180:183], v[148:151], v[112:127]
  ds_read_b128 v[188:191], v2 offset:31744
  v_cvt_pk_bf16_f32 v152, v96, v97
  v_exp_f32 v99, v99
  v_exp_f32 v100, v100
  v_cvt_pk_bf16_f32 v153, v98, v99
  v_smfmac_f32_16x16x64_bf16 v[192:195], v[16:19], v[144:151], v13
  s_and_b32 s82, s82, 7
  v_exp_f32 v101, v101
  v_mfma_f32_32x32x16_bf16 v[80:95], v[172:175], v[36:39], v[80:95]
  buffer_load_dwordx4 a[128:131], v30, s[20:23], s90 offen offset:0 sc1
  v_xor_b32 v2, 32768, v2
  v_exp_f32 v102, v102
  v_cvt_pk_bf16_f32 v154, v100, v101
  v_exp_f32 v103, v103
  v_exp_f32 v104, v104
  v_cvt_pk_bf16_f32 v155, v102, v103
  v_exp_f32 v105, v105
  v_exp_f32 v106, v106
  v_mfma_f32_32x32x16_bf16 v[128:143], v[176:179], v[152:155], v[128:143]
  s_waitcnt lgkmcnt(0)
  buffer_load_dwordx4 a[132:135], v30, s[20:23], s90 offen offset:256 sc1
  v_cvt_pk_bf16_f32 v156, v104, v105
  v_exp_f32 v107, v107
  v_exp_f32 v108, v108
  v_cvt_pk_bf16_f32 v157, v106, v107
  v_exp_f32 v109, v109
  v_exp_f32 v110, v110
  v_exp_f32 v111, v111
  v_cvt_pk_bf16_f32 v158, v108, v109
  v_cvt_pk_bf16_f32 v159, v110, v111
  s_waitcnt vmcnt(18) lgkmcnt(0)
  s_barrier
  v_mfma_f32_32x32x16_bf16 v[96:111], v[168:171], v[40:43], v[64:79]
  ds_read_b128 v[160:163], v2 offset:0
  v_exp_f32 v80, v80
  v_exp_f32 v81, v81
  v_exp_f32 v82, v82
  v_mfma_f32_32x32x16_bf16 v[128:143], v[180:183], v[156:159], v[128:143]
  ds_read_b128 v[164:167], v2 offset:1024
  v_cvt_pk_bf16_f32 v144, v80, v81
  v_exp_f32 v83, v83
  v_exp_f32 v84, v84
  v_cvt_pk_bf16_f32 v145, v82, v83
  v_smfmac_f32_16x16x64_bf16 v[196:199], v[16:19], v[152:159], v13
  s_lshl_b32 s83, s82, 15
  v_exp_f32 v85, v85
  v_mfma_f32_32x32x16_bf16 v[96:111], v[172:175], v[44:47], v[96:111]
  buffer_load_dwordx4 a[136:139], v30, s[20:23], s90 offen offset:2048 sc1
  s_add_u32 s83, s83, s81
  v_exp_f32 v86, v86
  v_cvt_pk_bf16_f32 v146, v84, v85
  v_exp_f32 v87, v87
  v_exp_f32 v88, v88
  v_cvt_pk_bf16_f32 v147, v86, v87
  v_exp_f32 v89, v89
  v_exp_f32 v90, v90
  v_mfma_f32_32x32x16_bf16 v[112:127], v[184:187], v[144:147], v[112:127]
  s_waitcnt lgkmcnt(0)
  buffer_load_dwordx4 a[140:143], v30, s[20:23], s90 offen offset:2304 sc1
  s_add_u32 s90, s90, 4096
  v_cvt_pk_bf16_f32 v148, v88, v89
  v_exp_f32 v91, v91
  v_exp_f32 v92, v92
  v_cvt_pk_bf16_f32 v149, v90, v91
  v_exp_f32 v93, v93
  v_exp_f32 v94, v94
  v_exp_f32 v95, v95
  v_cvt_pk_bf16_f32 v150, v92, v93
  v_cvt_pk_bf16_f32 v151, v94, v95
  v_mfma_f32_32x32x16_bf16 v[80:95], v[160:163], v[32:35], v[48:63]
  ds_read_b128 v[176:179], v2 offset:2048
  v_exp_f32 v96, v96
  v_exp_f32 v97, v97
  v_exp_f32 v98, v98
  v_mfma_f32_32x32x16_bf16 v[112:127], v[188:191], v[148:151], v[112:127]
  ds_read_b128 v[180:183], v2 offset:3072
  v_cvt_pk_bf16_f32 v152, v96, v97
  v_exp_f32 v99, v99
  v_exp_f32 v100, v100
  v_cvt_pk_bf16_f32 v153, v98, v99
  v_smfmac_f32_16x16x64_bf16 v[192:195], v[16:19], v[144:151], v13
  v_exp_f32 v101, v101
  v_mfma_f32_32x32x16_bf16 v[80:95], v[164:167], v[36:39], v[80:95]
  buffer_load_dwordx4 a[144:147], v30, s[20:23], s90 offen offset:0 sc1
  v_exp_f32 v102, v102
  v_cvt_pk_bf16_f32 v154, v100, v101
  v_exp_f32 v103, v103
  v_exp_f32 v104, v104
  v_cvt_pk_bf16_f32 v155, v102, v103
  v_exp_f32 v105, v105
  v_exp_f32 v106, v106
  v_mfma_f32_32x32x16_bf16 v[128:143], v[184:187], v[152:155], v[128:143]
  s_waitcnt lgkmcnt(0)
  buffer_load_dwordx4 a[148:151], v30, s[20:23], s90 offen offset:256 sc1
  v_cvt_pk_bf16_f32 v156, v104, v105
  v_exp_f32 v107, v107
  v_exp_f32 v108, v108
  v_cvt_pk_bf16_f32 v157, v106, v107
  v_exp_f32 v109, v109
  v_exp_f32 v110, v110
  v_exp_f32 v111, v111
  v_cvt_pk_bf16_f32 v158, v108, v109
  v_cvt_pk_bf16_f32 v159, v110, v111
  v_mfma_f32_32x32x16_bf16 v[96:111], v[160:163], v[40:43], v[64:79]
  ds_read_b128 v[168:171], v2 offset:4096
  v_exp_f32 v80, v80
  v_exp_f32 v81, v81
  v_exp_f32 v82, v82
  v_mfma_f32_32x32x16_bf16 v[128:143], v[188:191], v[156:159], v[128:143]
  ds_read_b128 v[172:175], v2 offset:5120
  v_cvt_pk_bf16_f32 v144, v80, v81
  v_exp_f32 v83, v83
  v_exp_f32 v84, v84
  v_cvt_pk_bf16_f32 v145, v82, v83
  v_smfmac_f32_16x16x64_bf16 v[196:199], v[16:19], v[152:159], v13
  buffer_load_dwordx4 a[152:155], v30, s[20:23], s90 offen offset:2048 sc1
  v_exp_f32 v85, v85
  v_mfma_f32_32x32x16_bf16 v[96:111], v[164:167], v[44:47], v[96:111]
  buffer_load_dwordx4 a[156:159], v30, s[20:23], s90 offen offset:2304 sc1
  s_add_u32 s90, s90, 4096
  v_exp_f32 v86, v86
  v_cvt_pk_bf16_f32 v146, v84, v85
  v_exp_f32 v87, v87
  v_exp_f32 v88, v88
  v_cvt_pk_bf16_f32 v147, v86, v87
  v_exp_f32 v89, v89
  v_exp_f32 v90, v90
  v_mfma_f32_32x32x16_bf16 v[112:127], v[176:179], v[144:147], v[112:127]
  s_waitcnt lgkmcnt(0)
  buffer_load_dwordx4 a[160:163], v30, s[20:23], s90 offen offset:0 sc1
  v_cvt_pk_bf16_f32 v148, v88, v89
  v_exp_f32 v91, v91
  v_exp_f32 v92, v92
  v_cvt_pk_bf16_f32 v149, v90, v91
  v_exp_f32 v93, v93
  v_exp_f32 v94, v94
  v_exp_f32 v95, v95
  v_cvt_pk_bf16_f32 v150, v92, v93
  v_cvt_pk_bf16_f32 v151, v94, v95
  v_mfma_f32_32x32x16_bf16 v[80:95], v[168:171], v[32:35], v[48:63]
  ds_read_b128 v[184:187], v2 offset:6144
  v_exp_f32 v96, v96
  v_exp_f32 v97, v97
  v_exp_f32 v98, v98
  v_mfma_f32_32x32x16_bf16 v[112:127], v[180:183], v[148:151], v[112:127]
  ds_read_b128 v[188:191], v2 offset:7168
  v_cvt_pk_bf16_f32 v152, v96, v97
  v_exp_f32 v99, v99
  v_exp_f32 v100, v100
  v_cvt_pk_bf16_f32 v153, v98, v99
  v_smfmac_f32_16x16x64_bf16 v[192:195], v[16:19], v[144:151], v13
  buffer_load_dwordx4 a[164:167], v30, s[20:23], s90 offen offset:256 sc1
  v_exp_f32 v101, v101
  v_mfma_f32_32x32x16_bf16 v[80:95], v[172:175], v[36:39], v[80:95]
  buffer_load_dwordx4 a[168:171], v30, s[20:23], s90 offen offset:2048 sc1
  v_exp_f32 v102, v102
  v_cvt_pk_bf16_f32 v154, v100, v101
  v_exp_f32 v103, v103
  v_exp_f32 v104, v104
  v_cvt_pk_bf16_f32 v155, v102, v103
  v_exp_f32 v105, v105
  v_exp_f32 v106, v106
  v_mfma_f32_32x32x16_bf16 v[128:143], v[176:179], v[152:155], v[128:143]
  s_waitcnt lgkmcnt(0)
  buffer_load_dwordx4 a[172:175], v30, s[20:23], s90 offen offset:2304 sc1
  s_add_u32 s90, s90, 4096
  v_cvt_pk_bf16_f32 v156, v104, v105
  v_exp_f32 v107, v107
  v_exp_f32 v108, v108
  v_cvt_pk_bf16_f32 v157, v106, v107
  v_exp_f32 v109, v109
  v_exp_f32 v110, v110
  v_exp_f32 v111, v111
  v_cvt_pk_bf16_f32 v158, v108, v109
  v_cvt_pk_bf16_f32 v159, v110, v111
  v_mfma_f32_32x32x16_bf16 v[96:111], v[168:171], v[40:43], v[64:79]
  ds_read_b128 v[160:163], v2 offset:8192
  v_exp_f32 v80, v80
  v_exp_f32 v81, v81
  v_exp_f32 v82, v82
  v_mfma_f32_32x32x16_bf16 v[128:143], v[180:183], v[156:159], v[128:143]
  ds_read_b128 v[164:167], v2 offset:9216
  v_cvt_pk_bf16_f32 v144, v80, v81
  v_exp_f32 v83, v83
  v_exp_f32 v84, v84
  v_cvt_pk_bf16_f32 v145, v82, v83
  v_smfmac_f32_16x16x64_bf16 v[196:199], v[16:19], v[152:159], v13
  buffer_load_dwordx4 a[176:179], v30, s[20:23], s90 offen offset:0 sc1
  v_exp_f32 v85, v85
  v_mfma_f32_32x32x16_bf16 v[96:111], v[172:175], v[44:47], v[96:111]
  buffer_load_dwordx4 a[180:183], v30, s[20:23], s90 offen offset:256 sc1
  v_exp_f32 v86, v86
  v_cvt_pk_bf16_f32 v146, v84, v85
  v_exp_f32 v87, v87
  v_exp_f32 v88, v88
  v_cvt_pk_bf16_f32 v147, v86, v87
  v_exp_f32 v89, v89
L_touch6:
  s_cbranch_execz L_tdisp2
  v_exp_f32 v90, v90
  v_mfma_f32_32x32x16_bf16 v[112:127], v[184:187], v[144:147], v[112:127]
  s_waitcnt lgkmcnt(0)
  buffer_load_dwordx4 a[184:187], v30, s[20:23], s90 offen offset:2048 sc1
  v_cvt_pk_bf16_f32 v148, v88, v89
  v_exp_f32 v91, v91
  v_exp_f32 v92, v92
  v_cvt_pk_bf16_f32 v149, v90, v91
  v_exp_f32 v93, v93
  v_exp_f32 v94, v94
  v_exp_f32 v95, v95
  v_cvt_pk_bf16_f32 v150, v92, v93
  v_cvt_pk_bf16_f32 v151, v94, v95
  v_mfma_f32_32x32x16_bf16 v[80:95], v[160:163], v[32:35], v[48:63]
  ds_read_b128 v[176:179], v2 offset:10240
  v_exp_f32 v96, v96
  v_exp_f32 v97, v97
  v_exp_f32 v98, v98
  v_mfma_f32_32x32x16_bf16 v[112:127], v[188:191], v[148:151], v[112:127]
  ds_read_b128 v[180:183], v2 offset:11264
  v_cvt_pk_bf16_f32 v152, v96, v97
  v_exp_f32 v99, v99
  v_exp_f32 v100, v100
  v_cvt_pk_bf16_f32 v153, v98, v99
  v_smfmac_f32_16x16x64_bf16 v[192:195], v[16:19], v[144:151], v13
  buffer_load_dwordx4 a[188:191], v30, s[20:23], s90 offen offset:2304 sc1
  s_add_u32 s90, s90, 4096
  v_exp_f32 v101, v101
  v_mfma_f32_32x32x16_bf16 v[80:95], v[164:167], v[36:39], v[80:95]
  buffer_load_dwordx4 a[192:195], v30, s[20:23], s90 offen offset:0 sc1
  v_exp_f32 v102, v102
  v_cvt_pk_bf16_f32 v154, v100, v101
  v_exp_f32 v103, v103
  v_exp_f32 v104, v104
  v_cvt_pk_bf16_f32 v155, v102, v103
  v_exp_f32 v105, v105
  v_exp_f32 v106, v106
  v_mfma_f32_32x32x16_bf16 v[128:143], v[184:187], v[152:155], v[128:143]
  s_waitcnt lgkmcnt(0)
  buffer_load_dwordx4 a[196:199], v30, s[20:23], s90 offen offset:256 sc1
  v_cvt_pk_bf16_f32 v156, v104, v105
  v_exp_f32 v107, v107
  v_exp_f32 v108, v108
  v_cvt_pk_bf16_f32 v157, v106, v107
  v_exp_f32 v109, v109
  v_exp_f32 v110, v110
  v_exp_f32 v111, v111
  v_cvt_pk_bf16_f32 v158, v108, v109
  v_cvt_pk_bf16_f32 v159, v110, v111
  v_mfma_f32_32x32x16_bf16 v[96:111], v[160:163], v[40:43], v[64:79]
  ds_read_b128 v[168:171], v2 offset:12288
  v_exp_f32 v80, v80
  v_exp_f32 v81, v81
  v_exp_f32 v82, v82
  v_mfma_f32_32x32x16_bf16 v[128:143], v[188:191], v[156:159], v[128:143]
  ds_read_b128 v[172:175], v2 offset:13312
  v_cvt_pk_bf16_f32 v144, v80, v81
  v_exp_f32 v83, v83
  v_exp_f32 v84, v84
  v_cvt_pk_bf16_f32 v145, v82, v83
  v_smfmac_f32_16x16x64_bf16 v[196:199], v[16:19], v[152:159], v13
  v_exp_f32 v85, v85
  v_mfma_f32_32x32x16_bf16 v[96:111], v[164:167], v[44:47], v[96:111]
  buffer_load_dwordx4 a[200:203], v30, s[20:23], s90 offen offset:2048 sc1
  v_exp_f32 v86, v86
  v_cvt_pk_bf16_f32 v146, v84, v85
  v_exp_f32 v87, v87
  v_exp_f32 v88, v88
  v_cvt_pk_bf16_f32 v147, v86, v87
  v_exp_f32 v89, v89
  v_exp_f32 v90, v90
  v_mfma_f32_32x32x16_bf16 v[112:127], v[176:179], v[144:147], v[112:127]
  s_waitcnt lgkmcnt(0)
  buffer_load_dwordx4 a[204:207], v30, s[20:23], s90 offen offset:2304 sc1
  s_add_u32 s90, s90, 4096
  v_cvt_pk_bf16_f32 v148, v88, v89
  v_exp_f32 v91, v91
  v_exp_f32 v92, v92
  v_cvt_pk_bf16_f32 v149, v90, v91
  v_exp_f32 v93, v93
  v_exp_f32 v94, v94
  v_exp_f32 v95, v95
  v_cvt_pk_bf16_f32 v150, v92, v93
  v_cvt_pk_bf16_f32 v151, v94, v95
  v_mfma_f32_32x32x16_bf16 v[80:95], v[168:171], v[32:35], v[48:63]
  ds_read_b128 v[184:187], v2 offset:14336
  v_exp_f32 v96, v96
  v_exp_f32 v97, v97
  v_exp_f32 v98, v98
  v_mfma_f32_32x32x16_bf16 v[112:127], v[180:183], v[148:151], v[112:127]
  ds_read_b128 v[188:191], v2 offset:15360
  v_cvt_pk_bf16_f32 v152, v96, v97
  v_exp_f32 v99, v99
  v_exp_f32 v100, v100
  v_cvt_pk_bf16_f32 v153, v98, v99
  v_smfmac_f32_16x16x64_bf16 v[192:195], v[16:19], v[144:151], v13
  v_exp_f32 v101, v101
  v_mfma_f32_32x32x16_bf16 v[80:95], v[172:175], v[36:39], v[80:95]
  buffer_load_dwordx4 a[208:211], v30, s[20:23], s90 offen offset:0 sc1
  v_exp_f32 v102, v102
  v_cvt_pk_bf16_f32 v154, v100, v101
  v_exp_f32 v103, v103
  v_exp_f32 v104, v104
  v_cvt_pk_bf16_f32 v155, v102, v103
  v_exp_f32 v105, v105
  v_exp_f32 v106, v106
  v_mfma_f32_32x32x16_bf16 v[128:143], v[176:179], v[152:155], v[128:143]
  s_waitcnt lgkmcnt(0)
  buffer_load_dwordx4 a[212:215], v30, s[20:23], s90 offen offset:256 sc1
  v_cvt_pk_bf16_f32 v156, v104, v105
  v_exp_f32 v107, v107
  v_exp_f32 v108, v108
  v_cvt_pk_bf16_f32 v157, v106, v107
  v_exp_f32 v109, v109
  v_exp_f32 v110, v110
  v_exp_f32 v111, v111
  v_cvt_pk_bf16_f32 v158, v108, v109
  v_cvt_pk_bf16_f32 v159, v110, v111
  v_mfma_f32_32x32x16_bf16 v[96:111], v[168:171], v[40:43], v[64:79]
  ds_read_b128 v[160:163], v2 offset:16384
  v_exp_f32 v80, v80
  v_exp_f32 v81, v81
  v_exp_f32 v82, v82
  v_mfma_f32_32x32x16_bf16 v[128:143], v[180:183], v[156:159], v[128:143]
  ds_read_b128 v[164:167], v2 offset:17408
  v_cvt_pk_bf16_f32 v144, v80, v81
  v_exp_f32 v83, v83
  v_exp_f32 v84, v84
  v_cvt_pk_bf16_f32 v145, v82, v83
  v_smfmac_f32_16x16x64_bf16 v[196:199], v[16:19], v[152:159], v13
  v_exp_f32 v85, v85
  v_mfma_f32_32x32x16_bf16 v[96:111], v[172:175], v[44:47], v[96:111]
  buffer_load_dwordx4 a[216:219], v30, s[20:23], s90 offen offset:2048 sc1
  v_exp_f32 v86, v86
  v_cvt_pk_bf16_f32 v146, v84, v85
  v_exp_f32 v87, v87
  v_exp_f32 v88, v88
  v_cvt_pk_bf16_f32 v147, v86, v87
  v_exp_f32 v89, v89
  v_exp_f32 v90, v90
  v_mfma_f32_32x32x16_bf16 v[112:127], v[184:187], v[144:147], v[112:127]
  s_waitcnt lgkmcnt(0)
  buffer_load_dwordx4 a[220:223], v30, s[20:23], s90 offen offset:2304 sc1
  s_add_u32 s90, s90, 4096
  v_cvt_pk_bf16_f32 v148, v88, v89
  v_exp_f32 v91, v91
  v_exp_f32 v92, v92
  v_cvt_pk_bf16_f32 v149, v90, v91
  v_exp_f32 v93, v93
  v_exp_f32 v94, v94
  v_exp_f32 v95, v95
  v_cvt_pk_bf16_f32 v150, v92, v93
  v_cvt_pk_bf16_f32 v151, v94, v95
  v_mfma_f32_32x32x16_bf16 v[80:95], v[160:163], v[32:35], v[48:63]
  ds_read_b128 v[176:179], v2 offset:18432
  v_exp_f32 v96, v96
  v_exp_f32 v97, v97
  v_exp_f32 v98, v98
  v_mfma_f32_32x32x16_bf16 v[112:127], v[188:191], v[148:151], v[112:127]
  ds_read_b128 v[180:183], v2 offset:19456
  v_cvt_pk_bf16_f32 v152, v96, v97
  v_exp_f32 v99, v99
  v_exp_f32 v100, v100
  v_cvt_pk_bf16_f32 v153, v98, v99
  v_smfmac_f32_16x16x64_bf16 v[192:195], v[16:19], v[144:151], v13
  v_exp_f32 v101, v101
  v_mfma_f32_32x32x16_bf16 v[80:95], v[164:167], v[36:39], v[80:95]
  buffer_load_dwordx4 v[200:203], v30, s[20:23], s90 offen offset:0 sc1
  v_exp_f32 v102, v102
  v_cvt_pk_bf16_f32 v154, v100, v101
  v_exp_f32 v103, v103
  v_exp_f32 v104, v104
  v_cvt_pk_bf16_f32 v155, v102, v103
  v_exp_f32 v105, v105
  v_exp_f32 v106, v106
  v_mfma_f32_32x32x16_bf16 v[128:143], v[184:187], v[152:155], v[128:143]
  s_waitcnt lgkmcnt(0)
  buffer_load_dwordx4 v[204:207], v30, s[20:23], s90 offen offset:256 sc1
  v_cvt_pk_bf16_f32 v156, v104, v105
  v_exp_f32 v107, v107
  v_exp_f32 v108, v108
  v_cvt_pk_bf16_f32 v157, v106, v107
  v_exp_f32 v109, v109
  v_exp_f32 v110, v110
  v_exp_f32 v111, v111
  v_cvt_pk_bf16_f32 v158, v108, v109
  v_cvt_pk_bf16_f32 v159, v110, v111
  v_mfma_f32_32x32x16_bf16 v[96:111], v[160:163], v[40:43], v[64:79]
  ds_read_b128 v[168:171], v2 offset:20480
  v_exp_f32 v80, v80
  v_exp_f32 v81, v81
  v_exp_f32 v82, v82
  v_mfma_f32_32x32x16_bf16 v[128:143], v[188:191], v[156:159], v[128:143]
  ds_read_b128 v[172:175], v2 offset:21504
  v_cvt_pk_bf16_f32 v144, v80, v81
  v_exp_f32 v83, v83
  v_exp_f32 v84, v84
  v_cvt_pk_bf16_f32 v145, v82, v83
  v_smfmac_f32_16x16x64_bf16 v[196:199], v[16:19], v[152:159], v13
  v_exp_f32 v85, v85
  v_mfma_f32_32x32x16_bf16 v[96:111], v[164:167], v[44:47], v[96:111]
  buffer_load_dwordx4 v[208:211], v30, s[20:23], s90 offen offset:2048 sc1
  v_exp_f32 v86, v86
  v_cvt_pk_bf16_f32 v146, v84, v85
  v_exp_f32 v87, v87
  v_exp_f32 v88, v88
  v_cvt_pk_bf16_f32 v147, v86, v87
  v_exp_f32 v89, v89
  v_exp_f32 v90, v90
  v_mfma_f32_32x32x16_bf16 v[112:127], v[176:179], v[144:147], v[112:127]
  s_waitcnt lgkmcnt(0)
  buffer_load_dwordx4 v[212:215], v30, s[20:23], s90 offen offset:2304 sc1
  s_add_u32 s90, s90, 4096
  v_cvt_pk_bf16_f32 v148, v88, v89
  v_exp_f32 v91, v91
  v_exp_f32 v92, v92
  v_cvt_pk_bf16_f32 v149, v90, v91
  v_exp_f32 v93, v93
  v_exp_f32 v94, v94
  v_exp_f32 v95, v95
  v_cvt_pk_bf16_f32 v150, v92, v93
  v_cvt_pk_bf16_f32 v151, v94, v95
  v_mfma_f32_32x32x16_bf16 v[80:95], v[168:171], v[32:35], v[48:63]
  ds_read_b128 v[184:187], v2 offset:22528
  v_exp_f32 v96, v96
  v_exp_f32 v97, v97
  v_exp_f32 v98, v98
  v_mfma_f32_32x32x16_bf16 v[112:127], v[180:183], v[148:151], v[112:127]
  ds_read_b128 v[188:191], v2 offset:23552
  v_cvt_pk_bf16_f32 v152, v96, v97
  v_exp_f32 v99, v99
  v_exp_f32 v100, v100
  v_cvt_pk_bf16_f32 v153, v98, v99
  v_smfmac_f32_16x16x64_bf16 v[192:195], v[16:19], v[144:151], v13
  v_exp_f32 v101, v101
  v_mfma_f32_32x32x16_bf16 v[80:95], v[172:175], v[36:39], v[80:95]
  buffer_load_dwordx4 v[216:219], v30, s[20:23], s90 offen offset:0 sc1
  v_exp_f32 v102, v102
  v_cvt_pk_bf16_f32 v154, v100, v101
  v_exp_f32 v103, v103
  v_exp_f32 v104, v104
  v_cvt_pk_bf16_f32 v155, v102, v103
  v_exp_f32 v105, v105
  v_exp_f32 v106, v106
  v_mfma_f32_32x32x16_bf16 v[128:143], v[176:179], v[152:155], v[128:143]
  s_waitcnt lgkmcnt(0)
  buffer_load_dwordx4 v[220:223], v30, s[20:23], s90 offen offset:256 sc1
  v_cvt_pk_bf16_f32 v156, v104, v105
  v_exp_f32 v107, v107
  v_exp_f32 v108, v108
  v_cvt_pk_bf16_f32 v157, v106, v107
  v_exp_f32 v109, v109
  v_exp_f32 v110, v110
  v_exp_f32 v111, v111
  v_cvt_pk_bf16_f32 v158, v108, v109
  v_cvt_pk_bf16_f32 v159, v110, v111
  v_mfma_f32_32x32x16_bf16 v[96:111], v[168:171], v[40:43], v[64:79]
  ds_read_b128 v[160:163], v2 offset:24576
  v_exp_f32 v80, v80
  v_exp_f32 v81, v81
  v_exp_f32 v82, v82
  v_mfma_f32_32x32x16_bf16 v[128:143], v[180:183], v[156:159], v[128:143]
  ds_read_b128 v[164:167], v2 offset:25600
  v_cvt_pk_bf16_f32 v144, v80, v81
  v_exp_f32 v83, v83
  v_exp_f32 v84, v84
  v_cvt_pk_bf16_f32 v145, v82, v83
  v_smfmac_f32_16x16x64_bf16 v[196:199], v[16:19], v[152:159], v13
  v_accvgpr_read_b32 v20, a234
  v_exp_f32 v85, v85
  v_mfma_f32_32x32x16_bf16 v[96:111], v[172:175], v[44:47], v[96:111]
  buffer_load_dwordx4 v[224:227], v30, s[20:23], s90 offen offset:2048 sc1
  v_exp_f32 v86, v86
  v_cvt_pk_bf16_f32 v146, v84, v85
  v_exp_f32 v87, v87
  v_exp_f32 v88, v88
  v_cvt_pk_bf16_f32 v147, v86, v87
  v_exp_f32 v89, v89
  v_exp_f32 v90, v90
  v_mfma_f32_32x32x16_bf16 v[112:127], v[184:187], v[144:147], v[112:127]
  s_waitcnt lgkmcnt(0)
  buffer_load_dwordx4 v[228:231], v30, s[20:23], s90 offen offset:2304 sc1
  s_add_u32 s90, s90, 4096
  v_xor_b32 v21, 32, v20
  v_cvt_pk_bf16_f32 v148, v88, v89
  v_exp_f32 v91, v91
  v_exp_f32 v92, v92
  v_cvt_pk_bf16_f32 v149, v90, v91
  v_exp_f32 v93, v93
  v_exp_f32 v94, v94
  v_exp_f32 v95, v95
  v_cvt_pk_bf16_f32 v150, v92, v93
  v_cvt_pk_bf16_f32 v151, v94, v95
  v_mfma_f32_32x32x16_bf16 v[80:95], v[160:163], v[32:35], v[48:63]
  ds_read_b128 v[176:179], v2 offset:26624
  v_exp_f32 v96, v96
  v_exp_f32 v97, v97
  v_exp_f32 v98, v98
  v_mfma_f32_32x32x16_bf16 v[112:127], v[188:191], v[148:151], v[112:127]
  ds_read_b128 v[180:183], v2 offset:27648
  v_cvt_pk_bf16_f32 v152, v96, v97
  v_exp_f32 v99, v99
  v_exp_f32 v100, v100
  v_cvt_pk_bf16_f32 v153, v98, v99
  v_smfmac_f32_16x16x64_bf16 v[192:195], v[16:19], v[144:151], v13
  v_xor_b32 v22, 64, v20
  v_exp_f32 v101, v101
  v_mfma_f32_32x32x16_bf16 v[80:95], v[164:167], v[36:39], v[80:95]
  buffer_load_dwordx4 v[232:235], v30, s[20:23], s90 offen offset:0 sc1
  v_exp_f32 v102, v102
  v_cvt_pk_bf16_f32 v154, v100, v101
  v_exp_f32 v103, v103
  v_exp_f32 v104, v104
  v_cvt_pk_bf16_f32 v155, v102, v103
  v_exp_f32 v105, v105
  v_exp_f32 v106, v106
  v_mfma_f32_32x32x16_bf16 v[128:143], v[184:187], v[152:155], v[128:143]
  s_waitcnt lgkmcnt(0)
  buffer_load_dwordx4 v[236:239], v30, s[20:23], s90 offen offset:256 sc1
  v_xor_b32 v23, 96, v20
  v_cvt_pk_bf16_f32 v156, v104, v105
  v_exp_f32 v107, v107
  v_exp_f32 v108, v108
  v_cvt_pk_bf16_f32 v157, v106, v107
  v_exp_f32 v109, v109
  v_exp_f32 v110, v110
  v_exp_f32 v111, v111
  v_cvt_pk_bf16_f32 v158, v108, v109
  v_cvt_pk_bf16_f32 v159, v110, v111
  v_mfma_f32_32x32x16_bf16 v[96:111], v[160:163], v[40:43], v[64:79]
  ds_read_b128 v[168:171], v2 offset:28672
  v_exp_f32 v80, v80
  v_exp_f32 v81, v81
  v_exp_f32 v82, v82
  v_mfma_f32_32x32x16_bf16 v[128:143], v[188:191], v[156:159], v[128:143]
  ds_read_b128 v[172:175], v2 offset:29696
  v_cvt_pk_bf16_f32 v144, v80, v81
  v_exp_f32 v83, v83
  v_exp_f32 v84, v84
  v_cvt_pk_bf16_f32 v145, v82, v83
  v_smfmac_f32_16x16x64_bf16 v[196:199], v[16:19], v[152:159], v13
  v_xor_b32 v26, 128, v20
  v_exp_f32 v85, v85
  v_mfma_f32_32x32x16_bf16 v[96:111], v[164:167], v[44:47], v[96:111]
  buffer_load_dwordx4 v[240:243], v30, s[20:23], s90 offen offset:2048 sc1
  v_exp_f32 v86, v86
  v_cvt_pk_bf16_f32 v146, v84, v85
  v_exp_f32 v87, v87
  v_exp_f32 v88, v88
  v_cvt_pk_bf16_f32 v147, v86, v87
  v_exp_f32 v89, v89
  v_exp_f32 v90, v90
  v_mfma_f32_32x32x16_bf16 v[112:127], v[176:179], v[144:147], v[112:127]
  s_waitcnt lgkmcnt(0)
  buffer_load_dwordx4 v[244:247], v30, s[20:23], s90 offen offset:2304 sc1
  s_add_u32 s90, s90, 4096
  v_xor_b32 v27, 160, v20
  v_cvt_pk_bf16_f32 v148, v88, v89
  v_exp_f32 v91, v91
  v_exp_f32 v92, v92
  v_cvt_pk_bf16_f32 v149, v90, v91
  v_exp_f32 v93, v93
  v_exp_f32 v94, v94
  v_exp_f32 v95, v95
  v_cvt_pk_bf16_f32 v150, v92, v93
  v_cvt_pk_bf16_f32 v151, v94, v95
  v_mfma_f32_32x32x16_bf16 v[80:95], v[168:171], v[32:35], v[48:63]
  ds_read_b128 v[184:187], v2 offset:30720
  v_exp_f32 v96, v96
  v_exp_f32 v97, v97
  v_exp_f32 v98, v98
  v_mfma_f32_32x32x16_bf16 v[112:127], v[180:183], v[148:151], v[112:127]
  ds_read_b128 v[188:191], v2 offset:31744
  v_cvt_pk_bf16_f32 v152, v96, v97
  v_exp_f32 v99, v99
  v_exp_f32 v100, v100
  v_cvt_pk_bf16_f32 v153, v98, v99
  v_smfmac_f32_16x16x64_bf16 v[192:195], v[16:19], v[144:151], v13
  v_xor_b32 v28, 192, v20
  v_exp_f32 v101, v101
  v_mfma_f32_32x32x16_bf16 v[80:95], v[172:175], v[36:39], v[80:95]
  buffer_load_dwordx4 v[248:251], v30, s[20:23], s90 offen offset:0 sc1
  v_exp_f32 v102, v102
  v_cvt_pk_bf16_f32 v154, v100, v101
  v_exp_f32 v103, v103
  v_exp_f32 v104, v104
  v_cvt_pk_bf16_f32 v155, v102, v103
  v_exp_f32 v105, v105
  v_exp_f32 v106, v106
  v_mfma_f32_32x32x16_bf16 v[128:143], v[176:179], v[152:155], v[128:143]
  s_waitcnt lgkmcnt(0)
  buffer_load_dwordx4 v[252:255], v30, s[20:23], s90 offen offset:256 sc1
  v_xor_b32 v29, 224, v20
  v_cvt_pk_bf16_f32 v156, v104, v105
  v_exp_f32 v107, v107
  v_exp_f32 v108, v108
  v_cvt_pk_bf16_f32 v157, v106, v107
  v_exp_f32 v109, v109
  v_exp_f32 v110, v110
  v_exp_f32 v111, v111
  v_cvt_pk_bf16_f32 v158, v108, v109
  v_cvt_pk_bf16_f32 v159, v110, v111
  v_mfma_f32_32x32x16_bf16 v[96:111], v[168:171], v[40:43], v[64:79]
  v_exp_f32 v80, v80
  v_exp_f32 v81, v81
  v_exp_f32 v82, v82
  v_mfma_f32_32x32x16_bf16 v[128:143], v[180:183], v[156:159], v[128:143]
  v_cvt_pk_bf16_f32 v144, v80, v81
  v_exp_f32 v83, v83
  v_exp_f32 v84, v84
  v_cvt_pk_bf16_f32 v145, v82, v83
  v_smfmac_f32_16x16x64_bf16 v[196:199], v[16:19], v[152:159], v13
  v_exp_f32 v85, v85
  v_mfma_f32_32x32x16_bf16 v[96:111], v[172:175], v[44:47], v[96:111]
  v_exp_f32 v86, v86
  v_cvt_pk_bf16_f32 v146, v84, v85
  v_exp_f32 v87, v87
  v_exp_f32 v88, v88
  v_cvt_pk_bf16_f32 v147, v86, v87
  v_exp_f32 v89, v89
  v_exp_f32 v90, v90
  v_mfma_f32_32x32x16_bf16 v[112:127], v[184:187], v[144:147], v[112:127]
  v_cvt_pk_bf16_f32 v148, v88, v89
  v_exp_f32 v91, v91
  v_exp_f32 v92, v92
  v_cvt_pk_bf16_f32 v149, v90, v91
  v_exp_f32 v93, v93
  v_exp_f32 v94, v94
  v_exp_f32 v95, v95
  v_cvt_pk_bf16_f32 v150, v92, v93
  v_cvt_pk_bf16_f32 v151, v94, v95
  v_exp_f32 v96, v96
  v_exp_f32 v97, v97
  v_exp_f32 v98, v98
  v_mfma_f32_32x32x16_bf16 v[112:127], v[188:191], v[148:151], v[112:127]
  v_cvt_pk_bf16_f32 v152, v96, v97
  v_exp_f32 v99, v99
  v_exp_f32 v100, v100
  v_cvt_pk_bf16_f32 v153, v98, v99
  v_smfmac_f32_16x16x64_bf16 v[192:195], v[16:19], v[144:151], v13
  v_exp_f32 v101, v101
  v_exp_f32 v102, v102
  v_cvt_pk_bf16_f32 v154, v100, v101
  v_exp_f32 v103, v103
  v_exp_f32 v104, v104
  v_cvt_pk_bf16_f32 v155, v102, v103
  v_exp_f32 v105, v105
  v_exp_f32 v106, v106
  v_mfma_f32_32x32x16_bf16 v[128:143], v[184:187], v[152:155], v[128:143]
  v_cvt_pk_bf16_f32 v156, v104, v105
  v_exp_f32 v107, v107
  v_exp_f32 v108, v108
  v_cvt_pk_bf16_f32 v157, v106, v107
  v_exp_f32 v109, v109
  v_exp_f32 v110, v110
  v_exp_f32 v111, v111
  v_cvt_pk_bf16_f32 v158, v108, v109
  v_cvt_pk_bf16_f32 v159, v110, v111
  s_nop 1
  v_mfma_f32_32x32x16_bf16 v[128:143], v[188:191], v[156:159], v[128:143]
  v_smfmac_f32_16x16x64_bf16 v[196:199], v[16:19], v[152:159], v13
  v_add_f32 v192, v192, v193
  s_nop 6
  v_add_f32 v196, v196, v197
  s_mov_b32 s70, s97
  s_add_u32 s71, s97, 65536
  v_add_f32 v13, v192, v196
  v_cmp_ngt_f32 vcc, 0x4e800000, v13
  s_nop 0
  s_cbranch_vccnz L_fallback
L_norm:
  s_lshl_b32 s89, s3, 13
  s_cmp_eq_u32 s68, 1
  s_cbranch_scc1 L_s3b
  ds_read_b64_tr_b16 v[160:161], v20 offset:0
  ds_read_b64_tr_b16 v[162:163], v20 offset:1024
  ds_read_b64_tr_b16 v[164:165], v21 offset:0
  ds_read_b64_tr_b16 v[166:167], v21 offset:1024
  ds_read_b64_tr_b16 v[168:169], v22 offset:0
  ds_read_b64_tr_b16 v[170:171], v22 offset:1024
  ds_read_b64_tr_b16 v[172:173], v23 offset:0
  ds_read_b64_tr_b16 v[174:175], v23 offset:1024
  ds_read_b64_tr_b16 v[176:177], v26 offset:0
  ds_read_b64_tr_b16 v[178:179], v26 offset:1024
  ds_read_b64_tr_b16 v[180:181], v27 offset:0
  ds_read_b64_tr_b16 v[182:183], v27 offset:1024
  ds_read_b64_tr_b16 v[184:185], v28 offset:0
  ds_read_b64_tr_b16 v[186:187], v28 offset:1024
  v_rcp_f32 v12, v192
  v_rcp_f32 v13, v196
  v_mul_f32 v112, v12, v112
  v_mul_f32 v113, v12, v113
  v_mul_f32 v114, v12, v114
  v_mul_f32 v115, v12, v115
  v_mul_f32 v116, v12, v116
  v_mul_f32 v117, v12, v117
  v_mul_f32 v118, v12, v118
  v_mul_f32 v119, v12, v119
  v_mul_f32 v120, v12, v120
  v_mul_f32 v121, v12, v121
  v_mul_f32 v122, v12, v122
  v_mul_f32 v123, v12, v123
  v_mul_f32 v124, v12, v124
  v_mul_f32 v125, v12, v125
  v_mul_f32 v126, v12, v126
  v_mul_f32 v127, v12, v127
  v_cvt_pk_bf16_f32 v144, v112, v113
  v_cvt_pk_bf16_f32 v145, v114, v115
  s_waitcnt lgkmcnt(12)
  v_mfma_f32_16x16x32_bf16 v[48:51], v[160:163], a[0:3], 0
  ds_read_b64_tr_b16 v[188:189], v29 offset:0
  v_cvt_pk_bf16_f32 v146, v116, v117
  v_mfma_f32_16x16x32_bf16 v[52:55], v[160:163], a[4:7], 0
  ds_read_b64_tr_b16 v[190:191], v29 offset:1024
  v_cvt_pk_bf16_f32 v147, v118, v119
  s_waitcnt lgkmcnt(12)
  v_mfma_f32_16x16x32_bf16 v[56:59], v[164:167], a[0:3], 0
  ds_read_b64_tr_b16 v[160:161], v20 offset:8192
  v_cvt_pk_bf16_f32 v148, v120, v121
  v_mfma_f32_16x16x32_bf16 v[60:63], v[164:167], a[4:7], 0
  ds_read_b64_tr_b16 v[162:163], v20 offset:9216
  s_waitcnt lgkmcnt(10)
  v_mfma_f32_16x16x32_bf16 v[64:67], v[168:171], a[0:3], 0
  ds_read_b64_tr_b16 v[164:165], v21 offset:8192
  v_cvt_pk_bf16_f32 v149, v122, v123
  v_mfma_f32_16x16x32_bf16 v[68:71], v[168:171], a[4:7], 0
  ds_read_b64_tr_b16 v[166:167], v21 offset:9216
  v_cvt_pk_bf16_f32 v150, v124, v125
  v_mfma_f32_16x16x32_bf16 v[72:75], v[172:175], a[0:3], 0
  ds_read_b64_tr_b16 v[168:169], v22 offset:8192
  v_cvt_pk_bf16_f32 v151, v126, v127
  v_mfma_f32_16x16x32_bf16 v[76:79], v[172:175], a[4:7], 0
  ds_read_b64_tr_b16 v[170:171], v22 offset:9216
  s_waitcnt lgkmcnt(10)
  v_mfma_f32_16x16x32_bf16 v[80:83], v[176:179], a[0:3], 0
  ds_read_b64_tr_b16 v[172:173], v23 offset:8192
  buffer_store_dwordx4 v[144:147], v4, s[20:23], s70 offen offset:0 sc1
  v_mfma_f32_16x16x32_bf16 v[84:87], v[176:179], a[4:7], 0
  ds_read_b64_tr_b16 v[174:175], v23 offset:9216
  buffer_store_dwordx4 v[148:151], v4, s[20:23], s70 offen offset:1024 sc1
  v_mfma_f32_16x16x32_bf16 v[88:91], v[180:183], a[0:3], 0
  ds_read_b64_tr_b16 v[176:177], v26 offset:8192
  v_mul_f32 v128, v13, v128
  v_mfma_f32_16x16x32_bf16 v[92:95], v[180:183], a[4:7], 0
  ds_read_b64_tr_b16 v[178:179], v26 offset:9216
  s_waitcnt lgkmcnt(10)
  v_mfma_f32_16x16x32_bf16 v[96:99], v[184:187], a[0:3], 0
  ds_read_b64_tr_b16 v[180:181], v27 offset:8192
  v_mul_f32 v129, v13, v129
  v_mul_f32 v130, v13, v130
  v_mfma_f32_16x16x32_bf16 v[100:103], v[184:187], a[4:7], 0
  ds_read_b64_tr_b16 v[182:183], v27 offset:9216
  v_mul_f32 v131, v13, v131
  v_mfma_f32_16x16x32_bf16 v[104:107], v[188:191], a[0:3], 0
  ds_read_b64_tr_b16 v[184:185], v28 offset:8192
  v_mul_f32 v132, v13, v132
  v_mfma_f32_16x16x32_bf16 v[108:111], v[188:191], a[4:7], 0
  ds_read_b64_tr_b16 v[186:187], v28 offset:9216
  s_waitcnt lgkmcnt(10)
  v_mul_f32 v133, v13, v133
  v_mul_f32 v134, v13, v134
  s_barrier
  v_mfma_f32_16x16x32_bf16 v[48:51], v[160:163], a[8:11], v[48:51]
  ds_read_b64_tr_b16 v[188:189], v29 offset:8192
  v_mul_f32 v135, v13, v135
  v_mfma_f32_16x16x32_bf16 v[52:55], v[160:163], a[12:15], v[52:55]
  ds_read_b64_tr_b16 v[190:191], v29 offset:9216
  v_mul_f32 v136, v13, v136
  v_mfma_f32_16x16x32_bf16 v[56:59], v[164:167], a[8:11], v[56:59]
  ds_read_b64_tr_b16 v[160:161], v20 offset:16384
  v_mul_f32 v137, v13, v137
  v_mfma_f32_16x16x32_bf16 v[60:63], v[164:167], a[12:15], v[60:63]
  ds_read_b64_tr_b16 v[162:163], v20 offset:17408
  s_waitcnt lgkmcnt(10)
  v_mfma_f32_16x16x32_bf16 v[64:67], v[168:171], a[8:11], v[64:67]
  ds_read_b64_tr_b16 v[164:165], v21 offset:16384
  v_mul_f32 v138, v13, v138
  v_mfma_f32_16x16x32_bf16 v[68:71], v[168:171], a[12:15], v[68:71]
  ds_read_b64_tr_b16 v[166:167], v21 offset:17408
  v_mul_f32 v139, v13, v139
  v_mfma_f32_16x16x32_bf16 v[72:75], v[172:175], a[8:11], v[72:75]
  ds_read_b64_tr_b16 v[168:169], v22 offset:16384
  v_mul_f32 v140, v13, v140
  v_mfma_f32_16x16x32_bf16 v[76:79], v[172:175], a[12:15], v[76:79]
  ds_read_b64_tr_b16 v[170:171], v22 offset:17408
  s_waitcnt lgkmcnt(10)
  v_mfma_f32_16x16x32_bf16 v[80:83], v[176:179], a[8:11], v[80:83]
  ds_read_b64_tr_b16 v[172:173], v23 offset:16384
  v_mul_f32 v141, v13, v141
  v_mul_f32 v142, v13, v142
  v_mfma_f32_16x16x32_bf16 v[84:87], v[176:179], a[12:15], v[84:87]
  ds_read_b64_tr_b16 v[174:175], v23 offset:17408
  v_mul_f32 v143, v13, v143
  v_mfma_f32_16x16x32_bf16 v[88:91], v[180:183], a[8:11], v[88:91]
  ds_read_b64_tr_b16 v[176:177], v26 offset:16384
  v_cvt_pk_bf16_f32 v152, v128, v129
  v_mfma_f32_16x16x32_bf16 v[92:95], v[180:183], a[12:15], v[92:95]
  ds_read_b64_tr_b16 v[178:179], v26 offset:17408
  s_waitcnt lgkmcnt(10)
  v_mfma_f32_16x16x32_bf16 v[96:99], v[184:187], a[8:11], v[96:99]
  ds_read_b64_tr_b16 v[180:181], v27 offset:16384
  v_cvt_pk_bf16_f32 v153, v130, v131
  v_cvt_pk_bf16_f32 v154, v132, v133
  v_mfma_f32_16x16x32_bf16 v[100:103], v[184:187], a[12:15], v[100:103]
  ds_read_b64_tr_b16 v[182:183], v27 offset:17408
  v_cvt_pk_bf16_f32 v155, v134, v135
  v_mfma_f32_16x16x32_bf16 v[104:107], v[188:191], a[8:11], v[104:107]
  ds_read_b64_tr_b16 v[184:185], v28 offset:16384
  v_cvt_pk_bf16_f32 v156, v136, v137
  v_mfma_f32_16x16x32_bf16 v[108:111], v[188:191], a[12:15], v[108:111]
  ds_read_b64_tr_b16 v[186:187], v28 offset:17408
  s_waitcnt lgkmcnt(10)
  v_mfma_f32_16x16x32_bf16 v[48:51], v[160:163], a[16:19], v[48:51]
  ds_read_b64_tr_b16 v[188:189], v29 offset:16384
  v_cvt_pk_bf16_f32 v157, v138, v139
  v_mfma_f32_16x16x32_bf16 v[52:55], v[160:163], a[20:23], v[52:55]
  ds_read_b64_tr_b16 v[190:191], v29 offset:17408
  v_cvt_pk_bf16_f32 v158, v140, v141
  v_mfma_f32_16x16x32_bf16 v[56:59], v[164:167], a[16:19], v[56:59]
  ds_read_b64_tr_b16 v[160:161], v20 offset:24576
  v_cvt_pk_bf16_f32 v159, v142, v143
  v_mfma_f32_16x16x32_bf16 v[60:63], v[164:167], a[20:23], v[60:63]
  ds_read_b64_tr_b16 v[162:163], v20 offset:25600
  s_waitcnt lgkmcnt(10)
  v_mfma_f32_16x16x32_bf16 v[64:67], v[168:171], a[16:19], v[64:67]
  ds_read_b64_tr_b16 v[164:165], v21 offset:24576
  v_add_u32 v20, 32768, v20
  v_mfma_f32_16x16x32_bf16 v[68:71], v[168:171], a[20:23], v[68:71]
  ds_read_b64_tr_b16 v[166:167], v21 offset:25600
  buffer_store_dwordx4 v[152:155], v4, s[20:23], s71 offen offset:0 sc1
  v_mfma_f32_16x16x32_bf16 v[72:75], v[172:175], a[16:19], v[72:75]
  ds_read_b64_tr_b16 v[168:169], v22 offset:24576
  v_add_u32 v21, 32768, v21
  v_mfma_f32_16x16x32_bf16 v[76:79], v[172:175], a[20:23], v[76:79]
  ds_read_b64_tr_b16 v[170:171], v22 offset:25600
  s_waitcnt lgkmcnt(10)
  v_mfma_f32_16x16x32_bf16 v[80:83], v[176:179], a[16:19], v[80:83]
  ds_read_b64_tr_b16 v[172:173], v23 offset:24576
  buffer_store_dwordx4 v[156:159], v4, s[20:23], s71 offen offset:1024 sc1
  v_mfma_f32_16x16x32_bf16 v[84:87], v[176:179], a[20:23], v[84:87]
  ds_read_b64_tr_b16 v[174:175], v23 offset:25600
  v_add_u32 v22, 32768, v22
  v_mfma_f32_16x16x32_bf16 v[88:91], v[180:183], a[16:19], v[88:91]
  ds_read_b64_tr_b16 v[176:177], v26 offset:24576
  v_add_u32 v23, 32768, v23
  v_mfma_f32_16x16x32_bf16 v[92:95], v[180:183], a[20:23], v[92:95]
  ds_read_b64_tr_b16 v[178:179], v26 offset:25600
  s_waitcnt lgkmcnt(10)
  v_mfma_f32_16x16x32_bf16 v[96:99], v[184:187], a[16:19], v[96:99]
  ds_read_b64_tr_b16 v[180:181], v27 offset:24576
  v_add_u32 v26, 32768, v26
  s_add_u32 m0, s89, 0
  v_mfma_f32_16x16x32_bf16 v[100:103], v[184:187], a[20:23], v[100:103]
  ds_read_b64_tr_b16 v[182:183], v27 offset:25600
  v_add_u32 v27, 32768, v27
  v_mfma_f32_16x16x32_bf16 v[104:107], v[188:191], a[16:19], v[104:107]
  ds_read_b64_tr_b16 v[184:185], v28 offset:24576
L_touch7:
  s_cbranch_execz L_touch11
  buffer_load_dwordx4 v8, s[24:27], s87 offen offset:0 lds
  v_mfma_f32_16x16x32_bf16 v[108:111], v[188:191], a[20:23], v[108:111]
  ds_read_b64_tr_b16 v[186:187], v28 offset:25600
  s_waitcnt lgkmcnt(10)
  v_mfma_f32_16x16x32_bf16 v[48:51], v[160:163], a[24:27], v[48:51]
  ds_read_b64_tr_b16 v[188:189], v29 offset:24576
  v_add_u32 v28, 32768, v28
  v_mfma_f32_16x16x32_bf16 v[52:55], v[160:163], a[28:31], v[52:55]
  ds_read_b64_tr_b16 v[190:191], v29 offset:25600
  v_add_u32 v29, 32768, v29
  v_mfma_f32_16x16x32_bf16 v[56:59], v[164:167], a[24:27], v[56:59]
  buffer_load_dwordx4 v9, s[24:27], s87 offen offset:1024 lds
  v_mfma_f32_16x16x32_bf16 v[60:63], v[164:167], a[28:31], v[60:63]
  s_waitcnt lgkmcnt(8)
  v_mfma_f32_16x16x32_bf16 v[64:67], v[168:171], a[24:27], v[64:67]
  buffer_load_dwordx4 v10, s[24:27], s87 offen offset:2048 lds
  v_mfma_f32_16x16x32_bf16 v[68:71], v[168:171], a[28:31], v[68:71]
  s_waitcnt lgkmcnt(0)
  s_barrier
  v_mfma_f32_16x16x32_bf16 v[72:75], v[172:175], a[24:27], v[72:75]
  ds_read_b64_tr_b16 v[160:161], v20 offset:0
  ds_read_b64_tr_b16 v[162:163], v20 offset:1024
  v_mfma_f32_16x16x32_bf16 v[76:79], v[172:175], a[28:31], v[76:79]
  ds_read_b64_tr_b16 v[164:165], v21 offset:0
  ds_read_b64_tr_b16 v[166:167], v21 offset:1024
  v_mfma_f32_16x16x32_bf16 v[80:83], v[176:179], a[24:27], v[80:83]
  ds_read_b64_tr_b16 v[168:169], v22 offset:0
  ds_read_b64_tr_b16 v[170:171], v22 offset:1024
  buffer_load_dwordx4 v11, s[24:27], s87 offen offset:3072 lds
  v_mfma_f32_16x16x32_bf16 v[84:87], v[176:179], a[28:31], v[84:87]
  ds_read_b64_tr_b16 v[172:173], v23 offset:0
  ds_read_b64_tr_b16 v[174:175], v23 offset:1024
  v_mfma_f32_16x16x32_bf16 v[88:91], v[180:183], a[24:27], v[88:91]
  ds_read_b64_tr_b16 v[176:177], v26 offset:0
  v_mfma_f32_16x16x32_bf16 v[92:95], v[180:183], a[28:31], v[92:95]
  ds_read_b64_tr_b16 v[178:179], v26 offset:1024
  v_mfma_f32_16x16x32_bf16 v[96:99], v[184:187], a[24:27], v[96:99]
  ds_read_b64_tr_b16 v[180:181], v27 offset:0
  s_add_u32 m0, s89, 4096
  v_mfma_f32_16x16x32_bf16 v[100:103], v[184:187], a[28:31], v[100:103]
  ds_read_b64_tr_b16 v[182:183], v27 offset:1024
  v_mfma_f32_16x16x32_bf16 v[104:107], v[188:191], a[24:27], v[104:107]
  ds_read_b64_tr_b16 v[184:185], v28 offset:0
  buffer_load_dwordx4 v8, s[24:27], s88 offen offset:0 lds
  v_mfma_f32_16x16x32_bf16 v[108:111], v[188:191], a[28:31], v[108:111]
  ds_read_b64_tr_b16 v[186:187], v28 offset:1024
  s_waitcnt lgkmcnt(10)
  v_mfma_f32_16x16x32_bf16 v[48:51], v[160:163], a[32:35], v[48:51]
  ds_read_b64_tr_b16 v[188:189], v29 offset:0
  v_mfma_f32_16x16x32_bf16 v[52:55], v[160:163], a[36:39], v[52:55]
  ds_read_b64_tr_b16 v[190:191], v29 offset:1024
  v_mfma_f32_16x16x32_bf16 v[56:59], v[164:167], a[32:35], v[56:59]
  ds_read_b64_tr_b16 v[160:161], v20 offset:8192
  s_waitcnt vmcnt(62)
  buffer_load_dwordx4 v9, s[24:27], s88 offen offset:1024 lds
  v_mfma_f32_16x16x32_bf16 v[60:63], v[164:167], a[36:39], v[60:63]
  ds_read_b64_tr_b16 v[162:163], v20 offset:9216
  s_waitcnt lgkmcnt(10)
  v_mfma_f32_16x16x32_bf16 v[64:67], v[168:171], a[32:35], v[64:67]
  ds_read_b64_tr_b16 v[164:165], v21 offset:8192
  v_mfma_f32_16x16x32_bf16 v[68:71], v[168:171], a[36:39], v[68:71]
  ds_read_b64_tr_b16 v[166:167], v21 offset:9216
  v_mfma_f32_16x16x32_bf16 v[72:75], v[172:175], a[32:35], v[72:75]
  ds_read_b64_tr_b16 v[168:169], v22 offset:8192
  s_waitcnt vmcnt(62)
  buffer_load_dwordx4 v10, s[24:27], s88 offen offset:2048 lds
  v_mfma_f32_16x16x32_bf16 v[76:79], v[172:175], a[36:39], v[76:79]
  ds_read_b64_tr_b16 v[170:171], v22 offset:9216
  s_waitcnt lgkmcnt(10)
  v_mfma_f32_16x16x32_bf16 v[80:83], v[176:179], a[32:35], v[80:83]
  ds_read_b64_tr_b16 v[172:173], v23 offset:8192
  v_mfma_f32_16x16x32_bf16 v[84:87], v[176:179], a[36:39], v[84:87]
  ds_read_b64_tr_b16 v[174:175], v23 offset:9216
  v_mfma_f32_16x16x32_bf16 v[88:91], v[180:183], a[32:35], v[88:91]
  ds_read_b64_tr_b16 v[176:177], v26 offset:8192
  s_waitcnt vmcnt(62)
  buffer_load_dwordx4 v11, s[24:27], s88 offen offset:3072 lds
  v_mfma_f32_16x16x32_bf16 v[92:95], v[180:183], a[36:39], v[92:95]
  ds_read_b64_tr_b16 v[178:179], v26 offset:9216
  s_waitcnt lgkmcnt(10)
  v_mfma_f32_16x16x32_bf16 v[96:99], v[184:187], a[32:35], v[96:99]
  ds_read_b64_tr_b16 v[180:181], v27 offset:8192
  s_add_u32 s87, s87, 262144
  v_mfma_f32_16x16x32_bf16 v[100:103], v[184:187], a[36:39], v[100:103]
  ds_read_b64_tr_b16 v[182:183], v27 offset:9216
  s_add_u32 s88, s88, 262144
  v_mfma_f32_16x16x32_bf16 v[104:107], v[188:191], a[32:35], v[104:107]
  ds_read_b64_tr_b16 v[184:185], v28 offset:8192
  s_add_u32 m0, s89, 32768
  v_mfma_f32_16x16x32_bf16 v[108:111], v[188:191], a[36:39], v[108:111]
  ds_read_b64_tr_b16 v[186:187], v28 offset:9216
  s_waitcnt lgkmcnt(10)
  v_mfma_f32_16x16x32_bf16 v[48:51], v[160:163], a[40:43], v[48:51]
  ds_read_b64_tr_b16 v[188:189], v29 offset:8192
  s_waitcnt vmcnt(62)
  buffer_load_dwordx4 v8, s[24:27], s87 offen offset:0 lds
  v_mfma_f32_16x16x32_bf16 v[52:55], v[160:163], a[44:47], v[52:55]
  ds_read_b64_tr_b16 v[190:191], v29 offset:9216
  v_accvgpr_read_b32 v36, a235
  v_mfma_f32_16x16x32_bf16 v[56:59], v[164:167], a[40:43], v[56:59]
  ds_read_b64_tr_b16 v[160:161], v20 offset:16384
  s_waitcnt vmcnt(62)
  buffer_load_dwordx4 v9, s[24:27], s87 offen offset:1024 lds
  v_mfma_f32_16x16x32_bf16 v[60:63], v[164:167], a[44:47], v[60:63]
  ds_read_b64_tr_b16 v[162:163], v20 offset:17408
  s_waitcnt lgkmcnt(10)
  v_mfma_f32_16x16x32_bf16 v[64:67], v[168:171], a[40:43], v[64:67]
  ds_read_b64_tr_b16 v[164:165], v21 offset:16384
  v_add_u32 v36, 98304, v36
  v_mfma_f32_16x16x32_bf16 v[68:71], v[168:171], a[44:47], v[68:71]
  ds_read_b64_tr_b16 v[166:167], v21 offset:17408
  v_xor_b32 v37, 32, v36
  v_mfma_f32_16x16x32_bf16 v[72:75], v[172:175], a[40:43], v[72:75]
  ds_read_b64_tr_b16 v[168:169], v22 offset:16384
  v_xor_b32 v38, 64, v36
  v_mfma_f32_16x16x32_bf16 v[76:79], v[172:175], a[44:47], v[76:79]
  ds_read_b64_tr_b16 v[170:171], v22 offset:17408
  s_waitcnt lgkmcnt(10)
  s_waitcnt vmcnt(10)
  s_barrier
  s_cmp_lg_u32 s3, 0
  s_cbranch_scc1 L_sig21
  s_mov_b64 exec, 1
  v_mov_b32 v5, 7
  buffer_store_dword v5, off, s[20:23], s69 sc1
  s_mov_b64 exec, -1
L_sig21:
  v_mfma_f32_16x16x32_bf16 v[80:83], v[176:179], a[40:43], v[80:83]
  ds_read_b64_tr_b16 v[172:173], v23 offset:16384
  buffer_load_dwordx4 v10, s[24:27], s87 offen offset:2048 lds
  v_mfma_f32_16x16x32_bf16 v[84:87], v[176:179], a[44:47], v[84:87]
  ds_read_b64_tr_b16 v[174:175], v23 offset:17408
  v_xor_b32 v39, 96, v36
  v_mfma_f32_16x16x32_bf16 v[88:91], v[180:183], a[40:43], v[88:91]
  ds_read_b64_tr_b16 v[176:177], v26 offset:16384
  v_mfma_f32_16x16x32_bf16 v[92:95], v[180:183], a[44:47], v[92:95]
  ds_read_b64_tr_b16 v[178:179], v26 offset:17408
  s_waitcnt lgkmcnt(10)
  v_mfma_f32_16x16x32_bf16 v[96:99], v[184:187], a[40:43], v[96:99]
  ds_read_b64_tr_b16 v[180:181], v27 offset:16384
  buffer_load_dwordx4 v11, s[24:27], s87 offen offset:3072 lds
  v_mfma_f32_16x16x32_bf16 v[100:103], v[184:187], a[44:47], v[100:103]
  ds_read_b64_tr_b16 v[182:183], v27 offset:17408
  v_accvgpr_read_b32 v32, a236
  v_mfma_f32_16x16x32_bf16 v[104:107], v[188:191], a[40:43], v[104:107]
  ds_read_b64_tr_b16 v[184:185], v28 offset:16384
  s_add_u32 m0, s89, 36864
  v_mfma_f32_16x16x32_bf16 v[108:111], v[188:191], a[44:47], v[108:111]
  ds_read_b64_tr_b16 v[186:187], v28 offset:17408
  s_waitcnt lgkmcnt(10)
  v_mfma_f32_16x16x32_bf16 v[48:51], v[160:163], a[48:51], v[48:51]
  ds_read_b64_tr_b16 v[188:189], v29 offset:16384
  v_accvgpr_read_b32 v33, a237
  v_mfma_f32_16x16x32_bf16 v[52:55], v[160:163], a[52:55], v[52:55]
  ds_read_b64_tr_b16 v[190:191], v29 offset:17408
  buffer_load_dwordx4 v8, s[24:27], s88 offen offset:0 lds
  v_mfma_f32_16x16x32_bf16 v[56:59], v[164:167], a[48:51], v[56:59]
  ds_read_b64_tr_b16 v[160:161], v20 offset:24576
  v_accvgpr_read_b32 v34, a238
  v_mfma_f32_16x16x32_bf16 v[60:63], v[164:167], a[52:55], v[60:63]
  ds_read_b64_tr_b16 v[162:163], v20 offset:25600
  s_waitcnt lgkmcnt(10)
  v_mfma_f32_16x16x32_bf16 v[64:67], v[168:171], a[48:51], v[64:67]
  ds_read_b64_tr_b16 v[164:165], v21 offset:24576
  v_add_u32 v20, 32768, v20
  v_accvgpr_read_b32 v35, a239
  v_mfma_f32_16x16x32_bf16 v[68:71], v[168:171], a[52:55], v[68:71]
  ds_read_b64_tr_b16 v[166:167], v21 offset:25600
  v_add_u32 v21, 32768, v21
  v_mfma_f32_16x16x32_bf16 v[72:75], v[172:175], a[48:51], v[72:75]
  ds_read_b64_tr_b16 v[168:169], v22 offset:24576
  buffer_load_dwordx4 v9, s[24:27], s88 offen offset:1024 lds
  v_accvgpr_read_b32 v44, a243
  v_mfma_f32_16x16x32_bf16 v[76:79], v[172:175], a[52:55], v[76:79]
  ds_read_b64_tr_b16 v[170:171], v22 offset:25600
  s_waitcnt lgkmcnt(10)
  v_mfma_f32_16x16x32_bf16 v[80:83], v[176:179], a[48:51], v[80:83]
  ds_read_b64_tr_b16 v[172:173], v23 offset:24576
  v_add_u32 v22, 32768, v22
  v_add_u32 v45, 32768, v44
  v_mfma_f32_16x16x32_bf16 v[84:87], v[176:179], a[52:55], v[84:87]
  ds_read_b64_tr_b16 v[174:175], v23 offset:25600
  v_add_u32 v23, 32768, v23
  v_mfma_f32_16x16x32_bf16 v[88:91], v[180:183], a[48:51], v[88:91]
  ds_read_b64_tr_b16 v[176:177], v26 offset:24576
  buffer_load_dwordx4 v10, s[24:27], s88 offen offset:2048 lds
  v_sub_f32 v12, 1.0, v6
  v_mfma_f32_16x16x32_bf16 v[92:95], v[180:183], a[52:55], v[92:95]
  ds_read_b64_tr_b16 v[178:179], v26 offset:25600
  s_waitcnt lgkmcnt(10)
  v_mfma_f32_16x16x32_bf16 v[96:99], v[184:187], a[48:51], v[96:99]
  ds_read_b64_tr_b16 v[180:181], v27 offset:24576
  v_add_u32 v26, 32768, v26
  v_cvt_pk_bf16_f32 v12, v12, v12
  v_mfma_f32_16x16x32_bf16 v[100:103], v[184:187], a[52:55], v[100:103]
  ds_read_b64_tr_b16 v[182:183], v27 offset:25600
  v_add_u32 v27, 32768, v27
  v_mfma_f32_16x16x32_bf16 v[104:107], v[188:191], a[48:51], v[104:107]
  ds_read_b64_tr_b16 v[184:185], v28 offset:24576
  buffer_load_dwordx4 v11, s[24:27], s88 offen offset:3072 lds
  s_add_u32 s87, s87, 262144
  v_mfma_f32_16x16x32_bf16 v[108:111], v[188:191], a[52:55], v[108:111]
  ds_read_b64_tr_b16 v[186:187], v28 offset:25600
  s_waitcnt lgkmcnt(10)
  s_add_u32 s88, s88, 262144
  v_mfma_f32_16x16x32_bf16 v[48:51], v[160:163], a[56:59], v[48:51]
  ds_read_b64_tr_b16 v[188:189], v29 offset:24576
  v_and_b32 v41, 0xffff0000, v12
  v_add_u32 v28, 32768, v28
  v_mfma_f32_16x16x32_bf16 v[52:55], v[160:163], a[60:63], v[52:55]
  ds_read_b64_tr_b16 v[190:191], v29 offset:25600
  s_add_u32 m0, s89, 65536
  v_lshrrev_b32 v40, 16, v12
  v_mfma_f32_16x16x32_bf16 v[56:59], v[164:167], a[56:59], v[56:59]
  v_add_u32 v29, 32768, v29
  v_mfma_f32_16x16x32_bf16 v[60:63], v[164:167], a[60:63], v[60:63]
  s_waitcnt lgkmcnt(8)
  buffer_load_dwordx4 v8, s[24:27], s87 offen offset:0 lds
  v_mfma_f32_16x16x32_bf16 v[64:67], v[168:171], a[56:59], v[64:67]
  v_sub_f32 v12, 1.0, v31
  v_cvt_pk_bf16_f32 v12, v12, v12
  v_mfma_f32_16x16x32_bf16 v[68:71], v[168:171], a[60:63], v[68:71]
  v_and_b32 v43, 0xffff0000, v12
  s_waitcnt lgkmcnt(0)
  s_barrier
  v_mfma_f32_16x16x32_bf16 v[72:75], v[172:175], a[56:59], v[72:75]
  ds_read_b64_tr_b16 v[160:161], v20 offset:0
  ds_read_b64_tr_b16 v[162:163], v20 offset:1024
  buffer_load_dwordx4 v9, s[24:27], s87 offen offset:1024 lds
  v_mfma_f32_16x16x32_bf16 v[76:79], v[172:175], a[60:63], v[76:79]
  ds_read_b64_tr_b16 v[164:165], v21 offset:0
  ds_read_b64_tr_b16 v[166:167], v21 offset:1024
  v_mfma_f32_16x16x32_bf16 v[80:83], v[176:179], a[56:59], v[80:83]
  ds_read_b64_tr_b16 v[168:169], v22 offset:0
  ds_read_b64_tr_b16 v[170:171], v22 offset:1024
  v_lshrrev_b32 v42, 16, v12
  v_mfma_f32_16x16x32_bf16 v[84:87], v[176:179], a[60:63], v[84:87]
  ds_read_b64_tr_b16 v[172:173], v23 offset:0
  ds_read_b64_tr_b16 v[174:175], v23 offset:1024
  s_lshl_b32 s61, s67, 8
  v_mfma_f32_16x16x32_bf16 v[88:91], v[180:183], a[56:59], v[88:91]
  ds_read_b64_tr_b16 v[176:177], v26 offset:0
  buffer_load_dwordx4 v10, s[24:27], s87 offen offset:2048 lds
  v_mfma_f32_16x16x32_bf16 v[92:95], v[180:183], a[60:63], v[92:95]
  ds_read_b64_tr_b16 v[178:179], v26 offset:1024
  v_mfma_f32_16x16x32_bf16 v[96:99], v[184:187], a[56:59], v[96:99]
  ds_read_b64_tr_b16 v[180:181], v27 offset:0
  s_lshl_b32 s62, s68, 7
  v_mfma_f32_16x16x32_bf16 v[100:103], v[184:187], a[60:63], v[100:103]
  ds_read_b64_tr_b16 v[182:183], v27 offset:1024
  s_add_u32 s73, s61, s62
  v_mfma_f32_16x16x32_bf16 v[104:107], v[188:191], a[56:59], v[104:107]
  ds_read_b64_tr_b16 v[184:185], v28 offset:0
  buffer_load_dwordx4 v11, s[24:27], s87 offen offset:3072 lds
  v_mfma_f32_16x16x32_bf16 v[108:111], v[188:191], a[60:63], v[108:111]
  ds_read_b64_tr_b16 v[186:187], v28 offset:1024
  s_waitcnt lgkmcnt(10)
  v_mfma_f32_16x16x32_bf16 v[48:51], v[160:163], a[64:67], v[48:51]
  ds_read_b64_tr_b16 v[188:189], v29 offset:0
  s_add_u32 m0, s89, 69632
  v_mfma_f32_16x16x32_bf16 v[52:55], v[160:163], a[68:71], v[52:55]
  ds_read_b64_tr_b16 v[190:191], v29 offset:1024
  v_mfma_f32_16x16x32_bf16 v[56:59], v[164:167], a[64:67], v[56:59]
  ds_read_b64_tr_b16 v[160:161], v20 offset:8192
  buffer_load_dwordx4 v8, s[24:27], s88 offen offset:0 lds
  v_mfma_f32_16x16x32_bf16 v[60:63], v[164:167], a[68:71], v[60:63]
  ds_read_b64_tr_b16 v[162:163], v20 offset:9216
  s_waitcnt lgkmcnt(10)
  v_mfma_f32_16x16x32_bf16 v[64:67], v[168:171], a[64:67], v[64:67]
  ds_read_b64_tr_b16 v[164:165], v21 offset:8192
  v_mfma_f32_16x16x32_bf16 v[68:71], v[168:171], a[68:71], v[68:71]
  ds_read_b64_tr_b16 v[166:167], v21 offset:9216
  v_mfma_f32_16x16x32_bf16 v[72:75], v[172:175], a[64:67], v[72:75]
  ds_read_b64_tr_b16 v[168:169], v22 offset:8192
  buffer_load_dwordx4 v9, s[24:27], s88 offen offset:1024 lds
  v_mfma_f32_16x16x32_bf16 v[76:79], v[172:175], a[68:71], v[76:79]
  ds_read_b64_tr_b16 v[170:171], v22 offset:9216
  s_waitcnt lgkmcnt(10)
  v_mfma_f32_16x16x32_bf16 v[80:83], v[176:179], a[64:67], v[80:83]
  ds_read_b64_tr_b16 v[172:173], v23 offset:8192
  v_mfma_f32_16x16x32_bf16 v[84:87], v[176:179], a[68:71], v[84:87]
  ds_read_b64_tr_b16 v[174:175], v23 offset:9216
  v_mfma_f32_16x16x32_bf16 v[88:91], v[180:183], a[64:67], v[88:91]
  ds_read_b64_tr_b16 v[176:177], v26 offset:8192
  buffer_load_dwordx4 v10, s[24:27], s88 offen offset:2048 lds
  v_mfma_f32_16x16x32_bf16 v[92:95], v[180:183], a[68:71], v[92:95]
  ds_read_b64_tr_b16 v[178:179], v26 offset:9216
  s_waitcnt lgkmcnt(10)
  v_mfma_f32_16x16x32_bf16 v[96:99], v[184:187], a[64:67], v[96:99]
  ds_read_b64_tr_b16 v[180:181], v27 offset:8192
  v_mfma_f32_16x16x32_bf16 v[100:103], v[184:187], a[68:71], v[100:103]
  ds_read_b64_tr_b16 v[182:183], v27 offset:9216
  v_mfma_f32_16x16x32_bf16 v[104:107], v[188:191], a[64:67], v[104:107]
  ds_read_b64_tr_b16 v[184:185], v28 offset:8192
  buffer_load_dwordx4 v11, s[24:27], s88 offen offset:3072 lds
  v_mfma_f32_16x16x32_bf16 v[108:111], v[188:191], a[68:71], v[108:111]
  ds_read_b64_tr_b16 v[186:187], v28 offset:9216
  s_waitcnt lgkmcnt(10)
  v_mfma_f32_16x16x32_bf16 v[48:51], v[160:163], a[72:75], v[48:51]
  ds_read_b64_tr_b16 v[188:189], v29 offset:8192
  s_add_u32 s87, s87, 262144
  v_mfma_f32_16x16x32_bf16 v[52:55], v[160:163], a[76:79], v[52:55]
  ds_read_b64_tr_b16 v[190:191], v29 offset:9216
  s_add_u32 s88, s88, 262144
  v_mfma_f32_16x16x32_bf16 v[56:59], v[164:167], a[72:75], v[56:59]
  ds_read_b64_tr_b16 v[160:161], v20 offset:16384
  s_add_u32 m0, s89, 98304
  v_mfma_f32_16x16x32_bf16 v[60:63], v[164:167], a[76:79], v[60:63]
  ds_read_b64_tr_b16 v[162:163], v20 offset:17408
  s_waitcnt lgkmcnt(10)
  v_mfma_f32_16x16x32_bf16 v[64:67], v[168:171], a[72:75], v[64:67]
  ds_read_b64_tr_b16 v[164:165], v21 offset:16384
  buffer_load_dwordx4 v8, s[24:27], s87 offen offset:0 lds
  v_mfma_f32_16x16x32_bf16 v[68:71], v[168:171], a[76:79], v[68:71]
  ds_read_b64_tr_b16 v[166:167], v21 offset:17408
  v_mfma_f32_16x16x32_bf16 v[72:75], v[172:175], a[72:75], v[72:75]
  ds_read_b64_tr_b16 v[168:169], v22 offset:16384
  v_mfma_f32_16x16x32_bf16 v[76:79], v[172:175], a[76:79], v[76:79]
  ds_read_b64_tr_b16 v[170:171], v22 offset:17408
  s_waitcnt lgkmcnt(10)
  v_mfma_f32_16x16x32_bf16 v[80:83], v[176:179], a[72:75], v[80:83]
  ds_read_b64_tr_b16 v[172:173], v23 offset:16384
  buffer_load_dwordx4 v9, s[24:27], s87 offen offset:1024 lds
  v_mfma_f32_16x16x32_bf16 v[84:87], v[176:179], a[76:79], v[84:87]
  ds_read_b64_tr_b16 v[174:175], v23 offset:17408
  v_mfma_f32_16x16x32_bf16 v[88:91], v[180:183], a[72:75], v[88:91]
  ds_read_b64_tr_b16 v[176:177], v26 offset:16384
  v_mfma_f32_16x16x32_bf16 v[92:95], v[180:183], a[76:79], v[92:95]
  ds_read_b64_tr_b16 v[178:179], v26 offset:17408
  s_waitcnt lgkmcnt(10)
  v_mfma_f32_16x16x32_bf16 v[96:99], v[184:187], a[72:75], v[96:99]
  ds_read_b64_tr_b16 v[180:181], v27 offset:16384
  buffer_load_dwordx4 v10, s[24:27], s87 offen offset:2048 lds
  v_mfma_f32_16x16x32_bf16 v[100:103], v[184:187], a[76:79], v[100:103]
  ds_read_b64_tr_b16 v[182:183], v27 offset:17408
  v_mfma_f32_16x16x32_bf16 v[104:107], v[188:191], a[72:75], v[104:107]
  ds_read_b64_tr_b16 v[184:185], v28 offset:16384
  v_mfma_f32_16x16x32_bf16 v[108:111], v[188:191], a[76:79], v[108:111]
  ds_read_b64_tr_b16 v[186:187], v28 offset:17408
  s_waitcnt lgkmcnt(10)
  v_mfma_f32_16x16x32_bf16 v[48:51], v[160:163], a[80:83], v[48:51]
  ds_read_b64_tr_b16 v[188:189], v29 offset:16384
  buffer_load_dwordx4 v11, s[24:27], s87 offen offset:3072 lds
  v_mfma_f32_16x16x32_bf16 v[52:55], v[160:163], a[84:87], v[52:55]
  ds_read_b64_tr_b16 v[190:191], v29 offset:17408
  v_mfma_f32_16x16x32_bf16 v[56:59], v[164:167], a[80:83], v[56:59]
  ds_read_b64_tr_b16 v[160:161], v20 offset:24576
  v_mfma_f32_16x16x32_bf16 v[60:63], v[164:167], a[84:87], v[60:63]
  ds_read_b64_tr_b16 v[162:163], v20 offset:25600
  s_waitcnt lgkmcnt(10)
  v_mfma_f32_16x16x32_bf16 v[64:67], v[168:171], a[80:83], v[64:67]
  ds_read_b64_tr_b16 v[164:165], v21 offset:24576
  v_add_u32 v20, 4294836224, v20
  s_add_u32 m0, s89, 102400
  v_mfma_f32_16x16x32_bf16 v[68:71], v[168:171], a[84:87], v[68:71]
  ds_read_b64_tr_b16 v[166:167], v21 offset:25600
  v_add_u32 v21, 4294836224, v21
  v_mfma_f32_16x16x32_bf16 v[72:75], v[172:175], a[80:83], v[72:75]
  ds_read_b64_tr_b16 v[168:169], v22 offset:24576
  buffer_load_dwordx4 v8, s[24:27], s88 offen offset:0 lds
  v_mfma_f32_16x16x32_bf16 v[76:79], v[172:175], a[84:87], v[76:79]
  ds_read_b64_tr_b16 v[170:171], v22 offset:25600
  s_waitcnt lgkmcnt(10)
  v_mfma_f32_16x16x32_bf16 v[80:83], v[176:179], a[80:83], v[80:83]
  ds_read_b64_tr_b16 v[172:173], v23 offset:24576
  v_add_u32 v22, 4294836224, v22
  v_mfma_f32_16x16x32_bf16 v[84:87], v[176:179], a[84:87], v[84:87]
  ds_read_b64_tr_b16 v[174:175], v23 offset:25600
  v_add_u32 v23, 4294836224, v23
  v_mfma_f32_16x16x32_bf16 v[88:91], v[180:183], a[80:83], v[88:91]
  ds_read_b64_tr_b16 v[176:177], v26 offset:24576
  buffer_load_dwordx4 v9, s[24:27], s88 offen offset:1024 lds
  v_mfma_f32_16x16x32_bf16 v[92:95], v[180:183], a[84:87], v[92:95]
  ds_read_b64_tr_b16 v[178:179], v26 offset:25600
  s_waitcnt lgkmcnt(10)
  v_mfma_f32_16x16x32_bf16 v[96:99], v[184:187], a[80:83], v[96:99]
  ds_read_b64_tr_b16 v[180:181], v27 offset:24576
  v_add_u32 v26, 4294836224, v26
  v_mfma_f32_16x16x32_bf16 v[100:103], v[184:187], a[84:87], v[100:103]
  ds_read_b64_tr_b16 v[182:183], v27 offset:25600
  v_add_u32 v27, 4294836224, v27
  v_mfma_f32_16x16x32_bf16 v[104:107], v[188:191], a[80:83], v[104:107]
  ds_read_b64_tr_b16 v[184:185], v28 offset:24576
  v_mfma_f32_16x16x32_bf16 v[108:111], v[188:191], a[84:87], v[108:111]
  ds_read_b64_tr_b16 v[186:187], v28 offset:25600
  s_waitcnt lgkmcnt(10)
  v_mfma_f32_16x16x32_bf16 v[48:51], v[160:163], a[88:91], v[48:51]
  ds_read_b64_tr_b16 v[188:189], v29 offset:24576
  v_add_u32 v28, 4294836224, v28
  v_mfma_f32_16x16x32_bf16 v[52:55], v[160:163], a[92:95], v[52:55]
  ds_read_b64_tr_b16 v[190:191], v29 offset:25600
  buffer_load_dwordx4 v10, s[24:27], s88 offen offset:2048 lds
  v_mfma_f32_16x16x32_bf16 v[56:59], v[164:167], a[88:91], v[56:59]
  v_add_u32 v29, 4294836224, v29
  v_mfma_f32_16x16x32_bf16 v[60:63], v[164:167], a[92:95], v[60:63]
  s_waitcnt lgkmcnt(8)
  buffer_load_dwordx4 v11, s[24:27], s88 offen offset:3072 lds
  v_mfma_f32_16x16x32_bf16 v[64:67], v[168:171], a[88:91], v[64:67]
  s_add_u32 s87, s87, 262144
  s_add_u32 s88, s88, 262144
  v_mfma_f32_16x16x32_bf16 v[68:71], v[168:171], a[92:95], v[68:71]
  s_waitcnt vmcnt(24) lgkmcnt(0)
  s_barrier
  v_mfma_f32_16x16x32_bf16 v[72:75], v[172:175], a[88:91], v[72:75]
  ds_read_b64_tr_b16 v[160:161], v20 offset:0
  ds_read_b64_tr_b16 v[162:163], v20 offset:1024
  buffer_load_dwordx4 a[0:3], v30, s[20:23], s90 offen offset:2048 sc1
  v_mfma_f32_16x16x32_bf16 v[76:79], v[172:175], a[92:95], v[76:79]
  ds_read_b64_tr_b16 v[164:165], v21 offset:0
  ds_read_b64_tr_b16 v[166:167], v21 offset:1024
  v_mfma_f32_16x16x32_bf16 v[80:83], v[176:179], a[88:91], v[80:83]
  ds_read_b64_tr_b16 v[168:169], v22 offset:0
  ds_read_b64_tr_b16 v[170:171], v22 offset:1024
  s_add_u32 m0, s89, 131072
  v_mfma_f32_16x16x32_bf16 v[84:87], v[176:179], a[92:95], v[84:87]
  ds_read_b64_tr_b16 v[172:173], v23 offset:0
  ds_read_b64_tr_b16 v[174:175], v23 offset:1024
  v_mfma_f32_16x16x32_bf16 v[88:91], v[180:183], a[88:91], v[88:91]
  ds_read_b64_tr_b16 v[176:177], v26 offset:0
  buffer_load_dwordx4 v8, s[24:27], s87 offen offset:0 lds
  v_mfma_f32_16x16x32_bf16 v[92:95], v[180:183], a[92:95], v[92:95]
  ds_read_b64_tr_b16 v[178:179], v26 offset:1024
  v_mfma_f32_16x16x32_bf16 v[96:99], v[184:187], a[88:91], v[96:99]
  ds_read_b64_tr_b16 v[180:181], v27 offset:0
  v_mfma_f32_16x16x32_bf16 v[100:103], v[184:187], a[92:95], v[100:103]
  ds_read_b64_tr_b16 v[182:183], v27 offset:1024
  v_mfma_f32_16x16x32_bf16 v[104:107], v[188:191], a[88:91], v[104:107]
  ds_read_b64_tr_b16 v[184:185], v28 offset:0
  buffer_load_dwordx4 v9, s[24:27], s87 offen offset:1024 lds
  v_mfma_f32_16x16x32_bf16 v[108:111], v[188:191], a[92:95], v[108:111]
  ds_read_b64_tr_b16 v[186:187], v28 offset:1024
  s_waitcnt lgkmcnt(10)
  v_mfma_f32_16x16x32_bf16 v[48:51], v[160:163], a[96:99], v[48:51]
  ds_read_b64_tr_b16 v[188:189], v29 offset:0
  v_mfma_f32_16x16x32_bf16 v[52:55], v[160:163], a[100:103], v[52:55]
  ds_read_b64_tr_b16 v[190:191], v29 offset:1024
  v_mfma_f32_16x16x32_bf16 v[56:59], v[164:167], a[96:99], v[56:59]
  ds_read_b64_tr_b16 v[160:161], v20 offset:8192
  buffer_load_dwordx4 v10, s[24:27], s87 offen offset:2048 lds
  v_mfma_f32_16x16x32_bf16 v[60:63], v[164:167], a[100:103], v[60:63]
  ds_read_b64_tr_b16 v[162:163], v20 offset:9216
  s_waitcnt lgkmcnt(10)
  v_mfma_f32_16x16x32_bf16 v[64:67], v[168:171], a[96:99], v[64:67]
  ds_read_b64_tr_b16 v[164:165], v21 offset:8192
  v_mfma_f32_16x16x32_bf16 v[68:71], v[168:171], a[100:103], v[68:71]
  ds_read_b64_tr_b16 v[166:167], v21 offset:9216
  v_mfma_f32_16x16x32_bf16 v[72:75], v[172:175], a[96:99], v[72:75]
  ds_read_b64_tr_b16 v[168:169], v22 offset:8192
  buffer_load_dwordx4 v11, s[24:27], s87 offen offset:3072 lds
  v_mfma_f32_16x16x32_bf16 v[76:79], v[172:175], a[100:103], v[76:79]
  ds_read_b64_tr_b16 v[170:171], v22 offset:9216
  s_waitcnt lgkmcnt(10)
  v_mfma_f32_16x16x32_bf16 v[80:83], v[176:179], a[96:99], v[80:83]
  ds_read_b64_tr_b16 v[172:173], v23 offset:8192
  v_mfma_f32_16x16x32_bf16 v[84:87], v[176:179], a[100:103], v[84:87]
  ds_read_b64_tr_b16 v[174:175], v23 offset:9216
  v_mfma_f32_16x16x32_bf16 v[88:91], v[180:183], a[96:99], v[88:91]
  ds_read_b64_tr_b16 v[176:177], v26 offset:8192
  s_add_u32 m0, s89, 135168
  v_mfma_f32_16x16x32_bf16 v[92:95], v[180:183], a[100:103], v[92:95]
  ds_read_b64_tr_b16 v[178:179], v26 offset:9216
  s_waitcnt lgkmcnt(10)
  v_mfma_f32_16x16x32_bf16 v[96:99], v[184:187], a[96:99], v[96:99]
  ds_read_b64_tr_b16 v[180:181], v27 offset:8192
  buffer_load_dwordx4 v8, s[24:27], s88 offen offset:0 lds
  v_mfma_f32_16x16x32_bf16 v[100:103], v[184:187], a[100:103], v[100:103]
  ds_read_b64_tr_b16 v[182:183], v27 offset:9216
  v_mfma_f32_16x16x32_bf16 v[104:107], v[188:191], a[96:99], v[104:107]
  ds_read_b64_tr_b16 v[184:185], v28 offset:8192
  v_mfma_f32_16x16x32_bf16 v[108:111], v[188:191], a[100:103], v[108:111]
  ds_read_b64_tr_b16 v[186:187], v28 offset:9216
  s_waitcnt lgkmcnt(10)
  v_mfma_f32_16x16x32_bf16 v[48:51], v[160:163], a[104:107], v[48:51]
  ds_read_b64_tr_b16 v[188:189], v29 offset:8192
  buffer_load_dwordx4 v9, s[24:27], s88 offen offset:1024 lds
  v_mfma_f32_16x16x32_bf16 v[52:55], v[160:163], a[108:111], v[52:55]
  ds_read_b64_tr_b16 v[190:191], v29 offset:9216
  v_mfma_f32_16x16x32_bf16 v[56:59], v[164:167], a[104:107], v[56:59]
  ds_read_b64_tr_b16 v[160:161], v20 offset:16384
  v_mfma_f32_16x16x32_bf16 v[60:63], v[164:167], a[108:111], v[60:63]
  ds_read_b64_tr_b16 v[162:163], v20 offset:17408
  s_waitcnt lgkmcnt(10)
  v_mfma_f32_16x16x32_bf16 v[64:67], v[168:171], a[104:107], v[64:67]
  ds_read_b64_tr_b16 v[164:165], v21 offset:16384
  buffer_load_dwordx4 v10, s[24:27], s88 offen offset:2048 lds
  v_mfma_f32_16x16x32_bf16 v[68:71], v[168:171], a[108:111], v[68:71]
  ds_read_b64_tr_b16 v[166:167], v21 offset:17408
  v_mfma_f32_16x16x32_bf16 v[72:75], v[172:175], a[104:107], v[72:75]
  ds_read_b64_tr_b16 v[168:169], v22 offset:16384
  v_mfma_f32_16x16x32_bf16 v[76:79], v[172:175], a[108:111], v[76:79]
  ds_read_b64_tr_b16 v[170:171], v22 offset:17408
  s_waitcnt lgkmcnt(10)
  v_mfma_f32_16x16x32_bf16 v[80:83], v[176:179], a[104:107], v[80:83]
  ds_read_b64_tr_b16 v[172:173], v23 offset:16384
  buffer_load_dwordx4 v11, s[24:27], s88 offen offset:3072 lds
  v_mfma_f32_16x16x32_bf16 v[84:87], v[176:179], a[108:111], v[84:87]
  ds_read_b64_tr_b16 v[174:175], v23 offset:17408
  s_add_u32 s87, s87, 262144
  v_mfma_f32_16x16x32_bf16 v[88:91], v[180:183], a[104:107], v[88:91]
  ds_read_b64_tr_b16 v[176:177], v26 offset:16384
  s_add_u32 s88, s88, 262144
  v_mfma_f32_16x16x32_bf16 v[92:95], v[180:183], a[108:111], v[92:95]
  ds_read_b64_tr_b16 v[178:179], v26 offset:17408
  s_waitcnt lgkmcnt(10)
  v_mfma_f32_16x16x32_bf16 v[96:99], v[184:187], a[104:107], v[96:99]
  ds_read_b64_tr_b16 v[180:181], v27 offset:16384
  buffer_load_dwordx4 a[4:7], v30, s[20:23], s90 offen offset:2304 sc1
  v_mfma_f32_16x16x32_bf16 v[100:103], v[184:187], a[108:111], v[100:103]
  ds_read_b64_tr_b16 v[182:183], v27 offset:17408
  s_add_u32 s90, s90, 4096
  v_mfma_f32_16x16x32_bf16 v[104:107], v[188:191], a[104:107], v[104:107]
  ds_read_b64_tr_b16 v[184:185], v28 offset:16384
  v_mfma_f32_16x16x32_bf16 v[108:111], v[188:191], a[108:111], v[108:111]
  ds_read_b64_tr_b16 v[186:187], v28 offset:17408
  s_waitcnt lgkmcnt(10)
  v_mfma_f32_16x16x32_bf16 v[48:51], v[160:163], a[112:115], v[48:51]
  ds_read_b64_tr_b16 v[188:189], v29 offset:16384
  buffer_load_dwordx4 a[8:11], v30, s[20:23], s90 offen offset:0 sc1
  v_mfma_f32_16x16x32_bf16 v[52:55], v[160:163], a[116:119], v[52:55]
  ds_read_b64_tr_b16 v[190:191], v29 offset:17408
  v_mfma_f32_16x16x32_bf16 v[56:59], v[164:167], a[112:115], v[56:59]
  ds_read_b64_tr_b16 v[160:161], v20 offset:24576
  v_mfma_f32_16x16x32_bf16 v[60:63], v[164:167], a[116:119], v[60:63]
  ds_read_b64_tr_b16 v[162:163], v20 offset:25600
  s_waitcnt lgkmcnt(10)
  v_mfma_f32_16x16x32_bf16 v[64:67], v[168:171], a[112:115], v[64:67]
  ds_read_b64_tr_b16 v[164:165], v21 offset:24576
  v_add_u32 v20, 32768, v20
  v_mfma_f32_16x16x32_bf16 v[68:71], v[168:171], a[116:119], v[68:71]
  ds_read_b64_tr_b16 v[166:167], v21 offset:25600
  v_add_u32 v21, 32768, v21
  v_mfma_f32_16x16x32_bf16 v[72:75], v[172:175], a[112:115], v[72:75]
  ds_read_b64_tr_b16 v[168:169], v22 offset:24576
  buffer_load_dwordx4 a[12:15], v30, s[20:23], s90 offen offset:256 sc1
  v_mfma_f32_16x16x32_bf16 v[76:79], v[172:175], a[116:119], v[76:79]
  ds_read_b64_tr_b16 v[170:171], v22 offset:25600
  s_waitcnt lgkmcnt(10)
  v_mfma_f32_16x16x32_bf16 v[80:83], v[176:179], a[112:115], v[80:83]
  ds_read_b64_tr_b16 v[172:173], v23 offset:24576
  v_add_u32 v22, 32768, v22
  v_mfma_f32_16x16x32_bf16 v[84:87], v[176:179], a[116:119], v[84:87]
  ds_read_b64_tr_b16 v[174:175], v23 offset:25600
  v_add_u32 v23, 32768, v23
  v_mfma_f32_16x16x32_bf16 v[88:91], v[180:183], a[112:115], v[88:91]
  ds_read_b64_tr_b16 v[176:177], v26 offset:24576
  v_mfma_f32_16x16x32_bf16 v[92:95], v[180:183], a[116:119], v[92:95]
L_touch8:
  s_cbranch_execz L_touch12
  ds_read_b64_tr_b16 v[178:179], v26 offset:25600
  s_waitcnt lgkmcnt(10)
  v_mfma_f32_16x16x32_bf16 v[96:99], v[184:187], a[112:115], v[96:99]
  ds_read_b64_tr_b16 v[180:181], v27 offset:24576
  v_add_u32 v26, 32768, v26
  v_mfma_f32_16x16x32_bf16 v[100:103], v[184:187], a[116:119], v[100:103]
  ds_read_b64_tr_b16 v[182:183], v27 offset:25600
  buffer_load_dwordx4 a[16:19], v30, s[20:23], s90 offen offset:2048 sc1
  v_mfma_f32_16x16x32_bf16 v[104:107], v[188:191], a[112:115], v[104:107]
  ds_read_b64_tr_b16 v[184:185], v28 offset:24576
  v_add_u32 v27, 32768, v27
  v_mfma_f32_16x16x32_bf16 v[108:111], v[188:191], a[116:119], v[108:111]
  ds_read_b64_tr_b16 v[186:187], v28 offset:25600
  s_waitcnt lgkmcnt(10)
  v_mfma_f32_16x16x32_bf16 v[48:51], v[160:163], a[120:123], v[48:51]
  ds_read_b64_tr_b16 v[188:189], v29 offset:24576
  v_add_u32 v28, 32768, v28
  v_mfma_f32_16x16x32_bf16 v[52:55], v[160:163], a[124:127], v[52:55]
  ds_read_b64_tr_b16 v[190:191], v29 offset:25600
  buffer_load_dwordx4 a[20:23], v30, s[20:23], s90 offen offset:2304 sc1
  v_mfma_f32_16x16x32_bf16 v[56:59], v[164:167], a[120:123], v[56:59]
  s_add_u32 s90, s90, 4096
  v_add_u32 v29, 32768, v29
  v_mfma_f32_16x16x32_bf16 v[60:63], v[164:167], a[124:127], v[60:63]
  s_waitcnt lgkmcnt(8)
  buffer_load_dwordx4 a[24:27], v30, s[20:23], s90 offen offset:0 sc1
  v_mfma_f32_16x16x32_bf16 v[64:67], v[168:171], a[120:123], v[64:67]
  v_mfma_f32_16x16x32_bf16 v[68:71], v[168:171], a[124:127], v[68:71]
  s_waitcnt vmcnt(31) lgkmcnt(0)
  s_barrier
  v_mfma_f32_16x16x32_bf16 v[72:75], v[172:175], a[120:123], v[72:75]
  ds_read_b64_tr_b16 v[160:161], v20 offset:0
  ds_read_b64_tr_b16 v[162:163], v20 offset:1024
  buffer_load_dwordx4 a[28:31], v30, s[20:23], s90 offen offset:256 sc1
  v_mfma_f32_16x16x32_bf16 v[76:79], v[172:175], a[124:127], v[76:79]
  ds_read_b64_tr_b16 v[164:165], v21 offset:0
  ds_read_b64_tr_b16 v[166:167], v21 offset:1024
  v_mfma_f32_16x16x32_bf16 v[80:83], v[176:179], a[120:123], v[80:83]
  ds_read_b64_tr_b16 v[168:169], v22 offset:0
  ds_read_b64_tr_b16 v[170:171], v22 offset:1024
  s_add_u32 m0, s89, 0
  v_mfma_f32_16x16x32_bf16 v[84:87], v[176:179], a[124:127], v[84:87]
  ds_read_b64_tr_b16 v[172:173], v23 offset:0
  ds_read_b64_tr_b16 v[174:175], v23 offset:1024
  v_mfma_f32_16x16x32_bf16 v[88:91], v[180:183], a[120:123], v[88:91]
  ds_read_b64_tr_b16 v[176:177], v26 offset:0
  buffer_load_dwordx4 v8, s[24:27], s87 offen offset:0 lds
  v_mfma_f32_16x16x32_bf16 v[92:95], v[180:183], a[124:127], v[92:95]
  ds_read_b64_tr_b16 v[178:179], v26 offset:1024
  v_mfma_f32_16x16x32_bf16 v[96:99], v[184:187], a[120:123], v[96:99]
  ds_read_b64_tr_b16 v[180:181], v27 offset:0
  v_mfma_f32_16x16x32_bf16 v[100:103], v[184:187], a[124:127], v[100:103]
  ds_read_b64_tr_b16 v[182:183], v27 offset:1024
  v_mfma_f32_16x16x32_bf16 v[104:107], v[188:191], a[120:123], v[104:107]
  ds_read_b64_tr_b16 v[184:185], v28 offset:0
  buffer_load_dwordx4 v9, s[24:27], s87 offen offset:1024 lds
  v_mfma_f32_16x16x32_bf16 v[108:111], v[188:191], a[124:127], v[108:111]
  ds_read_b64_tr_b16 v[186:187], v28 offset:1024
  s_waitcnt lgkmcnt(10)
  v_mfma_f32_16x16x32_bf16 v[48:51], v[160:163], a[128:131], v[48:51]
  ds_read_b64_tr_b16 v[188:189], v29 offset:0
  v_mfma_f32_16x16x32_bf16 v[52:55], v[160:163], a[132:135], v[52:55]
  ds_read_b64_tr_b16 v[190:191], v29 offset:1024
  v_mfma_f32_16x16x32_bf16 v[56:59], v[164:167], a[128:131], v[56:59]
  ds_read_b64_tr_b16 v[160:161], v20 offset:8192
  v_mfma_f32_16x16x32_bf16 v[60:63], v[164:167], a[132:135], v[60:63]
  ds_read_b64_tr_b16 v[162:163], v20 offset:9216
  s_waitcnt lgkmcnt(10)
  v_mfma_f32_16x16x32_bf16 v[64:67], v[168:171], a[128:131], v[64:67]
  ds_read_b64_tr_b16 v[164:165], v21 offset:8192
  buffer_load_dwordx4 v10, s[24:27], s87 offen offset:2048 lds
  v_mfma_f32_16x16x32_bf16 v[68:71], v[168:171], a[132:135], v[68:71]
  ds_read_b64_tr_b16 v[166:167], v21 offset:9216
  v_mfma_f32_16x16x32_bf16 v[72:75], v[172:175], a[128:131], v[72:75]
  ds_read_b64_tr_b16 v[168:169], v22 offset:8192
  v_mfma_f32_16x16x32_bf16 v[76:79], v[172:175], a[132:135], v[76:79]
  ds_read_b64_tr_b16 v[170:171], v22 offset:9216
  s_waitcnt lgkmcnt(10)
  v_mfma_f32_16x16x32_bf16 v[80:83], v[176:179], a[128:131], v[80:83]
  ds_read_b64_tr_b16 v[172:173], v23 offset:8192
  buffer_load_dwordx4 v11, s[24:27], s87 offen offset:3072 lds
  v_mfma_f32_16x16x32_bf16 v[84:87], v[176:179], a[132:135], v[84:87]
  ds_read_b64_tr_b16 v[174:175], v23 offset:9216
  v_mfma_f32_16x16x32_bf16 v[88:91], v[180:183], a[128:131], v[88:91]
  ds_read_b64_tr_b16 v[176:177], v26 offset:8192
  s_add_u32 m0, s89, 4096
  v_mfma_f32_16x16x32_bf16 v[92:95], v[180:183], a[132:135], v[92:95]
  ds_read_b64_tr_b16 v[178:179], v26 offset:9216
  s_waitcnt lgkmcnt(10)
  v_mfma_f32_16x16x32_bf16 v[96:99], v[184:187], a[128:131], v[96:99]
  ds_read_b64_tr_b16 v[180:181], v27 offset:8192
  buffer_load_dwordx4 v8, s[24:27], s88 offen offset:0 lds
  v_mfma_f32_16x16x32_bf16 v[100:103], v[184:187], a[132:135], v[100:103]
  ds_read_b64_tr_b16 v[182:183], v27 offset:9216
  v_mfma_f32_16x16x32_bf16 v[104:107], v[188:191], a[128:131], v[104:107]
  ds_read_b64_tr_b16 v[184:185], v28 offset:8192
  v_mfma_f32_16x16x32_bf16 v[108:111], v[188:191], a[132:135], v[108:111]
  ds_read_b64_tr_b16 v[186:187], v28 offset:9216
  s_waitcnt lgkmcnt(10)
  v_mfma_f32_16x16x32_bf16 v[48:51], v[160:163], a[136:139], v[48:51]
  ds_read_b64_tr_b16 v[188:189], v29 offset:8192
  buffer_load_dwordx4 v9, s[24:27], s88 offen offset:1024 lds
  v_mfma_f32_16x16x32_bf16 v[52:55], v[160:163], a[140:143], v[52:55]
  ds_read_b64_tr_b16 v[190:191], v29 offset:9216
  v_mfma_f32_16x16x32_bf16 v[56:59], v[164:167], a[136:139], v[56:59]
  ds_read_b64_tr_b16 v[160:161], v20 offset:16384
  v_mfma_f32_16x16x32_bf16 v[60:63], v[164:167], a[140:143], v[60:63]
  ds_read_b64_tr_b16 v[162:163], v20 offset:17408
  s_waitcnt lgkmcnt(10)
  v_mfma_f32_16x16x32_bf16 v[64:67], v[168:171], a[136:139], v[64:67]
  ds_read_b64_tr_b16 v[164:165], v21 offset:16384
  buffer_load_dwordx4 v10, s[24:27], s88 offen offset:2048 lds
  v_mfma_f32_16x16x32_bf16 v[68:71], v[168:171], a[140:143], v[68:71]
  ds_read_b64_tr_b16 v[166:167], v21 offset:17408
  v_mfma_f32_16x16x32_bf16 v[72:75], v[172:175], a[136:139], v[72:75]
  ds_read_b64_tr_b16 v[168:169], v22 offset:16384
  v_mfma_f32_16x16x32_bf16 v[76:79], v[172:175], a[140:143], v[76:79]
  ds_read_b64_tr_b16 v[170:171], v22 offset:17408
  s_waitcnt lgkmcnt(10)
  v_mfma_f32_16x16x32_bf16 v[80:83], v[176:179], a[136:139], v[80:83]
  ds_read_b64_tr_b16 v[172:173], v23 offset:16384
  buffer_load_dwordx4 v11, s[24:27], s88 offen offset:3072 lds
  v_mfma_f32_16x16x32_bf16 v[84:87], v[176:179], a[140:143], v[84:87]
  ds_read_b64_tr_b16 v[174:175], v23 offset:17408
  s_add_u32 s87, s87, 262144
  v_mfma_f32_16x16x32_bf16 v[88:91], v[180:183], a[136:139], v[88:91]
  ds_read_b64_tr_b16 v[176:177], v26 offset:16384
  s_add_u32 s88, s88, 262144
  v_mfma_f32_16x16x32_bf16 v[92:95], v[180:183], a[140:143], v[92:95]
  ds_read_b64_tr_b16 v[178:179], v26 offset:17408
  s_waitcnt lgkmcnt(10)
  v_mfma_f32_16x16x32_bf16 v[96:99], v[184:187], a[136:139], v[96:99]
  ds_read_b64_tr_b16 v[180:181], v27 offset:16384
  buffer_load_dwordx4 a[32:35], v30, s[20:23], s90 offen offset:2048 sc1
  v_mfma_f32_16x16x32_bf16 v[100:103], v[184:187], a[140:143], v[100:103]
  ds_read_b64_tr_b16 v[182:183], v27 offset:17408
  v_mfma_f32_16x16x32_bf16 v[104:107], v[188:191], a[136:139], v[104:107]
  ds_read_b64_tr_b16 v[184:185], v28 offset:16384
  v_mfma_f32_16x16x32_bf16 v[108:111], v[188:191], a[140:143], v[108:111]
  ds_read_b64_tr_b16 v[186:187], v28 offset:17408
  s_waitcnt lgkmcnt(10)
  v_mfma_f32_16x16x32_bf16 v[48:51], v[160:163], a[144:147], v[48:51]
  ds_read_b64_tr_b16 v[188:189], v29 offset:16384
  v_mfma_f32_16x16x32_bf16 v[52:55], v[160:163], a[148:151], v[52:55]
  ds_read_b64_tr_b16 v[190:191], v29 offset:17408
  v_mfma_f32_16x16x32_bf16 v[56:59], v[164:167], a[144:147], v[56:59]
  ds_read_b64_tr_b16 v[160:161], v20 offset:24576
  v_mfma_f32_16x16x32_bf16 v[60:63], v[164:167], a[148:151], v[60:63]
  ds_read_b64_tr_b16 v[162:163], v20 offset:25600
  s_waitcnt lgkmcnt(10)
  v_mfma_f32_16x16x32_bf16 v[64:67], v[168:171], a[144:147], v[64:67]
  ds_read_b64_tr_b16 v[164:165], v21 offset:24576
  v_add_u32 v20, 32768, v20
  v_mfma_f32_16x16x32_bf16 v[68:71], v[168:171], a[148:151], v[68:71]
  ds_read_b64_tr_b16 v[166:167], v21 offset:25600
  buffer_load_dwordx4 a[36:39], v30, s[20:23], s90 offen offset:2304 sc1
  v_mfma_f32_16x16x32_bf16 v[72:75], v[172:175], a[144:147], v[72:75]
  ds_read_b64_tr_b16 v[168:169], v22 offset:24576
  s_add_u32 s90, s90, 4096
  v_add_u32 v21, 32768, v21
  v_mfma_f32_16x16x32_bf16 v[76:79], v[172:175], a[148:151], v[76:79]
  ds_read_b64_tr_b16 v[170:171], v22 offset:25600
  s_waitcnt lgkmcnt(10)
  v_mfma_f32_16x16x32_bf16 v[80:83], v[176:179], a[144:147], v[80:83]
  ds_read_b64_tr_b16 v[172:173], v23 offset:24576
  v_add_u32 v22, 32768, v22
  v_mfma_f32_16x16x32_bf16 v[84:87], v[176:179], a[148:151], v[84:87]
  ds_read_b64_tr_b16 v[174:175], v23 offset:25600
  buffer_load_dwordx4 a[40:43], v30, s[20:23], s90 offen offset:0 sc1
  v_mfma_f32_16x16x32_bf16 v[88:91], v[180:183], a[144:147], v[88:91]
  ds_read_b64_tr_b16 v[176:177], v26 offset:24576
  v_add_u32 v23, 32768, v23
  v_mfma_f32_16x16x32_bf16 v[92:95], v[180:183], a[148:151], v[92:95]
  ds_read_b64_tr_b16 v[178:179], v26 offset:25600
  s_waitcnt lgkmcnt(10)
  v_mfma_f32_16x16x32_bf16 v[96:99], v[184:187], a[144:147], v[96:99]
  ds_read_b64_tr_b16 v[180:181], v27 offset:24576
  v_add_u32 v26, 32768, v26
  v_mfma_f32_16x16x32_bf16 v[100:103], v[184:187], a[148:151], v[100:103]
  ds_read_b64_tr_b16 v[182:183], v27 offset:25600
  buffer_load_dwordx4 a[44:47], v30, s[20:23], s90 offen offset:256 sc1
  v_mfma_f32_16x16x32_bf16 v[104:107], v[188:191], a[144:147], v[104:107]
  ds_read_b64_tr_b16 v[184:185], v28 offset:24576
  v_add_u32 v27, 32768, v27
  v_mfma_f32_16x16x32_bf16 v[108:111], v[188:191], a[148:151], v[108:111]
  ds_read_b64_tr_b16 v[186:187], v28 offset:25600
  s_waitcnt lgkmcnt(10)
  v_mfma_f32_16x16x32_bf16 v[48:51], v[160:163], a[152:155], v[48:51]
  ds_read_b64_tr_b16 v[188:189], v29 offset:24576
  v_add_u32 v28, 32768, v28
  v_mfma_f32_16x16x32_bf16 v[52:55], v[160:163], a[156:159], v[52:55]
  ds_read_b64_tr_b16 v[190:191], v29 offset:25600
  buffer_load_dwordx4 a[48:51], v30, s[20:23], s90 offen offset:2048 sc1
  v_mfma_f32_16x16x32_bf16 v[56:59], v[164:167], a[152:155], v[56:59]
  v_add_u32 v29, 32768, v29
  v_mfma_f32_16x16x32_bf16 v[60:63], v[164:167], a[156:159], v[60:63]
  s_waitcnt lgkmcnt(8)
  buffer_load_dwordx4 a[52:55], v30, s[20:23], s90 offen offset:2304 sc1
  v_mfma_f32_16x16x32_bf16 v[64:67], v[168:171], a[152:155], v[64:67]
  s_add_u32 s90, s90, 4096
  v_mfma_f32_16x16x32_bf16 v[68:71], v[168:171], a[156:159], v[68:71]
  s_waitcnt vmcnt(38) lgkmcnt(0)
  s_barrier
  v_mfma_f32_16x16x32_bf16 v[72:75], v[172:175], a[152:155], v[72:75]
  ds_read_b64_tr_b16 v[160:161], v20 offset:0
  ds_read_b64_tr_b16 v[162:163], v20 offset:1024
  buffer_load_dwordx4 a[56:59], v30, s[20:23], s90 offen offset:0 sc1
  v_mfma_f32_16x16x32_bf16 v[76:79], v[172:175], a[156:159], v[76:79]
  ds_read_b64_tr_b16 v[164:165], v21 offset:0
  ds_read_b64_tr_b16 v[166:167], v21 offset:1024
  v_mfma_f32_16x16x32_bf16 v[80:83], v[176:179], a[152:155], v[80:83]
  ds_read_b64_tr_b16 v[168:169], v22 offset:0
  ds_read_b64_tr_b16 v[170:171], v22 offset:1024
  s_add_u32 m0, s89, 32768
  v_mfma_f32_16x16x32_bf16 v[84:87], v[176:179], a[156:159], v[84:87]
  ds_read_b64_tr_b16 v[172:173], v23 offset:0
  ds_read_b64_tr_b16 v[174:175], v23 offset:1024
  v_mfma_f32_16x16x32_bf16 v[88:91], v[180:183], a[152:155], v[88:91]
  ds_read_b64_tr_b16 v[176:177], v26 offset:0
  buffer_load_dwordx4 v8, s[24:27], s87 offen offset:0 lds
  v_mfma_f32_16x16x32_bf16 v[92:95], v[180:183], a[156:159], v[92:95]
  ds_read_b64_tr_b16 v[178:179], v26 offset:1024
  v_mfma_f32_16x16x32_bf16 v[96:99], v[184:187], a[152:155], v[96:99]
  ds_read_b64_tr_b16 v[180:181], v27 offset:0
  v_mfma_f32_16x16x32_bf16 v[100:103], v[184:187], a[156:159], v[100:103]
  ds_read_b64_tr_b16 v[182:183], v27 offset:1024
  v_mfma_f32_16x16x32_bf16 v[104:107], v[188:191], a[152:155], v[104:107]
  ds_read_b64_tr_b16 v[184:185], v28 offset:0
  v_mfma_f32_16x16x32_bf16 v[108:111], v[188:191], a[156:159], v[108:111]
  ds_read_b64_tr_b16 v[186:187], v28 offset:1024
  s_waitcnt lgkmcnt(10)
  v_mfma_f32_16x16x32_bf16 v[48:51], v[160:163], a[160:163], v[48:51]
  ds_read_b64_tr_b16 v[188:189], v29 offset:0
  buffer_load_dwordx4 v9, s[24:27], s87 offen offset:1024 lds
  v_mfma_f32_16x16x32_bf16 v[52:55], v[160:163], a[164:167], v[52:55]
  ds_read_b64_tr_b16 v[190:191], v29 offset:1024
  v_mfma_f32_16x16x32_bf16 v[56:59], v[164:167], a[160:163], v[56:59]
  ds_read_b64_tr_b16 v[160:161], v20 offset:8192
  v_mfma_f32_16x16x32_bf16 v[60:63], v[164:167], a[164:167], v[60:63]
  ds_read_b64_tr_b16 v[162:163], v20 offset:9216
  s_waitcnt lgkmcnt(10)
  v_mfma_f32_16x16x32_bf16 v[64:67], v[168:171], a[160:163], v[64:67]
  ds_read_b64_tr_b16 v[164:165], v21 offset:8192
  buffer_load_dwordx4 v10, s[24:27], s87 offen offset:2048 lds
  v_mfma_f32_16x16x32_bf16 v[68:71], v[168:171], a[164:167], v[68:71]
  ds_read_b64_tr_b16 v[166:167], v21 offset:9216
  v_mfma_f32_16x16x32_bf16 v[72:75], v[172:175], a[160:163], v[72:75]
  ds_read_b64_tr_b16 v[168:169], v22 offset:8192
  v_mfma_f32_16x16x32_bf16 v[76:79], v[172:175], a[164:167], v[76:79]
  ds_read_b64_tr_b16 v[170:171], v22 offset:9216
  s_waitcnt lgkmcnt(10)
  v_mfma_f32_16x16x32_bf16 v[80:83], v[176:179], a[160:163], v[80:83]
  ds_read_b64_tr_b16 v[172:173], v23 offset:8192
  buffer_load_dwordx4 v11, s[24:27], s87 offen offset:3072 lds
  v_mfma_f32_16x16x32_bf16 v[84:87], v[176:179], a[164:167], v[84:87]
  ds_read_b64_tr_b16 v[174:175], v23 offset:9216
  v_mfma_f32_16x16x32_bf16 v[88:91], v[180:183], a[160:163], v[88:91]
  ds_read_b64_tr_b16 v[176:177], v26 offset:8192
  s_add_u32 m0, s89, 36864
  v_mfma_f32_16x16x32_bf16 v[92:95], v[180:183], a[164:167], v[92:95]
  ds_read_b64_tr_b16 v[178:179], v26 offset:9216
  s_waitcnt lgkmcnt(10)
  v_mfma_f32_16x16x32_bf16 v[96:99], v[184:187], a[160:163], v[96:99]
  ds_read_b64_tr_b16 v[180:181], v27 offset:8192
  buffer_load_dwordx4 v8, s[24:27], s88 offen offset:0 lds
  v_mfma_f32_16x16x32_bf16 v[100:103], v[184:187], a[164:167], v[100:103]
  ds_read_b64_tr_b16 v[182:183], v27 offset:9216
  v_mfma_f32_16x16x32_bf16 v[104:107], v[188:191], a[160:163], v[104:107]
  ds_read_b64_tr_b16 v[184:185], v28 offset:8192
  v_mfma_f32_16x16x32_bf16 v[108:111], v[188:191], a[164:167], v[108:111]
  ds_read_b64_tr_b16 v[186:187], v28 offset:9216
  s_waitcnt lgkmcnt(10)
  v_mfma_f32_16x16x32_bf16 v[48:51], v[160:163], a[168:171], v[48:51]
  ds_read_b64_tr_b16 v[188:189], v29 offset:8192
  buffer_load_dwordx4 v9, s[24:27], s88 offen offset:1024 lds
  v_mfma_f32_16x16x32_bf16 v[52:55], v[160:163], a[172:175], v[52:55]
  ds_read_b64_tr_b16 v[190:191], v29 offset:9216
  v_mfma_f32_16x16x32_bf16 v[56:59], v[164:167], a[168:171], v[56:59]
  ds_read_b64_tr_b16 v[160:161], v20 offset:16384
  v_mfma_f32_16x16x32_bf16 v[60:63], v[164:167], a[172:175], v[60:63]
  ds_read_b64_tr_b16 v[162:163], v20 offset:17408
  s_waitcnt lgkmcnt(10)
  v_mfma_f32_16x16x32_bf16 v[64:67], v[168:171], a[168:171], v[64:67]
  ds_read_b64_tr_b16 v[164:165], v21 offset:16384
  buffer_load_dwordx4 v10, s[24:27], s88 offen offset:2048 lds
  v_mfma_f32_16x16x32_bf16 v[68:71], v[168:171], a[172:175], v[68:71]
  ds_read_b64_tr_b16 v[166:167], v21 offset:17408
  v_mfma_f32_16x16x32_bf16 v[72:75], v[172:175], a[168:171], v[72:75]
  ds_read_b64_tr_b16 v[168:169], v22 offset:16384
  v_mfma_f32_16x16x32_bf16 v[76:79], v[172:175], a[172:175], v[76:79]
  ds_read_b64_tr_b16 v[170:171], v22 offset:17408
  s_waitcnt lgkmcnt(10)
  v_mfma_f32_16x16x32_bf16 v[80:83], v[176:179], a[168:171], v[80:83]
  ds_read_b64_tr_b16 v[172:173], v23 offset:16384
  v_mfma_f32_16x16x32_bf16 v[84:87], v[176:179], a[172:175], v[84:87]
  ds_read_b64_tr_b16 v[174:175], v23 offset:17408
  v_mfma_f32_16x16x32_bf16 v[88:91], v[180:183], a[168:171], v[88:91]
  ds_read_b64_tr_b16 v[176:177], v26 offset:16384
  buffer_load_dwordx4 v11, s[24:27], s88 offen offset:3072 lds
  v_mfma_f32_16x16x32_bf16 v[92:95], v[180:183], a[172:175], v[92:95]
  ds_read_b64_tr_b16 v[178:179], v26 offset:17408
  s_waitcnt lgkmcnt(10)
  v_mfma_f32_16x16x32_bf16 v[96:99], v[184:187], a[168:171], v[96:99]
  ds_read_b64_tr_b16 v[180:181], v27 offset:16384
  s_add_u32 s87, s87, 262144
  v_mfma_f32_16x16x32_bf16 v[100:103], v[184:187], a[172:175], v[100:103]
  ds_read_b64_tr_b16 v[182:183], v27 offset:17408
  s_add_u32 s88, s88, 262144
  v_mfma_f32_16x16x32_bf16 v[104:107], v[188:191], a[168:171], v[104:107]
  ds_read_b64_tr_b16 v[184:185], v28 offset:16384
  buffer_load_dwordx4 a[60:63], v30, s[20:23], s90 offen offset:256 sc1
  v_mfma_f32_16x16x32_bf16 v[108:111], v[188:191], a[172:175], v[108:111]
  ds_read_b64_tr_b16 v[186:187], v28 offset:17408
  s_waitcnt lgkmcnt(10)
  v_mfma_f32_16x16x32_bf16 v[48:51], v[160:163], a[176:179], v[48:51]
  ds_read_b64_tr_b16 v[188:189], v29 offset:16384
  v_mfma_f32_16x16x32_bf16 v[52:55], v[160:163], a[180:183], v[52:55]
  ds_read_b64_tr_b16 v[190:191], v29 offset:17408
  v_mfma_f32_16x16x32_bf16 v[56:59], v[164:167], a[176:179], v[56:59]
  ds_read_b64_tr_b16 v[160:161], v20 offset:24576
  v_mfma_f32_16x16x32_bf16 v[60:63], v[164:167], a[180:183], v[60:63]
  ds_read_b64_tr_b16 v[162:163], v20 offset:25600
  s_waitcnt lgkmcnt(10)
  v_mfma_f32_16x16x32_bf16 v[64:67], v[168:171], a[176:179], v[64:67]
  ds_read_b64_tr_b16 v[164:165], v21 offset:24576
  v_add_u32 v20, 32768, v20
  v_mfma_f32_16x16x32_bf16 v[68:71], v[168:171], a[180:183], v[68:71]
  ds_read_b64_tr_b16 v[166:167], v21 offset:25600
  buffer_load_dwordx4 a[64:67], v30, s[20:23], s90 offen offset:2048 sc1
  v_mfma_f32_16x16x32_bf16 v[72:75], v[172:175], a[176:179], v[72:75]
  ds_read_b64_tr_b16 v[168:169], v22 offset:24576
  v_add_u32 v21, 32768, v21
  v_mfma_f32_16x16x32_bf16 v[76:79], v[172:175], a[180:183], v[76:79]
  ds_read_b64_tr_b16 v[170:171], v22 offset:25600
  s_waitcnt lgkmcnt(10)
  v_mfma_f32_16x16x32_bf16 v[80:83], v[176:179], a[176:179], v[80:83]
  ds_read_b64_tr_b16 v[172:173], v23 offset:24576
  v_add_u32 v22, 32768, v22
  v_mfma_f32_16x16x32_bf16 v[84:87], v[176:179], a[180:183], v[84:87]
  ds_read_b64_tr_b16 v[174:175], v23 offset:25600
  buffer_load_dwordx4 a[68:71], v30, s[20:23], s90 offen offset:2304 sc1
  v_mfma_f32_16x16x32_bf16 v[88:91], v[180:183], a[176:179], v[88:91]
  ds_read_b64_tr_b16 v[176:177], v26 offset:24576
  s_add_u32 s90, s90, 4096
  v_add_u32 v23, 32768, v23
  v_mfma_f32_16x16x32_bf16 v[92:95], v[180:183], a[180:183], v[92:95]
  ds_read_b64_tr_b16 v[178:179], v26 offset:25600
  s_waitcnt lgkmcnt(10)
  v_mfma_f32_16x16x32_bf16 v[96:99], v[184:187], a[176:179], v[96:99]
  ds_read_b64_tr_b16 v[180:181], v27 offset:24576
  v_add_u32 v26, 32768, v26
  v_mfma_f32_16x16x32_bf16 v[100:103], v[184:187], a[180:183], v[100:103]
  ds_read_b64_tr_b16 v[182:183], v27 offset:25600
  buffer_load_dwordx4 a[72:75], v30, s[20:23], s90 offen offset:0 sc1
  v_mfma_f32_16x16x32_bf16 v[104:107], v[188:191], a[176:179], v[104:107]
  ds_read_b64_tr_b16 v[184:185], v28 offset:24576
  v_add_u32 v27, 32768, v27
  v_mfma_f32_16x16x32_bf16 v[108:111], v[188:191], a[180:183], v[108:111]
  ds_read_b64_tr_b16 v[186:187], v28 offset:25600
  s_waitcnt lgkmcnt(10)
  v_mfma_f32_16x16x32_bf16 v[48:51], v[160:163], a[184:187], v[48:51]
  ds_read_b64_tr_b16 v[188:189], v29 offset:24576
  v_add_u32 v28, 32768, v28
  v_mfma_f32_16x16x32_bf16 v[52:55], v[160:163], a[188:191], v[52:55]
  ds_read_b64_tr_b16 v[190:191], v29 offset:25600
  buffer_load_dwordx4 a[76:79], v30, s[20:23], s90 offen offset:256 sc1
  v_mfma_f32_16x16x32_bf16 v[56:59], v[164:167], a[184:187], v[56:59]
  v_add_u32 v29, 32768, v29
  v_mfma_f32_16x16x32_bf16 v[60:63], v[164:167], a[188:191], v[60:63]
  s_waitcnt lgkmcnt(8)
  buffer_load_dwordx4 a[80:83], v30, s[20:23], s90 offen offset:2048 sc1
  v_mfma_f32_16x16x32_bf16 v[64:67], v[168:171], a[184:187], v[64:67]
  v_mfma_f32_16x16x32_bf16 v[68:71], v[168:171], a[188:191], v[68:71]
  s_waitcnt vmcnt(45) lgkmcnt(0)
  s_barrier
  v_mfma_f32_16x16x32_bf16 v[72:75], v[172:175], a[184:187], v[72:75]
  ds_read_b64_tr_b16 v[160:161], v20 offset:0
  ds_read_b64_tr_b16 v[162:163], v20 offset:1024
  s_add_u32 m0, s89, 65536
  v_mfma_f32_16x16x32_bf16 v[76:79], v[172:175], a[188:191], v[76:79]
  ds_read_b64_tr_b16 v[164:165], v21 offset:0
  ds_read_b64_tr_b16 v[166:167], v21 offset:1024
  v_mfma_f32_16x16x32_bf16 v[80:83], v[176:179], a[184:187], v[80:83]
  ds_read_b64_tr_b16 v[168:169], v22 offset:0
  ds_read_b64_tr_b16 v[170:171], v22 offset:1024
  buffer_load_dwordx4 v8, s[24:27], s87 offen offset:0 lds
  v_mfma_f32_16x16x32_bf16 v[84:87], v[176:179], a[188:191], v[84:87]
  ds_read_b64_tr_b16 v[172:173], v23 offset:0
  ds_read_b64_tr_b16 v[174:175], v23 offset:1024
  v_mfma_f32_16x16x32_bf16 v[88:91], v[180:183], a[184:187], v[88:91]
  ds_read_b64_tr_b16 v[176:177], v26 offset:0
  v_mfma_f32_16x16x32_bf16 v[92:95], v[180:183], a[188:191], v[92:95]
  ds_read_b64_tr_b16 v[178:179], v26 offset:1024
  v_mfma_f32_16x16x32_bf16 v[96:99], v[184:187], a[184:187], v[96:99]
  ds_read_b64_tr_b16 v[180:181], v27 offset:0
  buffer_load_dwordx4 v9, s[24:27], s87 offen offset:1024 lds
  v_mfma_f32_16x16x32_bf16 v[100:103], v[184:187], a[188:191], v[100:103]
  ds_read_b64_tr_b16 v[182:183], v27 offset:1024
  v_mfma_f32_16x16x32_bf16 v[104:107], v[188:191], a[184:187], v[104:107]
  ds_read_b64_tr_b16 v[184:185], v28 offset:0
  v_mfma_f32_16x16x32_bf16 v[108:111], v[188:191], a[188:191], v[108:111]
  ds_read_b64_tr_b16 v[186:187], v28 offset:1024
  s_waitcnt lgkmcnt(10)
  v_mfma_f32_16x16x32_bf16 v[48:51], v[160:163], a[192:195], v[48:51]
  ds_read_b64_tr_b16 v[188:189], v29 offset:0
  buffer_load_dwordx4 v10, s[24:27], s87 offen offset:2048 lds
  v_mfma_f32_16x16x32_bf16 v[52:55], v[160:163], a[196:199], v[52:55]
  ds_read_b64_tr_b16 v[190:191], v29 offset:1024
  v_mfma_f32_16x16x32_bf16 v[56:59], v[164:167], a[192:195], v[56:59]
  ds_read_b64_tr_b16 v[160:161], v20 offset:8192
  v_mfma_f32_16x16x32_bf16 v[60:63], v[164:167], a[196:199], v[60:63]
  ds_read_b64_tr_b16 v[162:163], v20 offset:9216
  s_waitcnt lgkmcnt(10)
  v_mfma_f32_16x16x32_bf16 v[64:67], v[168:171], a[192:195], v[64:67]
  ds_read_b64_tr_b16 v[164:165], v21 offset:8192
  buffer_load_dwordx4 v11, s[24:27], s87 offen offset:3072 lds
  v_mfma_f32_16x16x32_bf16 v[68:71], v[168:171], a[196:199], v[68:71]
  ds_read_b64_tr_b16 v[166:167], v21 offset:9216
  v_mfma_f32_16x16x32_bf16 v[72:75], v[172:175], a[192:195], v[72:75]
  ds_read_b64_tr_b16 v[168:169], v22 offset:8192
  s_add_u32 m0, s89, 69632
  v_mfma_f32_16x16x32_bf16 v[76:79], v[172:175], a[196:199], v[76:79]
  ds_read_b64_tr_b16 v[170:171], v22 offset:9216
  s_waitcnt lgkmcnt(10)
  v_mfma_f32_16x16x32_bf16 v[80:83], v[176:179], a[192:195], v[80:83]
  ds_read_b64_tr_b16 v[172:173], v23 offset:8192
  buffer_load_dwordx4 v8, s[24:27], s88 offen offset:0 lds
  v_mfma_f32_16x16x32_bf16 v[84:87], v[176:179], a[196:199], v[84:87]
  ds_read_b64_tr_b16 v[174:175], v23 offset:9216
  v_mfma_f32_16x16x32_bf16 v[88:91], v[180:183], a[192:195], v[88:91]
  ds_read_b64_tr_b16 v[176:177], v26 offset:8192
  v_mfma_f32_16x16x32_bf16 v[92:95], v[180:183], a[196:199], v[92:95]
  ds_read_b64_tr_b16 v[178:179], v26 offset:9216
  s_waitcnt lgkmcnt(10)
  v_mfma_f32_16x16x32_bf16 v[96:99], v[184:187], a[192:195], v[96:99]
  ds_read_b64_tr_b16 v[180:181], v27 offset:8192
  buffer_load_dwordx4 v9, s[24:27], s88 offen offset:1024 lds
  v_mfma_f32_16x16x32_bf16 v[100:103], v[184:187], a[196:199], v[100:103]
  ds_read_b64_tr_b16 v[182:183], v27 offset:9216
  v_mfma_f32_16x16x32_bf16 v[104:107], v[188:191], a[192:195], v[104:107]
  ds_read_b64_tr_b16 v[184:185], v28 offset:8192
  v_mfma_f32_16x16x32_bf16 v[108:111], v[188:191], a[196:199], v[108:111]
  ds_read_b64_tr_b16 v[186:187], v28 offset:9216
  s_waitcnt lgkmcnt(10)
  v_mfma_f32_16x16x32_bf16 v[48:51], v[160:163], a[200:203], v[48:51]
  ds_read_b64_tr_b16 v[188:189], v29 offset:8192
  buffer_load_dwordx4 v10, s[24:27], s88 offen offset:2048 lds
  v_mfma_f32_16x16x32_bf16 v[52:55], v[160:163], a[204:207], v[52:55]
  ds_read_b64_tr_b16 v[190:191], v29 offset:9216
  v_mfma_f32_16x16x32_bf16 v[56:59], v[164:167], a[200:203], v[56:59]
  ds_read_b64_tr_b16 v[160:161], v20 offset:16384
  v_mfma_f32_16x16x32_bf16 v[60:63], v[164:167], a[204:207], v[60:63]
  ds_read_b64_tr_b16 v[162:163], v20 offset:17408
  s_waitcnt lgkmcnt(10)
  v_mfma_f32_16x16x32_bf16 v[64:67], v[168:171], a[200:203], v[64:67]
  ds_read_b64_tr_b16 v[164:165], v21 offset:16384
  v_mfma_f32_16x16x32_bf16 v[68:71], v[168:171], a[204:207], v[68:71]
  ds_read_b64_tr_b16 v[166:167], v21 offset:17408
  v_mfma_f32_16x16x32_bf16 v[72:75], v[172:175], a[200:203], v[72:75]
  ds_read_b64_tr_b16 v[168:169], v22 offset:16384
  buffer_load_dwordx4 v11, s[24:27], s88 offen offset:3072 lds
  v_mfma_f32_16x16x32_bf16 v[76:79], v[172:175], a[204:207], v[76:79]
  ds_read_b64_tr_b16 v[170:171], v22 offset:17408
  s_waitcnt lgkmcnt(10)
  v_mfma_f32_16x16x32_bf16 v[80:83], v[176:179], a[200:203], v[80:83]
  ds_read_b64_tr_b16 v[172:173], v23 offset:16384
  s_add_u32 s87, s87, 262144
  v_mfma_f32_16x16x32_bf16 v[84:87], v[176:179], a[204:207], v[84:87]
  ds_read_b64_tr_b16 v[174:175], v23 offset:17408
  s_add_u32 s88, s88, 262144
  v_mfma_f32_16x16x32_bf16 v[88:91], v[180:183], a[200:203], v[88:91]
  ds_read_b64_tr_b16 v[176:177], v26 offset:16384
  buffer_load_dwordx4 a[84:87], v30, s[20:23], s90 offen offset:2304 sc1
  v_mfma_f32_16x16x32_bf16 v[92:95], v[180:183], a[204:207], v[92:95]
  ds_read_b64_tr_b16 v[178:179], v26 offset:17408
  s_waitcnt lgkmcnt(10)
  v_mfma_f32_16x16x32_bf16 v[96:99], v[184:187], a[200:203], v[96:99]
  ds_read_b64_tr_b16 v[180:181], v27 offset:16384
  s_add_u32 s90, s90, 4096
  v_mfma_f32_16x16x32_bf16 v[100:103], v[184:187], a[204:207], v[100:103]
  ds_read_b64_tr_b16 v[182:183], v27 offset:17408
  v_mfma_f32_16x16x32_bf16 v[104:107], v[188:191], a[200:203], v[104:107]
  ds_read_b64_tr_b16 v[184:185], v28 offset:16384
  buffer_load_dwordx4 a[88:91], v30, s[20:23], s90 offen offset:0 sc1
  v_mfma_f32_16x16x32_bf16 v[108:111], v[188:191], a[204:207], v[108:111]
  ds_read_b64_tr_b16 v[186:187], v28 offset:17408
  s_waitcnt lgkmcnt(10)
  v_mfma_f32_16x16x32_bf16 v[48:51], v[160:163], a[208:211], v[48:51]
  ds_read_b64_tr_b16 v[188:189], v29 offset:16384
  v_mfma_f32_16x16x32_bf16 v[52:55], v[160:163], a[212:215], v[52:55]
  ds_read_b64_tr_b16 v[190:191], v29 offset:17408
  v_mfma_f32_16x16x32_bf16 v[56:59], v[164:167], a[208:211], v[56:59]
  ds_read_b64_tr_b16 v[160:161], v20 offset:24576
  v_mfma_f32_16x16x32_bf16 v[60:63], v[164:167], a[212:215], v[60:63]
  ds_read_b64_tr_b16 v[162:163], v20 offset:25600
  s_waitcnt lgkmcnt(10)
  v_mfma_f32_16x16x32_bf16 v[64:67], v[168:171], a[208:211], v[64:67]
  ds_read_b64_tr_b16 v[164:165], v21 offset:24576
  v_add_u32 v20, 32768, v20
  v_mfma_f32_16x16x32_bf16 v[68:71], v[168:171], a[212:215], v[68:71]
  ds_read_b64_tr_b16 v[166:167], v21 offset:25600
  buffer_load_dwordx4 a[92:95], v30, s[20:23], s90 offen offset:256 sc1
  v_mfma_f32_16x16x32_bf16 v[72:75], v[172:175], a[208:211], v[72:75]
  ds_read_b64_tr_b16 v[168:169], v22 offset:24576
  v_add_u32 v21, 32768, v21
  v_mfma_f32_16x16x32_bf16 v[76:79], v[172:175], a[212:215], v[76:79]
  ds_read_b64_tr_b16 v[170:171], v22 offset:25600
  s_waitcnt lgkmcnt(10)
  v_mfma_f32_16x16x32_bf16 v[80:83], v[176:179], a[208:211], v[80:83]
  ds_read_b64_tr_b16 v[172:173], v23 offset:24576
  v_add_u32 v22, 32768, v22
  v_mfma_f32_16x16x32_bf16 v[84:87], v[176:179], a[212:215], v[84:87]
  ds_read_b64_tr_b16 v[174:175], v23 offset:25600
  buffer_load_dwordx4 a[96:99], v30, s[20:23], s90 offen offset:2048 sc1
  v_mfma_f32_16x16x32_bf16 v[88:91], v[180:183], a[208:211], v[88:91]
  ds_read_b64_tr_b16 v[176:177], v26 offset:24576
  v_add_u32 v23, 32768, v23
  v_mfma_f32_16x16x32_bf16 v[92:95], v[180:183], a[212:215], v[92:95]
  ds_read_b64_tr_b16 v[178:179], v26 offset:25600
  s_waitcnt lgkmcnt(10)
  v_mfma_f32_16x16x32_bf16 v[96:99], v[184:187], a[208:211], v[96:99]
  ds_read_b64_tr_b16 v[180:181], v27 offset:24576
  v_add_u32 v26, 32768, v26
  v_mfma_f32_16x16x32_bf16 v[100:103], v[184:187], a[212:215], v[100:103]
  ds_read_b64_tr_b16 v[182:183], v27 offset:25600
  buffer_load_dwordx4 a[100:103], v30, s[20:23], s90 offen offset:2304 sc1
  v_mfma_f32_16x16x32_bf16 v[104:107], v[188:191], a[208:211], v[104:107]
  ds_read_b64_tr_b16 v[184:185], v28 offset:24576
  s_add_u32 s90, s90, 4096
  v_mfma_f32_16x16x32_bf16 v[108:111], v[188:191], a[212:215], v[108:111]
  ds_read_b64_tr_b16 v[186:187], v28 offset:25600
  s_waitcnt lgkmcnt(10)
  v_mfma_f32_16x16x32_bf16 v[48:51], v[160:163], a[216:219], v[48:51]
  ds_read_b64_tr_b16 v[188:189], v29 offset:24576
  v_add_u32 v27, 32768, v27
  v_add_u32 v28, 32768, v28
  v_mfma_f32_16x16x32_bf16 v[52:55], v[160:163], a[220:223], v[52:55]
L_touch9:
  s_cbranch_execz L_touch13
  ds_read_b64_tr_b16 v[190:191], v29 offset:25600
  v_add_u32 v29, 32768, v29
  v_mfma_f32_16x16x32_bf16 v[56:59], v[164:167], a[216:219], v[56:59]
  buffer_load_dwordx4 a[104:107], v30, s[20:23], s90 offen offset:0 sc1
  v_mfma_f32_16x16x32_bf16 v[60:63], v[164:167], a[220:223], v[60:63]
  s_waitcnt lgkmcnt(8)
  v_mfma_f32_16x16x32_bf16 v[64:67], v[168:171], a[216:219], v[64:67]
  buffer_load_dwordx4 a[108:111], v30, s[20:23], s90 offen offset:256 sc1
  v_mfma_f32_16x16x32_bf16 v[68:71], v[168:171], a[220:223], v[68:71]
  s_waitcnt vmcnt(51) lgkmcnt(0)
  s_barrier
  v_mfma_f32_16x16x32_bf16 v[72:75], v[172:175], a[216:219], v[72:75]
  ds_read_b64_tr_b16 v[160:161], v20 offset:0
  ds_read_b64_tr_b16 v[162:163], v20 offset:1024
  s_add_u32 m0, s89, 98304
  v_mfma_f32_16x16x32_bf16 v[76:79], v[172:175], a[220:223], v[76:79]
  ds_read_b64_tr_b16 v[164:165], v21 offset:0
  ds_read_b64_tr_b16 v[166:167], v21 offset:1024
  v_mfma_f32_16x16x32_bf16 v[80:83], v[176:179], a[216:219], v[80:83]
  ds_read_b64_tr_b16 v[168:169], v22 offset:0
  ds_read_b64_tr_b16 v[170:171], v22 offset:1024
  buffer_load_dwordx4 v8, s[24:27], s87 offen offset:0 lds
  v_mfma_f32_16x16x32_bf16 v[84:87], v[176:179], a[220:223], v[84:87]
  ds_read_b64_tr_b16 v[172:173], v23 offset:0
  ds_read_b64_tr_b16 v[174:175], v23 offset:1024
  v_mfma_f32_16x16x32_bf16 v[88:91], v[180:183], a[216:219], v[88:91]
  ds_read_b64_tr_b16 v[176:177], v26 offset:0
  v_mfma_f32_16x16x32_bf16 v[92:95], v[180:183], a[220:223], v[92:95]
  ds_read_b64_tr_b16 v[178:179], v26 offset:1024
  v_mfma_f32_16x16x32_bf16 v[96:99], v[184:187], a[216:219], v[96:99]
  ds_read_b64_tr_b16 v[180:181], v27 offset:0
  buffer_load_dwordx4 v9, s[24:27], s87 offen offset:1024 lds
  v_mfma_f32_16x16x32_bf16 v[100:103], v[184:187], a[220:223], v[100:103]
  ds_read_b64_tr_b16 v[182:183], v27 offset:1024
  v_mfma_f32_16x16x32_bf16 v[104:107], v[188:191], a[216:219], v[104:107]
  ds_read_b64_tr_b16 v[184:185], v28 offset:0
  v_mfma_f32_16x16x32_bf16 v[108:111], v[188:191], a[220:223], v[108:111]
  ds_read_b64_tr_b16 v[186:187], v28 offset:1024
  s_waitcnt lgkmcnt(10)
  v_mfma_f32_16x16x32_bf16 v[48:51], v[160:163], v[200:203], v[48:51]
  ds_read_b64_tr_b16 v[188:189], v29 offset:0
  buffer_load_dwordx4 v10, s[24:27], s87 offen offset:2048 lds
  v_mfma_f32_16x16x32_bf16 v[52:55], v[160:163], v[204:207], v[52:55]
  ds_read_b64_tr_b16 v[190:191], v29 offset:1024
  v_mfma_f32_16x16x32_bf16 v[56:59], v[164:167], v[200:203], v[56:59]
  ds_read_b64_tr_b16 v[160:161], v20 offset:8192
  v_mfma_f32_16x16x32_bf16 v[60:63], v[164:167], v[204:207], v[60:63]
  ds_read_b64_tr_b16 v[162:163], v20 offset:9216
  s_waitcnt lgkmcnt(10)
  v_mfma_f32_16x16x32_bf16 v[64:67], v[168:171], v[200:203], v[64:67]
  ds_read_b64_tr_b16 v[164:165], v21 offset:8192
  buffer_load_dwordx4 v11, s[24:27], s87 offen offset:3072 lds
  v_mfma_f32_16x16x32_bf16 v[68:71], v[168:171], v[204:207], v[68:71]
  ds_read_b64_tr_b16 v[166:167], v21 offset:9216
  v_mfma_f32_16x16x32_bf16 v[72:75], v[172:175], v[200:203], v[72:75]
  ds_read_b64_tr_b16 v[168:169], v22 offset:8192
  s_add_u32 m0, s89, 102400
  v_mfma_f32_16x16x32_bf16 v[76:79], v[172:175], v[204:207], v[76:79]
  ds_read_b64_tr_b16 v[170:171], v22 offset:9216
  s_waitcnt lgkmcnt(10)
  v_mfma_f32_16x16x32_bf16 v[80:83], v[176:179], v[200:203], v[80:83]
  ds_read_b64_tr_b16 v[172:173], v23 offset:8192
  buffer_load_dwordx4 v8, s[24:27], s88 offen offset:0 lds
  v_mfma_f32_16x16x32_bf16 v[84:87], v[176:179], v[204:207], v[84:87]
  ds_read_b64_tr_b16 v[174:175], v23 offset:9216
  v_mfma_f32_16x16x32_bf16 v[88:91], v[180:183], v[200:203], v[88:91]
  ds_read_b64_tr_b16 v[176:177], v26 offset:8192
  v_mfma_f32_16x16x32_bf16 v[92:95], v[180:183], v[204:207], v[92:95]
  ds_read_b64_tr_b16 v[178:179], v26 offset:9216
  s_waitcnt lgkmcnt(10)
  v_mfma_f32_16x16x32_bf16 v[96:99], v[184:187], v[200:203], v[96:99]
  ds_read_b64_tr_b16 v[180:181], v27 offset:8192
  v_mfma_f32_16x16x32_bf16 v[100:103], v[184:187], v[204:207], v[100:103]
  ds_read_b64_tr_b16 v[182:183], v27 offset:9216
  v_mfma_f32_16x16x32_bf16 v[104:107], v[188:191], v[200:203], v[104:107]
  ds_read_b64_tr_b16 v[184:185], v28 offset:8192
  buffer_load_dwordx4 v9, s[24:27], s88 offen offset:1024 lds
  v_mfma_f32_16x16x32_bf16 v[108:111], v[188:191], v[204:207], v[108:111]
  ds_read_b64_tr_b16 v[186:187], v28 offset:9216
  s_waitcnt lgkmcnt(10)
  v_mfma_f32_16x16x32_bf16 v[48:51], v[160:163], v[208:211], v[48:51]
  ds_read_b64_tr_b16 v[188:189], v29 offset:8192
  v_mfma_f32_16x16x32_bf16 v[52:55], v[160:163], v[212:215], v[52:55]
  ds_read_b64_tr_b16 v[190:191], v29 offset:9216
  v_mfma_f32_16x16x32_bf16 v[56:59], v[164:167], v[208:211], v[56:59]
  ds_read_b64_tr_b16 v[160:161], v20 offset:16384
  buffer_load_dwordx4 v10, s[24:27], s88 offen offset:2048 lds
  v_mfma_f32_16x16x32_bf16 v[60:63], v[164:167], v[212:215], v[60:63]
  ds_read_b64_tr_b16 v[162:163], v20 offset:17408
  s_waitcnt lgkmcnt(10)
  v_mfma_f32_16x16x32_bf16 v[64:67], v[168:171], v[208:211], v[64:67]
  ds_read_b64_tr_b16 v[164:165], v21 offset:16384
  v_mfma_f32_16x16x32_bf16 v[68:71], v[168:171], v[212:215], v[68:71]
  ds_read_b64_tr_b16 v[166:167], v21 offset:17408
  v_mfma_f32_16x16x32_bf16 v[72:75], v[172:175], v[208:211], v[72:75]
  ds_read_b64_tr_b16 v[168:169], v22 offset:16384
  buffer_load_dwordx4 v11, s[24:27], s88 offen offset:3072 lds
  v_mfma_f32_16x16x32_bf16 v[76:79], v[172:175], v[212:215], v[76:79]
  ds_read_b64_tr_b16 v[170:171], v22 offset:17408
  s_waitcnt lgkmcnt(10)
  v_mfma_f32_16x16x32_bf16 v[80:83], v[176:179], v[208:211], v[80:83]
  ds_read_b64_tr_b16 v[172:173], v23 offset:16384
  s_add_u32 s87, s87, 262144
  v_mfma_f32_16x16x32_bf16 v[84:87], v[176:179], v[212:215], v[84:87]
  ds_read_b64_tr_b16 v[174:175], v23 offset:17408
  s_add_u32 s88, s88, 262144
  v_mfma_f32_16x16x32_bf16 v[88:91], v[180:183], v[208:211], v[88:91]
  ds_read_b64_tr_b16 v[176:177], v26 offset:16384
  buffer_load_dwordx4 a[112:115], v30, s[20:23], s90 offen offset:2048 sc1
  v_mfma_f32_16x16x32_bf16 v[92:95], v[180:183], v[212:215], v[92:95]
  ds_read_b64_tr_b16 v[178:179], v26 offset:17408
  s_waitcnt lgkmcnt(10)
  v_mfma_f32_16x16x32_bf16 v[96:99], v[184:187], v[208:211], v[96:99]
  ds_read_b64_tr_b16 v[180:181], v27 offset:16384
  v_mfma_f32_16x16x32_bf16 v[100:103], v[184:187], v[212:215], v[100:103]
  ds_read_b64_tr_b16 v[182:183], v27 offset:17408
  v_mfma_f32_16x16x32_bf16 v[104:107], v[188:191], v[208:211], v[104:107]
  ds_read_b64_tr_b16 v[184:185], v28 offset:16384
  buffer_load_dwordx4 a[116:119], v30, s[20:23], s90 offen offset:2304 sc1
  v_mfma_f32_16x16x32_bf16 v[108:111], v[188:191], v[212:215], v[108:111]
  ds_read_b64_tr_b16 v[186:187], v28 offset:17408
  s_waitcnt lgkmcnt(10)
  v_mfma_f32_16x16x32_bf16 v[48:51], v[160:163], v[216:219], v[48:51]
  ds_read_b64_tr_b16 v[188:189], v29 offset:16384
  s_add_u32 s90, s90, 4096
  v_mfma_f32_16x16x32_bf16 v[52:55], v[160:163], v[220:223], v[52:55]
  ds_read_b64_tr_b16 v[190:191], v29 offset:17408
  v_mfma_f32_16x16x32_bf16 v[56:59], v[164:167], v[216:219], v[56:59]
  ds_read_b64_tr_b16 v[160:161], v20 offset:24576
  v_mfma_f32_16x16x32_bf16 v[60:63], v[164:167], v[220:223], v[60:63]
  ds_read_b64_tr_b16 v[162:163], v20 offset:25600
  s_waitcnt lgkmcnt(10)
  v_mfma_f32_16x16x32_bf16 v[64:67], v[168:171], v[216:219], v[64:67]
  ds_read_b64_tr_b16 v[164:165], v21 offset:24576
  v_add_u32 v20, 4294836224, v20
  v_mfma_f32_16x16x32_bf16 v[68:71], v[168:171], v[220:223], v[68:71]
  ds_read_b64_tr_b16 v[166:167], v21 offset:25600
  buffer_load_dwordx4 a[120:123], v30, s[20:23], s90 offen offset:0 sc1
  v_mfma_f32_16x16x32_bf16 v[72:75], v[172:175], v[216:219], v[72:75]
  ds_read_b64_tr_b16 v[168:169], v22 offset:24576
  v_add_u32 v21, 4294836224, v21
  v_mfma_f32_16x16x32_bf16 v[76:79], v[172:175], v[220:223], v[76:79]
  ds_read_b64_tr_b16 v[170:171], v22 offset:25600
  s_waitcnt lgkmcnt(10)
  v_mfma_f32_16x16x32_bf16 v[80:83], v[176:179], v[216:219], v[80:83]
  ds_read_b64_tr_b16 v[172:173], v23 offset:24576
  v_add_u32 v22, 4294836224, v22
  v_mfma_f32_16x16x32_bf16 v[84:87], v[176:179], v[220:223], v[84:87]
  ds_read_b64_tr_b16 v[174:175], v23 offset:25600
  buffer_load_dwordx4 a[124:127], v30, s[20:23], s90 offen offset:256 sc1
  v_mfma_f32_16x16x32_bf16 v[88:91], v[180:183], v[216:219], v[88:91]
  ds_read_b64_tr_b16 v[176:177], v26 offset:24576
  v_add_u32 v23, 4294836224, v23
  v_mfma_f32_16x16x32_bf16 v[92:95], v[180:183], v[220:223], v[92:95]
  ds_read_b64_tr_b16 v[178:179], v26 offset:25600
  s_waitcnt lgkmcnt(10)
  v_mfma_f32_16x16x32_bf16 v[96:99], v[184:187], v[216:219], v[96:99]
  ds_read_b64_tr_b16 v[180:181], v27 offset:24576
  v_add_u32 v26, 4294836224, v26
  v_mfma_f32_16x16x32_bf16 v[100:103], v[184:187], v[220:223], v[100:103]
  ds_read_b64_tr_b16 v[182:183], v27 offset:25600
  v_add_u32 v27, 4294836224, v27
  v_mfma_f32_16x16x32_bf16 v[104:107], v[188:191], v[216:219], v[104:107]
  ds_read_b64_tr_b16 v[184:185], v28 offset:24576
  s_waitcnt vmcnt(62)
  buffer_load_dwordx4 a[128:131], v30, s[20:23], s90 offen offset:2048 sc1
  v_mfma_f32_16x16x32_bf16 v[108:111], v[188:191], v[220:223], v[108:111]
  ds_read_b64_tr_b16 v[186:187], v28 offset:25600
  s_waitcnt lgkmcnt(10)
  v_mfma_f32_16x16x32_bf16 v[48:51], v[160:163], v[224:227], v[48:51]
  ds_read_b64_tr_b16 v[188:189], v29 offset:24576
  v_add_u32 v28, 4294836224, v28
  v_mfma_f32_16x16x32_bf16 v[52:55], v[160:163], v[228:231], v[52:55]
  ds_read_b64_tr_b16 v[190:191], v29 offset:25600
  v_add_u32 v29, 4294836224, v29
  v_mfma_f32_16x16x32_bf16 v[56:59], v[164:167], v[224:227], v[56:59]
  s_waitcnt vmcnt(62)
  buffer_load_dwordx4 a[132:135], v30, s[20:23], s90 offen offset:2304 sc1
  s_add_u32 s90, s90, 4096
  v_mfma_f32_16x16x32_bf16 v[60:63], v[164:167], v[228:231], v[60:63]
  s_waitcnt lgkmcnt(8)
  v_mfma_f32_16x16x32_bf16 v[64:67], v[168:171], v[224:227], v[64:67]
  s_waitcnt vmcnt(62)
  buffer_load_dwordx4 a[136:139], v30, s[20:23], s90 offen offset:0 sc1
  v_mfma_f32_16x16x32_bf16 v[68:71], v[168:171], v[228:231], v[68:71]
  s_waitcnt vmcnt(51) lgkmcnt(0)
  s_barrier
  v_mfma_f32_16x16x32_bf16 v[72:75], v[172:175], v[224:227], v[72:75]
  ds_read_b64_tr_b16 v[160:161], v20 offset:0
  ds_read_b64_tr_b16 v[162:163], v20 offset:1024
  s_add_u32 m0, s89, 131072
  v_mfma_f32_16x16x32_bf16 v[76:79], v[172:175], v[228:231], v[76:79]
  ds_read_b64_tr_b16 v[164:165], v21 offset:0
  ds_read_b64_tr_b16 v[166:167], v21 offset:1024
  v_mfma_f32_16x16x32_bf16 v[80:83], v[176:179], v[224:227], v[80:83]
  ds_read_b64_tr_b16 v[168:169], v22 offset:0
  ds_read_b64_tr_b16 v[170:171], v22 offset:1024
  buffer_load_dwordx4 v8, s[24:27], s87 offen offset:0 lds
  v_mfma_f32_16x16x32_bf16 v[84:87], v[176:179], v[228:231], v[84:87]
  ds_read_b64_tr_b16 v[172:173], v23 offset:0
  ds_read_b64_tr_b16 v[174:175], v23 offset:1024
  v_mfma_f32_16x16x32_bf16 v[88:91], v[180:183], v[224:227], v[88:91]
  ds_read_b64_tr_b16 v[176:177], v26 offset:0
  v_mfma_f32_16x16x32_bf16 v[92:95], v[180:183], v[228:231], v[92:95]
  ds_read_b64_tr_b16 v[178:179], v26 offset:1024
  v_mfma_f32_16x16x32_bf16 v[96:99], v[184:187], v[224:227], v[96:99]
  ds_read_b64_tr_b16 v[180:181], v27 offset:0
  buffer_load_dwordx4 v9, s[24:27], s87 offen offset:1024 lds
  v_mfma_f32_16x16x32_bf16 v[100:103], v[184:187], v[228:231], v[100:103]
  ds_read_b64_tr_b16 v[182:183], v27 offset:1024
  v_mfma_f32_16x16x32_bf16 v[104:107], v[188:191], v[224:227], v[104:107]
  ds_read_b64_tr_b16 v[184:185], v28 offset:0
  v_mfma_f32_16x16x32_bf16 v[108:111], v[188:191], v[228:231], v[108:111]
  ds_read_b64_tr_b16 v[186:187], v28 offset:1024
  s_waitcnt lgkmcnt(10)
  v_mfma_f32_16x16x32_bf16 v[48:51], v[160:163], v[232:235], v[48:51]
  ds_read_b64_tr_b16 v[188:189], v29 offset:0
  buffer_load_dwordx4 v10, s[24:27], s87 offen offset:2048 lds
  v_mfma_f32_16x16x32_bf16 v[52:55], v[160:163], v[236:239], v[52:55]
  ds_read_b64_tr_b16 v[190:191], v29 offset:1024
  v_mfma_f32_16x16x32_bf16 v[56:59], v[164:167], v[232:235], v[56:59]
  ds_read_b64_tr_b16 v[160:161], v20 offset:8192
  v_mfma_f32_16x16x32_bf16 v[60:63], v[164:167], v[236:239], v[60:63]
  ds_read_b64_tr_b16 v[162:163], v20 offset:9216
  s_waitcnt lgkmcnt(10)
  v_mfma_f32_16x16x32_bf16 v[64:67], v[168:171], v[232:235], v[64:67]
  ds_read_b64_tr_b16 v[164:165], v21 offset:8192
  v_mfma_f32_16x16x32_bf16 v[68:71], v[168:171], v[236:239], v[68:71]
  ds_read_b64_tr_b16 v[166:167], v21 offset:9216
  v_mfma_f32_16x16x32_bf16 v[72:75], v[172:175], v[232:235], v[72:75]
  ds_read_b64_tr_b16 v[168:169], v22 offset:8192
  buffer_load_dwordx4 v11, s[24:27], s87 offen offset:3072 lds
  v_mfma_f32_16x16x32_bf16 v[76:79], v[172:175], v[236:239], v[76:79]
  ds_read_b64_tr_b16 v[170:171], v22 offset:9216
  s_waitcnt lgkmcnt(10)
  v_mfma_f32_16x16x32_bf16 v[80:83], v[176:179], v[232:235], v[80:83]
  ds_read_b64_tr_b16 v[172:173], v23 offset:8192
  s_add_u32 m0, s89, 135168
  v_mfma_f32_16x16x32_bf16 v[84:87], v[176:179], v[236:239], v[84:87]
  ds_read_b64_tr_b16 v[174:175], v23 offset:9216
  v_mfma_f32_16x16x32_bf16 v[88:91], v[180:183], v[232:235], v[88:91]
  ds_read_b64_tr_b16 v[176:177], v26 offset:8192
  buffer_load_dwordx4 v8, s[24:27], s88 offen offset:0 lds
  v_mfma_f32_16x16x32_bf16 v[92:95], v[180:183], v[236:239], v[92:95]
  ds_read_b64_tr_b16 v[178:179], v26 offset:9216
  s_waitcnt lgkmcnt(10)
  v_mfma_f32_16x16x32_bf16 v[96:99], v[184:187], v[232:235], v[96:99]
  ds_read_b64_tr_b16 v[180:181], v27 offset:8192
  v_mfma_f32_16x16x32_bf16 v[100:103], v[184:187], v[236:239], v[100:103]
  ds_read_b64_tr_b16 v[182:183], v27 offset:9216
  v_mfma_f32_16x16x32_bf16 v[104:107], v[188:191], v[232:235], v[104:107]
  ds_read_b64_tr_b16 v[184:185], v28 offset:8192
  buffer_load_dwordx4 v9, s[24:27], s88 offen offset:1024 lds
  v_mfma_f32_16x16x32_bf16 v[108:111], v[188:191], v[236:239], v[108:111]
  ds_read_b64_tr_b16 v[186:187], v28 offset:9216
  s_waitcnt lgkmcnt(10)
  v_mfma_f32_16x16x32_bf16 v[48:51], v[160:163], v[240:243], v[48:51]
  ds_read_b64_tr_b16 v[188:189], v29 offset:8192
  v_mfma_f32_16x16x32_bf16 v[52:55], v[160:163], v[244:247], v[52:55]
  ds_read_b64_tr_b16 v[190:191], v29 offset:9216
  v_mfma_f32_16x16x32_bf16 v[56:59], v[164:167], v[240:243], v[56:59]
  ds_read_b64_tr_b16 v[160:161], v20 offset:16384
  buffer_load_dwordx4 v10, s[24:27], s88 offen offset:2048 lds
  v_mfma_f32_16x16x32_bf16 v[60:63], v[164:167], v[244:247], v[60:63]
  ds_read_b64_tr_b16 v[162:163], v20 offset:17408
  s_waitcnt lgkmcnt(10)
  v_mfma_f32_16x16x32_bf16 v[64:67], v[168:171], v[240:243], v[64:67]
  ds_read_b64_tr_b16 v[164:165], v21 offset:16384
  v_mfma_f32_16x16x32_bf16 v[68:71], v[168:171], v[244:247], v[68:71]
  ds_read_b64_tr_b16 v[166:167], v21 offset:17408
  v_mfma_f32_16x16x32_bf16 v[72:75], v[172:175], v[240:243], v[72:75]
  ds_read_b64_tr_b16 v[168:169], v22 offset:16384
  buffer_load_dwordx4 v11, s[24:27], s88 offen offset:3072 lds
  v_mfma_f32_16x16x32_bf16 v[76:79], v[172:175], v[244:247], v[76:79]
  ds_read_b64_tr_b16 v[170:171], v22 offset:17408
  s_waitcnt lgkmcnt(10)
  v_mfma_f32_16x16x32_bf16 v[80:83], v[176:179], v[240:243], v[80:83]
  ds_read_b64_tr_b16 v[172:173], v23 offset:16384
  s_add_u32 s87, s87, 262144
  v_mfma_f32_16x16x32_bf16 v[84:87], v[176:179], v[244:247], v[84:87]
  ds_read_b64_tr_b16 v[174:175], v23 offset:17408
  s_add_u32 s88, s88, 262144
  v_mfma_f32_16x16x32_bf16 v[88:91], v[180:183], v[240:243], v[88:91]
  ds_read_b64_tr_b16 v[176:177], v26 offset:16384
  buffer_load_dwordx4 a[140:143], v30, s[20:23], s90 offen offset:256 sc1
  v_mfma_f32_16x16x32_bf16 v[92:95], v[180:183], v[244:247], v[92:95]
  ds_read_b64_tr_b16 v[178:179], v26 offset:17408
  s_waitcnt lgkmcnt(10)
  v_mfma_f32_16x16x32_bf16 v[96:99], v[184:187], v[240:243], v[96:99]
  ds_read_b64_tr_b16 v[180:181], v27 offset:16384
  v_mfma_f32_16x16x32_bf16 v[100:103], v[184:187], v[244:247], v[100:103]
  ds_read_b64_tr_b16 v[182:183], v27 offset:17408
  v_mfma_f32_16x16x32_bf16 v[104:107], v[188:191], v[240:243], v[104:107]
  ds_read_b64_tr_b16 v[184:185], v28 offset:16384
  buffer_load_dwordx4 a[144:147], v30, s[20:23], s90 offen offset:2048 sc1
  v_mfma_f32_16x16x32_bf16 v[108:111], v[188:191], v[244:247], v[108:111]
  ds_read_b64_tr_b16 v[186:187], v28 offset:17408
  s_waitcnt lgkmcnt(10)
  v_mfma_f32_16x16x32_bf16 v[48:51], v[160:163], v[248:251], v[48:51]
  ds_read_b64_tr_b16 v[188:189], v29 offset:16384
  v_mfma_f32_16x16x32_bf16 v[52:55], v[160:163], v[252:255], v[52:55]
  ds_read_b64_tr_b16 v[190:191], v29 offset:17408
  v_mfma_f32_16x16x32_bf16 v[56:59], v[164:167], v[248:251], v[56:59]
  ds_read_b64_tr_b16 v[160:161], v20 offset:24576
  v_mfma_f32_16x16x32_bf16 v[60:63], v[164:167], v[252:255], v[60:63]
  ds_read_b64_tr_b16 v[162:163], v20 offset:25600
  s_waitcnt lgkmcnt(10)
  v_mfma_f32_16x16x32_bf16 v[64:67], v[168:171], v[248:251], v[64:67]
  ds_read_b64_tr_b16 v[164:165], v21 offset:24576
  v_add_u32 v20, 32768, v20
  v_mfma_f32_16x16x32_bf16 v[68:71], v[168:171], v[252:255], v[68:71]
  ds_read_b64_tr_b16 v[166:167], v21 offset:25600
  v_add_u32 v21, 32768, v21
  v_mfma_f32_16x16x32_bf16 v[72:75], v[172:175], v[248:251], v[72:75]
  ds_read_b64_tr_b16 v[168:169], v22 offset:24576
  buffer_load_dwordx4 a[148:151], v30, s[20:23], s90 offen offset:2304 sc1
  v_mfma_f32_16x16x32_bf16 v[76:79], v[172:175], v[252:255], v[76:79]
  ds_read_b64_tr_b16 v[170:171], v22 offset:25600
  s_waitcnt lgkmcnt(10)
  v_mfma_f32_16x16x32_bf16 v[80:83], v[176:179], v[248:251], v[80:83]
  ds_read_b64_tr_b16 v[172:173], v23 offset:24576
  s_add_u32 s90, s90, 4096
  v_add_u32 v22, 32768, v22
  v_mfma_f32_16x16x32_bf16 v[84:87], v[176:179], v[252:255], v[84:87]
  ds_read_b64_tr_b16 v[174:175], v23 offset:25600
  v_add_u32 v23, 32768, v23
  v_mfma_f32_16x16x32_bf16 v[88:91], v[180:183], v[248:251], v[88:91]
  ds_read_b64_tr_b16 v[176:177], v26 offset:24576
  buffer_load_dwordx4 a[152:155], v30, s[20:23], s90 offen offset:0 sc1
  v_mfma_f32_16x16x32_bf16 v[92:95], v[180:183], v[252:255], v[92:95]
  ds_read_b64_tr_b16 v[178:179], v26 offset:25600
  s_waitcnt lgkmcnt(10)
  v_mfma_f32_16x16x32_bf16 v[96:99], v[184:187], v[248:251], v[96:99]
  ds_read_b64_tr_b16 v[180:181], v27 offset:24576
  v_add_u32 v26, 32768, v26
  v_mfma_f32_16x16x32_bf16 v[100:103], v[184:187], v[252:255], v[100:103]
  ds_read_b64_tr_b16 v[182:183], v27 offset:25600
  v_add_u32 v27, 32768, v27
  v_mfma_f32_16x16x32_bf16 v[104:107], v[188:191], v[248:251], v[104:107]
  ds_read_b64_tr_b16 v[184:185], v28 offset:24576
  s_waitcnt vmcnt(62)
  buffer_load_dwordx4 a[156:159], v30, s[20:23], s90 offen offset:256 sc1
  v_mfma_f32_16x16x32_bf16 v[108:111], v[188:191], v[252:255], v[108:111]
  ds_read_b64_tr_b16 v[186:187], v28 offset:25600
  s_waitcnt lgkmcnt(10)
  v_mfma_f32_16x16x32_bf16 v[48:51], v[160:163], a[0:3], v[48:51]
  ds_read_b64_tr_b16 v[188:189], v29 offset:24576
  v_add_u32 v28, 32768, v28
  v_mfma_f32_16x16x32_bf16 v[52:55], v[160:163], a[4:7], v[52:55]
  ds_read_b64_tr_b16 v[190:191], v29 offset:25600
  v_add_u32 v29, 32768, v29
  v_mfma_f32_16x16x32_bf16 v[56:59], v[164:167], a[0:3], v[56:59]
  s_waitcnt vmcnt(62)
  buffer_load_dwordx4 a[160:163], v30, s[20:23], s90 offen offset:2048 sc1
  v_mfma_f32_16x16x32_bf16 v[60:63], v[164:167], a[4:7], v[60:63]
  s_waitcnt lgkmcnt(8)
  v_mfma_f32_16x16x32_bf16 v[64:67], v[168:171], a[0:3], v[64:67]
  s_waitcnt vmcnt(62)
  buffer_load_dwordx4 a[164:167], v30, s[20:23], s90 offen offset:2304 sc1
  s_add_u32 s90, s90, 4096
  v_mfma_f32_16x16x32_bf16 v[68:71], v[168:171], a[4:7], v[68:71]
  s_waitcnt vmcnt(51) lgkmcnt(0)
  s_barrier
  v_mfma_f32_16x16x32_bf16 v[72:75], v[172:175], a[0:3], v[72:75]
  ds_read_b64_tr_b16 v[160:161], v20 offset:0
  ds_read_b64_tr_b16 v[162:163], v20 offset:1024
  s_add_u32 m0, s89, 0
  v_mfma_f32_16x16x32_bf16 v[76:79], v[172:175], a[4:7], v[76:79]
  ds_read_b64_tr_b16 v[164:165], v21 offset:0
  ds_read_b64_tr_b16 v[166:167], v21 offset:1024
  v_mfma_f32_16x16x32_bf16 v[80:83], v[176:179], a[0:3], v[80:83]
  ds_read_b64_tr_b16 v[168:169], v22 offset:0
  ds_read_b64_tr_b16 v[170:171], v22 offset:1024
  buffer_load_dwordx4 v8, s[24:27], s87 offen offset:0 lds
  v_mfma_f32_16x16x32_bf16 v[84:87], v[176:179], a[4:7], v[84:87]
  ds_read_b64_tr_b16 v[172:173], v23 offset:0
  ds_read_b64_tr_b16 v[174:175], v23 offset:1024
  v_mfma_f32_16x16x32_bf16 v[88:91], v[180:183], a[0:3], v[88:91]
  ds_read_b64_tr_b16 v[176:177], v26 offset:0
  v_mfma_f32_16x16x32_bf16 v[92:95], v[180:183], a[4:7], v[92:95]
  ds_read_b64_tr_b16 v[178:179], v26 offset:1024
  v_mfma_f32_16x16x32_bf16 v[96:99], v[184:187], a[0:3], v[96:99]
  ds_read_b64_tr_b16 v[180:181], v27 offset:0
  buffer_load_dwordx4 v9, s[24:27], s87 offen offset:1024 lds
  v_mfma_f32_16x16x32_bf16 v[100:103], v[184:187], a[4:7], v[100:103]
  ds_read_b64_tr_b16 v[182:183], v27 offset:1024
  v_mfma_f32_16x16x32_bf16 v[104:107], v[188:191], a[0:3], v[104:107]
  ds_read_b64_tr_b16 v[184:185], v28 offset:0
  v_mfma_f32_16x16x32_bf16 v[108:111], v[188:191], a[4:7], v[108:111]
  ds_read_b64_tr_b16 v[186:187], v28 offset:1024
  s_waitcnt lgkmcnt(10)
  v_mfma_f32_16x16x32_bf16 v[48:51], v[160:163], a[8:11], v[48:51]
  ds_read_b64_tr_b16 v[188:189], v29 offset:0
  v_mfma_f32_16x16x32_bf16 v[52:55], v[160:163], a[12:15], v[52:55]
  ds_read_b64_tr_b16 v[190:191], v29 offset:1024
  v_mfma_f32_16x16x32_bf16 v[56:59], v[164:167], a[8:11], v[56:59]
  ds_read_b64_tr_b16 v[160:161], v20 offset:8192
  buffer_load_dwordx4 v10, s[24:27], s87 offen offset:2048 lds
  v_mfma_f32_16x16x32_bf16 v[60:63], v[164:167], a[12:15], v[60:63]
  ds_read_b64_tr_b16 v[162:163], v20 offset:9216
  s_waitcnt lgkmcnt(10)
  v_mfma_f32_16x16x32_bf16 v[64:67], v[168:171], a[8:11], v[64:67]
  ds_read_b64_tr_b16 v[164:165], v21 offset:8192
  v_mfma_f32_16x16x32_bf16 v[68:71], v[168:171], a[12:15], v[68:71]
  ds_read_b64_tr_b16 v[166:167], v21 offset:9216
  v_mfma_f32_16x16x32_bf16 v[72:75], v[172:175], a[8:11], v[72:75]
  ds_read_b64_tr_b16 v[168:169], v22 offset:8192
  buffer_load_dwordx4 v11, s[24:27], s87 offen offset:3072 lds
  v_mfma_f32_16x16x32_bf16 v[76:79], v[172:175], a[12:15], v[76:79]
  ds_read_b64_tr_b16 v[170:171], v22 offset:9216
  s_waitcnt lgkmcnt(10)
  v_mfma_f32_16x16x32_bf16 v[80:83], v[176:179], a[8:11], v[80:83]
  ds_read_b64_tr_b16 v[172:173], v23 offset:8192
  s_add_u32 m0, s89, 4096
  v_mfma_f32_16x16x32_bf16 v[84:87], v[176:179], a[12:15], v[84:87]
  ds_read_b64_tr_b16 v[174:175], v23 offset:9216
  v_mfma_f32_16x16x32_bf16 v[88:91], v[180:183], a[8:11], v[88:91]
  ds_read_b64_tr_b16 v[176:177], v26 offset:8192
  buffer_load_dwordx4 v8, s[24:27], s88 offen offset:0 lds
  v_mfma_f32_16x16x32_bf16 v[92:95], v[180:183], a[12:15], v[92:95]
  ds_read_b64_tr_b16 v[178:179], v26 offset:9216
  s_waitcnt lgkmcnt(10)
  v_mfma_f32_16x16x32_bf16 v[96:99], v[184:187], a[8:11], v[96:99]
  ds_read_b64_tr_b16 v[180:181], v27 offset:8192
  v_mfma_f32_16x16x32_bf16 v[100:103], v[184:187], a[12:15], v[100:103]
  ds_read_b64_tr_b16 v[182:183], v27 offset:9216
  v_mfma_f32_16x16x32_bf16 v[104:107], v[188:191], a[8:11], v[104:107]
  ds_read_b64_tr_b16 v[184:185], v28 offset:8192
  buffer_load_dwordx4 v9, s[24:27], s88 offen offset:1024 lds
  v_mfma_f32_16x16x32_bf16 v[108:111], v[188:191], a[12:15], v[108:111]
  ds_read_b64_tr_b16 v[186:187], v28 offset:9216
  s_waitcnt lgkmcnt(10)
  v_mfma_f32_16x16x32_bf16 v[48:51], v[160:163], a[16:19], v[48:51]
  ds_read_b64_tr_b16 v[188:189], v29 offset:8192
  v_mfma_f32_16x16x32_bf16 v[52:55], v[160:163], a[20:23], v[52:55]
  ds_read_b64_tr_b16 v[190:191], v29 offset:9216
  v_mfma_f32_16x16x32_bf16 v[56:59], v[164:167], a[16:19], v[56:59]
  ds_read_b64_tr_b16 v[160:161], v20 offset:16384
  buffer_load_dwordx4 v10, s[24:27], s88 offen offset:2048 lds
  v_mfma_f32_16x16x32_bf16 v[60:63], v[164:167], a[20:23], v[60:63]
  ds_read_b64_tr_b16 v[162:163], v20 offset:17408
  s_waitcnt lgkmcnt(10)
  v_mfma_f32_16x16x32_bf16 v[64:67], v[168:171], a[16:19], v[64:67]
  ds_read_b64_tr_b16 v[164:165], v21 offset:16384
  v_mfma_f32_16x16x32_bf16 v[68:71], v[168:171], a[20:23], v[68:71]
  ds_read_b64_tr_b16 v[166:167], v21 offset:17408
  v_mfma_f32_16x16x32_bf16 v[72:75], v[172:175], a[16:19], v[72:75]
  ds_read_b64_tr_b16 v[168:169], v22 offset:16384
  buffer_load_dwordx4 v11, s[24:27], s88 offen offset:3072 lds
  v_mfma_f32_16x16x32_bf16 v[76:79], v[172:175], a[20:23], v[76:79]
  ds_read_b64_tr_b16 v[170:171], v22 offset:17408
  s_waitcnt lgkmcnt(10)
  v_mfma_f32_16x16x32_bf16 v[80:83], v[176:179], a[16:19], v[80:83]
  ds_read_b64_tr_b16 v[172:173], v23 offset:16384
  s_add_u32 s87, s87, 262144
  v_mfma_f32_16x16x32_bf16 v[84:87], v[176:179], a[20:23], v[84:87]
  ds_read_b64_tr_b16 v[174:175], v23 offset:17408
  s_add_u32 s88, s88, 262144
  v_mfma_f32_16x16x32_bf16 v[88:91], v[180:183], a[16:19], v[88:91]
  ds_read_b64_tr_b16 v[176:177], v26 offset:16384
  v_mfma_f32_16x16x32_bf16 v[92:95], v[180:183], a[20:23], v[92:95]
  ds_read_b64_tr_b16 v[178:179], v26 offset:17408
  s_waitcnt lgkmcnt(10)
  v_mfma_f32_16x16x32_bf16 v[96:99], v[184:187], a[16:19], v[96:99]
  ds_read_b64_tr_b16 v[180:181], v27 offset:16384
  buffer_load_dwordx4 a[168:171], v30, s[20:23], s90 offen offset:0 sc1
  v_mfma_f32_16x16x32_bf16 v[100:103], v[184:187], a[20:23], v[100:103]
  ds_read_b64_tr_b16 v[182:183], v27 offset:17408
  v_mfma_f32_16x16x32_bf16 v[104:107], v[188:191], a[16:19], v[104:107]
  ds_read_b64_tr_b16 v[184:185], v28 offset:16384
  v_mfma_f32_16x16x32_bf16 v[108:111], v[188:191], a[20:23], v[108:111]
  ds_read_b64_tr_b16 v[186:187], v28 offset:17408
  s_waitcnt lgkmcnt(10)
  v_mfma_f32_16x16x32_bf16 v[48:51], v[160:163], a[24:27], v[48:51]
  ds_read_b64_tr_b16 v[188:189], v29 offset:16384
  buffer_load_dwordx4 a[172:175], v30, s[20:23], s90 offen offset:256 sc1
  v_mfma_f32_16x16x32_bf16 v[52:55], v[160:163], a[28:31], v[52:55]
  ds_read_b64_tr_b16 v[190:191], v29 offset:17408
  v_mfma_f32_16x16x32_bf16 v[56:59], v[164:167], a[24:27], v[56:59]
  ds_read_b64_tr_b16 v[160:161], v20 offset:24576
  v_mfma_f32_16x16x32_bf16 v[60:63], v[164:167], a[28:31], v[60:63]
  ds_read_b64_tr_b16 v[162:163], v20 offset:25600
  s_waitcnt lgkmcnt(10)
  v_mfma_f32_16x16x32_bf16 v[64:67], v[168:171], a[24:27], v[64:67]
  ds_read_b64_tr_b16 v[164:165], v21 offset:24576
  v_add_u32 v20, 32768, v20
  v_mfma_f32_16x16x32_bf16 v[68:71], v[168:171], a[28:31], v[68:71]
  ds_read_b64_tr_b16 v[166:167], v21 offset:25600
  v_add_u32 v21, 32768, v21
  v_mfma_f32_16x16x32_bf16 v[72:75], v[172:175], a[24:27], v[72:75]
  ds_read_b64_tr_b16 v[168:169], v22 offset:24576
  buffer_load_dwordx4 a[176:179], v30, s[20:23], s90 offen offset:2048 sc1
  v_mfma_f32_16x16x32_bf16 v[76:79], v[172:175], a[28:31], v[76:79]
  ds_read_b64_tr_b16 v[170:171], v22 offset:25600
  s_waitcnt lgkmcnt(10)
  v_mfma_f32_16x16x32_bf16 v[80:83], v[176:179], a[24:27], v[80:83]
  ds_read_b64_tr_b16 v[172:173], v23 offset:24576
  v_add_u32 v22, 32768, v22
  v_mfma_f32_16x16x32_bf16 v[84:87], v[176:179], a[28:31], v[84:87]
  ds_read_b64_tr_b16 v[174:175], v23 offset:25600
  v_add_u32 v23, 32768, v23
  v_mfma_f32_16x16x32_bf16 v[88:91], v[180:183], a[24:27], v[88:91]
  ds_read_b64_tr_b16 v[176:177], v26 offset:24576
  buffer_load_dwordx4 a[180:183], v30, s[20:23], s90 offen offset:2304 sc1
  v_mfma_f32_16x16x32_bf16 v[92:95], v[180:183], a[28:31], v[92:95]
  ds_read_b64_tr_b16 v[178:179], v26 offset:25600
  s_waitcnt lgkmcnt(10)
  v_mfma_f32_16x16x32_bf16 v[96:99], v[184:187], a[24:27], v[96:99]
  ds_read_b64_tr_b16 v[180:181], v27 offset:24576
  s_add_u32 s90, s90, 4096
  v_add_u32 v26, 32768, v26
  v_mfma_f32_16x16x32_bf16 v[100:103], v[184:187], a[28:31], v[100:103]
  ds_read_b64_tr_b16 v[182:183], v27 offset:25600
  v_add_u32 v27, 32768, v27
  v_mfma_f32_16x16x32_bf16 v[104:107], v[188:191], a[24:27], v[104:107]
  ds_read_b64_tr_b16 v[184:185], v28 offset:24576
  s_waitcnt vmcnt(62)
  buffer_load_dwordx4 a[184:187], v30, s[20:23], s90 offen offset:0 sc1
  v_mfma_f32_16x16x32_bf16 v[108:111], v[188:191], a[28:31], v[108:111]
  ds_read_b64_tr_b16 v[186:187], v28 offset:25600
  s_waitcnt lgkmcnt(10)
  v_mfma_f32_16x16x32_bf16 v[48:51], v[160:163], a[32:35], v[48:51]
  ds_read_b64_tr_b16 v[188:189], v29 offset:24576
  v_add_u32 v28, 32768, v28
  v_mfma_f32_16x16x32_bf16 v[52:55], v[160:163], a[36:39], v[52:55]
  ds_read_b64_tr_b16 v[190:191], v29 offset:25600
  v_add_u32 v29, 32768, v29
  v_mfma_f32_16x16x32_bf16 v[56:59], v[164:167], a[32:35], v[56:59]
  s_waitcnt vmcnt(62)
  buffer_load_dwordx4 a[188:191], v30, s[20:23], s90 offen offset:256 sc1
  v_mfma_f32_16x16x32_bf16 v[60:63], v[164:167], a[36:39], v[60:63]
  s_waitcnt lgkmcnt(8)
  v_mfma_f32_16x16x32_bf16 v[64:67], v[168:171], a[32:35], v[64:67]
  s_waitcnt vmcnt(62)
  buffer_load_dwordx4 a[192:195], v30, s[20:23], s90 offen offset:2048 sc1
  v_mfma_f32_16x16x32_bf16 v[68:71], v[168:171], a[36:39], v[68:71]
  s_waitcnt vmcnt(52) lgkmcnt(0)
  s_barrier
  v_mfma_f32_16x16x32_bf16 v[72:75], v[172:175], a[32:35], v[72:75]
  ds_read_b64_tr_b16 v[160:161], v20 offset:0
  ds_read_b64_tr_b16 v[162:163], v20 offset:1024
  v_mfma_f32_16x16x32_bf16 v[76:79], v[172:175], a[36:39], v[76:79]
L_touch10:
  s_cbranch_execz L_tback
  ds_read_b64_tr_b16 v[164:165], v21 offset:0
  ds_read_b64_tr_b16 v[166:167], v21 offset:1024
  v_mfma_f32_16x16x32_bf16 v[80:83], v[176:179], a[32:35], v[80:83]
  ds_read_b64_tr_b16 v[168:169], v22 offset:0
  ds_read_b64_tr_b16 v[170:171], v22 offset:1024
  s_add_u32 m0, s89, 32768
  v_mfma_f32_16x16x32_bf16 v[84:87], v[176:179], a[36:39], v[84:87]
  ds_read_b64_tr_b16 v[172:173], v23 offset:0
  ds_read_b64_tr_b16 v[174:175], v23 offset:1024
  v_mfma_f32_16x16x32_bf16 v[88:91], v[180:183], a[32:35], v[88:91]
  ds_read_b64_tr_b16 v[176:177], v26 offset:0
  buffer_load_dwordx4 v8, s[24:27], s87 offen offset:0 lds
  v_mfma_f32_16x16x32_bf16 v[92:95], v[180:183], a[36:39], v[92:95]
  ds_read_b64_tr_b16 v[178:179], v26 offset:1024
  v_mfma_f32_16x16x32_bf16 v[96:99], v[184:187], a[32:35], v[96:99]
  ds_read_b64_tr_b16 v[180:181], v27 offset:0
  v_mfma_f32_16x16x32_bf16 v[100:103], v[184:187], a[36:39], v[100:103]
  ds_read_b64_tr_b16 v[182:183], v27 offset:1024
  v_mfma_f32_16x16x32_bf16 v[104:107], v[188:191], a[32:35], v[104:107]
  ds_read_b64_tr_b16 v[184:185], v28 offset:0
  buffer_load_dwordx4 v9, s[24:27], s87 offen offset:1024 lds
  v_mfma_f32_16x16x32_bf16 v[108:111], v[188:191], a[36:39], v[108:111]
  ds_read_b64_tr_b16 v[186:187], v28 offset:1024
  s_waitcnt lgkmcnt(10)
  v_mfma_f32_16x16x32_bf16 v[48:51], v[160:163], a[40:43], v[48:51]
  ds_read_b64_tr_b16 v[188:189], v29 offset:0
  v_mfma_f32_16x16x32_bf16 v[52:55], v[160:163], a[44:47], v[52:55]
  ds_read_b64_tr_b16 v[190:191], v29 offset:1024
  v_mfma_f32_16x16x32_bf16 v[56:59], v[164:167], a[40:43], v[56:59]
  ds_read_b64_tr_b16 v[160:161], v20 offset:8192
  buffer_load_dwordx4 v10, s[24:27], s87 offen offset:2048 lds
  v_mfma_f32_16x16x32_bf16 v[60:63], v[164:167], a[44:47], v[60:63]
  ds_read_b64_tr_b16 v[162:163], v20 offset:9216
  s_waitcnt lgkmcnt(10)
  v_mfma_f32_16x16x32_bf16 v[64:67], v[168:171], a[40:43], v[64:67]
  ds_read_b64_tr_b16 v[164:165], v21 offset:8192
  v_mfma_f32_16x16x32_bf16 v[68:71], v[168:171], a[44:47], v[68:71]
  ds_read_b64_tr_b16 v[166:167], v21 offset:9216
  v_mfma_f32_16x16x32_bf16 v[72:75], v[172:175], a[40:43], v[72:75]
  ds_read_b64_tr_b16 v[168:169], v22 offset:8192
  buffer_load_dwordx4 v11, s[24:27], s87 offen offset:3072 lds
  v_mfma_f32_16x16x32_bf16 v[76:79], v[172:175], a[44:47], v[76:79]
  ds_read_b64_tr_b16 v[170:171], v22 offset:9216
  s_waitcnt lgkmcnt(10)
  v_mfma_f32_16x16x32_bf16 v[80:83], v[176:179], a[40:43], v[80:83]
  ds_read_b64_tr_b16 v[172:173], v23 offset:8192
  s_add_u32 m0, s89, 36864
  v_mfma_f32_16x16x32_bf16 v[84:87], v[176:179], a[44:47], v[84:87]
  ds_read_b64_tr_b16 v[174:175], v23 offset:9216
  v_mfma_f32_16x16x32_bf16 v[88:91], v[180:183], a[40:43], v[88:91]
  ds_read_b64_tr_b16 v[176:177], v26 offset:8192
  buffer_load_dwordx4 v8, s[24:27], s88 offen offset:0 lds
  v_mfma_f32_16x16x32_bf16 v[92:95], v[180:183], a[44:47], v[92:95]
  ds_read_b64_tr_b16 v[178:179], v26 offset:9216
  s_waitcnt lgkmcnt(10)
  v_mfma_f32_16x16x32_bf16 v[96:99], v[184:187], a[40:43], v[96:99]
  ds_read_b64_tr_b16 v[180:181], v27 offset:8192
  v_mfma_f32_16x16x32_bf16 v[100:103], v[184:187], a[44:47], v[100:103]
  ds_read_b64_tr_b16 v[182:183], v27 offset:9216
  v_mfma_f32_16x16x32_bf16 v[104:107], v[188:191], a[40:43], v[104:107]
  ds_read_b64_tr_b16 v[184:185], v28 offset:8192
  buffer_load_dwordx4 v9, s[24:27], s88 offen offset:1024 lds
  v_mfma_f32_16x16x32_bf16 v[108:111], v[188:191], a[44:47], v[108:111]
  ds_read_b64_tr_b16 v[186:187], v28 offset:9216
  s_waitcnt lgkmcnt(10)
  v_mfma_f32_16x16x32_bf16 v[48:51], v[160:163], a[48:51], v[48:51]
  ds_read_b64_tr_b16 v[188:189], v29 offset:8192
  v_mfma_f32_16x16x32_bf16 v[52:55], v[160:163], a[52:55], v[52:55]
  ds_read_b64_tr_b16 v[190:191], v29 offset:9216
  v_mfma_f32_16x16x32_bf16 v[56:59], v[164:167], a[48:51], v[56:59]
  ds_read_b64_tr_b16 v[160:161], v20 offset:16384
  buffer_load_dwordx4 v10, s[24:27], s88 offen offset:2048 lds
  v_mfma_f32_16x16x32_bf16 v[60:63], v[164:167], a[52:55], v[60:63]
  ds_read_b64_tr_b16 v[162:163], v20 offset:17408
  s_waitcnt lgkmcnt(10)
  v_mfma_f32_16x16x32_bf16 v[64:67], v[168:171], a[48:51], v[64:67]
  ds_read_b64_tr_b16 v[164:165], v21 offset:16384
  v_mfma_f32_16x16x32_bf16 v[68:71], v[168:171], a[52:55], v[68:71]
  ds_read_b64_tr_b16 v[166:167], v21 offset:17408
  v_mfma_f32_16x16x32_bf16 v[72:75], v[172:175], a[48:51], v[72:75]
  ds_read_b64_tr_b16 v[168:169], v22 offset:16384
  v_mfma_f32_16x16x32_bf16 v[76:79], v[172:175], a[52:55], v[76:79]
  ds_read_b64_tr_b16 v[170:171], v22 offset:17408
  s_waitcnt lgkmcnt(10)
  v_mfma_f32_16x16x32_bf16 v[80:83], v[176:179], a[48:51], v[80:83]
  ds_read_b64_tr_b16 v[172:173], v23 offset:16384
  buffer_load_dwordx4 v11, s[24:27], s88 offen offset:3072 lds
  v_mfma_f32_16x16x32_bf16 v[84:87], v[176:179], a[52:55], v[84:87]
  ds_read_b64_tr_b16 v[174:175], v23 offset:17408
  s_add_u32 s87, s87, 262144
  v_mfma_f32_16x16x32_bf16 v[88:91], v[180:183], a[48:51], v[88:91]
  ds_read_b64_tr_b16 v[176:177], v26 offset:16384
  s_add_u32 s88, s88, 262144
  v_mfma_f32_16x16x32_bf16 v[92:95], v[180:183], a[52:55], v[92:95]
  ds_read_b64_tr_b16 v[178:179], v26 offset:17408
  s_waitcnt lgkmcnt(10)
  v_mfma_f32_16x16x32_bf16 v[96:99], v[184:187], a[48:51], v[96:99]
  ds_read_b64_tr_b16 v[180:181], v27 offset:16384
  buffer_load_dwordx4 a[196:199], v30, s[20:23], s90 offen offset:2304 sc1
  v_mfma_f32_16x16x32_bf16 v[100:103], v[184:187], a[52:55], v[100:103]
  ds_read_b64_tr_b16 v[182:183], v27 offset:17408
  s_add_u32 s90, s90, 4096
  v_mfma_f32_16x16x32_bf16 v[104:107], v[188:191], a[48:51], v[104:107]
  ds_read_b64_tr_b16 v[184:185], v28 offset:16384
  v_mfma_f32_16x16x32_bf16 v[108:111], v[188:191], a[52:55], v[108:111]
  ds_read_b64_tr_b16 v[186:187], v28 offset:17408
  s_waitcnt lgkmcnt(10)
  v_mfma_f32_16x16x32_bf16 v[48:51], v[160:163], a[56:59], v[48:51]
  ds_read_b64_tr_b16 v[188:189], v29 offset:16384
  buffer_load_dwordx4 a[200:203], v30, s[20:23], s90 offen offset:0 sc1
  v_mfma_f32_16x16x32_bf16 v[52:55], v[160:163], a[60:63], v[52:55]
  ds_read_b64_tr_b16 v[190:191], v29 offset:17408
  v_mfma_f32_16x16x32_bf16 v[56:59], v[164:167], a[56:59], v[56:59]
  ds_read_b64_tr_b16 v[160:161], v20 offset:24576
  v_mfma_f32_16x16x32_bf16 v[60:63], v[164:167], a[60:63], v[60:63]
  ds_read_b64_tr_b16 v[162:163], v20 offset:25600
  s_waitcnt lgkmcnt(10)
  v_mfma_f32_16x16x32_bf16 v[64:67], v[168:171], a[56:59], v[64:67]
  ds_read_b64_tr_b16 v[164:165], v21 offset:24576
  v_add_u32 v20, 32768, v20
  v_mfma_f32_16x16x32_bf16 v[68:71], v[168:171], a[60:63], v[68:71]
  ds_read_b64_tr_b16 v[166:167], v21 offset:25600
  v_add_u32 v21, 32768, v21
  v_mfma_f32_16x16x32_bf16 v[72:75], v[172:175], a[56:59], v[72:75]
  ds_read_b64_tr_b16 v[168:169], v22 offset:24576
  buffer_load_dwordx4 a[204:207], v30, s[20:23], s90 offen offset:256 sc1
  v_mfma_f32_16x16x32_bf16 v[76:79], v[172:175], a[60:63], v[76:79]
  ds_read_b64_tr_b16 v[170:171], v22 offset:25600
  s_waitcnt lgkmcnt(10)
  v_mfma_f32_16x16x32_bf16 v[80:83], v[176:179], a[56:59], v[80:83]
  ds_read_b64_tr_b16 v[172:173], v23 offset:24576
  v_add_u32 v22, 32768, v22
  v_mfma_f32_16x16x32_bf16 v[84:87], v[176:179], a[60:63], v[84:87]
  ds_read_b64_tr_b16 v[174:175], v23 offset:25600
  v_add_u32 v23, 32768, v23
  v_mfma_f32_16x16x32_bf16 v[88:91], v[180:183], a[56:59], v[88:91]
  ds_read_b64_tr_b16 v[176:177], v26 offset:24576
  s_waitcnt vmcnt(62)
  buffer_load_dwordx4 a[208:211], v30, s[20:23], s90 offen offset:2048 sc1
  v_mfma_f32_16x16x32_bf16 v[92:95], v[180:183], a[60:63], v[92:95]
  ds_read_b64_tr_b16 v[178:179], v26 offset:25600
  s_waitcnt lgkmcnt(10)
  v_mfma_f32_16x16x32_bf16 v[96:99], v[184:187], a[56:59], v[96:99]
  ds_read_b64_tr_b16 v[180:181], v27 offset:24576
  v_add_u32 v26, 32768, v26
  v_mfma_f32_16x16x32_bf16 v[100:103], v[184:187], a[60:63], v[100:103]
  ds_read_b64_tr_b16 v[182:183], v27 offset:25600
  v_add_u32 v27, 32768, v27
  v_mfma_f32_16x16x32_bf16 v[104:107], v[188:191], a[56:59], v[104:107]
  ds_read_b64_tr_b16 v[184:185], v28 offset:24576
  s_waitcnt vmcnt(62)
  buffer_load_dwordx4 a[212:215], v30, s[20:23], s90 offen offset:2304 sc1
  v_mfma_f32_16x16x32_bf16 v[108:111], v[188:191], a[60:63], v[108:111]
  ds_read_b64_tr_b16 v[186:187], v28 offset:25600
  s_waitcnt lgkmcnt(10)
  v_mfma_f32_16x16x32_bf16 v[48:51], v[160:163], a[64:67], v[48:51]
  ds_read_b64_tr_b16 v[188:189], v29 offset:24576
  s_add_u32 s90, s90, 4096
  v_mfma_f32_16x16x32_bf16 v[52:55], v[160:163], a[68:71], v[52:55]
  ds_read_b64_tr_b16 v[190:191], v29 offset:25600
  v_add_u32 v28, 32768, v28
  v_mfma_f32_16x16x32_bf16 v[56:59], v[164:167], a[64:67], v[56:59]
  v_add_u32 v29, 32768, v29
  v_mfma_f32_16x16x32_bf16 v[60:63], v[164:167], a[68:71], v[60:63]
  s_waitcnt lgkmcnt(8)
  s_waitcnt vmcnt(62)
  buffer_load_dwordx4 a[216:219], v30, s[20:23], s90 offen offset:0 sc1
  v_mfma_f32_16x16x32_bf16 v[64:67], v[168:171], a[64:67], v[64:67]
  v_mfma_f32_16x16x32_bf16 v[68:71], v[168:171], a[68:71], v[68:71]
  s_waitcnt vmcnt(51) lgkmcnt(0)
  s_barrier
  v_mfma_f32_16x16x32_bf16 v[72:75], v[172:175], a[64:67], v[72:75]
  ds_read_b64_tr_b16 v[160:161], v20 offset:0
  ds_read_b64_tr_b16 v[162:163], v20 offset:1024
  buffer_load_dwordx4 a[220:223], v30, s[20:23], s90 offen offset:256 sc1
  v_mfma_f32_16x16x32_bf16 v[76:79], v[172:175], a[68:71], v[76:79]
  ds_read_b64_tr_b16 v[164:165], v21 offset:0
  ds_read_b64_tr_b16 v[166:167], v21 offset:1024
  v_mfma_f32_16x16x32_bf16 v[80:83], v[176:179], a[64:67], v[80:83]
  ds_read_b64_tr_b16 v[168:169], v22 offset:0
  ds_read_b64_tr_b16 v[170:171], v22 offset:1024
  s_add_u32 m0, s89, 65536
  v_mfma_f32_16x16x32_bf16 v[84:87], v[176:179], a[68:71], v[84:87]
  ds_read_b64_tr_b16 v[172:173], v23 offset:0
  ds_read_b64_tr_b16 v[174:175], v23 offset:1024
  buffer_load_dword v25, v24, s[20:23], s94 offen sc1
  v_mfma_f32_16x16x32_bf16 v[88:91], v[180:183], a[64:67], v[88:91]
  ds_read_b64_tr_b16 v[176:177], v26 offset:0
  buffer_load_dwordx4 v8, s[24:27], s87 offen offset:0 lds
  v_mfma_f32_16x16x32_bf16 v[92:95], v[180:183], a[68:71], v[92:95]
  ds_read_b64_tr_b16 v[178:179], v26 offset:1024
  v_mfma_f32_16x16x32_bf16 v[96:99], v[184:187], a[64:67], v[96:99]
  ds_read_b64_tr_b16 v[180:181], v27 offset:0
  v_mfma_f32_16x16x32_bf16 v[100:103], v[184:187], a[68:71], v[100:103]
  ds_read_b64_tr_b16 v[182:183], v27 offset:1024
  v_mfma_f32_16x16x32_bf16 v[104:107], v[188:191], a[64:67], v[104:107]
  ds_read_b64_tr_b16 v[184:185], v28 offset:0
  buffer_load_dwordx4 v9, s[24:27], s87 offen offset:1024 lds
  v_mfma_f32_16x16x32_bf16 v[108:111], v[188:191], a[68:71], v[108:111]
  ds_read_b64_tr_b16 v[186:187], v28 offset:1024
  s_waitcnt lgkmcnt(10)
  v_mfma_f32_16x16x32_bf16 v[48:51], v[160:163], a[72:75], v[48:51]
  ds_read_b64_tr_b16 v[188:189], v29 offset:0
  v_mfma_f32_16x16x32_bf16 v[52:55], v[160:163], a[76:79], v[52:55]
  ds_read_b64_tr_b16 v[190:191], v29 offset:1024
  v_mfma_f32_16x16x32_bf16 v[56:59], v[164:167], a[72:75], v[56:59]
  ds_read_b64_tr_b16 v[160:161], v20 offset:8192
  buffer_load_dwordx4 v10, s[24:27], s87 offen offset:2048 lds
  v_mfma_f32_16x16x32_bf16 v[60:63], v[164:167], a[76:79], v[60:63]
  ds_read_b64_tr_b16 v[162:163], v20 offset:9216
  s_waitcnt lgkmcnt(10)
  v_mfma_f32_16x16x32_bf16 v[64:67], v[168:171], a[72:75], v[64:67]
  ds_read_b64_tr_b16 v[164:165], v21 offset:8192
  v_mfma_f32_16x16x32_bf16 v[68:71], v[168:171], a[76:79], v[68:71]
  ds_read_b64_tr_b16 v[166:167], v21 offset:9216
  v_mfma_f32_16x16x32_bf16 v[72:75], v[172:175], a[72:75], v[72:75]
  ds_read_b64_tr_b16 v[168:169], v22 offset:8192
  buffer_load_dwordx4 v11, s[24:27], s87 offen offset:3072 lds
  v_mfma_f32_16x16x32_bf16 v[76:79], v[172:175], a[76:79], v[76:79]
  ds_read_b64_tr_b16 v[170:171], v22 offset:9216
  s_waitcnt lgkmcnt(10)
  v_mfma_f32_16x16x32_bf16 v[80:83], v[176:179], a[72:75], v[80:83]
  ds_read_b64_tr_b16 v[172:173], v23 offset:8192
  s_add_u32 m0, s89, 69632
  v_mfma_f32_16x16x32_bf16 v[84:87], v[176:179], a[76:79], v[84:87]
  ds_read_b64_tr_b16 v[174:175], v23 offset:9216
  v_mfma_f32_16x16x32_bf16 v[88:91], v[180:183], a[72:75], v[88:91]
  ds_read_b64_tr_b16 v[176:177], v26 offset:8192
  buffer_load_dwordx4 v8, s[24:27], s88 offen offset:0 lds
  v_mfma_f32_16x16x32_bf16 v[92:95], v[180:183], a[76:79], v[92:95]
  ds_read_b64_tr_b16 v[178:179], v26 offset:9216
  s_waitcnt lgkmcnt(10)
  v_mfma_f32_16x16x32_bf16 v[96:99], v[184:187], a[72:75], v[96:99]
  ds_read_b64_tr_b16 v[180:181], v27 offset:8192
  v_mfma_f32_16x16x32_bf16 v[100:103], v[184:187], a[76:79], v[100:103]
  ds_read_b64_tr_b16 v[182:183], v27 offset:9216
  v_mfma_f32_16x16x32_bf16 v[104:107], v[188:191], a[72:75], v[104:107]
  ds_read_b64_tr_b16 v[184:185], v28 offset:8192
  v_mfma_f32_16x16x32_bf16 v[108:111], v[188:191], a[76:79], v[108:111]
  ds_read_b64_tr_b16 v[186:187], v28 offset:9216
  s_waitcnt lgkmcnt(10)
  v_mfma_f32_16x16x32_bf16 v[48:51], v[160:163], a[80:83], v[48:51]
  ds_read_b64_tr_b16 v[188:189], v29 offset:8192
  buffer_load_dwordx4 v9, s[24:27], s88 offen offset:1024 lds
  v_mfma_f32_16x16x32_bf16 v[52:55], v[160:163], a[84:87], v[52:55]
  ds_read_b64_tr_b16 v[190:191], v29 offset:9216
  v_mfma_f32_16x16x32_bf16 v[56:59], v[164:167], a[80:83], v[56:59]
  ds_read_b64_tr_b16 v[160:161], v20 offset:16384
  v_mfma_f32_16x16x32_bf16 v[60:63], v[164:167], a[84:87], v[60:63]
  ds_read_b64_tr_b16 v[162:163], v20 offset:17408
  s_waitcnt lgkmcnt(10)
  v_mfma_f32_16x16x32_bf16 v[64:67], v[168:171], a[80:83], v[64:67]
  ds_read_b64_tr_b16 v[164:165], v21 offset:16384
  buffer_load_dwordx4 v10, s[24:27], s88 offen offset:2048 lds
  v_mfma_f32_16x16x32_bf16 v[68:71], v[168:171], a[84:87], v[68:71]
  ds_read_b64_tr_b16 v[166:167], v21 offset:17408
  v_mfma_f32_16x16x32_bf16 v[72:75], v[172:175], a[80:83], v[72:75]
  ds_read_b64_tr_b16 v[168:169], v22 offset:16384
  v_mfma_f32_16x16x32_bf16 v[76:79], v[172:175], a[84:87], v[76:79]
  ds_read_b64_tr_b16 v[170:171], v22 offset:17408
  s_waitcnt lgkmcnt(10)
  v_mfma_f32_16x16x32_bf16 v[80:83], v[176:179], a[80:83], v[80:83]
  ds_read_b64_tr_b16 v[172:173], v23 offset:16384
  buffer_load_dwordx4 v11, s[24:27], s88 offen offset:3072 lds
  v_mfma_f32_16x16x32_bf16 v[84:87], v[176:179], a[84:87], v[84:87]
  ds_read_b64_tr_b16 v[174:175], v23 offset:17408
  s_add_u32 s87, s87, 262144
  v_mfma_f32_16x16x32_bf16 v[88:91], v[180:183], a[80:83], v[88:91]
  ds_read_b64_tr_b16 v[176:177], v26 offset:16384
  s_add_u32 s88, s88, 262144
  v_mfma_f32_16x16x32_bf16 v[92:95], v[180:183], a[84:87], v[92:95]
  ds_read_b64_tr_b16 v[178:179], v26 offset:17408
  s_waitcnt lgkmcnt(10)
  v_mfma_f32_16x16x32_bf16 v[96:99], v[184:187], a[80:83], v[96:99]
  ds_read_b64_tr_b16 v[180:181], v27 offset:16384
  buffer_load_dwordx4 v[200:203], v30, s[20:23], s90 offen offset:2048 sc1
  v_mfma_f32_16x16x32_bf16 v[100:103], v[184:187], a[84:87], v[100:103]
  ds_read_b64_tr_b16 v[182:183], v27 offset:17408
  v_mfma_f32_16x16x32_bf16 v[104:107], v[188:191], a[80:83], v[104:107]
  ds_read_b64_tr_b16 v[184:185], v28 offset:16384
  v_mfma_f32_16x16x32_bf16 v[108:111], v[188:191], a[84:87], v[108:111]
  ds_read_b64_tr_b16 v[186:187], v28 offset:17408
  s_waitcnt lgkmcnt(10)
  v_mfma_f32_16x16x32_bf16 v[48:51], v[160:163], a[88:91], v[48:51]
  ds_read_b64_tr_b16 v[188:189], v29 offset:16384
  buffer_load_dwordx4 v[204:207], v30, s[20:23], s90 offen offset:2304 sc1
  v_mfma_f32_16x16x32_bf16 v[52:55], v[160:163], a[92:95], v[52:55]
  ds_read_b64_tr_b16 v[190:191], v29 offset:17408
  s_add_u32 s90, s90, 4096
  v_mfma_f32_16x16x32_bf16 v[56:59], v[164:167], a[88:91], v[56:59]
  ds_read_b64_tr_b16 v[160:161], v20 offset:24576
  v_mfma_f32_16x16x32_bf16 v[60:63], v[164:167], a[92:95], v[60:63]
  ds_read_b64_tr_b16 v[162:163], v20 offset:25600
  s_waitcnt lgkmcnt(10)
  v_mfma_f32_16x16x32_bf16 v[64:67], v[168:171], a[88:91], v[64:67]
  ds_read_b64_tr_b16 v[164:165], v21 offset:24576
  v_add_u32 v20, 32768, v20
  v_mfma_f32_16x16x32_bf16 v[68:71], v[168:171], a[92:95], v[68:71]
  ds_read_b64_tr_b16 v[166:167], v21 offset:25600
  v_add_u32 v21, 32768, v21
  v_mfma_f32_16x16x32_bf16 v[72:75], v[172:175], a[88:91], v[72:75]
  ds_read_b64_tr_b16 v[168:169], v22 offset:24576
  v_mfma_f32_16x16x32_bf16 v[76:79], v[172:175], a[92:95], v[76:79]
  ds_read_b64_tr_b16 v[170:171], v22 offset:25600
  s_waitcnt lgkmcnt(10)
  v_mfma_f32_16x16x32_bf16 v[80:83], v[176:179], a[88:91], v[80:83]
  ds_read_b64_tr_b16 v[172:173], v23 offset:24576
  v_add_u32 v22, 32768, v22
  v_mfma_f32_16x16x32_bf16 v[84:87], v[176:179], a[92:95], v[84:87]
  ds_read_b64_tr_b16 v[174:175], v23 offset:25600
  v_add_u32 v23, 32768, v23
  v_mfma_f32_16x16x32_bf16 v[88:91], v[180:183], a[88:91], v[88:91]
  ds_read_b64_tr_b16 v[176:177], v26 offset:24576
  v_mfma_f32_16x16x32_bf16 v[92:95], v[180:183], a[92:95], v[92:95]
  ds_read_b64_tr_b16 v[178:179], v26 offset:25600
  s_waitcnt lgkmcnt(10)
  v_mfma_f32_16x16x32_bf16 v[96:99], v[184:187], a[88:91], v[96:99]
  ds_read_b64_tr_b16 v[180:181], v27 offset:24576
  v_add_u32 v26, 32768, v26
  v_mfma_f32_16x16x32_bf16 v[100:103], v[184:187], a[92:95], v[100:103]
  ds_read_b64_tr_b16 v[182:183], v27 offset:25600
  v_add_u32 v27, 32768, v27
  v_mfma_f32_16x16x32_bf16 v[104:107], v[188:191], a[88:91], v[104:107]
  ds_read_b64_tr_b16 v[184:185], v28 offset:24576
  v_mfma_f32_16x16x32_bf16 v[108:111], v[188:191], a[92:95], v[108:111]
  ds_read_b64_tr_b16 v[186:187], v28 offset:25600
  s_waitcnt lgkmcnt(10)
  v_mfma_f32_16x16x32_bf16 v[48:51], v[160:163], a[96:99], v[48:51]
  ds_read_b64_tr_b16 v[188:189], v29 offset:24576
  v_add_u32 v28, 32768, v28
  v_mfma_f32_16x16x32_bf16 v[52:55], v[160:163], a[100:103], v[52:55]
  ds_read_b64_tr_b16 v[190:191], v29 offset:25600
  v_add_u32 v29, 32768, v29
  v_mfma_f32_16x16x32_bf16 v[56:59], v[164:167], a[96:99], v[56:59]
  v_mfma_f32_16x16x32_bf16 v[60:63], v[164:167], a[100:103], v[60:63]
  s_waitcnt lgkmcnt(8)
  v_mfma_f32_16x16x32_bf16 v[64:67], v[168:171], a[96:99], v[64:67]
  v_mfma_f32_16x16x32_bf16 v[68:71], v[168:171], a[100:103], v[68:71]
  s_waitcnt vmcnt(48) lgkmcnt(0)
  s_barrier
  v_mfma_f32_16x16x32_bf16 v[72:75], v[172:175], a[96:99], v[72:75]
  ds_read_b64_tr_b16 v[160:161], v20 offset:0
  ds_read_b64_tr_b16 v[162:163], v20 offset:1024
  s_mov_b32 s87, s100
  v_mfma_f32_16x16x32_bf16 v[76:79], v[172:175], a[100:103], v[76:79]
  ds_read_b64_tr_b16 v[164:165], v21 offset:0
  ds_read_b64_tr_b16 v[166:167], v21 offset:1024
  v_mfma_f32_16x16x32_bf16 v[80:83], v[176:179], a[96:99], v[80:83]
  ds_read_b64_tr_b16 v[168:169], v22 offset:0
  ds_read_b64_tr_b16 v[170:171], v22 offset:1024
  s_add_u32 s88, s87, 65536
  v_mfma_f32_16x16x32_bf16 v[84:87], v[176:179], a[100:103], v[84:87]
  ds_read_b64_tr_b16 v[172:173], v23 offset:0
  ds_read_b64_tr_b16 v[174:175], v23 offset:1024
  s_add_u32 m0, s89, 98304
  v_mfma_f32_16x16x32_bf16 v[88:91], v[180:183], a[96:99], v[88:91]
  ds_read_b64_tr_b16 v[176:177], v26 offset:0
  buffer_load_dwordx4 v32, s[28:31], s87 offen offset:0 lds
  v_mfma_f32_16x16x32_bf16 v[92:95], v[180:183], a[100:103], v[92:95]
  ds_read_b64_tr_b16 v[178:179], v26 offset:1024
  v_mfma_f32_16x16x32_bf16 v[96:99], v[184:187], a[96:99], v[96:99]
  ds_read_b64_tr_b16 v[180:181], v27 offset:0
  buffer_load_dwordx4 v33, s[28:31], s87 offen offset:1024 lds
  v_mfma_f32_16x16x32_bf16 v[100:103], v[184:187], a[100:103], v[100:103]
  ds_read_b64_tr_b16 v[182:183], v27 offset:1024
  v_mfma_f32_16x16x32_bf16 v[104:107], v[188:191], a[96:99], v[104:107]
  ds_read_b64_tr_b16 v[184:185], v28 offset:0
  buffer_load_dwordx4 v34, s[28:31], s87 offen offset:2048 lds
  v_mfma_f32_16x16x32_bf16 v[108:111], v[188:191], a[100:103], v[108:111]
  ds_read_b64_tr_b16 v[186:187], v28 offset:1024
  s_waitcnt lgkmcnt(10)
  v_mfma_f32_16x16x32_bf16 v[48:51], v[160:163], a[104:107], v[48:51]
  ds_read_b64_tr_b16 v[188:189], v29 offset:0
  v_mfma_f32_16x16x32_bf16 v[52:55], v[160:163], a[108:111], v[52:55]
  ds_read_b64_tr_b16 v[190:191], v29 offset:1024
  v_mfma_f32_16x16x32_bf16 v[56:59], v[164:167], a[104:107], v[56:59]
  ds_read_b64_tr_b16 v[160:161], v20 offset:8192
  buffer_load_dwordx4 v35, s[28:31], s87 offen offset:3072 lds
  v_mfma_f32_16x16x32_bf16 v[60:63], v[164:167], a[108:111], v[60:63]
  ds_read_b64_tr_b16 v[162:163], v20 offset:9216
  s_waitcnt lgkmcnt(10)
  v_mfma_f32_16x16x32_bf16 v[64:67], v[168:171], a[104:107], v[64:67]
  ds_read_b64_tr_b16 v[164:165], v21 offset:8192
  s_add_u32 m0, s89, 102400
  v_mfma_f32_16x16x32_bf16 v[68:71], v[168:171], a[108:111], v[68:71]
  ds_read_b64_tr_b16 v[166:167], v21 offset:9216
  v_mfma_f32_16x16x32_bf16 v[72:75], v[172:175], a[104:107], v[72:75]
  ds_read_b64_tr_b16 v[168:169], v22 offset:8192
  buffer_load_dwordx4 v32, s[28:31], s88 offen offset:0 lds
  v_mfma_f32_16x16x32_bf16 v[76:79], v[172:175], a[108:111], v[76:79]
  ds_read_b64_tr_b16 v[170:171], v22 offset:9216
  s_waitcnt lgkmcnt(10)
  v_mfma_f32_16x16x32_bf16 v[80:83], v[176:179], a[104:107], v[80:83]
  ds_read_b64_tr_b16 v[172:173], v23 offset:8192
  v_mfma_f32_16x16x32_bf16 v[84:87], v[176:179], a[108:111], v[84:87]
  ds_read_b64_tr_b16 v[174:175], v23 offset:9216
  v_mfma_f32_16x16x32_bf16 v[88:91], v[180:183], a[104:107], v[88:91]
  ds_read_b64_tr_b16 v[176:177], v26 offset:8192
  buffer_load_dwordx4 v33, s[28:31], s88 offen offset:1024 lds
  v_mfma_f32_16x16x32_bf16 v[92:95], v[180:183], a[108:111], v[92:95]
  ds_read_b64_tr_b16 v[178:179], v26 offset:9216
  s_waitcnt lgkmcnt(10)
  v_mfma_f32_16x16x32_bf16 v[96:99], v[184:187], a[104:107], v[96:99]
  ds_read_b64_tr_b16 v[180:181], v27 offset:8192
  v_mfma_f32_16x16x32_bf16 v[100:103], v[184:187], a[108:111], v[100:103]
  ds_read_b64_tr_b16 v[182:183], v27 offset:9216
  v_mfma_f32_16x16x32_bf16 v[104:107], v[188:191], a[104:107], v[104:107]
  ds_read_b64_tr_b16 v[184:185], v28 offset:8192
  buffer_load_dwordx4 v34, s[28:31], s88 offen offset:2048 lds
  v_mfma_f32_16x16x32_bf16 v[108:111], v[188:191], a[108:111], v[108:111]
  ds_read_b64_tr_b16 v[186:187], v28 offset:9216
  s_waitcnt lgkmcnt(10)
  s_waitcnt vmcnt(17)
  v_cmp_gt_u32 vcc, 7, v25
  s_nop 0
  s_cbranch_vccnz L_retry3
L_cont3:
  v_mfma_f32_16x16x32_bf16 v[48:51], v[160:163], a[112:115], v[48:51]
  ds_read_b64_tr_b16 v[188:189], v29 offset:8192
  v_mfma_f32_16x16x32_bf16 v[52:55], v[160:163], a[116:119], v[52:55]
  ds_read_b64_tr_b16 v[190:191], v29 offset:9216
  v_mfma_f32_16x16x32_bf16 v[56:59], v[164:167], a[112:115], v[56:59]
  ds_read_b64_tr_b16 v[160:161], v20 offset:16384
  buffer_load_dwordx4 v35, s[28:31], s88 offen offset:3072 lds
  s_add_u32 s87, s87, 524288
  v_mfma_f32_16x16x32_bf16 v[60:63], v[164:167], a[116:119], v[60:63]
  ds_read_b64_tr_b16 v[162:163], v20 offset:17408
  s_waitcnt lgkmcnt(10)
  v_mfma_f32_16x16x32_bf16 v[64:67], v[168:171], a[112:115], v[64:67]
  ds_read_b64_tr_b16 v[164:165], v21 offset:16384
  s_and_b32 s87, s87, 0x1fffff
  v_mfma_f32_16x16x32_bf16 v[68:71], v[168:171], a[116:119], v[68:71]
  ds_read_b64_tr_b16 v[166:167], v21 offset:17408
  s_add_u32 s88, s87, 65536
  v_mfma_f32_16x16x32_bf16 v[72:75], v[172:175], a[112:115], v[72:75]
  ds_read_b64_tr_b16 v[168:169], v22 offset:16384
  s_lshl_b32 s63, s67, 13
  v_mfma_f32_16x16x32_bf16 v[76:79], v[172:175], a[116:119], v[76:79]
  ds_read_b64_tr_b16 v[170:171], v22 offset:17408
  s_waitcnt lgkmcnt(10)
  v_mfma_f32_16x16x32_bf16 v[80:83], v[176:179], a[112:115], v[80:83]
  ds_read_b64_tr_b16 v[172:173], v23 offset:16384
  s_and_b32 s63, s63, 0xffff
  v_mfma_f32_16x16x32_bf16 v[84:87], v[176:179], a[116:119], v[84:87]
  ds_read_b64_tr_b16 v[174:175], v23 offset:17408
  s_add_u32 s90, s96, s63
  v_mfma_f32_16x16x32_bf16 v[88:91], v[180:183], a[112:115], v[88:91]
  ds_read_b64_tr_b16 v[176:177], v26 offset:16384
  buffer_load_dwordx4 v[208:211], v30, s[20:23], s90 offen offset:0 sc1
  v_mfma_f32_16x16x32_bf16 v[92:95], v[180:183], a[116:119], v[92:95]
  ds_read_b64_tr_b16 v[178:179], v26 offset:17408
  s_waitcnt lgkmcnt(10)
  v_mfma_f32_16x16x32_bf16 v[96:99], v[184:187], a[112:115], v[96:99]
  ds_read_b64_tr_b16 v[180:181], v27 offset:16384
  buffer_load_dwordx4 v[212:215], v30, s[20:23], s90 offen offset:256 sc1
  v_mfma_f32_16x16x32_bf16 v[100:103], v[184:187], a[116:119], v[100:103]
  ds_read_b64_tr_b16 v[182:183], v27 offset:17408
  v_mfma_f32_16x16x32_bf16 v[104:107], v[188:191], a[112:115], v[104:107]
  ds_read_b64_tr_b16 v[184:185], v28 offset:16384
  v_mfma_f32_16x16x32_bf16 v[108:111], v[188:191], a[116:119], v[108:111]
  ds_read_b64_tr_b16 v[186:187], v28 offset:17408
  s_waitcnt lgkmcnt(10)
  v_mfma_f32_16x16x32_bf16 v[48:51], v[160:163], a[120:123], v[48:51]
  ds_read_b64_tr_b16 v[188:189], v29 offset:16384
  buffer_load_dwordx4 v[216:219], v30, s[20:23], s90 offen offset:2048 sc1
  v_mfma_f32_16x16x32_bf16 v[52:55], v[160:163], a[124:127], v[52:55]
  ds_read_b64_tr_b16 v[190:191], v29 offset:17408
  v_mfma_f32_16x16x32_bf16 v[56:59], v[164:167], a[120:123], v[56:59]
  ds_read_b64_tr_b16 v[160:161], v20 offset:24576
  v_mfma_f32_16x16x32_bf16 v[60:63], v[164:167], a[124:127], v[60:63]
  ds_read_b64_tr_b16 v[162:163], v20 offset:25600
  s_waitcnt lgkmcnt(10)
  v_mfma_f32_16x16x32_bf16 v[64:67], v[168:171], a[120:123], v[64:67]
  ds_read_b64_tr_b16 v[164:165], v21 offset:24576
  v_add_u32 v20, 4294836224, v20
  v_mfma_f32_16x16x32_bf16 v[68:71], v[168:171], a[124:127], v[68:71]
  ds_read_b64_tr_b16 v[166:167], v21 offset:25600
  v_add_u32 v21, 4294836224, v21
  v_mfma_f32_16x16x32_bf16 v[72:75], v[172:175], a[120:123], v[72:75]
  ds_read_b64_tr_b16 v[168:169], v22 offset:24576
  buffer_load_dwordx4 v[220:223], v30, s[20:23], s90 offen offset:2304 sc1
  s_add_u32 s63, s63, 4096
  v_mfma_f32_16x16x32_bf16 v[76:79], v[172:175], a[124:127], v[76:79]
  ds_read_b64_tr_b16 v[170:171], v22 offset:25600
  s_waitcnt lgkmcnt(10)
  v_mfma_f32_16x16x32_bf16 v[80:83], v[176:179], a[120:123], v[80:83]
  ds_read_b64_tr_b16 v[172:173], v23 offset:24576
  s_and_b32 s63, s63, 0xffff
  s_add_u32 s90, s96, s63
  v_mfma_f32_16x16x32_bf16 v[84:87], v[176:179], a[124:127], v[84:87]
  ds_read_b64_tr_b16 v[174:175], v23 offset:25600
  v_add_u32 v22, 4294836224, v22
  v_mfma_f32_16x16x32_bf16 v[88:91], v[180:183], a[120:123], v[88:91]
  ds_read_b64_tr_b16 v[176:177], v26 offset:24576
  v_add_u32 v23, 4294836224, v23
  v_mfma_f32_16x16x32_bf16 v[92:95], v[180:183], a[124:127], v[92:95]
  ds_read_b64_tr_b16 v[178:179], v26 offset:25600
  s_waitcnt lgkmcnt(10)
  v_mfma_f32_16x16x32_bf16 v[96:99], v[184:187], a[120:123], v[96:99]
  ds_read_b64_tr_b16 v[180:181], v27 offset:24576
  buffer_load_dwordx4 v[224:227], v30, s[20:23], s90 offen offset:0 sc1
  v_add_u32 v26, 4294836224, v26
  v_mfma_f32_16x16x32_bf16 v[100:103], v[184:187], a[124:127], v[100:103]
  ds_read_b64_tr_b16 v[182:183], v27 offset:25600
  v_add_u32 v27, 4294836224, v27
  v_mfma_f32_16x16x32_bf16 v[104:107], v[188:191], a[120:123], v[104:107]
  ds_read_b64_tr_b16 v[184:185], v28 offset:24576
  buffer_load_dwordx4 v[228:231], v30, s[20:23], s90 offen offset:256 sc1
  v_mfma_f32_16x16x32_bf16 v[108:111], v[188:191], a[124:127], v[108:111]
  ds_read_b64_tr_b16 v[186:187], v28 offset:25600
  s_waitcnt lgkmcnt(10)
  v_mfma_f32_16x16x32_bf16 v[48:51], v[160:163], a[128:131], v[48:51]
  ds_read_b64_tr_b16 v[188:189], v29 offset:24576
  v_add_u32 v28, 4294836224, v28
  v_mfma_f32_16x16x32_bf16 v[52:55], v[160:163], a[132:135], v[52:55]
  ds_read_b64_tr_b16 v[190:191], v29 offset:25600
  v_add_u32 v29, 4294836224, v29
  v_mfma_f32_16x16x32_bf16 v[56:59], v[164:167], a[128:131], v[56:59]
  buffer_load_dwordx4 v[232:235], v30, s[20:23], s90 offen offset:2048 sc1
  v_mfma_f32_16x16x32_bf16 v[60:63], v[164:167], a[132:135], v[60:63]
  s_waitcnt lgkmcnt(8)
  v_mfma_f32_16x16x32_bf16 v[64:67], v[168:171], a[128:131], v[64:67]
  v_mfma_f32_16x16x32_bf16 v[68:71], v[168:171], a[132:135], v[68:71]
  s_waitcnt lgkmcnt(0)
  s_barrier
  v_mfma_f32_16x16x32_bf16 v[72:75], v[172:175], a[128:131], v[72:75]
  ds_read_b64_tr_b16 v[160:161], v20 offset:0
  ds_read_b64_tr_b16 v[162:163], v20 offset:1024
  buffer_load_dwordx4 v[236:239], v30, s[20:23], s90 offen offset:2304 sc1
  s_add_u32 s63, s63, 4096
  v_mfma_f32_16x16x32_bf16 v[76:79], v[172:175], a[132:135], v[76:79]
  ds_read_b64_tr_b16 v[164:165], v21 offset:0
  ds_read_b64_tr_b16 v[166:167], v21 offset:1024
  v_mfma_f32_16x16x32_bf16 v[80:83], v[176:179], a[128:131], v[80:83]
  ds_read_b64_tr_b16 v[168:169], v22 offset:0
  ds_read_b64_tr_b16 v[170:171], v22 offset:1024
  s_and_b32 s63, s63, 0xffff
  v_mfma_f32_16x16x32_bf16 v[84:87], v[176:179], a[132:135], v[84:87]
  ds_read_b64_tr_b16 v[172:173], v23 offset:0
  ds_read_b64_tr_b16 v[174:175], v23 offset:1024
  s_add_u32 s90, s96, s63
  v_mfma_f32_16x16x32_bf16 v[88:91], v[180:183], a[128:131], v[88:91]
  ds_read_b64_tr_b16 v[176:177], v26 offset:0
L_touch11:
  s_cbranch_execz L_tback
  buffer_load_dwordx4 v[240:243], v30, s[20:23], s90 offen offset:0 sc1
  v_mfma_f32_16x16x32_bf16 v[92:95], v[180:183], a[132:135], v[92:95]
  ds_read_b64_tr_b16 v[178:179], v26 offset:1024
  v_mfma_f32_16x16x32_bf16 v[96:99], v[184:187], a[128:131], v[96:99]
  ds_read_b64_tr_b16 v[180:181], v27 offset:0
  v_mfma_f32_16x16x32_bf16 v[100:103], v[184:187], a[132:135], v[100:103]
  ds_read_b64_tr_b16 v[182:183], v27 offset:1024
  v_mfma_f32_16x16x32_bf16 v[104:107], v[188:191], a[128:131], v[104:107]
  ds_read_b64_tr_b16 v[184:185], v28 offset:0
  buffer_load_dwordx4 v[244:247], v30, s[20:23], s90 offen offset:256 sc1
  v_mfma_f32_16x16x32_bf16 v[108:111], v[188:191], a[132:135], v[108:111]
  ds_read_b64_tr_b16 v[186:187], v28 offset:1024
  s_waitcnt lgkmcnt(10)
  v_mfma_f32_16x16x32_bf16 v[48:51], v[160:163], a[136:139], v[48:51]
  ds_read_b64_tr_b16 v[188:189], v29 offset:0
  v_mfma_f32_16x16x32_bf16 v[52:55], v[160:163], a[140:143], v[52:55]
  ds_read_b64_tr_b16 v[190:191], v29 offset:1024
  v_mfma_f32_16x16x32_bf16 v[56:59], v[164:167], a[136:139], v[56:59]
  ds_read_b64_tr_b16 v[160:161], v20 offset:8192
  buffer_load_dwordx4 v[248:251], v30, s[20:23], s90 offen offset:2048 sc1
  v_mfma_f32_16x16x32_bf16 v[60:63], v[164:167], a[140:143], v[60:63]
  ds_read_b64_tr_b16 v[162:163], v20 offset:9216
  s_waitcnt lgkmcnt(10)
  v_mfma_f32_16x16x32_bf16 v[64:67], v[168:171], a[136:139], v[64:67]
  ds_read_b64_tr_b16 v[164:165], v21 offset:8192
  v_mfma_f32_16x16x32_bf16 v[68:71], v[168:171], a[140:143], v[68:71]
  ds_read_b64_tr_b16 v[166:167], v21 offset:9216
  v_mfma_f32_16x16x32_bf16 v[72:75], v[172:175], a[136:139], v[72:75]
  ds_read_b64_tr_b16 v[168:169], v22 offset:8192
  buffer_load_dwordx4 v[252:255], v30, s[20:23], s90 offen offset:2304 sc1
  s_add_u32 s63, s63, 4096
  v_mfma_f32_16x16x32_bf16 v[76:79], v[172:175], a[140:143], v[76:79]
  ds_read_b64_tr_b16 v[170:171], v22 offset:9216
  s_waitcnt lgkmcnt(10)
  v_mfma_f32_16x16x32_bf16 v[80:83], v[176:179], a[136:139], v[80:83]
  ds_read_b64_tr_b16 v[172:173], v23 offset:8192
  s_and_b32 s63, s63, 0xffff
  v_mfma_f32_16x16x32_bf16 v[84:87], v[176:179], a[140:143], v[84:87]
  ds_read_b64_tr_b16 v[174:175], v23 offset:9216
  s_add_u32 s90, s96, s63
  v_mfma_f32_16x16x32_bf16 v[88:91], v[180:183], a[136:139], v[88:91]
  ds_read_b64_tr_b16 v[176:177], v26 offset:8192
  buffer_load_dwordx4 a[0:3], v30, s[20:23], s90 offen offset:0 sc1
  v_mfma_f32_16x16x32_bf16 v[92:95], v[180:183], a[140:143], v[92:95]
  ds_read_b64_tr_b16 v[178:179], v26 offset:9216
  s_waitcnt lgkmcnt(10)
  v_mfma_f32_16x16x32_bf16 v[96:99], v[184:187], a[136:139], v[96:99]
  ds_read_b64_tr_b16 v[180:181], v27 offset:8192
  v_mfma_f32_16x16x32_bf16 v[100:103], v[184:187], a[140:143], v[100:103]
  ds_read_b64_tr_b16 v[182:183], v27 offset:9216
  v_mfma_f32_16x16x32_bf16 v[104:107], v[188:191], a[136:139], v[104:107]
  ds_read_b64_tr_b16 v[184:185], v28 offset:8192
  v_mfma_f32_16x16x32_bf16 v[108:111], v[188:191], a[140:143], v[108:111]
  ds_read_b64_tr_b16 v[186:187], v28 offset:9216
  s_waitcnt lgkmcnt(10)
  v_mfma_f32_16x16x32_bf16 v[48:51], v[160:163], a[144:147], v[48:51]
  ds_read_b64_tr_b16 v[188:189], v29 offset:8192
  buffer_load_dwordx4 a[4:7], v30, s[20:23], s90 offen offset:256 sc1
  v_mfma_f32_16x16x32_bf16 v[52:55], v[160:163], a[148:151], v[52:55]
  ds_read_b64_tr_b16 v[190:191], v29 offset:9216
  v_mfma_f32_16x16x32_bf16 v[56:59], v[164:167], a[144:147], v[56:59]
  ds_read_b64_tr_b16 v[160:161], v20 offset:16384
  s_add_u32 m0, s89, 131072
  v_mfma_f32_16x16x32_bf16 v[60:63], v[164:167], a[148:151], v[60:63]
  ds_read_b64_tr_b16 v[162:163], v20 offset:17408
  s_waitcnt lgkmcnt(10)
  v_mfma_f32_16x16x32_bf16 v[64:67], v[168:171], a[144:147], v[64:67]
  ds_read_b64_tr_b16 v[164:165], v21 offset:16384
  buffer_load_dwordx4 v32, s[28:31], s87 offen offset:0 lds
  v_mfma_f32_16x16x32_bf16 v[68:71], v[168:171], a[148:151], v[68:71]
  ds_read_b64_tr_b16 v[166:167], v21 offset:17408
  v_mfma_f32_16x16x32_bf16 v[72:75], v[172:175], a[144:147], v[72:75]
  ds_read_b64_tr_b16 v[168:169], v22 offset:16384
  v_mfma_f32_16x16x32_bf16 v[76:79], v[172:175], a[148:151], v[76:79]
  ds_read_b64_tr_b16 v[170:171], v22 offset:17408
  s_waitcnt lgkmcnt(10)
  v_mfma_f32_16x16x32_bf16 v[80:83], v[176:179], a[144:147], v[80:83]
  ds_read_b64_tr_b16 v[172:173], v23 offset:16384
  buffer_load_dwordx4 v33, s[28:31], s87 offen offset:1024 lds
  v_mfma_f32_16x16x32_bf16 v[84:87], v[176:179], a[148:151], v[84:87]
  ds_read_b64_tr_b16 v[174:175], v23 offset:17408
  v_mfma_f32_16x16x32_bf16 v[88:91], v[180:183], a[144:147], v[88:91]
  ds_read_b64_tr_b16 v[176:177], v26 offset:16384
  v_mfma_f32_16x16x32_bf16 v[92:95], v[180:183], a[148:151], v[92:95]
  ds_read_b64_tr_b16 v[178:179], v26 offset:17408
  s_waitcnt lgkmcnt(10)
  v_mfma_f32_16x16x32_bf16 v[96:99], v[184:187], a[144:147], v[96:99]
  ds_read_b64_tr_b16 v[180:181], v27 offset:16384
  buffer_load_dwordx4 v34, s[28:31], s87 offen offset:2048 lds
  v_mfma_f32_16x16x32_bf16 v[100:103], v[184:187], a[148:151], v[100:103]
  ds_read_b64_tr_b16 v[182:183], v27 offset:17408
  v_mfma_f32_16x16x32_bf16 v[104:107], v[188:191], a[144:147], v[104:107]
  ds_read_b64_tr_b16 v[184:185], v28 offset:16384
  v_mfma_f32_16x16x32_bf16 v[108:111], v[188:191], a[148:151], v[108:111]
  ds_read_b64_tr_b16 v[186:187], v28 offset:17408
  s_waitcnt lgkmcnt(10)
  v_mfma_f32_16x16x32_bf16 v[48:51], v[160:163], a[152:155], v[48:51]
  ds_read_b64_tr_b16 v[188:189], v29 offset:16384
  buffer_load_dwordx4 v35, s[28:31], s87 offen offset:3072 lds
  v_mfma_f32_16x16x32_bf16 v[52:55], v[160:163], a[156:159], v[52:55]
  ds_read_b64_tr_b16 v[190:191], v29 offset:17408
  v_mfma_f32_16x16x32_bf16 v[56:59], v[164:167], a[152:155], v[56:59]
  ds_read_b64_tr_b16 v[160:161], v20 offset:24576
  v_mfma_f32_16x16x32_bf16 v[60:63], v[164:167], a[156:159], v[60:63]
  ds_read_b64_tr_b16 v[162:163], v20 offset:25600
  s_waitcnt lgkmcnt(10)
  v_mfma_f32_16x16x32_bf16 v[64:67], v[168:171], a[152:155], v[64:67]
  ds_read_b64_tr_b16 v[164:165], v21 offset:24576
  v_add_u32 v20, 32768, v20
  s_add_u32 m0, s89, 135168
  v_mfma_f32_16x16x32_bf16 v[68:71], v[168:171], a[156:159], v[68:71]
  ds_read_b64_tr_b16 v[166:167], v21 offset:25600
  v_add_u32 v21, 32768, v21
  v_mfma_f32_16x16x32_bf16 v[72:75], v[172:175], a[152:155], v[72:75]
  ds_read_b64_tr_b16 v[168:169], v22 offset:24576
  buffer_load_dwordx4 v32, s[28:31], s88 offen offset:0 lds
  v_mfma_f32_16x16x32_bf16 v[76:79], v[172:175], a[156:159], v[76:79]
  ds_read_b64_tr_b16 v[170:171], v22 offset:25600
  s_waitcnt lgkmcnt(10)
  v_mfma_f32_16x16x32_bf16 v[80:83], v[176:179], a[152:155], v[80:83]
  ds_read_b64_tr_b16 v[172:173], v23 offset:24576
  v_add_u32 v22, 32768, v22
  v_mfma_f32_16x16x32_bf16 v[84:87], v[176:179], a[156:159], v[84:87]
  ds_read_b64_tr_b16 v[174:175], v23 offset:25600
  v_add_u32 v23, 32768, v23
  v_mfma_f32_16x16x32_bf16 v[88:91], v[180:183], a[152:155], v[88:91]
  ds_read_b64_tr_b16 v[176:177], v26 offset:24576
  buffer_load_dwordx4 v33, s[28:31], s88 offen offset:1024 lds
  v_mfma_f32_16x16x32_bf16 v[92:95], v[180:183], a[156:159], v[92:95]
  ds_read_b64_tr_b16 v[178:179], v26 offset:25600
  s_waitcnt lgkmcnt(10)
  v_mfma_f32_16x16x32_bf16 v[96:99], v[184:187], a[152:155], v[96:99]
  ds_read_b64_tr_b16 v[180:181], v27 offset:24576
  v_add_u32 v26, 32768, v26
  v_mfma_f32_16x16x32_bf16 v[100:103], v[184:187], a[156:159], v[100:103]
  ds_read_b64_tr_b16 v[182:183], v27 offset:25600
  v_add_u32 v27, 32768, v27
  v_mfma_f32_16x16x32_bf16 v[104:107], v[188:191], a[152:155], v[104:107]
  ds_read_b64_tr_b16 v[184:185], v28 offset:24576
  v_mfma_f32_16x16x32_bf16 v[108:111], v[188:191], a[156:159], v[108:111]
  ds_read_b64_tr_b16 v[186:187], v28 offset:25600
  s_waitcnt lgkmcnt(10)
  v_mfma_f32_16x16x32_bf16 v[48:51], v[160:163], a[160:163], v[48:51]
  ds_read_b64_tr_b16 v[188:189], v29 offset:24576
  v_add_u32 v28, 32768, v28
  v_mfma_f32_16x16x32_bf16 v[52:55], v[160:163], a[164:167], v[52:55]
  ds_read_b64_tr_b16 v[190:191], v29 offset:25600
  buffer_load_dwordx4 v34, s[28:31], s88 offen offset:2048 lds
  v_mfma_f32_16x16x32_bf16 v[56:59], v[164:167], a[160:163], v[56:59]
  v_add_u32 v29, 32768, v29
  v_mfma_f32_16x16x32_bf16 v[60:63], v[164:167], a[164:167], v[60:63]
  s_waitcnt lgkmcnt(8)
  buffer_load_dwordx4 v35, s[28:31], s88 offen offset:3072 lds
  s_add_u32 s87, s87, 524288
  v_mfma_f32_16x16x32_bf16 v[64:67], v[168:171], a[160:163], v[64:67]
  s_and_b32 s87, s87, 0x1fffff
  s_add_u32 s88, s87, 65536
  v_mfma_f32_16x16x32_bf16 v[68:71], v[168:171], a[164:167], v[68:71]
  s_waitcnt vmcnt(32) lgkmcnt(0)
  s_barrier
  v_mfma_f32_16x16x32_bf16 v[72:75], v[172:175], a[160:163], v[72:75]
  ds_read_b64_tr_b16 v[160:161], v20 offset:0
  ds_read_b64_tr_b16 v[162:163], v20 offset:1024
  buffer_load_dwordx4 a[8:11], v30, s[20:23], s90 offen offset:2048 sc1
  v_mfma_f32_16x16x32_bf16 v[76:79], v[172:175], a[164:167], v[76:79]
  ds_read_b64_tr_b16 v[164:165], v21 offset:0
  ds_read_b64_tr_b16 v[166:167], v21 offset:1024
  v_mfma_f32_16x16x32_bf16 v[80:83], v[176:179], a[160:163], v[80:83]
  ds_read_b64_tr_b16 v[168:169], v22 offset:0
  ds_read_b64_tr_b16 v[170:171], v22 offset:1024
  v_mfma_f32_16x16x32_bf16 v[84:87], v[176:179], a[164:167], v[84:87]
  ds_read_b64_tr_b16 v[172:173], v23 offset:0
  ds_read_b64_tr_b16 v[174:175], v23 offset:1024
  v_mfma_f32_16x16x32_bf16 v[88:91], v[180:183], a[160:163], v[88:91]
  ds_read_b64_tr_b16 v[176:177], v20 offset:8192
  buffer_load_dwordx4 a[12:15], v30, s[20:23], s90 offen offset:2304 sc1
  s_add_u32 s63, s63, 4096
  v_mfma_f32_16x16x32_bf16 v[92:95], v[180:183], a[164:167], v[92:95]
  ds_read_b64_tr_b16 v[178:179], v20 offset:9216
  v_mfma_f32_16x16x32_bf16 v[96:99], v[184:187], a[160:163], v[96:99]
  ds_read_b64_tr_b16 v[180:181], v21 offset:8192
  s_and_b32 s63, s63, 0xffff
  v_mfma_f32_16x16x32_bf16 v[100:103], v[184:187], a[164:167], v[100:103]
  ds_read_b64_tr_b16 v[182:183], v21 offset:9216
  s_add_u32 s90, s96, s63
  v_mfma_f32_16x16x32_bf16 v[104:107], v[188:191], a[160:163], v[104:107]
  ds_read_b64_tr_b16 v[184:185], v22 offset:8192
  buffer_load_dwordx4 a[16:19], v30, s[20:23], s90 offen offset:0 sc1
  v_mfma_f32_16x16x32_bf16 v[108:111], v[188:191], a[164:167], v[108:111]
  ds_read_b64_tr_b16 v[186:187], v22 offset:9216
  s_waitcnt lgkmcnt(10)
  v_mfma_f32_16x16x32_bf16 v[48:51], v[160:163], a[168:171], v[48:51]
  ds_read_b64_tr_b16 v[188:189], v23 offset:8192
  v_mfma_f32_16x16x32_bf16 v[52:55], v[160:163], a[172:175], v[52:55]
  ds_read_b64_tr_b16 v[190:191], v23 offset:9216
  v_mfma_f32_16x16x32_bf16 v[56:59], v[164:167], a[168:171], v[56:59]
  ds_read_b64_tr_b16 v[160:161], v20 offset:16384
  buffer_load_dwordx4 a[20:23], v30, s[20:23], s90 offen offset:256 sc1
  v_mfma_f32_16x16x32_bf16 v[60:63], v[164:167], a[172:175], v[60:63]
  ds_read_b64_tr_b16 v[162:163], v20 offset:17408
  s_waitcnt lgkmcnt(10)
  v_mfma_f32_16x16x32_bf16 v[64:67], v[168:171], a[168:171], v[64:67]
  ds_read_b64_tr_b16 v[164:165], v21 offset:16384
  v_mfma_f32_16x16x32_bf16 v[68:71], v[168:171], a[172:175], v[68:71]
  ds_read_b64_tr_b16 v[166:167], v21 offset:17408
  v_mfma_f32_16x16x32_bf16 v[72:75], v[172:175], a[168:171], v[72:75]
  ds_read_b64_tr_b16 v[168:169], v22 offset:16384
  buffer_load_dwordx4 a[24:27], v30, s[20:23], s90 offen offset:2048 sc1
  v_mfma_f32_16x16x32_bf16 v[76:79], v[172:175], a[172:175], v[76:79]
  ds_read_b64_tr_b16 v[170:171], v22 offset:17408
  s_waitcnt lgkmcnt(10)
  v_mfma_f32_16x16x32_bf16 v[48:51], v[176:179], a[176:179], v[48:51]
  ds_read_b64_tr_b16 v[172:173], v23 offset:16384
  v_mfma_f32_16x16x32_bf16 v[52:55], v[176:179], a[180:183], v[52:55]
  ds_read_b64_tr_b16 v[174:175], v23 offset:17408
  v_mfma_f32_16x16x32_bf16 v[56:59], v[180:183], a[176:179], v[56:59]
  ds_read_b64_tr_b16 v[176:177], v20 offset:24576
  v_mfma_f32_16x16x32_bf16 v[60:63], v[180:183], a[180:183], v[60:63]
  ds_read_b64_tr_b16 v[178:179], v20 offset:25600
  s_waitcnt lgkmcnt(10)
  v_mfma_f32_16x16x32_bf16 v[64:67], v[184:187], a[176:179], v[64:67]
  ds_read_b64_tr_b16 v[180:181], v21 offset:24576
  v_add_u32 v20, 32768, v20
  v_mfma_f32_16x16x32_bf16 v[68:71], v[184:187], a[180:183], v[68:71]
  ds_read_b64_tr_b16 v[182:183], v21 offset:25600
  v_add_u32 v21, 32768, v21
  v_mfma_f32_16x16x32_bf16 v[72:75], v[188:191], a[176:179], v[72:75]
  ds_read_b64_tr_b16 v[184:185], v22 offset:24576
  buffer_load_dwordx4 a[28:31], v30, s[20:23], s90 offen offset:2304 sc1
  s_add_u32 s63, s63, 4096
  v_mfma_f32_16x16x32_bf16 v[76:79], v[188:191], a[180:183], v[76:79]
  ds_read_b64_tr_b16 v[186:187], v22 offset:25600
  s_waitcnt lgkmcnt(10)
  v_mfma_f32_16x16x32_bf16 v[48:51], v[160:163], a[184:187], v[48:51]
  ds_read_b64_tr_b16 v[188:189], v23 offset:24576
  s_and_b32 s63, s63, 0xffff
  s_add_u32 s90, s96, s63
  v_mfma_f32_16x16x32_bf16 v[52:55], v[160:163], a[188:191], v[52:55]
  ds_read_b64_tr_b16 v[190:191], v23 offset:25600
  v_add_u32 v22, 32768, v22
  v_mfma_f32_16x16x32_bf16 v[56:59], v[164:167], a[184:187], v[56:59]
  ds_read_b64_tr_b16 v[160:161], v20 offset:0
  v_add_u32 v23, 32768, v23
  v_mfma_f32_16x16x32_bf16 v[60:63], v[164:167], a[188:191], v[60:63]
  ds_read_b64_tr_b16 v[162:163], v20 offset:1024
  s_waitcnt lgkmcnt(10)
  v_mfma_f32_16x16x32_bf16 v[64:67], v[168:171], a[184:187], v[64:67]
  ds_read_b64_tr_b16 v[164:165], v21 offset:0
  buffer_load_dwordx4 a[32:35], v30, s[20:23], s90 offen offset:0 sc1
  v_mfma_f32_16x16x32_bf16 v[68:71], v[168:171], a[188:191], v[68:71]
  ds_read_b64_tr_b16 v[166:167], v21 offset:1024
  buffer_load_dwordx4 a[36:39], v30, s[20:23], s90 offen offset:256 sc1
  v_mfma_f32_16x16x32_bf16 v[72:75], v[172:175], a[184:187], v[72:75]
  ds_read_b64_tr_b16 v[168:169], v22 offset:0
  v_mfma_f32_16x16x32_bf16 v[76:79], v[172:175], a[188:191], v[76:79]
  ds_read_b64_tr_b16 v[170:171], v22 offset:1024
  s_waitcnt lgkmcnt(10)
  v_mfma_f32_16x16x32_bf16 v[48:51], v[176:179], a[192:195], v[48:51]
  ds_read_b64_tr_b16 v[172:173], v23 offset:0
  buffer_load_dwordx4 a[40:43], v30, s[20:23], s90 offen offset:2048 sc1
  v_mfma_f32_16x16x32_bf16 v[52:55], v[176:179], a[196:199], v[52:55]
  ds_read_b64_tr_b16 v[174:175], v23 offset:1024
  v_mfma_f32_16x16x32_bf16 v[56:59], v[180:183], a[192:195], v[56:59]
  ds_read_b64_tr_b16 v[176:177], v20 offset:8192
  v_mfma_f32_16x16x32_bf16 v[60:63], v[180:183], a[196:199], v[60:63]
  ds_read_b64_tr_b16 v[178:179], v20 offset:9216
  s_waitcnt lgkmcnt(10)
  v_mfma_f32_16x16x32_bf16 v[64:67], v[184:187], a[192:195], v[64:67]
  ds_read_b64_tr_b16 v[180:181], v21 offset:8192
  buffer_load_dwordx4 a[44:47], v30, s[20:23], s90 offen offset:2304 sc1
  s_add_u32 s63, s63, 4096
  v_mfma_f32_16x16x32_bf16 v[68:71], v[184:187], a[196:199], v[68:71]
  ds_read_b64_tr_b16 v[182:183], v21 offset:9216
  s_and_b32 s63, s63, 0xffff
  v_mfma_f32_16x16x32_bf16 v[72:75], v[188:191], a[192:195], v[72:75]
  ds_read_b64_tr_b16 v[184:185], v22 offset:8192
  s_add_u32 s90, s96, s63
  v_mfma_f32_16x16x32_bf16 v[76:79], v[188:191], a[196:199], v[76:79]
  ds_read_b64_tr_b16 v[186:187], v22 offset:9216
  s_waitcnt lgkmcnt(10)
  v_mfma_f32_16x16x32_bf16 v[48:51], v[160:163], a[200:203], v[48:51]
  ds_read_b64_tr_b16 v[188:189], v23 offset:8192
  buffer_load_dwordx4 a[48:51], v30, s[20:23], s90 offen offset:0 sc1
  v_mfma_f32_16x16x32_bf16 v[52:55], v[160:163], a[204:207], v[52:55]
  ds_read_b64_tr_b16 v[190:191], v23 offset:9216
  v_mfma_f32_16x16x32_bf16 v[56:59], v[164:167], a[200:203], v[56:59]
  ds_read_b64_tr_b16 v[160:161], v20 offset:16384
  v_mfma_f32_16x16x32_bf16 v[60:63], v[164:167], a[204:207], v[60:63]
  ds_read_b64_tr_b16 v[162:163], v20 offset:17408
  s_waitcnt lgkmcnt(10)
  v_mfma_f32_16x16x32_bf16 v[64:67], v[168:171], a[200:203], v[64:67]
  ds_read_b64_tr_b16 v[164:165], v21 offset:16384
  v_mfma_f32_16x16x32_bf16 v[68:71], v[168:171], a[204:207], v[68:71]
  ds_read_b64_tr_b16 v[166:167], v21 offset:17408
  v_mfma_f32_16x16x32_bf16 v[72:75], v[172:175], a[200:203], v[72:75]
  ds_read_b64_tr_b16 v[168:169], v22 offset:16384
  buffer_load_dwordx4 a[52:55], v30, s[20:23], s90 offen offset:256 sc1
  v_mfma_f32_16x16x32_bf16 v[76:79], v[172:175], a[204:207], v[76:79]
  ds_read_b64_tr_b16 v[170:171], v22 offset:17408
  s_waitcnt lgkmcnt(10)
  v_mfma_f32_16x16x32_bf16 v[48:51], v[176:179], a[208:211], v[48:51]
  ds_read_b64_tr_b16 v[172:173], v23 offset:16384
  v_mfma_f32_16x16x32_bf16 v[52:55], v[176:179], a[212:215], v[52:55]
  ds_read_b64_tr_b16 v[174:175], v23 offset:17408
  v_mfma_f32_16x16x32_bf16 v[56:59], v[180:183], a[208:211], v[56:59]
  ds_read_b64_tr_b16 v[176:177], v20 offset:24576
  buffer_load_dwordx4 a[56:59], v30, s[20:23], s90 offen offset:2048 sc1
  v_mfma_f32_16x16x32_bf16 v[60:63], v[180:183], a[212:215], v[60:63]
  ds_read_b64_tr_b16 v[178:179], v20 offset:25600
  s_waitcnt lgkmcnt(10)
  v_mfma_f32_16x16x32_bf16 v[64:67], v[184:187], a[208:211], v[64:67]
  ds_read_b64_tr_b16 v[180:181], v21 offset:24576
  v_mfma_f32_16x16x32_bf16 v[68:71], v[184:187], a[212:215], v[68:71]
  ds_read_b64_tr_b16 v[182:183], v21 offset:25600
  v_mfma_f32_16x16x32_bf16 v[72:75], v[188:191], a[208:211], v[72:75]
  ds_read_b64_tr_b16 v[184:185], v22 offset:24576
  buffer_load_dwordx4 a[60:63], v30, s[20:23], s90 offen offset:2304 sc1
  s_add_u32 s63, s63, 4096
  v_mfma_f32_16x16x32_bf16 v[76:79], v[188:191], a[212:215], v[76:79]
  ds_read_b64_tr_b16 v[186:187], v22 offset:25600
  s_waitcnt lgkmcnt(10)
  v_mfma_f32_16x16x32_bf16 v[48:51], v[160:163], a[216:219], v[48:51]
  ds_read_b64_tr_b16 v[188:189], v23 offset:24576
  s_and_b32 s63, s63, 0xffff
  v_mfma_f32_16x16x32_bf16 v[52:55], v[160:163], a[220:223], v[52:55]
  ds_read_b64_tr_b16 v[190:191], v23 offset:25600
  s_add_u32 s90, s96, s63
  v_mfma_f32_16x16x32_bf16 v[56:59], v[164:167], a[216:219], v[56:59]
  ds_read_b64_tr_b16 v[160:161], v26 offset:0
  buffer_load_dwordx4 a[64:67], v30, s[20:23], s90 offen offset:0 sc1
  v_mfma_f32_16x16x32_bf16 v[60:63], v[164:167], a[220:223], v[60:63]
  ds_read_b64_tr_b16 v[162:163], v26 offset:1024
  s_waitcnt lgkmcnt(10)
  v_mfma_f32_16x16x32_bf16 v[64:67], v[168:171], a[216:219], v[64:67]
  ds_read_b64_tr_b16 v[164:165], v27 offset:0
  v_mfma_f32_16x16x32_bf16 v[68:71], v[168:171], a[220:223], v[68:71]
  ds_read_b64_tr_b16 v[166:167], v27 offset:1024
  v_mfma_f32_16x16x32_bf16 v[72:75], v[172:175], a[216:219], v[72:75]
  ds_read_b64_tr_b16 v[168:169], v28 offset:0
  buffer_load_dwordx4 a[68:71], v30, s[20:23], s90 offen offset:256 sc1
  v_mfma_f32_16x16x32_bf16 v[76:79], v[172:175], a[220:223], v[76:79]
  ds_read_b64_tr_b16 v[170:171], v28 offset:1024
  s_waitcnt lgkmcnt(10)
  s_waitcnt vmcnt(47)
  v_mfma_f32_16x16x32_bf16 v[48:51], v[176:179], v[200:203], v[48:51]
  ds_read_b64_tr_b16 v[172:173], v29 offset:0
  s_add_u32 m0, s89, 0
  s_waitcnt vmcnt(46)
  v_mfma_f32_16x16x32_bf16 v[52:55], v[176:179], v[204:207], v[52:55]
  ds_read_b64_tr_b16 v[174:175], v29 offset:1024
  v_mfma_f32_16x16x32_bf16 v[56:59], v[180:183], v[200:203], v[56:59]
  ds_read_b64_tr_b16 v[176:177], v26 offset:8192
  buffer_load_dwordx4 v32, s[28:31], s87 offen offset:0 lds
  v_mfma_f32_16x16x32_bf16 v[60:63], v[180:183], v[204:207], v[60:63]
  ds_read_b64_tr_b16 v[178:179], v26 offset:9216
  s_waitcnt lgkmcnt(10)
  v_mfma_f32_16x16x32_bf16 v[64:67], v[184:187], v[200:203], v[64:67]
  ds_read_b64_tr_b16 v[180:181], v27 offset:8192
  v_mfma_f32_16x16x32_bf16 v[68:71], v[184:187], v[204:207], v[68:71]
  ds_read_b64_tr_b16 v[182:183], v27 offset:9216
  v_mfma_f32_16x16x32_bf16 v[72:75], v[188:191], v[200:203], v[72:75]
  ds_read_b64_tr_b16 v[184:185], v28 offset:8192
  buffer_load_dwordx4 v33, s[28:31], s87 offen offset:1024 lds
  v_mfma_f32_16x16x32_bf16 v[76:79], v[188:191], v[204:207], v[76:79]
  ds_read_b64_tr_b16 v[186:187], v28 offset:9216
  s_waitcnt lgkmcnt(10)
  v_mfma_f32_16x16x32_bf16 v[80:83], v[160:163], a[168:171], v[80:83]
  ds_read_b64_tr_b16 v[188:189], v29 offset:8192
  v_mfma_f32_16x16x32_bf16 v[84:87], v[160:163], a[172:175], v[84:87]
  ds_read_b64_tr_b16 v[190:191], v29 offset:9216
  v_mfma_f32_16x16x32_bf16 v[88:91], v[164:167], a[168:171], v[88:91]
  ds_read_b64_tr_b16 v[160:161], v26 offset:16384
  v_mfma_f32_16x16x32_bf16 v[92:95], v[164:167], a[172:175], v[92:95]
  ds_read_b64_tr_b16 v[162:163], v26 offset:17408
  s_waitcnt lgkmcnt(10)
  v_mfma_f32_16x16x32_bf16 v[96:99], v[168:171], a[168:171], v[96:99]
  ds_read_b64_tr_b16 v[164:165], v27 offset:16384
  buffer_load_dwordx4 v34, s[28:31], s87 offen offset:2048 lds
  v_mfma_f32_16x16x32_bf16 v[100:103], v[168:171], a[172:175], v[100:103]
  ds_read_b64_tr_b16 v[166:167], v27 offset:17408
  v_mfma_f32_16x16x32_bf16 v[104:107], v[172:175], a[168:171], v[104:107]
  ds_read_b64_tr_b16 v[168:169], v28 offset:16384
  v_cvt_pk_bf16_f32 v144, v48, v49
  v_mfma_f32_16x16x32_bf16 v[108:111], v[172:175], a[172:175], v[108:111]
  ds_read_b64_tr_b16 v[170:171], v28 offset:17408
  s_waitcnt lgkmcnt(10)
  v_mfma_f32_16x16x32_bf16 v[80:83], v[176:179], a[176:179], v[80:83]
  ds_read_b64_tr_b16 v[172:173], v29 offset:16384
  v_cvt_pk_bf16_f32 v145, v50, v51
  v_cvt_pk_bf16_f32 v146, v52, v53
  v_mfma_f32_16x16x32_bf16 v[84:87], v[176:179], a[180:183], v[84:87]
  ds_read_b64_tr_b16 v[174:175], v29 offset:17408
  v_cvt_pk_bf16_f32 v147, v54, v55
  v_mfma_f32_16x16x32_bf16 v[88:91], v[180:183], a[176:179], v[88:91]
  ds_read_b64_tr_b16 v[176:177], v26 offset:24576
  buffer_load_dwordx4 v35, s[28:31], s87 offen offset:3072 lds
  v_mfma_f32_16x16x32_bf16 v[92:95], v[180:183], a[180:183], v[92:95]
  ds_read_b64_tr_b16 v[178:179], v26 offset:25600
  s_waitcnt lgkmcnt(10)
  v_add_u32 v26, 32768, v26
  v_mfma_f32_16x16x32_bf16 v[96:99], v[184:187], a[176:179], v[96:99]
  ds_read_b64_tr_b16 v[180:181], v27 offset:24576
  v_cvt_pk_bf16_f32 v148, v56, v57
  v_cvt_pk_bf16_f32 v149, v58, v59
  v_mfma_f32_16x16x32_bf16 v[100:103], v[184:187], a[180:183], v[100:103]
  ds_read_b64_tr_b16 v[182:183], v27 offset:25600
  buffer_store_dwordx4 v[144:147], v4, s[20:23], s93 offen offset:0 sc1
  v_add_u32 v27, 32768, v27
  v_mfma_f32_16x16x32_bf16 v[104:107], v[188:191], a[176:179], v[104:107]
  ds_read_b64_tr_b16 v[184:185], v28 offset:24576
  v_cvt_pk_bf16_f32 v150, v60, v61
  v_cvt_pk_bf16_f32 v151, v62, v63
  v_mfma_f32_16x16x32_bf16 v[108:111], v[188:191], a[180:183], v[108:111]
  ds_read_b64_tr_b16 v[186:187], v28 offset:25600
  s_waitcnt lgkmcnt(10)
  v_add_u32 v28, 32768, v28
  v_mfma_f32_16x16x32_bf16 v[80:83], v[160:163], a[184:187], v[80:83]
  ds_read_b64_tr_b16 v[188:189], v29 offset:24576
  v_cvt_pk_bf16_f32 v152, v64, v65
  v_cvt_pk_bf16_f32 v153, v66, v67
  v_mfma_f32_16x16x32_bf16 v[84:87], v[160:163], a[188:191], v[84:87]
  ds_read_b64_tr_b16 v[190:191], v29 offset:25600
  buffer_store_dwordx4 v[148:151], v4, s[20:23], s93 offen offset:1024 sc1
  v_add_u32 v29, 32768, v29
  v_mfma_f32_16x16x32_bf16 v[88:91], v[164:167], a[184:187], v[88:91]
  ds_read_b64_tr_b16 v[160:161], v26 offset:0
  v_cvt_pk_bf16_f32 v154, v68, v69
  v_cvt_pk_bf16_f32 v155, v70, v71
  v_mfma_f32_16x16x32_bf16 v[92:95], v[164:167], a[188:191], v[92:95]
  ds_read_b64_tr_b16 v[162:163], v26 offset:1024
  s_waitcnt lgkmcnt(10)
  v_mfma_f32_16x16x32_bf16 v[96:99], v[168:171], a[184:187], v[96:99]
  ds_read_b64_tr_b16 v[164:165], v27 offset:0
  v_cvt_pk_bf16_f32 v156, v72, v73
  v_cvt_pk_bf16_f32 v157, v74, v75
  v_mfma_f32_16x16x32_bf16 v[100:103], v[168:171], a[188:191], v[100:103]
  ds_read_b64_tr_b16 v[166:167], v27 offset:1024
  buffer_store_dwordx4 v[152:155], v4, s[20:23], s93 offen offset:2048 sc1
  v_mfma_f32_16x16x32_bf16 v[104:107], v[172:175], a[184:187], v[104:107]
  ds_read_b64_tr_b16 v[168:169], v28 offset:0
  v_cvt_pk_bf16_f32 v158, v76, v77
  v_mfma_f32_16x16x32_bf16 v[108:111], v[172:175], a[188:191], v[108:111]
  ds_read_b64_tr_b16 v[170:171], v28 offset:1024
  s_waitcnt lgkmcnt(10)
  v_mfma_f32_16x16x32_bf16 v[80:83], v[176:179], a[192:195], v[80:83]
  ds_read_b64_tr_b16 v[172:173], v29 offset:0
  v_cvt_pk_bf16_f32 v159, v78, v79
  v_mfma_f32_16x16x32_bf16 v[84:87], v[176:179], a[196:199], v[84:87]
  ds_read_b64_tr_b16 v[174:175], v29 offset:1024
  buffer_store_dwordx4 v[156:159], v4, s[20:23], s93 offen offset:3072 sc1
  v_mfma_f32_16x16x32_bf16 v[88:91], v[180:183], a[192:195], v[88:91]
  ds_read_b64_tr_b16 v[176:177], v26 offset:8192
  s_xor_b32 s93, s93, 32768
  v_mfma_f32_16x16x32_bf16 v[92:95], v[180:183], a[196:199], v[92:95]
  ds_read_b64_tr_b16 v[178:179], v26 offset:9216
  s_waitcnt lgkmcnt(10)
  v_mfma_f32_16x16x32_bf16 v[96:99], v[184:187], a[192:195], v[96:99]
  ds_read_b64_tr_b16 v[180:181], v27 offset:8192
  s_xor_b32 s62, s65, 32
  v_mfma_f32_16x16x32_bf16 v[100:103], v[184:187], a[196:199], v[100:103]
  ds_read_b64_tr_b16 v[182:183], v27 offset:9216
  v_mfma_f32_16x16x32_bf16 v[104:107], v[188:191], a[192:195], v[104:107]
  ds_read_b64_tr_b16 v[184:185], v28 offset:8192
  s_lshl_b32 s62, s62, 7
  v_mfma_f32_16x16x32_bf16 v[108:111], v[188:191], a[196:199], v[108:111]
  ds_read_b64_tr_b16 v[186:187], v28 offset:9216
  s_waitcnt lgkmcnt(10)
  v_mfma_f32_16x16x32_bf16 v[80:83], v[160:163], a[200:203], v[80:83]
  ds_read_b64_tr_b16 v[188:189], v29 offset:8192
  v_mov_b32 v24, s62
  v_mfma_f32_16x16x32_bf16 v[84:87], v[160:163], a[204:207], v[84:87]
  ds_read_b64_tr_b16 v[190:191], v29 offset:9216
  v_mfma_f32_16x16x32_bf16 v[88:91], v[164:167], a[200:203], v[88:91]
  ds_read_b64_tr_b16 v[160:161], v26 offset:16384
  v_mfma_f32_16x16x32_bf16 v[92:95], v[164:167], a[204:207], v[92:95]
  ds_read_b64_tr_b16 v[162:163], v26 offset:17408
  s_waitcnt lgkmcnt(10)
  v_mfma_f32_16x16x32_bf16 v[96:99], v[168:171], a[200:203], v[96:99]
  ds_read_b64_tr_b16 v[164:165], v27 offset:16384
  v_mfma_f32_16x16x32_bf16 v[100:103], v[168:171], a[204:207], v[100:103]
  ds_read_b64_tr_b16 v[166:167], v27 offset:17408
  v_mfma_f32_16x16x32_bf16 v[104:107], v[172:175], a[200:203], v[104:107]
  ds_read_b64_tr_b16 v[168:169], v28 offset:16384
  v_mfma_f32_16x16x32_bf16 v[108:111], v[172:175], a[204:207], v[108:111]
  ds_read_b64_tr_b16 v[170:171], v28 offset:17408
  s_waitcnt lgkmcnt(10)
  v_mfma_f32_16x16x32_bf16 v[80:83], v[176:179], a[208:211], v[80:83]
  ds_read_b64_tr_b16 v[172:173], v29 offset:16384
  v_mfma_f32_16x16x32_bf16 v[84:87], v[176:179], a[212:215], v[84:87]
  ds_read_b64_tr_b16 v[174:175], v29 offset:17408
  v_mfma_f32_16x16x32_bf16 v[88:91], v[180:183], a[208:211], v[88:91]
  ds_read_b64_tr_b16 v[176:177], v26 offset:24576
  v_mfma_f32_16x16x32_bf16 v[92:95], v[180:183], a[212:215], v[92:95]
  ds_read_b64_tr_b16 v[178:179], v26 offset:25600
  s_waitcnt lgkmcnt(10)
  v_mfma_f32_16x16x32_bf16 v[96:99], v[184:187], a[208:211], v[96:99]
  ds_read_b64_tr_b16 v[180:181], v27 offset:24576
  v_mfma_f32_16x16x32_bf16 v[100:103], v[184:187], a[212:215], v[100:103]
  ds_read_b64_tr_b16 v[182:183], v27 offset:25600
  v_mfma_f32_16x16x32_bf16 v[104:107], v[188:191], a[208:211], v[104:107]
  ds_read_b64_tr_b16 v[184:185], v28 offset:24576
  v_mfma_f32_16x16x32_bf16 v[108:111], v[188:191], a[212:215], v[108:111]
  ds_read_b64_tr_b16 v[186:187], v28 offset:25600
  s_waitcnt lgkmcnt(10)
  v_mfma_f32_16x16x32_bf16 v[80:83], v[160:163], a[216:219], v[80:83]
  ds_read_b64_tr_b16 v[188:189], v29 offset:24576
  v_mfma_f32_16x16x32_bf16 v[84:87], v[160:163], a[220:223], v[84:87]
  ds_read_b64_tr_b16 v[190:191], v29 offset:25600
  v_mfma_f32_16x16x32_bf16 v[88:91], v[164:167], a[216:219], v[88:91]
  v_mfma_f32_16x16x32_bf16 v[92:95], v[164:167], a[220:223], v[92:95]
  s_waitcnt lgkmcnt(8)
  v_mfma_f32_16x16x32_bf16 v[96:99], v[168:171], a[216:219], v[96:99]
  v_mfma_f32_16x16x32_bf16 v[100:103], v[168:171], a[220:223], v[100:103]
  s_waitcnt vmcnt(46) lgkmcnt(0)
  s_barrier
  v_mfma_f32_16x16x32_bf16 v[104:107], v[172:175], a[216:219], v[104:107]
  ds_read_b64_tr_b16 v[160:161], v36 offset:0
  ds_read_b64_tr_b16 v[162:163], v36 offset:512
  v_mfma_f32_16x16x32_bf16 v[108:111], v[172:175], a[220:223], v[108:111]
  ds_read_b64_tr_b16 v[164:165], v37 offset:0
  ds_read_b64_tr_b16 v[166:167], v37 offset:512
  v_mfma_f32_16x16x32_bf16 v[80:83], v[176:179], v[200:203], v[80:83]
  ds_read_b64_tr_b16 v[168:169], v38 offset:0
  ds_read_b64_tr_b16 v[170:171], v38 offset:512
  v_mfma_f32_16x16x32_bf16 v[84:87], v[176:179], v[204:207], v[84:87]
  ds_read_b64_tr_b16 v[172:173], v39 offset:0
  ds_read_b64_tr_b16 v[174:175], v39 offset:512
  v_mfma_f32_16x16x32_bf16 v[88:91], v[180:183], v[200:203], v[88:91]
  ds_read_b64_tr_b16 v[176:177], v36 offset:4096
  v_mfma_f32_16x16x32_bf16 v[92:95], v[180:183], v[204:207], v[92:95]
  ds_read_b64_tr_b16 v[178:179], v36 offset:4608
  v_mfma_f32_16x16x32_bf16 v[96:99], v[184:187], v[200:203], v[96:99]
  ds_read_b64_tr_b16 v[180:181], v37 offset:4096
  v_mfma_f32_16x16x32_bf16 v[100:103], v[184:187], v[204:207], v[100:103]
  ds_read_b64_tr_b16 v[182:183], v37 offset:4608
  v_mfma_f32_16x16x32_bf16 v[104:107], v[188:191], v[200:203], v[104:107]
  ds_read_b64_tr_b16 v[184:185], v38 offset:4096
  v_mfma_f32_16x16x32_bf16 v[108:111], v[188:191], v[204:207], v[108:111]
  ds_read_b64_tr_b16 v[186:187], v38 offset:4608
  s_waitcnt lgkmcnt(10)
  s_waitcnt vmcnt(45)
  v_mfma_f32_16x16x32_bf16 v[112:115], v[160:163], v[208:211], 0
L_touch12:
  s_cbranch_execz L_tback
  ds_read_b64_tr_b16 v[188:189], v39 offset:4096
  s_waitcnt vmcnt(44)
  v_mfma_f32_16x16x32_bf16 v[116:119], v[160:163], v[212:215], 0
  ds_read_b64_tr_b16 v[190:191], v39 offset:4608
  v_mfma_f32_16x16x32_bf16 v[120:123], v[164:167], v[208:211], 0
  ds_read_b64_tr_b16 v[160:161], v36 offset:8192
  v_mfma_f32_16x16x32_bf16 v[124:127], v[164:167], v[212:215], 0
  ds_read_b64_tr_b16 v[162:163], v36 offset:8704
  s_waitcnt lgkmcnt(10)
  v_mfma_f32_16x16x32_bf16 v[128:131], v[168:171], v[208:211], 0
  ds_read_b64_tr_b16 v[164:165], v37 offset:8192
  v_mul_f32 v80, v41, v80
  v_mfma_f32_16x16x32_bf16 v[132:135], v[168:171], v[212:215], 0
  ds_read_b64_tr_b16 v[166:167], v37 offset:8704
  v_mfma_f32_16x16x32_bf16 v[136:139], v[172:175], v[208:211], 0
  ds_read_b64_tr_b16 v[168:169], v38 offset:8192
  s_add_u32 m0, s89, 4096
  v_mfma_f32_16x16x32_bf16 v[140:143], v[172:175], v[212:215], 0
  ds_read_b64_tr_b16 v[170:171], v38 offset:8704
  s_waitcnt lgkmcnt(10)
  s_waitcnt vmcnt(43)
  v_mfma_f32_16x16x32_bf16 v[112:115], v[176:179], v[216:219], v[112:115]
  ds_read_b64_tr_b16 v[172:173], v39 offset:8192
  v_mul_f32 v81, v41, v81
  s_waitcnt vmcnt(42)
  v_mfma_f32_16x16x32_bf16 v[116:119], v[176:179], v[220:223], v[116:119]
  ds_read_b64_tr_b16 v[174:175], v39 offset:8704
  buffer_load_dwordx4 v32, s[28:31], s88 offen offset:0 lds
  v_mfma_f32_16x16x32_bf16 v[120:123], v[180:183], v[216:219], v[120:123]
  ds_read_b64_tr_b16 v[176:177], v36 offset:12288
  v_mul_f32 v82, v41, v82
  v_mfma_f32_16x16x32_bf16 v[124:127], v[180:183], v[220:223], v[124:127]
  ds_read_b64_tr_b16 v[178:179], v36 offset:12800
  s_waitcnt lgkmcnt(10)
  v_mfma_f32_16x16x32_bf16 v[128:131], v[184:187], v[216:219], v[128:131]
  ds_read_b64_tr_b16 v[180:181], v37 offset:12288
  v_mul_f32 v83, v41, v83
  v_mfma_f32_16x16x32_bf16 v[132:135], v[184:187], v[220:223], v[132:135]
  ds_read_b64_tr_b16 v[182:183], v37 offset:12800
  buffer_load_dwordx4 v33, s[28:31], s88 offen offset:1024 lds
  v_mfma_f32_16x16x32_bf16 v[136:139], v[188:191], v[216:219], v[136:139]
  ds_read_b64_tr_b16 v[184:185], v38 offset:12288
  v_mul_f32 v84, v43, v84
  v_mfma_f32_16x16x32_bf16 v[140:143], v[188:191], v[220:223], v[140:143]
  ds_read_b64_tr_b16 v[186:187], v38 offset:12800
  s_waitcnt lgkmcnt(10)
  s_waitcnt vmcnt(43)
  v_mfma_f32_16x16x32_bf16 v[112:115], v[160:163], v[224:227], v[112:115]
  ds_read_b64_tr_b16 v[188:189], v39 offset:12288
  v_mul_f32 v85, v43, v85
  s_waitcnt vmcnt(42)
  v_mfma_f32_16x16x32_bf16 v[116:119], v[160:163], v[228:231], v[116:119]
  ds_read_b64_tr_b16 v[190:191], v39 offset:12800
  buffer_load_dwordx4 v34, s[28:31], s88 offen offset:2048 lds
  v_mfma_f32_16x16x32_bf16 v[120:123], v[164:167], v[224:227], v[120:123]
  ds_read_b64_tr_b16 v[160:161], v36 offset:16384
  v_mul_f32 v86, v43, v86
  v_mfma_f32_16x16x32_bf16 v[124:127], v[164:167], v[228:231], v[124:127]
  ds_read_b64_tr_b16 v[162:163], v36 offset:16896
  s_waitcnt lgkmcnt(10)
  v_mfma_f32_16x16x32_bf16 v[128:131], v[168:171], v[224:227], v[128:131]
  ds_read_b64_tr_b16 v[164:165], v37 offset:16384
  v_mul_f32 v87, v43, v87
  v_mfma_f32_16x16x32_bf16 v[132:135], v[168:171], v[228:231], v[132:135]
  ds_read_b64_tr_b16 v[166:167], v37 offset:16896
  buffer_load_dwordx4 v35, s[28:31], s88 offen offset:3072 lds
  s_add_u32 s87, s87, 524288
  v_mfma_f32_16x16x32_bf16 v[136:139], v[172:175], v[224:227], v[136:139]
  ds_read_b64_tr_b16 v[168:169], v38 offset:16384
  s_and_b32 s87, s87, 0x1fffff
  s_add_u32 s88, s87, 65536
  v_mfma_f32_16x16x32_bf16 v[140:143], v[172:175], v[228:231], v[140:143]
  ds_read_b64_tr_b16 v[170:171], v38 offset:16896
  s_waitcnt lgkmcnt(10)
  s_waitcnt vmcnt(43)
  v_mfma_f32_16x16x32_bf16 v[112:115], v[176:179], v[232:235], v[112:115]
  ds_read_b64_tr_b16 v[172:173], v39 offset:16384
  v_mul_f32 v88, v41, v88
  s_waitcnt vmcnt(42)
  v_mfma_f32_16x16x32_bf16 v[116:119], v[176:179], v[236:239], v[116:119]
  ds_read_b64_tr_b16 v[174:175], v39 offset:16896
  v_mul_f32 v89, v41, v89
  v_mfma_f32_16x16x32_bf16 v[120:123], v[180:183], v[232:235], v[120:123]
  ds_read_b64_tr_b16 v[176:177], v36 offset:20480
  v_mul_f32 v90, v41, v90
  v_mfma_f32_16x16x32_bf16 v[124:127], v[180:183], v[236:239], v[124:127]
  ds_read_b64_tr_b16 v[178:179], v36 offset:20992
  s_waitcnt lgkmcnt(10)
  v_mfma_f32_16x16x32_bf16 v[128:131], v[184:187], v[232:235], v[128:131]
  ds_read_b64_tr_b16 v[180:181], v37 offset:20480
  buffer_load_dwordx4 a[72:75], v30, s[20:23], s90 offen offset:2048 sc1
  v_mfma_f32_16x16x32_bf16 v[132:135], v[184:187], v[236:239], v[132:135]
  ds_read_b64_tr_b16 v[182:183], v37 offset:20992
  v_mul_f32 v91, v41, v91
  v_mfma_f32_16x16x32_bf16 v[136:139], v[188:191], v[232:235], v[136:139]
  ds_read_b64_tr_b16 v[184:185], v38 offset:20480
  v_mul_f32 v92, v43, v92
  v_mfma_f32_16x16x32_bf16 v[140:143], v[188:191], v[236:239], v[140:143]
  ds_read_b64_tr_b16 v[186:187], v38 offset:20992
  s_waitcnt lgkmcnt(10)
  buffer_load_dwordx4 a[76:79], v30, s[20:23], s90 offen offset:2304 sc1
  s_waitcnt vmcnt(43)
  v_mfma_f32_16x16x32_bf16 v[112:115], v[160:163], v[240:243], v[112:115]
  ds_read_b64_tr_b16 v[188:189], v39 offset:20480
  s_add_u32 s63, s63, 4096
  s_and_b32 s63, s63, 0xffff
  s_waitcnt vmcnt(42)
  v_mfma_f32_16x16x32_bf16 v[116:119], v[160:163], v[244:247], v[116:119]
  ds_read_b64_tr_b16 v[190:191], v39 offset:20992
  s_add_u32 s90, s96, s63
  v_mfma_f32_16x16x32_bf16 v[120:123], v[164:167], v[240:243], v[120:123]
  ds_read_b64_tr_b16 v[160:161], v36 offset:24576
  v_mul_f32 v93, v43, v93
  v_mul_f32 v94, v43, v94
  v_mfma_f32_16x16x32_bf16 v[124:127], v[164:167], v[244:247], v[124:127]
  ds_read_b64_tr_b16 v[162:163], v36 offset:25088
  s_waitcnt lgkmcnt(10)
  v_mfma_f32_16x16x32_bf16 v[128:131], v[168:171], v[240:243], v[128:131]
  ds_read_b64_tr_b16 v[164:165], v37 offset:24576
  buffer_load_dwordx4 a[80:83], v30, s[20:23], s90 offen offset:0 sc1
  v_mfma_f32_16x16x32_bf16 v[132:135], v[168:171], v[244:247], v[132:135]
  ds_read_b64_tr_b16 v[166:167], v37 offset:25088
  v_mul_f32 v95, v43, v95
  v_mfma_f32_16x16x32_bf16 v[136:139], v[172:175], v[240:243], v[136:139]
  ds_read_b64_tr_b16 v[168:169], v38 offset:24576
  v_mul_f32 v96, v41, v96
  v_mfma_f32_16x16x32_bf16 v[140:143], v[172:175], v[244:247], v[140:143]
  ds_read_b64_tr_b16 v[170:171], v38 offset:25088
  s_waitcnt lgkmcnt(10)
  s_waitcnt vmcnt(42)
  v_mfma_f32_16x16x32_bf16 v[112:115], v[176:179], v[248:251], v[112:115]
  ds_read_b64_tr_b16 v[172:173], v39 offset:24576
  buffer_load_dwordx4 a[84:87], v30, s[20:23], s90 offen offset:256 sc1
  s_waitcnt vmcnt(42)
  v_mfma_f32_16x16x32_bf16 v[116:119], v[176:179], v[252:255], v[116:119]
  ds_read_b64_tr_b16 v[174:175], v39 offset:25088
  v_mul_f32 v97, v41, v97
  v_mfma_f32_16x16x32_bf16 v[120:123], v[180:183], v[248:251], v[120:123]
  ds_read_b64_tr_b16 v[176:177], v36 offset:28672
  v_mul_f32 v98, v41, v98
  v_mfma_f32_16x16x32_bf16 v[124:127], v[180:183], v[252:255], v[124:127]
  ds_read_b64_tr_b16 v[178:179], v36 offset:29184
  s_waitcnt lgkmcnt(10)
  v_mfma_f32_16x16x32_bf16 v[128:131], v[184:187], v[248:251], v[128:131]
  ds_read_b64_tr_b16 v[180:181], v37 offset:28672
  v_add_u32 v36, 32768, v36
  v_mfma_f32_16x16x32_bf16 v[132:135], v[184:187], v[252:255], v[132:135]
  ds_read_b64_tr_b16 v[182:183], v37 offset:29184
  buffer_load_dwordx4 a[88:91], v30, s[20:23], s90 offen offset:2048 sc1
  v_mul_f32 v99, v41, v99
  v_mfma_f32_16x16x32_bf16 v[136:139], v[188:191], v[248:251], v[136:139]
  ds_read_b64_tr_b16 v[184:185], v38 offset:28672
  v_add_u32 v37, 32768, v37
  v_mul_f32 v100, v43, v100
  v_mfma_f32_16x16x32_bf16 v[140:143], v[188:191], v[252:255], v[140:143]
  ds_read_b64_tr_b16 v[186:187], v38 offset:29184
  s_waitcnt lgkmcnt(10)
  v_add_u32 v38, 32768, v38
  s_waitcnt vmcnt(42)
  v_mfma_f32_16x16x32_bf16 v[112:115], v[160:163], a[0:3], v[112:115]
  ds_read_b64_tr_b16 v[188:189], v39 offset:28672
  buffer_load_dwordx4 a[92:95], v30, s[20:23], s90 offen offset:2304 sc1
  s_add_u32 s63, s63, 4096
  s_waitcnt vmcnt(42)
  v_mfma_f32_16x16x32_bf16 v[116:119], v[160:163], a[4:7], v[116:119]
  ds_read_b64_tr_b16 v[190:191], v39 offset:29184
  s_and_b32 s63, s63, 0xffff
  s_add_u32 s90, s96, s63
  v_mfma_f32_16x16x32_bf16 v[120:123], v[164:167], a[0:3], v[120:123]
  v_mul_f32 v101, v43, v101
  v_add_u32 v39, 32768, v39
  v_mul_f32 v102, v43, v102
  v_mfma_f32_16x16x32_bf16 v[124:127], v[164:167], a[4:7], v[124:127]
  s_waitcnt lgkmcnt(8)
  buffer_load_dwordx4 a[96:99], v30, s[20:23], s90 offen offset:0 sc1
  v_mfma_f32_16x16x32_bf16 v[128:131], v[168:171], a[0:3], v[128:131]
  v_mul_f32 v103, v43, v103
  v_mul_f32 v104, v41, v104
  v_mfma_f32_16x16x32_bf16 v[132:135], v[168:171], a[4:7], v[132:135]
  s_waitcnt vmcnt(11) lgkmcnt(0)
  s_barrier
  s_cmp_lg_u32 s3, 0
  s_cbranch_scc1 L_sig23
  s_mov_b64 exec, 1
  v_mov_b32 v5, 15
  buffer_store_dword v5, off, s[20:23], s69 sc1
  s_mov_b64 exec, -1
L_sig23:
  v_mfma_f32_16x16x32_bf16 v[136:139], v[172:175], a[0:3], v[136:139]
  ds_read_b64_tr_b16 v[160:161], v36 offset:0
  ds_read_b64_tr_b16 v[162:163], v36 offset:512
  v_mul_f32 v105, v41, v105
  v_mfma_f32_16x16x32_bf16 v[140:143], v[172:175], a[4:7], v[140:143]
  ds_read_b64_tr_b16 v[164:165], v37 offset:0
  ds_read_b64_tr_b16 v[166:167], v37 offset:512
  v_mfma_f32_16x16x32_bf16 v[112:115], v[176:179], a[8:11], v[112:115]
  ds_read_b64_tr_b16 v[168:169], v38 offset:0
  ds_read_b64_tr_b16 v[170:171], v38 offset:512
  buffer_load_dwordx4 a[100:103], v30, s[20:23], s90 offen offset:256 sc1
  v_mfma_f32_16x16x32_bf16 v[116:119], v[176:179], a[12:15], v[116:119]
  ds_read_b64_tr_b16 v[172:173], v39 offset:0
  ds_read_b64_tr_b16 v[174:175], v39 offset:512
  v_mul_f32 v106, v41, v106
  v_mfma_f32_16x16x32_bf16 v[120:123], v[180:183], a[8:11], v[120:123]
  ds_read_b64_tr_b16 v[176:177], v36 offset:4096
  v_mul_f32 v107, v41, v107
  v_mfma_f32_16x16x32_bf16 v[124:127], v[180:183], a[12:15], v[124:127]
  ds_read_b64_tr_b16 v[178:179], v36 offset:4608
  v_mfma_f32_16x16x32_bf16 v[128:131], v[184:187], a[8:11], v[128:131]
  ds_read_b64_tr_b16 v[180:181], v37 offset:4096
  buffer_load_dwordx4 a[104:107], v30, s[20:23], s90 offen offset:2048 sc1
  v_mfma_f32_16x16x32_bf16 v[132:135], v[184:187], a[12:15], v[132:135]
  ds_read_b64_tr_b16 v[182:183], v37 offset:4608
  v_mul_f32 v108, v43, v108
  v_mfma_f32_16x16x32_bf16 v[136:139], v[188:191], a[8:11], v[136:139]
  ds_read_b64_tr_b16 v[184:185], v38 offset:4096
  v_mul_f32 v109, v43, v109
  v_mfma_f32_16x16x32_bf16 v[140:143], v[188:191], a[12:15], v[140:143]
  ds_read_b64_tr_b16 v[186:187], v38 offset:4608
  s_waitcnt lgkmcnt(10)
  v_mfma_f32_16x16x32_bf16 v[112:115], v[160:163], a[16:19], v[112:115]
  ds_read_b64_tr_b16 v[188:189], v39 offset:4096
  buffer_load_dwordx4 a[108:111], v30, s[20:23], s90 offen offset:2304 sc1
  s_add_u32 s63, s63, 4096
  v_mfma_f32_16x16x32_bf16 v[116:119], v[160:163], a[20:23], v[116:119]
  ds_read_b64_tr_b16 v[190:191], v39 offset:4608
  s_and_b32 s63, s63, 0xffff
  v_mfma_f32_16x16x32_bf16 v[120:123], v[164:167], a[16:19], v[120:123]
  ds_read_b64_tr_b16 v[160:161], v36 offset:8192
  s_add_u32 s90, s96, s63
  v_mfma_f32_16x16x32_bf16 v[124:127], v[164:167], a[20:23], v[124:127]
  ds_read_b64_tr_b16 v[162:163], v36 offset:8704
  s_waitcnt lgkmcnt(10)
  v_mfma_f32_16x16x32_bf16 v[128:131], v[168:171], a[16:19], v[128:131]
  ds_read_b64_tr_b16 v[164:165], v37 offset:8192
  v_mul_f32 v110, v43, v110
  v_mfma_f32_16x16x32_bf16 v[132:135], v[168:171], a[20:23], v[132:135]
  ds_read_b64_tr_b16 v[166:167], v37 offset:8704
  v_mul_f32_e64 v111, v43, v111
  v_mfma_f32_16x16x32_bf16 v[136:139], v[172:175], a[16:19], v[136:139]
  ds_read_b64_tr_b16 v[168:169], v38 offset:8192
  buffer_load_dwordx4 a[112:115], v30, s[20:23], s90 offen offset:0 sc1
  v_mfma_f32_16x16x32_bf16 v[140:143], v[172:175], a[20:23], v[140:143]
  ds_read_b64_tr_b16 v[170:171], v38 offset:8704
  s_waitcnt lgkmcnt(10)
  v_mfma_f32_16x16x32_bf16 v[112:115], v[176:179], a[24:27], v[112:115]
  ds_read_b64_tr_b16 v[172:173], v39 offset:8192
  buffer_load_dwordx4 a[116:119], v30, s[20:23], s90 offen offset:256 sc1
  v_mfma_f32_16x16x32_bf16 v[116:119], v[176:179], a[28:31], v[116:119]
  ds_read_b64_tr_b16 v[174:175], v39 offset:8704
  v_mfma_f32_16x16x32_bf16 v[120:123], v[180:183], a[24:27], v[120:123]
  ds_read_b64_tr_b16 v[176:177], v36 offset:12288
  v_mfma_f32_16x16x32_bf16 v[124:127], v[180:183], a[28:31], v[124:127]
  ds_read_b64_tr_b16 v[178:179], v36 offset:12800
  s_waitcnt lgkmcnt(10)
  v_mfma_f32_16x16x32_bf16 v[128:131], v[184:187], a[24:27], v[128:131]
  ds_read_b64_tr_b16 v[180:181], v37 offset:12288
  buffer_load_dwordx4 a[120:123], v30, s[20:23], s90 offen offset:2048 sc1
  v_mfma_f32_16x16x32_bf16 v[132:135], v[184:187], a[28:31], v[132:135]
  ds_read_b64_tr_b16 v[182:183], v37 offset:12800
  v_mfma_f32_16x16x32_bf16 v[136:139], v[188:191], a[24:27], v[136:139]
  ds_read_b64_tr_b16 v[184:185], v38 offset:12288
  v_mfma_f32_16x16x32_bf16 v[140:143], v[188:191], a[28:31], v[140:143]
  ds_read_b64_tr_b16 v[186:187], v38 offset:12800
  s_waitcnt lgkmcnt(10)
  v_mfma_f32_16x16x32_bf16 v[112:115], v[160:163], a[32:35], v[112:115]
  ds_read_b64_tr_b16 v[188:189], v39 offset:12288
  v_mfma_f32_16x16x32_bf16 v[116:119], v[160:163], a[36:39], v[116:119]
  ds_read_b64_tr_b16 v[190:191], v39 offset:12800
  v_mfma_f32_16x16x32_bf16 v[120:123], v[164:167], a[32:35], v[120:123]
  ds_read_b64_tr_b16 v[160:161], v36 offset:16384
  buffer_load_dwordx4 a[124:127], v30, s[20:23], s90 offen offset:2304 sc1
  s_add_u32 s63, s63, 4096
  v_mfma_f32_16x16x32_bf16 v[124:127], v[164:167], a[36:39], v[124:127]
  ds_read_b64_tr_b16 v[162:163], v36 offset:16896
  s_waitcnt lgkmcnt(10)
  v_mfma_f32_16x16x32_bf16 v[128:131], v[168:171], a[32:35], v[128:131]
  ds_read_b64_tr_b16 v[164:165], v37 offset:16384
  s_and_b32 s63, s63, 0xffff
  v_mfma_f32_16x16x32_bf16 v[132:135], v[168:171], a[36:39], v[132:135]
  ds_read_b64_tr_b16 v[166:167], v37 offset:16896
  s_add_u32 s90, s96, s63
  v_mfma_f32_16x16x32_bf16 v[136:139], v[172:175], a[32:35], v[136:139]
  ds_read_b64_tr_b16 v[168:169], v38 offset:16384
  buffer_load_dwordx4 a[128:131], v30, s[20:23], s90 offen offset:0 sc1
  v_mfma_f32_16x16x32_bf16 v[140:143], v[172:175], a[36:39], v[140:143]
  ds_read_b64_tr_b16 v[170:171], v38 offset:16896
  s_waitcnt lgkmcnt(10)
  v_mfma_f32_16x16x32_bf16 v[112:115], v[176:179], a[40:43], v[112:115]
  ds_read_b64_tr_b16 v[172:173], v39 offset:16384
  v_mfma_f32_16x16x32_bf16 v[116:119], v[176:179], a[44:47], v[116:119]
  ds_read_b64_tr_b16 v[174:175], v39 offset:16896
  v_mfma_f32_16x16x32_bf16 v[120:123], v[180:183], a[40:43], v[120:123]
  ds_read_b64_tr_b16 v[176:177], v36 offset:20480
  buffer_load_dwordx4 a[132:135], v30, s[20:23], s90 offen offset:256 sc1
  v_mfma_f32_16x16x32_bf16 v[124:127], v[180:183], a[44:47], v[124:127]
  ds_read_b64_tr_b16 v[178:179], v36 offset:20992
  s_waitcnt lgkmcnt(10)
  v_mfma_f32_16x16x32_bf16 v[128:131], v[184:187], a[40:43], v[128:131]
  ds_read_b64_tr_b16 v[180:181], v37 offset:20480
  s_add_u32 m0, s89, 32768
  v_mfma_f32_16x16x32_bf16 v[132:135], v[184:187], a[44:47], v[132:135]
  ds_read_b64_tr_b16 v[182:183], v37 offset:20992
  buffer_load_dword v25, v24, s[20:23], s94 offen sc1
  v_mfma_f32_16x16x32_bf16 v[136:139], v[188:191], a[40:43], v[136:139]
  ds_read_b64_tr_b16 v[184:185], v38 offset:20480
  buffer_load_dwordx4 v32, s[28:31], s87 offen offset:0 lds
  v_mfma_f32_16x16x32_bf16 v[140:143], v[188:191], a[44:47], v[140:143]
  ds_read_b64_tr_b16 v[186:187], v38 offset:20992
  s_waitcnt lgkmcnt(10)
  v_mfma_f32_16x16x32_bf16 v[112:115], v[160:163], a[48:51], v[112:115]
  ds_read_b64_tr_b16 v[188:189], v39 offset:20480
  v_mfma_f32_16x16x32_bf16 v[116:119], v[160:163], a[52:55], v[116:119]
  ds_read_b64_tr_b16 v[190:191], v39 offset:20992
  v_mfma_f32_16x16x32_bf16 v[120:123], v[164:167], a[48:51], v[120:123]
  ds_read_b64_tr_b16 v[160:161], v36 offset:24576
  buffer_load_dwordx4 v33, s[28:31], s87 offen offset:1024 lds
  v_mfma_f32_16x16x32_bf16 v[124:127], v[164:167], a[52:55], v[124:127]
  ds_read_b64_tr_b16 v[162:163], v36 offset:25088
  s_waitcnt lgkmcnt(10)
  v_mfma_f32_16x16x32_bf16 v[128:131], v[168:171], a[48:51], v[128:131]
  ds_read_b64_tr_b16 v[164:165], v37 offset:24576
  v_mfma_f32_16x16x32_bf16 v[132:135], v[168:171], a[52:55], v[132:135]
  ds_read_b64_tr_b16 v[166:167], v37 offset:25088
  v_mfma_f32_16x16x32_bf16 v[136:139], v[172:175], a[48:51], v[136:139]
  ds_read_b64_tr_b16 v[168:169], v38 offset:24576
  buffer_load_dwordx4 v34, s[28:31], s87 offen offset:2048 lds
  v_mfma_f32_16x16x32_bf16 v[140:143], v[172:175], a[52:55], v[140:143]
  ds_read_b64_tr_b16 v[170:171], v38 offset:25088
  s_waitcnt lgkmcnt(10)
  v_mfma_f32_16x16x32_bf16 v[112:115], v[176:179], a[56:59], v[112:115]
  ds_read_b64_tr_b16 v[172:173], v39 offset:24576
  buffer_load_dwordx4 v35, s[28:31], s87 offen offset:3072 lds
  v_mfma_f32_16x16x32_bf16 v[116:119], v[176:179], a[60:63], v[116:119]
  ds_read_b64_tr_b16 v[174:175], v39 offset:25088
  s_add_u32 m0, s89, 36864
  v_mfma_f32_16x16x32_bf16 v[120:123], v[180:183], a[56:59], v[120:123]
  ds_read_b64_tr_b16 v[176:177], v36 offset:28672
  v_mfma_f32_16x16x32_bf16 v[124:127], v[180:183], a[60:63], v[124:127]
  ds_read_b64_tr_b16 v[178:179], v36 offset:29184
  s_waitcnt lgkmcnt(10)
  v_mfma_f32_16x16x32_bf16 v[128:131], v[184:187], a[56:59], v[128:131]
  ds_read_b64_tr_b16 v[180:181], v37 offset:28672
  v_add_u32 v36, 4294836224, v36
  v_mfma_f32_16x16x32_bf16 v[132:135], v[184:187], a[60:63], v[132:135]
  ds_read_b64_tr_b16 v[182:183], v37 offset:29184
  buffer_load_dwordx4 v32, s[28:31], s88 offen offset:0 lds
  v_mfma_f32_16x16x32_bf16 v[136:139], v[188:191], a[56:59], v[136:139]
  ds_read_b64_tr_b16 v[184:185], v38 offset:28672
  v_add_u32 v37, 4294836224, v37
  v_mfma_f32_16x16x32_bf16 v[140:143], v[188:191], a[60:63], v[140:143]
  ds_read_b64_tr_b16 v[186:187], v38 offset:29184
  s_waitcnt lgkmcnt(10)
  v_mfma_f32_16x16x32_bf16 v[112:115], v[160:163], a[64:67], v[112:115]
  ds_read_b64_tr_b16 v[188:189], v39 offset:28672
  buffer_load_dwordx4 v33, s[28:31], s88 offen offset:1024 lds
  v_add_u32 v38, 4294836224, v38
  v_mfma_f32_16x16x32_bf16 v[116:119], v[160:163], a[68:71], v[116:119]
  ds_read_b64_tr_b16 v[190:191], v39 offset:29184
  buffer_load_dwordx4 v34, s[28:31], s88 offen offset:2048 lds
  v_add_u32 v39, 4294836224, v39
  v_mfma_f32_16x16x32_bf16 v[120:123], v[164:167], a[64:67], v[120:123]
  buffer_load_dwordx4 v35, s[28:31], s88 offen offset:3072 lds
  s_add_u32 s87, s87, 524288
  s_and_b32 s87, s87, 0x1fffff
  v_mfma_f32_16x16x32_bf16 v[124:127], v[164:167], a[68:71], v[124:127]
  s_waitcnt lgkmcnt(8)
  s_add_u32 s88, s87, 65536
  v_mfma_f32_16x16x32_bf16 v[128:131], v[168:171], a[64:67], v[128:131]
  buffer_load_dwordx4 a[136:139], v30, s[20:23], s90 offen offset:2048 sc1
  buffer_load_dwordx4 a[140:143], v30, s[20:23], s90 offen offset:2304 sc1
  s_add_u32 s63, s63, 4096
  v_mfma_f32_16x16x32_bf16 v[132:135], v[168:171], a[68:71], v[132:135]
  s_and_b32 s63, s63, 0xffff
  s_add_u32 s90, s96, s63
  s_waitcnt vmcnt(27) lgkmcnt(0)
  s_barrier
  v_mfma_f32_16x16x32_bf16 v[136:139], v[172:175], a[64:67], v[136:139]
  ds_read_b64_tr_b16 v[160:161], v36 offset:0
  ds_read_b64_tr_b16 v[162:163], v36 offset:512
  buffer_load_dwordx4 a[144:147], v30, s[20:23], s90 offen offset:0 sc1
  v_mfma_f32_16x16x32_bf16 v[140:143], v[172:175], a[68:71], v[140:143]
  ds_read_b64_tr_b16 v[164:165], v37 offset:0
  ds_read_b64_tr_b16 v[166:167], v37 offset:512
  s_waitcnt vmcnt(27)
  v_mfma_f32_16x16x32_bf16 v[112:115], v[176:179], a[72:75], v[112:115]
  ds_read_b64_tr_b16 v[168:169], v38 offset:0
  ds_read_b64_tr_b16 v[170:171], v38 offset:512
  buffer_load_dwordx4 a[148:151], v30, s[20:23], s90 offen offset:256 sc1
  s_waitcnt vmcnt(27)
  v_mfma_f32_16x16x32_bf16 v[116:119], v[176:179], a[76:79], v[116:119]
  ds_read_b64_tr_b16 v[172:173], v39 offset:0
  ds_read_b64_tr_b16 v[174:175], v39 offset:512
  v_mfma_f32_16x16x32_bf16 v[120:123], v[180:183], a[72:75], v[120:123]
  ds_read_b64_tr_b16 v[176:177], v36 offset:4096
  buffer_load_dwordx4 a[152:155], v30, s[20:23], s90 offen offset:2048 sc1
  v_mfma_f32_16x16x32_bf16 v[124:127], v[180:183], a[76:79], v[124:127]
  ds_read_b64_tr_b16 v[178:179], v36 offset:4608
  v_mfma_f32_16x16x32_bf16 v[128:131], v[184:187], a[72:75], v[128:131]
  ds_read_b64_tr_b16 v[180:181], v37 offset:4096
  buffer_load_dwordx4 a[156:159], v30, s[20:23], s90 offen offset:2304 sc1
  s_add_u32 s63, s63, 4096
  v_mfma_f32_16x16x32_bf16 v[132:135], v[184:187], a[76:79], v[132:135]
  ds_read_b64_tr_b16 v[182:183], v37 offset:4608
  s_and_b32 s63, s63, 0xffff
  v_mfma_f32_16x16x32_bf16 v[136:139], v[188:191], a[72:75], v[136:139]
  ds_read_b64_tr_b16 v[184:185], v38 offset:4096
  s_add_u32 s90, s96, s63
  v_mfma_f32_16x16x32_bf16 v[140:143], v[188:191], a[76:79], v[140:143]
  ds_read_b64_tr_b16 v[186:187], v38 offset:4608
  s_waitcnt lgkmcnt(10)
  s_waitcnt vmcnt(28)
  v_mfma_f32_16x16x32_bf16 v[112:115], v[160:163], a[80:83], v[112:115]
  ds_read_b64_tr_b16 v[188:189], v39 offset:4096
  buffer_load_dwordx4 a[160:163], v30, s[20:23], s90 offen offset:0 sc1
  s_waitcnt vmcnt(28)
  v_mfma_f32_16x16x32_bf16 v[116:119], v[160:163], a[84:87], v[116:119]
  ds_read_b64_tr_b16 v[190:191], v39 offset:4608
  buffer_load_dwordx4 a[164:167], v30, s[20:23], s90 offen offset:256 sc1
  v_mfma_f32_16x16x32_bf16 v[120:123], v[164:167], a[80:83], v[120:123]
  ds_read_b64_tr_b16 v[160:161], v36 offset:8192
  buffer_load_dwordx4 a[168:171], v30, s[20:23], s90 offen offset:2048 sc1
  v_mfma_f32_16x16x32_bf16 v[124:127], v[164:167], a[84:87], v[124:127]
  ds_read_b64_tr_b16 v[162:163], v36 offset:8704
  s_waitcnt lgkmcnt(10)
  v_mfma_f32_16x16x32_bf16 v[128:131], v[168:171], a[80:83], v[128:131]
  ds_read_b64_tr_b16 v[164:165], v37 offset:8192
  buffer_load_dwordx4 a[172:175], v30, s[20:23], s90 offen offset:2304 sc1
  s_add_u32 s63, s63, 4096
  v_mfma_f32_16x16x32_bf16 v[132:135], v[168:171], a[84:87], v[132:135]
  ds_read_b64_tr_b16 v[166:167], v37 offset:8704
  s_and_b32 s63, s63, 0xffff
  v_mfma_f32_16x16x32_bf16 v[136:139], v[172:175], a[80:83], v[136:139]
  ds_read_b64_tr_b16 v[168:169], v38 offset:8192
  s_add_u32 s90, s96, s63
  v_mfma_f32_16x16x32_bf16 v[140:143], v[172:175], a[84:87], v[140:143]
  ds_read_b64_tr_b16 v[170:171], v38 offset:8704
  s_waitcnt lgkmcnt(10)
  s_waitcnt vmcnt(30)
  v_mfma_f32_16x16x32_bf16 v[112:115], v[176:179], a[88:91], v[112:115]
  ds_read_b64_tr_b16 v[172:173], v39 offset:8192
  buffer_load_dwordx4 a[176:179], v30, s[20:23], s90 offen offset:0 sc1
  s_waitcnt vmcnt(30)
  v_mfma_f32_16x16x32_bf16 v[116:119], v[176:179], a[92:95], v[116:119]
  ds_read_b64_tr_b16 v[174:175], v39 offset:8704
  buffer_load_dwordx4 a[180:183], v30, s[20:23], s90 offen offset:256 sc1
  v_mfma_f32_16x16x32_bf16 v[120:123], v[180:183], a[88:91], v[120:123]
  ds_read_b64_tr_b16 v[176:177], v36 offset:12288
  buffer_load_dwordx4 a[184:187], v30, s[20:23], s90 offen offset:2048 sc1
  v_mfma_f32_16x16x32_bf16 v[124:127], v[180:183], a[92:95], v[124:127]
  ds_read_b64_tr_b16 v[178:179], v36 offset:12800
  s_waitcnt lgkmcnt(10)
  v_mfma_f32_16x16x32_bf16 v[128:131], v[184:187], a[88:91], v[128:131]
  ds_read_b64_tr_b16 v[180:181], v37 offset:12288
  buffer_load_dwordx4 a[188:191], v30, s[20:23], s90 offen offset:2304 sc1
  s_add_u32 s63, s63, 4096
  v_mfma_f32_16x16x32_bf16 v[132:135], v[184:187], a[92:95], v[132:135]
  ds_read_b64_tr_b16 v[182:183], v37 offset:12800
  s_and_b32 s63, s63, 0xffff
  v_mfma_f32_16x16x32_bf16 v[136:139], v[188:191], a[88:91], v[136:139]
  ds_read_b64_tr_b16 v[184:185], v38 offset:12288
  s_add_u32 s90, s96, s63
  v_mfma_f32_16x16x32_bf16 v[140:143], v[188:191], a[92:95], v[140:143]
  ds_read_b64_tr_b16 v[186:187], v38 offset:12800
  s_waitcnt lgkmcnt(10)
  s_waitcnt vmcnt(32)
  v_mfma_f32_16x16x32_bf16 v[112:115], v[160:163], a[96:99], v[112:115]
  ds_read_b64_tr_b16 v[188:189], v39 offset:12288
  buffer_load_dwordx4 a[192:195], v30, s[20:23], s90 offen offset:0 sc1
  s_waitcnt vmcnt(32)
  v_mfma_f32_16x16x32_bf16 v[116:119], v[160:163], a[100:103], v[116:119]
  ds_read_b64_tr_b16 v[190:191], v39 offset:12800
  buffer_load_dwordx4 a[196:199], v30, s[20:23], s90 offen offset:256 sc1
  v_mfma_f32_16x16x32_bf16 v[120:123], v[164:167], a[96:99], v[120:123]
  ds_read_b64_tr_b16 v[160:161], v36 offset:16384
  buffer_load_dwordx4 a[200:203], v30, s[20:23], s90 offen offset:2048 sc1
  v_mfma_f32_16x16x32_bf16 v[124:127], v[164:167], a[100:103], v[124:127]
  ds_read_b64_tr_b16 v[162:163], v36 offset:16896
  s_waitcnt lgkmcnt(10)
  v_mfma_f32_16x16x32_bf16 v[128:131], v[168:171], a[96:99], v[128:131]
  ds_read_b64_tr_b16 v[164:165], v37 offset:16384
  buffer_load_dwordx4 a[204:207], v30, s[20:23], s90 offen offset:2304 sc1
  s_add_u32 s63, s63, 4096
  v_mfma_f32_16x16x32_bf16 v[132:135], v[168:171], a[100:103], v[132:135]
  ds_read_b64_tr_b16 v[166:167], v37 offset:16896
  s_and_b32 s63, s63, 0xffff
  v_mfma_f32_16x16x32_bf16 v[136:139], v[172:175], a[96:99], v[136:139]
  ds_read_b64_tr_b16 v[168:169], v38 offset:16384
  s_add_u32 s90, s96, s63
  v_mfma_f32_16x16x32_bf16 v[140:143], v[172:175], a[100:103], v[140:143]
  ds_read_b64_tr_b16 v[170:171], v38 offset:16896
  s_waitcnt lgkmcnt(10)
  s_waitcnt vmcnt(26)
  v_cmp_gt_u32 vcc, 15, v25
  s_nop 0
  s_cbranch_vccnz L_retry4
L_cont4:
  v_mfma_f32_16x16x32_bf16 v[112:115], v[176:179], a[104:107], v[112:115]
  ds_read_b64_tr_b16 v[172:173], v39 offset:16384
  buffer_load_dwordx4 v[144:147], v4, s[20:23], s93 offen offset:0 sc1
  v_mfma_f32_16x16x32_bf16 v[116:119], v[176:179], a[108:111], v[116:119]
  ds_read_b64_tr_b16 v[174:175], v39 offset:16896
  v_mfma_f32_16x16x32_bf16 v[120:123], v[180:183], a[104:107], v[120:123]
  ds_read_b64_tr_b16 v[176:177], v36 offset:20480
  buffer_load_dwordx4 v[148:151], v4, s[20:23], s93 offen offset:1024 sc1
  v_mfma_f32_16x16x32_bf16 v[124:127], v[180:183], a[108:111], v[124:127]
  ds_read_b64_tr_b16 v[178:179], v36 offset:20992
  s_waitcnt lgkmcnt(10)
  v_mfma_f32_16x16x32_bf16 v[128:131], v[184:187], a[104:107], v[128:131]
  ds_read_b64_tr_b16 v[180:181], v37 offset:20480
  buffer_load_dwordx4 v[152:155], v4, s[20:23], s93 offen offset:2048 sc1
  v_mfma_f32_16x16x32_bf16 v[132:135], v[184:187], a[108:111], v[132:135]
  ds_read_b64_tr_b16 v[182:183], v37 offset:20992
  v_mfma_f32_16x16x32_bf16 v[136:139], v[188:191], a[104:107], v[136:139]
  ds_read_b64_tr_b16 v[184:185], v38 offset:20480
  buffer_load_dwordx4 v[156:159], v4, s[20:23], s93 offen offset:3072 sc1
  v_mfma_f32_16x16x32_bf16 v[140:143], v[188:191], a[108:111], v[140:143]
  ds_read_b64_tr_b16 v[186:187], v38 offset:20992
  s_waitcnt lgkmcnt(10)
  v_mfma_f32_16x16x32_bf16 v[112:115], v[160:163], a[112:115], v[112:115]
  ds_read_b64_tr_b16 v[188:189], v39 offset:20480
  v_mfma_f32_16x16x32_bf16 v[116:119], v[160:163], a[116:119], v[116:119]
  ds_read_b64_tr_b16 v[190:191], v39 offset:20992
  v_mfma_f32_16x16x32_bf16 v[120:123], v[164:167], a[112:115], v[120:123]
  ds_read_b64_tr_b16 v[160:161], v36 offset:24576
  v_mfma_f32_16x16x32_bf16 v[124:127], v[164:167], a[116:119], v[124:127]
  ds_read_b64_tr_b16 v[162:163], v36 offset:25088
  s_waitcnt lgkmcnt(10)
  v_mfma_f32_16x16x32_bf16 v[128:131], v[168:171], a[112:115], v[128:131]
  ds_read_b64_tr_b16 v[164:165], v37 offset:24576
  v_mfma_f32_16x16x32_bf16 v[132:135], v[168:171], a[116:119], v[132:135]
  ds_read_b64_tr_b16 v[166:167], v37 offset:25088
  v_mfma_f32_16x16x32_bf16 v[136:139], v[172:175], a[112:115], v[136:139]
  ds_read_b64_tr_b16 v[168:169], v38 offset:24576
  v_mfma_f32_16x16x32_bf16 v[140:143], v[172:175], a[116:119], v[140:143]
  ds_read_b64_tr_b16 v[170:171], v38 offset:25088
  s_waitcnt lgkmcnt(10)
  v_mfma_f32_16x16x32_bf16 v[112:115], v[176:179], a[120:123], v[112:115]
  ds_read_b64_tr_b16 v[172:173], v39 offset:24576
  v_mfma_f32_16x16x32_bf16 v[116:119], v[176:179], a[124:127], v[116:119]
  ds_read_b64_tr_b16 v[174:175], v39 offset:25088
  v_mfma_f32_16x16x32_bf16 v[120:123], v[180:183], a[120:123], v[120:123]
  ds_read_b64_tr_b16 v[176:177], v36 offset:28672
  v_mfma_f32_16x16x32_bf16 v[124:127], v[180:183], a[124:127], v[124:127]
  ds_read_b64_tr_b16 v[178:179], v36 offset:29184
  s_waitcnt lgkmcnt(10)
  v_mfma_f32_16x16x32_bf16 v[128:131], v[184:187], a[120:123], v[128:131]
  ds_read_b64_tr_b16 v[180:181], v37 offset:28672
  v_add_u32 v36, 32768, v36
  v_mfma_f32_16x16x32_bf16 v[132:135], v[184:187], a[124:127], v[132:135]
  ds_read_b64_tr_b16 v[182:183], v37 offset:29184
  v_add_u32 v37, 32768, v37
  v_mfma_f32_16x16x32_bf16 v[136:139], v[188:191], a[120:123], v[136:139]
  ds_read_b64_tr_b16 v[184:185], v38 offset:28672
  v_mfma_f32_16x16x32_bf16 v[140:143], v[188:191], a[124:127], v[140:143]
  ds_read_b64_tr_b16 v[186:187], v38 offset:29184
  s_waitcnt lgkmcnt(10)
  v_mfma_f32_16x16x32_bf16 v[112:115], v[160:163], a[128:131], v[112:115]
  ds_read_b64_tr_b16 v[188:189], v39 offset:28672
  v_add_u32 v38, 32768, v38
  v_mfma_f32_16x16x32_bf16 v[116:119], v[160:163], a[132:135], v[116:119]
  ds_read_b64_tr_b16 v[190:191], v39 offset:29184
  v_add_u32 v39, 32768, v39
  v_mfma_f32_16x16x32_bf16 v[120:123], v[164:167], a[128:131], v[120:123]
  v_mfma_f32_16x16x32_bf16 v[124:127], v[164:167], a[132:135], v[124:127]
  s_waitcnt lgkmcnt(8)
  v_mfma_f32_16x16x32_bf16 v[128:131], v[168:171], a[128:131], v[128:131]
  v_mfma_f32_16x16x32_bf16 v[132:135], v[168:171], a[132:135], v[132:135]
  s_waitcnt vmcnt(22) lgkmcnt(0)
  s_barrier
  v_mfma_f32_16x16x32_bf16 v[136:139], v[172:175], a[128:131], v[136:139]
  ds_read_b64_tr_b16 v[160:161], v36 offset:0
L_touch13:
  s_cbranch_execz L_tback
  ds_read_b64_tr_b16 v[162:163], v36 offset:512
  v_mfma_f32_16x16x32_bf16 v[140:143], v[172:175], a[132:135], v[140:143]
  ds_read_b64_tr_b16 v[164:165], v37 offset:0
  ds_read_b64_tr_b16 v[166:167], v37 offset:512
  s_waitcnt vmcnt(21)
  v_mfma_f32_16x16x32_bf16 v[112:115], v[176:179], a[136:139], v[112:115]
  ds_read_b64_tr_b16 v[168:169], v36 offset:4096
  ds_read_b64_tr_b16 v[170:171], v36 offset:4608
  s_waitcnt vmcnt(20)
  v_mfma_f32_16x16x32_bf16 v[116:119], v[176:179], a[140:143], v[116:119]
  ds_read_b64_tr_b16 v[172:173], v37 offset:4096
  ds_read_b64_tr_b16 v[174:175], v37 offset:4608
  v_mfma_f32_16x16x32_bf16 v[120:123], v[180:183], a[136:139], v[120:123]
  ds_read_b64_tr_b16 v[176:177], v36 offset:8192
  v_mfma_f32_16x16x32_bf16 v[124:127], v[180:183], a[140:143], v[124:127]
  ds_read_b64_tr_b16 v[178:179], v36 offset:8704
  v_mfma_f32_16x16x32_bf16 v[128:131], v[184:187], a[136:139], v[128:131]
  ds_read_b64_tr_b16 v[180:181], v37 offset:8192
  v_mfma_f32_16x16x32_bf16 v[132:135], v[184:187], a[140:143], v[132:135]
  ds_read_b64_tr_b16 v[182:183], v37 offset:8704
  v_mfma_f32_16x16x32_bf16 v[136:139], v[188:191], a[136:139], v[136:139]
  ds_read_b64_tr_b16 v[184:185], v36 offset:12288
  v_mfma_f32_16x16x32_bf16 v[140:143], v[188:191], a[140:143], v[140:143]
  ds_read_b64_tr_b16 v[186:187], v36 offset:12800
  s_waitcnt lgkmcnt(10)
  s_waitcnt vmcnt(19)
  v_mfma_f32_16x16x32_bf16 v[112:115], v[160:163], a[144:147], v[112:115]
  ds_read_b64_tr_b16 v[188:189], v37 offset:12288
  s_waitcnt vmcnt(18)
  v_mfma_f32_16x16x32_bf16 v[116:119], v[160:163], a[148:151], v[116:119]
  ds_read_b64_tr_b16 v[190:191], v37 offset:12800
  v_mfma_f32_16x16x32_bf16 v[120:123], v[164:167], a[144:147], v[120:123]
  ds_read_b64_tr_b16 v[160:161], v36 offset:16384
  v_mfma_f32_16x16x32_bf16 v[124:127], v[164:167], a[148:151], v[124:127]
  ds_read_b64_tr_b16 v[162:163], v36 offset:16896
  s_waitcnt lgkmcnt(10)
  s_waitcnt vmcnt(17)
  v_mfma_f32_16x16x32_bf16 v[112:115], v[168:171], a[152:155], v[112:115]
  ds_read_b64_tr_b16 v[164:165], v37 offset:16384
  s_waitcnt vmcnt(16)
  v_mfma_f32_16x16x32_bf16 v[116:119], v[168:171], a[156:159], v[116:119]
  ds_read_b64_tr_b16 v[166:167], v37 offset:16896
  v_mfma_f32_16x16x32_bf16 v[120:123], v[172:175], a[152:155], v[120:123]
  ds_read_b64_tr_b16 v[168:169], v36 offset:20480
  v_mfma_f32_16x16x32_bf16 v[124:127], v[172:175], a[156:159], v[124:127]
  ds_read_b64_tr_b16 v[170:171], v36 offset:20992
  s_waitcnt lgkmcnt(10)
  s_waitcnt vmcnt(15)
  v_mfma_f32_16x16x32_bf16 v[112:115], v[176:179], a[160:163], v[112:115]
  ds_read_b64_tr_b16 v[172:173], v37 offset:20480
  s_waitcnt vmcnt(14)
  v_mfma_f32_16x16x32_bf16 v[116:119], v[176:179], a[164:167], v[116:119]
  ds_read_b64_tr_b16 v[174:175], v37 offset:20992
  v_mfma_f32_16x16x32_bf16 v[120:123], v[180:183], a[160:163], v[120:123]
  ds_read_b64_tr_b16 v[176:177], v36 offset:24576
  v_mfma_f32_16x16x32_bf16 v[124:127], v[180:183], a[164:167], v[124:127]
  ds_read_b64_tr_b16 v[178:179], v36 offset:25088
  s_waitcnt lgkmcnt(10)
  s_waitcnt vmcnt(13)
  v_mfma_f32_16x16x32_bf16 v[112:115], v[184:187], a[168:171], v[112:115]
  ds_read_b64_tr_b16 v[180:181], v37 offset:24576
  s_waitcnt vmcnt(12)
  v_mfma_f32_16x16x32_bf16 v[116:119], v[184:187], a[172:175], v[116:119]
  ds_read_b64_tr_b16 v[182:183], v37 offset:25088
  v_mfma_f32_16x16x32_bf16 v[120:123], v[188:191], a[168:171], v[120:123]
  ds_read_b64_tr_b16 v[184:185], v36 offset:28672
  v_mfma_f32_16x16x32_bf16 v[124:127], v[188:191], a[172:175], v[124:127]
  ds_read_b64_tr_b16 v[186:187], v36 offset:29184
  s_waitcnt lgkmcnt(10)
  s_waitcnt vmcnt(11)
  v_mfma_f32_16x16x32_bf16 v[112:115], v[160:163], a[176:179], v[112:115]
  ds_read_b64_tr_b16 v[188:189], v37 offset:28672
  s_waitcnt vmcnt(10)
  v_mfma_f32_16x16x32_bf16 v[116:119], v[160:163], a[180:183], v[116:119]
  ds_read_b64_tr_b16 v[190:191], v37 offset:29184
  v_mfma_f32_16x16x32_bf16 v[120:123], v[164:167], a[176:179], v[120:123]
  ds_read_b64_tr_b16 v[160:161], v38 offset:0
  v_mfma_f32_16x16x32_bf16 v[124:127], v[164:167], a[180:183], v[124:127]
  ds_read_b64_tr_b16 v[162:163], v38 offset:512
  s_waitcnt lgkmcnt(10)
  s_waitcnt vmcnt(9)
  v_mfma_f32_16x16x32_bf16 v[112:115], v[168:171], a[184:187], v[112:115]
  ds_read_b64_tr_b16 v[164:165], v39 offset:0
  s_waitcnt vmcnt(8)
  v_mfma_f32_16x16x32_bf16 v[116:119], v[168:171], a[188:191], v[116:119]
  ds_read_b64_tr_b16 v[166:167], v39 offset:512
  v_mfma_f32_16x16x32_bf16 v[120:123], v[172:175], a[184:187], v[120:123]
  ds_read_b64_tr_b16 v[168:169], v38 offset:4096
  v_mfma_f32_16x16x32_bf16 v[124:127], v[172:175], a[188:191], v[124:127]
  ds_read_b64_tr_b16 v[170:171], v38 offset:4608
  s_waitcnt lgkmcnt(10)
  s_waitcnt vmcnt(7)
  v_mfma_f32_16x16x32_bf16 v[112:115], v[176:179], a[192:195], v[112:115]
  ds_read_b64_tr_b16 v[172:173], v39 offset:4096
  s_waitcnt vmcnt(6)
  v_mfma_f32_16x16x32_bf16 v[116:119], v[176:179], a[196:199], v[116:119]
  ds_read_b64_tr_b16 v[174:175], v39 offset:4608
  v_mfma_f32_16x16x32_bf16 v[120:123], v[180:183], a[192:195], v[120:123]
  ds_read_b64_tr_b16 v[176:177], v38 offset:8192
  v_mfma_f32_16x16x32_bf16 v[124:127], v[180:183], a[196:199], v[124:127]
  ds_read_b64_tr_b16 v[178:179], v38 offset:8704
  s_waitcnt lgkmcnt(10)
  s_waitcnt vmcnt(5)
  v_mfma_f32_16x16x32_bf16 v[112:115], v[184:187], a[200:203], v[112:115]
  ds_read_b64_tr_b16 v[180:181], v39 offset:8192
  s_waitcnt vmcnt(4)
  v_mfma_f32_16x16x32_bf16 v[116:119], v[184:187], a[204:207], v[116:119]
  ds_read_b64_tr_b16 v[182:183], v39 offset:8704
  v_mfma_f32_16x16x32_bf16 v[120:123], v[188:191], a[200:203], v[120:123]
  ds_read_b64_tr_b16 v[184:185], v38 offset:12288
  v_mfma_f32_16x16x32_bf16 v[124:127], v[188:191], a[204:207], v[124:127]
  ds_read_b64_tr_b16 v[186:187], v38 offset:12800
  s_waitcnt lgkmcnt(10)
  v_mfma_f32_16x16x32_bf16 v[128:131], v[160:163], a[144:147], v[128:131]
  ds_read_b64_tr_b16 v[188:189], v39 offset:12288
  s_waitcnt vmcnt(3)
  v_dot2_f32_bf16 v80, v144, v40, v80
  v_mfma_f32_16x16x32_bf16 v[132:135], v[160:163], a[148:151], v[132:135]
  ds_read_b64_tr_b16 v[190:191], v39 offset:12800
  v_dot2_f32_bf16 v81, v144, v41, v81
  v_mfma_f32_16x16x32_bf16 v[136:139], v[164:167], a[144:147], v[136:139]
  ds_read_b64_tr_b16 v[160:161], v38 offset:16384
  v_dot2_f32_bf16 v82, v145, v40, v82
  v_mfma_f32_16x16x32_bf16 v[140:143], v[164:167], a[148:151], v[140:143]
  ds_read_b64_tr_b16 v[162:163], v38 offset:16896
  s_waitcnt lgkmcnt(10)
  v_mfma_f32_16x16x32_bf16 v[128:131], v[168:171], a[152:155], v[128:131]
  ds_read_b64_tr_b16 v[164:165], v39 offset:16384
  v_dot2_f32_bf16 v83, v145, v41, v83
  v_mfma_f32_16x16x32_bf16 v[132:135], v[168:171], a[156:159], v[132:135]
  ds_read_b64_tr_b16 v[166:167], v39 offset:16896
  v_dot2_f32_bf16 v84, v146, v42, v84
  v_mfma_f32_16x16x32_bf16 v[136:139], v[172:175], a[152:155], v[136:139]
  ds_read_b64_tr_b16 v[168:169], v38 offset:20480
  v_dot2_f32_bf16 v85, v146, v43, v85
  v_mfma_f32_16x16x32_bf16 v[140:143], v[172:175], a[156:159], v[140:143]
  ds_read_b64_tr_b16 v[170:171], v38 offset:20992
  s_waitcnt lgkmcnt(10)
  v_mfma_f32_16x16x32_bf16 v[128:131], v[176:179], a[160:163], v[128:131]
  ds_read_b64_tr_b16 v[172:173], v39 offset:20480
  v_dot2_f32_bf16 v86, v147, v42, v86
  v_dot2_f32_bf16 v87, v147, v43, v87
  v_mfma_f32_16x16x32_bf16 v[132:135], v[176:179], a[164:167], v[132:135]
  ds_read_b64_tr_b16 v[174:175], v39 offset:20992
  s_waitcnt vmcnt(2)
  v_dot2_f32_bf16 v88, v148, v40, v88
  v_mfma_f32_16x16x32_bf16 v[136:139], v[180:183], a[160:163], v[136:139]
  ds_read_b64_tr_b16 v[176:177], v38 offset:24576
  v_dot2_f32_bf16 v89, v148, v41, v89
  v_mfma_f32_16x16x32_bf16 v[140:143], v[180:183], a[164:167], v[140:143]
  ds_read_b64_tr_b16 v[178:179], v38 offset:25088
  s_waitcnt lgkmcnt(10)
  v_mfma_f32_16x16x32_bf16 v[128:131], v[184:187], a[168:171], v[128:131]
  ds_read_b64_tr_b16 v[180:181], v39 offset:24576
  v_dot2_f32_bf16 v90, v149, v40, v90
  v_dot2_f32_bf16 v91, v149, v41, v91
  v_mfma_f32_16x16x32_bf16 v[132:135], v[184:187], a[172:175], v[132:135]
  ds_read_b64_tr_b16 v[182:183], v39 offset:25088
  v_dot2_f32_bf16 v92, v150, v42, v92
  v_mfma_f32_16x16x32_bf16 v[136:139], v[188:191], a[168:171], v[136:139]
  ds_read_b64_tr_b16 v[184:185], v38 offset:28672
  v_dot2_f32_bf16 v93, v150, v43, v93
  v_mfma_f32_16x16x32_bf16 v[140:143], v[188:191], a[172:175], v[140:143]
  ds_read_b64_tr_b16 v[186:187], v38 offset:29184
  s_waitcnt lgkmcnt(10)
  v_mfma_f32_16x16x32_bf16 v[128:131], v[160:163], a[176:179], v[128:131]
  ds_read_b64_tr_b16 v[188:189], v39 offset:28672
  v_dot2_f32_bf16 v94, v151, v42, v94
  v_dot2_f32_bf16 v95, v151, v43, v95
  v_mfma_f32_16x16x32_bf16 v[132:135], v[160:163], a[180:183], v[132:135]
  ds_read_b64_tr_b16 v[190:191], v39 offset:29184
  s_waitcnt vmcnt(1)
  v_dot2_f32_bf16 v96, v152, v40, v96
  v_mfma_f32_16x16x32_bf16 v[136:139], v[164:167], a[176:179], v[136:139]
  v_dot2_f32_bf16 v97, v152, v41, v97
  v_dot2_f32_bf16 v98, v153, v40, v98
  v_dot2_f32_bf16 v99, v153, v41, v99
  v_mfma_f32_16x16x32_bf16 v[140:143], v[164:167], a[180:183], v[140:143]
  s_waitcnt lgkmcnt(8)
  v_fma_f32 v80, v112, v6, v80
  v_mfma_f32_16x16x32_bf16 v[128:131], v[168:171], a[184:187], v[128:131]
  v_fma_f32 v81, v113, v6, v81
  v_fma_f32 v82, v114, v6, v82
  v_fma_f32 v83, v115, v6, v83
  v_mfma_f32_16x16x32_bf16 v[132:135], v[168:171], a[188:191], v[132:135]
  v_cvt_pk_bf16_f32 v48, v80, v81
  v_cvt_pk_bf16_f32 v49, v82, v83
  v_mfma_f32_16x16x32_bf16 v[136:139], v[172:175], a[184:187], v[136:139]
  v_fma_f32 v88, v120, v6, v88
  v_fma_f32 v89, v121, v6, v89
  v_fma_f32 v90, v122, v6, v90
  v_mfma_f32_16x16x32_bf16 v[140:143], v[172:175], a[188:191], v[140:143]
  s_waitcnt lgkmcnt(4)
  v_fma_f32 v91, v123, v6, v91
  v_mfma_f32_16x16x32_bf16 v[128:131], v[176:179], a[192:195], v[128:131]
  v_cvt_pk_bf16_f32 v50, v88, v89
  v_cvt_pk_bf16_f32 v51, v90, v91
  v_fma_f32 v84, v116, v31, v84
  v_mfma_f32_16x16x32_bf16 v[132:135], v[176:179], a[196:199], v[132:135]
  v_fma_f32 v85, v117, v31, v85
  v_mfma_f32_16x16x32_bf16 v[136:139], v[180:183], a[192:195], v[136:139]
  v_fma_f32 v86, v118, v31, v86
  v_fma_f32 v87, v119, v31, v87
  v_cvt_pk_bf16_f32 v52, v84, v85
  v_mfma_f32_16x16x32_bf16 v[140:143], v[180:183], a[196:199], v[140:143]
  s_waitcnt lgkmcnt(0)
  v_cvt_pk_bf16_f32 v53, v86, v87
  v_mfma_f32_16x16x32_bf16 v[128:131], v[184:187], a[200:203], v[128:131]
  v_fma_f32 v92, v124, v31, v92
  v_fma_f32 v93, v125, v31, v93
  v_fma_f32 v94, v126, v31, v94
  v_mfma_f32_16x16x32_bf16 v[132:135], v[184:187], a[204:207], v[132:135]
  v_fma_f32 v95, v127, v31, v95
  v_mfma_f32_16x16x32_bf16 v[136:139], v[188:191], a[200:203], v[136:139]
  v_cvt_pk_bf16_f32 v54, v92, v93
  v_cvt_pk_bf16_f32 v55, v94, v95
  v_permlane16_swap_b32 v48, v50
  v_mfma_f32_16x16x32_bf16 v[140:143], v[188:191], a[204:207], v[140:143]
  v_permlane16_swap_b32 v49, v51
  v_permlane16_swap_b32 v52, v54
  v_permlane16_swap_b32_e64 v53, v55
  buffer_store_dwordx4 v[48:51], v44, s[32:35], s73 offen offset:0
  buffer_store_dwordx4 v[52:55], v45, s[32:35], s73 offen offset:0
  v_dot2_f32_bf16 v100, v154, v42, v100
  v_dot2_f32_bf16 v101, v154, v43, v101
  v_dot2_f32_bf16 v102, v155, v42, v102
  v_dot2_f32_bf16 v103, v155, v43, v103
  s_nop 0
  s_waitcnt vmcnt(2)
  v_dot2_f32_bf16 v104, v156, v40, v104
  v_dot2_f32_bf16 v105, v156, v41, v105
  v_dot2_f32_bf16 v106, v157, v40, v106
  v_dot2_f32_bf16 v107, v157, v41, v107
  v_dot2_f32_bf16 v108, v158, v42, v108
  v_dot2_f32_bf16 v109, v158, v43, v109
  v_dot2_f32_bf16 v110, v159, v42, v110
  v_dot2_f32_bf16 v111, v159, v43, v111
  v_fma_f32 v96, v128, v6, v96
  v_fma_f32 v97, v129, v6, v97
  v_fma_f32 v98, v130, v6, v98
  v_fma_f32 v99, v131, v6, v99
  v_cvt_pk_bf16_f32 v56, v96, v97
  v_cvt_pk_bf16_f32 v57, v98, v99
  v_fma_f32 v104, v136, v6, v104
  v_fma_f32 v105, v137, v6, v105
  v_fma_f32 v106, v138, v6, v106
  v_fma_f32 v107, v139, v6, v107
  v_cvt_pk_bf16_f32 v58, v104, v105
  v_cvt_pk_bf16_f32 v59, v106, v107
  v_fma_f32 v100, v132, v31, v100
  v_fma_f32 v101, v133, v31, v101
  v_fma_f32 v102, v134, v31, v102
  v_fma_f32 v103, v135, v31, v103
  v_cvt_pk_bf16_f32 v60, v100, v101
  v_cvt_pk_bf16_f32 v61, v102, v103
  v_fma_f32 v108, v140, v31, v108
  v_fma_f32 v109, v141, v31, v109
  v_fma_f32 v110, v142, v31, v110
  v_fma_f32 v111, v143, v31, v111
  v_cvt_pk_bf16_f32 v62, v108, v109
  v_cvt_pk_bf16_f32 v63, v110, v111
  v_permlane16_swap_b32 v56, v58
  v_permlane16_swap_b32 v57, v59
  v_permlane16_swap_b32 v60, v62
  v_permlane16_swap_b32 v61, v63
  buffer_store_dwordx4 v[56:59], v44, s[32:35], s73 offen offset:64
  buffer_store_dwordx4 v[60:63], v45, s[32:35], s73 offen offset:64
  s_endpgm
L_s3b:
  s_cbranch_execz L_touch17
  ds_read_b64_tr_b16 v[160:161], v20 offset:0
  ds_read_b64_tr_b16 v[162:163], v20 offset:1024
  ds_read_b64_tr_b16 v[164:165], v21 offset:0
  ds_read_b64_tr_b16 v[166:167], v21 offset:1024
  ds_read_b64_tr_b16 v[168:169], v22 offset:0
  ds_read_b64_tr_b16 v[170:171], v22 offset:1024
  ds_read_b64_tr_b16 v[172:173], v23 offset:0
  ds_read_b64_tr_b16 v[174:175], v23 offset:1024
  ds_read_b64_tr_b16 v[176:177], v26 offset:0
  ds_read_b64_tr_b16 v[178:179], v26 offset:1024
  ds_read_b64_tr_b16 v[180:181], v27 offset:0
  ds_read_b64_tr_b16 v[182:183], v27 offset:1024
  ds_read_b64_tr_b16 v[184:185], v28 offset:0
  ds_read_b64_tr_b16 v[186:187], v28 offset:1024
  v_rcp_f32 v12, v192
  v_rcp_f32 v13, v196
  v_mul_f32 v112, v12, v112
  v_mul_f32 v113, v12, v113
  v_mul_f32 v114, v12, v114
  v_mul_f32 v115, v12, v115
  v_mul_f32 v116, v12, v116
  v_mul_f32 v117, v12, v117
  v_mul_f32 v118, v12, v118
  v_mul_f32 v119, v12, v119
  v_mul_f32 v120, v12, v120
  v_mul_f32 v121, v12, v121
  v_mul_f32 v122, v12, v122
  v_mul_f32 v123, v12, v123
  v_mul_f32 v124, v12, v124
  v_mul_f32 v125, v12, v125
  v_mul_f32 v126, v12, v126
  v_mul_f32 v127, v12, v127
  v_cvt_pk_bf16_f32 v144, v112, v113
  v_cvt_pk_bf16_f32 v145, v114, v115
  s_waitcnt lgkmcnt(12)
  v_mfma_f32_16x16x32_bf16 v[48:51], v[160:163], a[0:3], 0
  ds_read_b64_tr_b16 v[188:189], v29 offset:0
  v_cvt_pk_bf16_f32 v146, v116, v117
  v_mfma_f32_16x16x32_bf16 v[52:55], v[160:163], a[4:7], 0
  ds_read_b64_tr_b16 v[190:191], v29 offset:1024
  v_cvt_pk_bf16_f32 v147, v118, v119
  s_waitcnt lgkmcnt(12)
  v_mfma_f32_16x16x32_bf16 v[56:59], v[164:167], a[0:3], 0
  ds_read_b64_tr_b16 v[160:161], v20 offset:8192
  v_cvt_pk_bf16_f32 v148, v120, v121
  v_mfma_f32_16x16x32_bf16 v[60:63], v[164:167], a[4:7], 0
  ds_read_b64_tr_b16 v[162:163], v20 offset:9216
  s_waitcnt lgkmcnt(10)
  v_mfma_f32_16x16x32_bf16 v[64:67], v[168:171], a[0:3], 0
  ds_read_b64_tr_b16 v[164:165], v21 offset:8192
  v_cvt_pk_bf16_f32 v149, v122, v123
  v_mfma_f32_16x16x32_bf16 v[68:71], v[168:171], a[4:7], 0
  ds_read_b64_tr_b16 v[166:167], v21 offset:9216
  v_cvt_pk_bf16_f32 v150, v124, v125
  v_mfma_f32_16x16x32_bf16 v[72:75], v[172:175], a[0:3], 0
  ds_read_b64_tr_b16 v[168:169], v22 offset:8192
  v_cvt_pk_bf16_f32 v151, v126, v127
  v_mfma_f32_16x16x32_bf16 v[76:79], v[172:175], a[4:7], 0
  ds_read_b64_tr_b16 v[170:171], v22 offset:9216
  s_waitcnt lgkmcnt(10)
  v_mfma_f32_16x16x32_bf16 v[80:83], v[176:179], a[0:3], 0
  ds_read_b64_tr_b16 v[172:173], v23 offset:8192
  buffer_store_dwordx4 v[144:147], v4, s[20:23], s70 offen offset:0 sc1
  v_mfma_f32_16x16x32_bf16 v[84:87], v[176:179], a[4:7], 0
  ds_read_b64_tr_b16 v[174:175], v23 offset:9216
  buffer_store_dwordx4 v[148:151], v4, s[20:23], s70 offen offset:1024 sc1
  v_mfma_f32_16x16x32_bf16 v[88:91], v[180:183], a[0:3], 0
  ds_read_b64_tr_b16 v[176:177], v26 offset:8192
  v_mul_f32 v128, v13, v128
  v_mfma_f32_16x16x32_bf16 v[92:95], v[180:183], a[4:7], 0
  ds_read_b64_tr_b16 v[178:179], v26 offset:9216
  s_waitcnt lgkmcnt(10)
  v_mfma_f32_16x16x32_bf16 v[96:99], v[184:187], a[0:3], 0
  ds_read_b64_tr_b16 v[180:181], v27 offset:8192
  v_mul_f32 v129, v13, v129
  v_mul_f32 v130, v13, v130
  v_mfma_f32_16x16x32_bf16 v[100:103], v[184:187], a[4:7], 0
  ds_read_b64_tr_b16 v[182:183], v27 offset:9216
  v_mul_f32 v131, v13, v131
  v_mfma_f32_16x16x32_bf16 v[104:107], v[188:191], a[0:3], 0
  ds_read_b64_tr_b16 v[184:185], v28 offset:8192
  v_mul_f32 v132, v13, v132
  v_mfma_f32_16x16x32_bf16 v[108:111], v[188:191], a[4:7], 0
  ds_read_b64_tr_b16 v[186:187], v28 offset:9216
  s_waitcnt lgkmcnt(10)
  v_mul_f32 v133, v13, v133
  v_mul_f32 v134, v13, v134
  s_barrier
  v_mfma_f32_16x16x32_bf16 v[48:51], v[160:163], a[8:11], v[48:51]
  ds_read_b64_tr_b16 v[188:189], v29 offset:8192
  v_mul_f32 v135, v13, v135
  v_mfma_f32_16x16x32_bf16 v[52:55], v[160:163], a[12:15], v[52:55]
  ds_read_b64_tr_b16 v[190:191], v29 offset:9216
  v_mul_f32 v136, v13, v136
  v_mfma_f32_16x16x32_bf16 v[56:59], v[164:167], a[8:11], v[56:59]
  ds_read_b64_tr_b16 v[160:161], v20 offset:16384
  v_mul_f32 v137, v13, v137
  v_mfma_f32_16x16x32_bf16 v[60:63], v[164:167], a[12:15], v[60:63]
  ds_read_b64_tr_b16 v[162:163], v20 offset:17408
  s_waitcnt lgkmcnt(10)
  v_mfma_f32_16x16x32_bf16 v[64:67], v[168:171], a[8:11], v[64:67]
  ds_read_b64_tr_b16 v[164:165], v21 offset:16384
  v_mul_f32 v138, v13, v138
  v_mfma_f32_16x16x32_bf16 v[68:71], v[168:171], a[12:15], v[68:71]
  ds_read_b64_tr_b16 v[166:167], v21 offset:17408
  v_mul_f32 v139, v13, v139
  v_mfma_f32_16x16x32_bf16 v[72:75], v[172:175], a[8:11], v[72:75]
  ds_read_b64_tr_b16 v[168:169], v22 offset:16384
  v_mul_f32 v140, v13, v140
  v_mfma_f32_16x16x32_bf16 v[76:79], v[172:175], a[12:15], v[76:79]
  ds_read_b64_tr_b16 v[170:171], v22 offset:17408
  s_waitcnt lgkmcnt(10)
  v_mfma_f32_16x16x32_bf16 v[80:83], v[176:179], a[8:11], v[80:83]
  ds_read_b64_tr_b16 v[172:173], v23 offset:16384
  v_mul_f32 v141, v13, v141
  v_mul_f32 v142, v13, v142
  v_mfma_f32_16x16x32_bf16 v[84:87], v[176:179], a[12:15], v[84:87]
  ds_read_b64_tr_b16 v[174:175], v23 offset:17408
  v_mul_f32 v143, v13, v143
  v_mfma_f32_16x16x32_bf16 v[88:91], v[180:183], a[8:11], v[88:91]
  ds_read_b64_tr_b16 v[176:177], v26 offset:16384
  v_cvt_pk_bf16_f32 v152, v128, v129
  v_mfma_f32_16x16x32_bf16 v[92:95], v[180:183], a[12:15], v[92:95]
  ds_read_b64_tr_b16 v[178:179], v26 offset:17408
  s_waitcnt lgkmcnt(10)
  v_mfma_f32_16x16x32_bf16 v[96:99], v[184:187], a[8:11], v[96:99]
  ds_read_b64_tr_b16 v[180:181], v27 offset:16384
  v_cvt_pk_bf16_f32 v153, v130, v131
  v_cvt_pk_bf16_f32 v154, v132, v133
  v_mfma_f32_16x16x32_bf16 v[100:103], v[184:187], a[12:15], v[100:103]
  ds_read_b64_tr_b16 v[182:183], v27 offset:17408
  v_cvt_pk_bf16_f32 v155, v134, v135
  v_mfma_f32_16x16x32_bf16 v[104:107], v[188:191], a[8:11], v[104:107]
  ds_read_b64_tr_b16 v[184:185], v28 offset:16384
  v_cvt_pk_bf16_f32 v156, v136, v137
  v_mfma_f32_16x16x32_bf16 v[108:111], v[188:191], a[12:15], v[108:111]
  ds_read_b64_tr_b16 v[186:187], v28 offset:17408
  s_waitcnt lgkmcnt(10)
  v_mfma_f32_16x16x32_bf16 v[48:51], v[160:163], a[16:19], v[48:51]
  ds_read_b64_tr_b16 v[188:189], v29 offset:16384
  v_cvt_pk_bf16_f32 v157, v138, v139
  v_mfma_f32_16x16x32_bf16 v[52:55], v[160:163], a[20:23], v[52:55]
  ds_read_b64_tr_b16 v[190:191], v29 offset:17408
  v_cvt_pk_bf16_f32 v158, v140, v141
  v_mfma_f32_16x16x32_bf16 v[56:59], v[164:167], a[16:19], v[56:59]
  ds_read_b64_tr_b16 v[160:161], v20 offset:24576
  v_cvt_pk_bf16_f32 v159, v142, v143
  v_mfma_f32_16x16x32_bf16 v[60:63], v[164:167], a[20:23], v[60:63]
  ds_read_b64_tr_b16 v[162:163], v20 offset:25600
  s_waitcnt lgkmcnt(10)
  v_mfma_f32_16x16x32_bf16 v[64:67], v[168:171], a[16:19], v[64:67]
  ds_read_b64_tr_b16 v[164:165], v21 offset:24576
  v_add_u32 v20, 32768, v20
  v_mfma_f32_16x16x32_bf16 v[68:71], v[168:171], a[20:23], v[68:71]
  ds_read_b64_tr_b16 v[166:167], v21 offset:25600
  buffer_store_dwordx4 v[152:155], v4, s[20:23], s71 offen offset:0 sc1
  v_mfma_f32_16x16x32_bf16 v[72:75], v[172:175], a[16:19], v[72:75]
  ds_read_b64_tr_b16 v[168:169], v22 offset:24576
  v_add_u32 v21, 32768, v21
  v_mfma_f32_16x16x32_bf16 v[76:79], v[172:175], a[20:23], v[76:79]
  ds_read_b64_tr_b16 v[170:171], v22 offset:25600
  s_waitcnt lgkmcnt(10)
  v_mfma_f32_16x16x32_bf16 v[80:83], v[176:179], a[16:19], v[80:83]
  ds_read_b64_tr_b16 v[172:173], v23 offset:24576
  buffer_store_dwordx4 v[156:159], v4, s[20:23], s71 offen offset:1024 sc1
  v_mfma_f32_16x16x32_bf16 v[84:87], v[176:179], a[20:23], v[84:87]
  ds_read_b64_tr_b16 v[174:175], v23 offset:25600
  v_add_u32 v22, 32768, v22
  v_mfma_f32_16x16x32_bf16 v[88:91], v[180:183], a[16:19], v[88:91]
  ds_read_b64_tr_b16 v[176:177], v26 offset:24576
  v_add_u32 v23, 32768, v23
  v_mfma_f32_16x16x32_bf16 v[92:95], v[180:183], a[20:23], v[92:95]
  ds_read_b64_tr_b16 v[178:179], v26 offset:25600
  s_waitcnt lgkmcnt(10)
  v_mfma_f32_16x16x32_bf16 v[96:99], v[184:187], a[16:19], v[96:99]
  ds_read_b64_tr_b16 v[180:181], v27 offset:24576
  v_add_u32 v26, 32768, v26
  s_add_u32 m0, s89, 0
  v_mfma_f32_16x16x32_bf16 v[100:103], v[184:187], a[20:23], v[100:103]
  ds_read_b64_tr_b16 v[182:183], v27 offset:25600
  v_add_u32 v27, 32768, v27
  v_mfma_f32_16x16x32_bf16 v[104:107], v[188:191], a[16:19], v[104:107]
  ds_read_b64_tr_b16 v[184:185], v28 offset:24576
  buffer_load_dwordx4 v8, s[24:27], s87 offen offset:0 lds
  v_mfma_f32_16x16x32_bf16 v[108:111], v[188:191], a[20:23], v[108:111]
  ds_read_b64_tr_b16 v[186:187], v28 offset:25600
  s_waitcnt lgkmcnt(10)
  v_mfma_f32_16x16x32_bf16 v[48:51], v[160:163], a[24:27], v[48:51]
  ds_read_b64_tr_b16 v[188:189], v29 offset:24576
  v_add_u32 v28, 32768, v28
  v_mfma_f32_16x16x32_bf16 v[52:55], v[160:163], a[28:31], v[52:55]
  ds_read_b64_tr_b16 v[190:191], v29 offset:25600
  v_add_u32 v29, 32768, v29
  v_mfma_f32_16x16x32_bf16 v[56:59], v[164:167], a[24:27], v[56:59]
  buffer_load_dwordx4 v9, s[24:27], s87 offen offset:1024 lds
  v_mfma_f32_16x16x32_bf16 v[60:63], v[164:167], a[28:31], v[60:63]
  s_waitcnt lgkmcnt(8)
  v_mfma_f32_16x16x32_bf16 v[64:67], v[168:171], a[24:27], v[64:67]
  buffer_load_dwordx4 v10, s[24:27], s87 offen offset:2048 lds
  v_mfma_f32_16x16x32_bf16 v[68:71], v[168:171], a[28:31], v[68:71]
  s_waitcnt lgkmcnt(0)
  s_barrier
  v_mfma_f32_16x16x32_bf16 v[72:75], v[172:175], a[24:27], v[72:75]
  ds_read_b64_tr_b16 v[160:161], v20 offset:0
  ds_read_b64_tr_b16 v[162:163], v20 offset:1024
  v_mfma_f32_16x16x32_bf16 v[76:79], v[172:175], a[28:31], v[76:79]
  ds_read_b64_tr_b16 v[164:165], v21 offset:0
  ds_read_b64_tr_b16 v[166:167], v21 offset:1024
  v_mfma_f32_16x16x32_bf16 v[80:83], v[176:179], a[24:27], v[80:83]
  ds_read_b64_tr_b16 v[168:169], v22 offset:0
  ds_read_b64_tr_b16 v[170:171], v22 offset:1024
  buffer_load_dwordx4 v11, s[24:27], s87 offen offset:3072 lds
  v_mfma_f32_16x16x32_bf16 v[84:87], v[176:179], a[28:31], v[84:87]
  ds_read_b64_tr_b16 v[172:173], v23 offset:0
  ds_read_b64_tr_b16 v[174:175], v23 offset:1024
  v_mfma_f32_16x16x32_bf16 v[88:91], v[180:183], a[24:27], v[88:91]
  ds_read_b64_tr_b16 v[176:177], v26 offset:0
  v_mfma_f32_16x16x32_bf16 v[92:95], v[180:183], a[28:31], v[92:95]
  ds_read_b64_tr_b16 v[178:179], v26 offset:1024
  v_mfma_f32_16x16x32_bf16 v[96:99], v[184:187], a[24:27], v[96:99]
  ds_read_b64_tr_b16 v[180:181], v27 offset:0
  s_add_u32 m0, s89, 4096
  v_mfma_f32_16x16x32_bf16 v[100:103], v[184:187], a[28:31], v[100:103]
  ds_read_b64_tr_b16 v[182:183], v27 offset:1024
  v_mfma_f32_16x16x32_bf16 v[104:107], v[188:191], a[24:27], v[104:107]
  ds_read_b64_tr_b16 v[184:185], v28 offset:0
  buffer_load_dwordx4 v8, s[24:27], s88 offen offset:0 lds
  v_mfma_f32_16x16x32_bf16 v[108:111], v[188:191], a[28:31], v[108:111]
  ds_read_b64_tr_b16 v[186:187], v28 offset:1024
  s_waitcnt lgkmcnt(10)
  v_mfma_f32_16x16x32_bf16 v[48:51], v[160:163], a[32:35], v[48:51]
  ds_read_b64_tr_b16 v[188:189], v29 offset:0
  v_mfma_f32_16x16x32_bf16 v[52:55], v[160:163], a[36:39], v[52:55]
  ds_read_b64_tr_b16 v[190:191], v29 offset:1024
  v_mfma_f32_16x16x32_bf16 v[56:59], v[164:167], a[32:35], v[56:59]
  ds_read_b64_tr_b16 v[160:161], v20 offset:8192
  s_waitcnt vmcnt(62)
  buffer_load_dwordx4 v9, s[24:27], s88 offen offset:1024 lds
  v_mfma_f32_16x16x32_bf16 v[60:63], v[164:167], a[36:39], v[60:63]
  ds_read_b64_tr_b16 v[162:163], v20 offset:9216
  s_waitcnt lgkmcnt(10)
  v_mfma_f32_16x16x32_bf16 v[64:67], v[168:171], a[32:35], v[64:67]
  ds_read_b64_tr_b16 v[164:165], v21 offset:8192
  v_mfma_f32_16x16x32_bf16 v[68:71], v[168:171], a[36:39], v[68:71]
  ds_read_b64_tr_b16 v[166:167], v21 offset:9216
  v_mfma_f32_16x16x32_bf16 v[72:75], v[172:175], a[32:35], v[72:75]
  ds_read_b64_tr_b16 v[168:169], v22 offset:8192
  s_waitcnt vmcnt(62)
  buffer_load_dwordx4 v10, s[24:27], s88 offen offset:2048 lds
  v_mfma_f32_16x16x32_bf16 v[76:79], v[172:175], a[36:39], v[76:79]
  ds_read_b64_tr_b16 v[170:171], v22 offset:9216
  s_waitcnt lgkmcnt(10)
  v_mfma_f32_16x16x32_bf16 v[80:83], v[176:179], a[32:35], v[80:83]
  ds_read_b64_tr_b16 v[172:173], v23 offset:8192
  v_mfma_f32_16x16x32_bf16 v[84:87], v[176:179], a[36:39], v[84:87]
  ds_read_b64_tr_b16 v[174:175], v23 offset:9216
  v_mfma_f32_16x16x32_bf16 v[88:91], v[180:183], a[32:35], v[88:91]
  ds_read_b64_tr_b16 v[176:177], v26 offset:8192
  s_waitcnt vmcnt(62)
  buffer_load_dwordx4 v11, s[24:27], s88 offen offset:3072 lds
  v_mfma_f32_16x16x32_bf16 v[92:95], v[180:183], a[36:39], v[92:95]
  ds_read_b64_tr_b16 v[178:179], v26 offset:9216
  s_waitcnt lgkmcnt(10)
  v_mfma_f32_16x16x32_bf16 v[96:99], v[184:187], a[32:35], v[96:99]
  ds_read_b64_tr_b16 v[180:181], v27 offset:8192
  s_add_u32 s87, s87, 262144
  v_mfma_f32_16x16x32_bf16 v[100:103], v[184:187], a[36:39], v[100:103]
  ds_read_b64_tr_b16 v[182:183], v27 offset:9216
  s_add_u32 s88, s88, 262144
  v_mfma_f32_16x16x32_bf16 v[104:107], v[188:191], a[32:35], v[104:107]
  ds_read_b64_tr_b16 v[184:185], v28 offset:8192
  s_add_u32 m0, s89, 32768
  v_mfma_f32_16x16x32_bf16 v[108:111], v[188:191], a[36:39], v[108:111]
  ds_read_b64_tr_b16 v[186:187], v28 offset:9216
  s_waitcnt lgkmcnt(10)
  v_mfma_f32_16x16x32_bf16 v[48:51], v[160:163], a[40:43], v[48:51]
  ds_read_b64_tr_b16 v[188:189], v29 offset:8192
  s_waitcnt vmcnt(62)
  buffer_load_dwordx4 v8, s[24:27], s87 offen offset:0 lds
  v_mfma_f32_16x16x32_bf16 v[52:55], v[160:163], a[44:47], v[52:55]
  ds_read_b64_tr_b16 v[190:191], v29 offset:9216
  v_accvgpr_read_b32 v36, a235
  v_mfma_f32_16x16x32_bf16 v[56:59], v[164:167], a[40:43], v[56:59]
  ds_read_b64_tr_b16 v[160:161], v20 offset:16384
  s_waitcnt vmcnt(62)
  buffer_load_dwordx4 v9, s[24:27], s87 offen offset:1024 lds
  v_mfma_f32_16x16x32_bf16 v[60:63], v[164:167], a[44:47], v[60:63]
  ds_read_b64_tr_b16 v[162:163], v20 offset:17408
  s_waitcnt lgkmcnt(10)
  v_mfma_f32_16x16x32_bf16 v[64:67], v[168:171], a[40:43], v[64:67]
  ds_read_b64_tr_b16 v[164:165], v21 offset:16384
  v_add_u32 v36, 131072, v36
  v_mfma_f32_16x16x32_bf16 v[68:71], v[168:171], a[44:47], v[68:71]
  ds_read_b64_tr_b16 v[166:167], v21 offset:17408
  v_xor_b32 v37, 32, v36
  v_mfma_f32_16x16x32_bf16 v[72:75], v[172:175], a[40:43], v[72:75]
  ds_read_b64_tr_b16 v[168:169], v22 offset:16384
  v_xor_b32 v38, 64, v36
  v_mfma_f32_16x16x32_bf16 v[76:79], v[172:175], a[44:47], v[76:79]
L_touch14:
  s_cbranch_execz L_touch18
  ds_read_b64_tr_b16 v[170:171], v22 offset:17408
  s_waitcnt lgkmcnt(10)
  s_waitcnt vmcnt(10)
  s_barrier
  s_cmp_lg_u32 s3, 0
  s_cbranch_scc1 L_sig26
  s_mov_b64 exec, 1
  v_mov_b32 v5, 7
  buffer_store_dword v5, off, s[20:23], s69 sc1
  s_mov_b64 exec, -1
L_sig26:
  v_mfma_f32_16x16x32_bf16 v[80:83], v[176:179], a[40:43], v[80:83]
  ds_read_b64_tr_b16 v[172:173], v23 offset:16384
  buffer_load_dwordx4 v10, s[24:27], s87 offen offset:2048 lds
  v_mfma_f32_16x16x32_bf16 v[84:87], v[176:179], a[44:47], v[84:87]
  ds_read_b64_tr_b16 v[174:175], v23 offset:17408
  v_xor_b32 v39, 96, v36
  v_mfma_f32_16x16x32_bf16 v[88:91], v[180:183], a[40:43], v[88:91]
  ds_read_b64_tr_b16 v[176:177], v26 offset:16384
  v_mfma_f32_16x16x32_bf16 v[92:95], v[180:183], a[44:47], v[92:95]
  ds_read_b64_tr_b16 v[178:179], v26 offset:17408
  s_waitcnt lgkmcnt(10)
  v_mfma_f32_16x16x32_bf16 v[96:99], v[184:187], a[40:43], v[96:99]
  ds_read_b64_tr_b16 v[180:181], v27 offset:16384
  buffer_load_dwordx4 v11, s[24:27], s87 offen offset:3072 lds
  v_mfma_f32_16x16x32_bf16 v[100:103], v[184:187], a[44:47], v[100:103]
  ds_read_b64_tr_b16 v[182:183], v27 offset:17408
  v_accvgpr_read_b32 v32, a236
  v_mfma_f32_16x16x32_bf16 v[104:107], v[188:191], a[40:43], v[104:107]
  ds_read_b64_tr_b16 v[184:185], v28 offset:16384
  s_add_u32 m0, s89, 36864
  v_mfma_f32_16x16x32_bf16 v[108:111], v[188:191], a[44:47], v[108:111]
  ds_read_b64_tr_b16 v[186:187], v28 offset:17408
  s_waitcnt lgkmcnt(10)
  v_mfma_f32_16x16x32_bf16 v[48:51], v[160:163], a[48:51], v[48:51]
  ds_read_b64_tr_b16 v[188:189], v29 offset:16384
  v_accvgpr_read_b32 v33, a237
  v_mfma_f32_16x16x32_bf16 v[52:55], v[160:163], a[52:55], v[52:55]
  ds_read_b64_tr_b16 v[190:191], v29 offset:17408
  buffer_load_dwordx4 v8, s[24:27], s88 offen offset:0 lds
  v_mfma_f32_16x16x32_bf16 v[56:59], v[164:167], a[48:51], v[56:59]
  ds_read_b64_tr_b16 v[160:161], v20 offset:24576
  v_accvgpr_read_b32 v34, a238
  v_mfma_f32_16x16x32_bf16 v[60:63], v[164:167], a[52:55], v[60:63]
  ds_read_b64_tr_b16 v[162:163], v20 offset:25600
  s_waitcnt lgkmcnt(10)
  v_mfma_f32_16x16x32_bf16 v[64:67], v[168:171], a[48:51], v[64:67]
  ds_read_b64_tr_b16 v[164:165], v21 offset:24576
  v_add_u32 v20, 32768, v20
  v_accvgpr_read_b32 v35, a239
  v_mfma_f32_16x16x32_bf16 v[68:71], v[168:171], a[52:55], v[68:71]
  ds_read_b64_tr_b16 v[166:167], v21 offset:25600
  v_add_u32 v21, 32768, v21
  v_mfma_f32_16x16x32_bf16 v[72:75], v[172:175], a[48:51], v[72:75]
  ds_read_b64_tr_b16 v[168:169], v22 offset:24576
  buffer_load_dwordx4 v9, s[24:27], s88 offen offset:1024 lds
  v_accvgpr_read_b32 v44, a243
  v_mfma_f32_16x16x32_bf16 v[76:79], v[172:175], a[52:55], v[76:79]
  ds_read_b64_tr_b16 v[170:171], v22 offset:25600
  s_waitcnt lgkmcnt(10)
  v_mfma_f32_16x16x32_bf16 v[80:83], v[176:179], a[48:51], v[80:83]
  ds_read_b64_tr_b16 v[172:173], v23 offset:24576
  v_add_u32 v22, 32768, v22
  v_add_u32 v45, 32768, v44
  v_mfma_f32_16x16x32_bf16 v[84:87], v[176:179], a[52:55], v[84:87]
  ds_read_b64_tr_b16 v[174:175], v23 offset:25600
  v_add_u32 v23, 32768, v23
  v_mfma_f32_16x16x32_bf16 v[88:91], v[180:183], a[48:51], v[88:91]
  ds_read_b64_tr_b16 v[176:177], v26 offset:24576
  buffer_load_dwordx4 v10, s[24:27], s88 offen offset:2048 lds
  v_sub_f32 v12, 1.0, v6
  v_mfma_f32_16x16x32_bf16 v[92:95], v[180:183], a[52:55], v[92:95]
  ds_read_b64_tr_b16 v[178:179], v26 offset:25600
  s_waitcnt lgkmcnt(10)
  v_mfma_f32_16x16x32_bf16 v[96:99], v[184:187], a[48:51], v[96:99]
  ds_read_b64_tr_b16 v[180:181], v27 offset:24576
  v_add_u32 v26, 32768, v26
  v_cvt_pk_bf16_f32 v12, v12, v12
  v_mfma_f32_16x16x32_bf16 v[100:103], v[184:187], a[52:55], v[100:103]
  ds_read_b64_tr_b16 v[182:183], v27 offset:25600
  v_add_u32 v27, 32768, v27
  v_mfma_f32_16x16x32_bf16 v[104:107], v[188:191], a[48:51], v[104:107]
  ds_read_b64_tr_b16 v[184:185], v28 offset:24576
  buffer_load_dwordx4 v11, s[24:27], s88 offen offset:3072 lds
  s_add_u32 s87, s87, 262144
  v_mfma_f32_16x16x32_bf16 v[108:111], v[188:191], a[52:55], v[108:111]
  ds_read_b64_tr_b16 v[186:187], v28 offset:25600
  s_waitcnt lgkmcnt(10)
  s_add_u32 s88, s88, 262144
  v_mfma_f32_16x16x32_bf16 v[48:51], v[160:163], a[56:59], v[48:51]
  ds_read_b64_tr_b16 v[188:189], v29 offset:24576
  v_and_b32 v41, 0xffff0000, v12
  v_add_u32 v28, 32768, v28
  v_mfma_f32_16x16x32_bf16 v[52:55], v[160:163], a[60:63], v[52:55]
  ds_read_b64_tr_b16 v[190:191], v29 offset:25600
  s_add_u32 m0, s89, 65536
  v_lshrrev_b32 v40, 16, v12
  v_mfma_f32_16x16x32_bf16 v[56:59], v[164:167], a[56:59], v[56:59]
  v_add_u32 v29, 32768, v29
  v_mfma_f32_16x16x32_bf16 v[60:63], v[164:167], a[60:63], v[60:63]
  s_waitcnt lgkmcnt(8)
  buffer_load_dwordx4 v8, s[24:27], s87 offen offset:0 lds
  v_mfma_f32_16x16x32_bf16 v[64:67], v[168:171], a[56:59], v[64:67]
  v_sub_f32 v12, 1.0, v31
  v_cvt_pk_bf16_f32 v12, v12, v12
  v_mfma_f32_16x16x32_bf16 v[68:71], v[168:171], a[60:63], v[68:71]
  v_and_b32 v43, 0xffff0000, v12
  s_waitcnt lgkmcnt(0)
  s_barrier
  v_mfma_f32_16x16x32_bf16 v[72:75], v[172:175], a[56:59], v[72:75]
  ds_read_b64_tr_b16 v[160:161], v20 offset:0
  ds_read_b64_tr_b16 v[162:163], v20 offset:1024
  buffer_load_dwordx4 v9, s[24:27], s87 offen offset:1024 lds
  v_mfma_f32_16x16x32_bf16 v[76:79], v[172:175], a[60:63], v[76:79]
  ds_read_b64_tr_b16 v[164:165], v21 offset:0
  ds_read_b64_tr_b16 v[166:167], v21 offset:1024
  v_mfma_f32_16x16x32_bf16 v[80:83], v[176:179], a[56:59], v[80:83]
  ds_read_b64_tr_b16 v[168:169], v22 offset:0
  ds_read_b64_tr_b16 v[170:171], v22 offset:1024
  v_lshrrev_b32 v42, 16, v12
  v_mfma_f32_16x16x32_bf16 v[84:87], v[176:179], a[60:63], v[84:87]
  ds_read_b64_tr_b16 v[172:173], v23 offset:0
  ds_read_b64_tr_b16 v[174:175], v23 offset:1024
  s_lshl_b32 s61, s67, 8
  v_mfma_f32_16x16x32_bf16 v[88:91], v[180:183], a[56:59], v[88:91]
  ds_read_b64_tr_b16 v[176:177], v26 offset:0
  buffer_load_dwordx4 v10, s[24:27], s87 offen offset:2048 lds
  v_mfma_f32_16x16x32_bf16 v[92:95], v[180:183], a[60:63], v[92:95]
  ds_read_b64_tr_b16 v[178:179], v26 offset:1024
  v_mfma_f32_16x16x32_bf16 v[96:99], v[184:187], a[56:59], v[96:99]
  ds_read_b64_tr_b16 v[180:181], v27 offset:0
  s_lshl_b32 s62, s68, 7
  v_mfma_f32_16x16x32_bf16 v[100:103], v[184:187], a[60:63], v[100:103]
  ds_read_b64_tr_b16 v[182:183], v27 offset:1024
  s_add_u32 s73, s61, s62
  v_mfma_f32_16x16x32_bf16 v[104:107], v[188:191], a[56:59], v[104:107]
  ds_read_b64_tr_b16 v[184:185], v28 offset:0
  buffer_load_dwordx4 v11, s[24:27], s87 offen offset:3072 lds
  v_mfma_f32_16x16x32_bf16 v[108:111], v[188:191], a[60:63], v[108:111]
  ds_read_b64_tr_b16 v[186:187], v28 offset:1024
  s_waitcnt lgkmcnt(10)
  v_mfma_f32_16x16x32_bf16 v[48:51], v[160:163], a[64:67], v[48:51]
  ds_read_b64_tr_b16 v[188:189], v29 offset:0
  s_add_u32 m0, s89, 69632
  v_mfma_f32_16x16x32_bf16 v[52:55], v[160:163], a[68:71], v[52:55]
  ds_read_b64_tr_b16 v[190:191], v29 offset:1024
  v_mfma_f32_16x16x32_bf16 v[56:59], v[164:167], a[64:67], v[56:59]
  ds_read_b64_tr_b16 v[160:161], v20 offset:8192
  buffer_load_dwordx4 v8, s[24:27], s88 offen offset:0 lds
  v_mfma_f32_16x16x32_bf16 v[60:63], v[164:167], a[68:71], v[60:63]
  ds_read_b64_tr_b16 v[162:163], v20 offset:9216
  s_waitcnt lgkmcnt(10)
  v_mfma_f32_16x16x32_bf16 v[64:67], v[168:171], a[64:67], v[64:67]
  ds_read_b64_tr_b16 v[164:165], v21 offset:8192
  v_mfma_f32_16x16x32_bf16 v[68:71], v[168:171], a[68:71], v[68:71]
  ds_read_b64_tr_b16 v[166:167], v21 offset:9216
  v_mfma_f32_16x16x32_bf16 v[72:75], v[172:175], a[64:67], v[72:75]
  ds_read_b64_tr_b16 v[168:169], v22 offset:8192
  buffer_load_dwordx4 v9, s[24:27], s88 offen offset:1024 lds
  v_mfma_f32_16x16x32_bf16 v[76:79], v[172:175], a[68:71], v[76:79]
  ds_read_b64_tr_b16 v[170:171], v22 offset:9216
  s_waitcnt lgkmcnt(10)
  v_mfma_f32_16x16x32_bf16 v[80:83], v[176:179], a[64:67], v[80:83]
  ds_read_b64_tr_b16 v[172:173], v23 offset:8192
  v_mfma_f32_16x16x32_bf16 v[84:87], v[176:179], a[68:71], v[84:87]
  ds_read_b64_tr_b16 v[174:175], v23 offset:9216
  v_mfma_f32_16x16x32_bf16 v[88:91], v[180:183], a[64:67], v[88:91]
  ds_read_b64_tr_b16 v[176:177], v26 offset:8192
  buffer_load_dwordx4 v10, s[24:27], s88 offen offset:2048 lds
  v_mfma_f32_16x16x32_bf16 v[92:95], v[180:183], a[68:71], v[92:95]
  ds_read_b64_tr_b16 v[178:179], v26 offset:9216
  s_waitcnt lgkmcnt(10)
  v_mfma_f32_16x16x32_bf16 v[96:99], v[184:187], a[64:67], v[96:99]
  ds_read_b64_tr_b16 v[180:181], v27 offset:8192
  v_mfma_f32_16x16x32_bf16 v[100:103], v[184:187], a[68:71], v[100:103]
  ds_read_b64_tr_b16 v[182:183], v27 offset:9216
  v_mfma_f32_16x16x32_bf16 v[104:107], v[188:191], a[64:67], v[104:107]
  ds_read_b64_tr_b16 v[184:185], v28 offset:8192
  buffer_load_dwordx4 v11, s[24:27], s88 offen offset:3072 lds
  v_mfma_f32_16x16x32_bf16 v[108:111], v[188:191], a[68:71], v[108:111]
  ds_read_b64_tr_b16 v[186:187], v28 offset:9216
  s_waitcnt lgkmcnt(10)
  v_mfma_f32_16x16x32_bf16 v[48:51], v[160:163], a[72:75], v[48:51]
  ds_read_b64_tr_b16 v[188:189], v29 offset:8192
  s_add_u32 s87, s87, 262144
  v_mfma_f32_16x16x32_bf16 v[52:55], v[160:163], a[76:79], v[52:55]
  ds_read_b64_tr_b16 v[190:191], v29 offset:9216
  s_add_u32 s88, s88, 262144
  v_mfma_f32_16x16x32_bf16 v[56:59], v[164:167], a[72:75], v[56:59]
  ds_read_b64_tr_b16 v[160:161], v20 offset:16384
  s_add_u32 m0, s89, 98304
  v_mfma_f32_16x16x32_bf16 v[60:63], v[164:167], a[76:79], v[60:63]
  ds_read_b64_tr_b16 v[162:163], v20 offset:17408
  s_waitcnt lgkmcnt(10)
  v_mfma_f32_16x16x32_bf16 v[64:67], v[168:171], a[72:75], v[64:67]
  ds_read_b64_tr_b16 v[164:165], v21 offset:16384
  buffer_load_dwordx4 v8, s[24:27], s87 offen offset:0 lds
  v_mfma_f32_16x16x32_bf16 v[68:71], v[168:171], a[76:79], v[68:71]
  ds_read_b64_tr_b16 v[166:167], v21 offset:17408
  v_mfma_f32_16x16x32_bf16 v[72:75], v[172:175], a[72:75], v[72:75]
  ds_read_b64_tr_b16 v[168:169], v22 offset:16384
  v_mfma_f32_16x16x32_bf16 v[76:79], v[172:175], a[76:79], v[76:79]
  ds_read_b64_tr_b16 v[170:171], v22 offset:17408
  s_waitcnt lgkmcnt(10)
  v_mfma_f32_16x16x32_bf16 v[80:83], v[176:179], a[72:75], v[80:83]
  ds_read_b64_tr_b16 v[172:173], v23 offset:16384
  buffer_load_dwordx4 v9, s[24:27], s87 offen offset:1024 lds
  v_mfma_f32_16x16x32_bf16 v[84:87], v[176:179], a[76:79], v[84:87]
  ds_read_b64_tr_b16 v[174:175], v23 offset:17408
  v_mfma_f32_16x16x32_bf16 v[88:91], v[180:183], a[72:75], v[88:91]
  ds_read_b64_tr_b16 v[176:177], v26 offset:16384
  v_mfma_f32_16x16x32_bf16 v[92:95], v[180:183], a[76:79], v[92:95]
  ds_read_b64_tr_b16 v[178:179], v26 offset:17408
  s_waitcnt lgkmcnt(10)
  v_mfma_f32_16x16x32_bf16 v[96:99], v[184:187], a[72:75], v[96:99]
  ds_read_b64_tr_b16 v[180:181], v27 offset:16384
  buffer_load_dwordx4 v10, s[24:27], s87 offen offset:2048 lds
  v_mfma_f32_16x16x32_bf16 v[100:103], v[184:187], a[76:79], v[100:103]
  ds_read_b64_tr_b16 v[182:183], v27 offset:17408
  v_mfma_f32_16x16x32_bf16 v[104:107], v[188:191], a[72:75], v[104:107]
  ds_read_b64_tr_b16 v[184:185], v28 offset:16384
  v_mfma_f32_16x16x32_bf16 v[108:111], v[188:191], a[76:79], v[108:111]
  ds_read_b64_tr_b16 v[186:187], v28 offset:17408
  s_waitcnt lgkmcnt(10)
  v_mfma_f32_16x16x32_bf16 v[48:51], v[160:163], a[80:83], v[48:51]
  ds_read_b64_tr_b16 v[188:189], v29 offset:16384
  buffer_load_dwordx4 v11, s[24:27], s87 offen offset:3072 lds
  v_mfma_f32_16x16x32_bf16 v[52:55], v[160:163], a[84:87], v[52:55]
  ds_read_b64_tr_b16 v[190:191], v29 offset:17408
  v_mfma_f32_16x16x32_bf16 v[56:59], v[164:167], a[80:83], v[56:59]
  ds_read_b64_tr_b16 v[160:161], v20 offset:24576
  v_mfma_f32_16x16x32_bf16 v[60:63], v[164:167], a[84:87], v[60:63]
  ds_read_b64_tr_b16 v[162:163], v20 offset:25600
  s_waitcnt lgkmcnt(10)
  v_mfma_f32_16x16x32_bf16 v[64:67], v[168:171], a[80:83], v[64:67]
  ds_read_b64_tr_b16 v[164:165], v21 offset:24576
  v_add_u32 v20, 4294836224, v20
  s_add_u32 m0, s89, 102400
  v_mfma_f32_16x16x32_bf16 v[68:71], v[168:171], a[84:87], v[68:71]
  ds_read_b64_tr_b16 v[166:167], v21 offset:25600
  v_add_u32 v21, 4294836224, v21
  v_mfma_f32_16x16x32_bf16 v[72:75], v[172:175], a[80:83], v[72:75]
  ds_read_b64_tr_b16 v[168:169], v22 offset:24576
  buffer_load_dwordx4 v8, s[24:27], s88 offen offset:0 lds
  v_mfma_f32_16x16x32_bf16 v[76:79], v[172:175], a[84:87], v[76:79]
  ds_read_b64_tr_b16 v[170:171], v22 offset:25600
  s_waitcnt lgkmcnt(10)
  v_mfma_f32_16x16x32_bf16 v[80:83], v[176:179], a[80:83], v[80:83]
  ds_read_b64_tr_b16 v[172:173], v23 offset:24576
  v_add_u32 v22, 4294836224, v22
  v_mfma_f32_16x16x32_bf16 v[84:87], v[176:179], a[84:87], v[84:87]
  ds_read_b64_tr_b16 v[174:175], v23 offset:25600
  v_add_u32 v23, 4294836224, v23
  v_mfma_f32_16x16x32_bf16 v[88:91], v[180:183], a[80:83], v[88:91]
  ds_read_b64_tr_b16 v[176:177], v26 offset:24576
  buffer_load_dwordx4 v9, s[24:27], s88 offen offset:1024 lds
  v_mfma_f32_16x16x32_bf16 v[92:95], v[180:183], a[84:87], v[92:95]
  ds_read_b64_tr_b16 v[178:179], v26 offset:25600
  s_waitcnt lgkmcnt(10)
  v_mfma_f32_16x16x32_bf16 v[96:99], v[184:187], a[80:83], v[96:99]
  ds_read_b64_tr_b16 v[180:181], v27 offset:24576
  v_add_u32 v26, 4294836224, v26
  v_mfma_f32_16x16x32_bf16 v[100:103], v[184:187], a[84:87], v[100:103]
  ds_read_b64_tr_b16 v[182:183], v27 offset:25600
  v_add_u32 v27, 4294836224, v27
  v_mfma_f32_16x16x32_bf16 v[104:107], v[188:191], a[80:83], v[104:107]
  ds_read_b64_tr_b16 v[184:185], v28 offset:24576
  v_mfma_f32_16x16x32_bf16 v[108:111], v[188:191], a[84:87], v[108:111]
  ds_read_b64_tr_b16 v[186:187], v28 offset:25600
  s_waitcnt lgkmcnt(10)
  v_mfma_f32_16x16x32_bf16 v[48:51], v[160:163], a[88:91], v[48:51]
  ds_read_b64_tr_b16 v[188:189], v29 offset:24576
  v_add_u32 v28, 4294836224, v28
  v_mfma_f32_16x16x32_bf16 v[52:55], v[160:163], a[92:95], v[52:55]
  ds_read_b64_tr_b16 v[190:191], v29 offset:25600
  buffer_load_dwordx4 v10, s[24:27], s88 offen offset:2048 lds
  v_mfma_f32_16x16x32_bf16 v[56:59], v[164:167], a[88:91], v[56:59]
  v_add_u32 v29, 4294836224, v29
  v_mfma_f32_16x16x32_bf16 v[60:63], v[164:167], a[92:95], v[60:63]
  s_waitcnt lgkmcnt(8)
  buffer_load_dwordx4 v11, s[24:27], s88 offen offset:3072 lds
  v_mfma_f32_16x16x32_bf16 v[64:67], v[168:171], a[88:91], v[64:67]
  s_add_u32 s87, s87, 262144
  s_add_u32 s88, s88, 262144
  v_mfma_f32_16x16x32_bf16 v[68:71], v[168:171], a[92:95], v[68:71]
  s_waitcnt vmcnt(24) lgkmcnt(0)
  s_barrier
  v_mfma_f32_16x16x32_bf16 v[72:75], v[172:175], a[88:91], v[72:75]
  ds_read_b64_tr_b16 v[160:161], v20 offset:0
  ds_read_b64_tr_b16 v[162:163], v20 offset:1024
  buffer_load_dwordx4 a[0:3], v30, s[20:23], s90 offen offset:2048 sc1
  v_mfma_f32_16x16x32_bf16 v[76:79], v[172:175], a[92:95], v[76:79]
  ds_read_b64_tr_b16 v[164:165], v21 offset:0
  ds_read_b64_tr_b16 v[166:167], v21 offset:1024
  v_mfma_f32_16x16x32_bf16 v[80:83], v[176:179], a[88:91], v[80:83]
  ds_read_b64_tr_b16 v[168:169], v22 offset:0
  ds_read_b64_tr_b16 v[170:171], v22 offset:1024
  s_add_u32 m0, s89, 131072
  v_mfma_f32_16x16x32_bf16 v[84:87], v[176:179], a[92:95], v[84:87]
  ds_read_b64_tr_b16 v[172:173], v23 offset:0
  ds_read_b64_tr_b16 v[174:175], v23 offset:1024
  v_mfma_f32_16x16x32_bf16 v[88:91], v[180:183], a[88:91], v[88:91]
  ds_read_b64_tr_b16 v[176:177], v26 offset:0
  buffer_load_dwordx4 v8, s[24:27], s87 offen offset:0 lds
  v_mfma_f32_16x16x32_bf16 v[92:95], v[180:183], a[92:95], v[92:95]
  ds_read_b64_tr_b16 v[178:179], v26 offset:1024
  v_mfma_f32_16x16x32_bf16 v[96:99], v[184:187], a[88:91], v[96:99]
  ds_read_b64_tr_b16 v[180:181], v27 offset:0
  v_mfma_f32_16x16x32_bf16 v[100:103], v[184:187], a[92:95], v[100:103]
  ds_read_b64_tr_b16 v[182:183], v27 offset:1024
  v_mfma_f32_16x16x32_bf16 v[104:107], v[188:191], a[88:91], v[104:107]
  ds_read_b64_tr_b16 v[184:185], v28 offset:0
  buffer_load_dwordx4 v9, s[24:27], s87 offen offset:1024 lds
  v_mfma_f32_16x16x32_bf16 v[108:111], v[188:191], a[92:95], v[108:111]
  ds_read_b64_tr_b16 v[186:187], v28 offset:1024
  s_waitcnt lgkmcnt(10)
  v_mfma_f32_16x16x32_bf16 v[48:51], v[160:163], a[96:99], v[48:51]
  ds_read_b64_tr_b16 v[188:189], v29 offset:0
  v_mfma_f32_16x16x32_bf16 v[52:55], v[160:163], a[100:103], v[52:55]
  ds_read_b64_tr_b16 v[190:191], v29 offset:1024
  v_mfma_f32_16x16x32_bf16 v[56:59], v[164:167], a[96:99], v[56:59]
  ds_read_b64_tr_b16 v[160:161], v20 offset:8192
  buffer_load_dwordx4 v10, s[24:27], s87 offen offset:2048 lds
  v_mfma_f32_16x16x32_bf16 v[60:63], v[164:167], a[100:103], v[60:63]
  ds_read_b64_tr_b16 v[162:163], v20 offset:9216
  s_waitcnt lgkmcnt(10)
  v_mfma_f32_16x16x32_bf16 v[64:67], v[168:171], a[96:99], v[64:67]
  ds_read_b64_tr_b16 v[164:165], v21 offset:8192
  v_mfma_f32_16x16x32_bf16 v[68:71], v[168:171], a[100:103], v[68:71]
  ds_read_b64_tr_b16 v[166:167], v21 offset:9216
  v_mfma_f32_16x16x32_bf16 v[72:75], v[172:175], a[96:99], v[72:75]
  ds_read_b64_tr_b16 v[168:169], v22 offset:8192
  buffer_load_dwordx4 v11, s[24:27], s87 offen offset:3072 lds
  v_mfma_f32_16x16x32_bf16 v[76:79], v[172:175], a[100:103], v[76:79]
  ds_read_b64_tr_b16 v[170:171], v22 offset:9216
  s_waitcnt lgkmcnt(10)
  v_mfma_f32_16x16x32_bf16 v[80:83], v[176:179], a[96:99], v[80:83]
  ds_read_b64_tr_b16 v[172:173], v23 offset:8192
  v_mfma_f32_16x16x32_bf16 v[84:87], v[176:179], a[100:103], v[84:87]
  ds_read_b64_tr_b16 v[174:175], v23 offset:9216
  v_mfma_f32_16x16x32_bf16 v[88:91], v[180:183], a[96:99], v[88:91]
  ds_read_b64_tr_b16 v[176:177], v26 offset:8192
  s_add_u32 m0, s89, 135168
  v_mfma_f32_16x16x32_bf16 v[92:95], v[180:183], a[100:103], v[92:95]
  ds_read_b64_tr_b16 v[178:179], v26 offset:9216
  s_waitcnt lgkmcnt(10)
  v_mfma_f32_16x16x32_bf16 v[96:99], v[184:187], a[96:99], v[96:99]
  ds_read_b64_tr_b16 v[180:181], v27 offset:8192
  buffer_load_dwordx4 v8, s[24:27], s88 offen offset:0 lds
  v_mfma_f32_16x16x32_bf16 v[100:103], v[184:187], a[100:103], v[100:103]
  ds_read_b64_tr_b16 v[182:183], v27 offset:9216
  v_mfma_f32_16x16x32_bf16 v[104:107], v[188:191], a[96:99], v[104:107]
  ds_read_b64_tr_b16 v[184:185], v28 offset:8192
  v_mfma_f32_16x16x32_bf16 v[108:111], v[188:191], a[100:103], v[108:111]
  ds_read_b64_tr_b16 v[186:187], v28 offset:9216
  s_waitcnt lgkmcnt(10)
  v_mfma_f32_16x16x32_bf16 v[48:51], v[160:163], a[104:107], v[48:51]
  ds_read_b64_tr_b16 v[188:189], v29 offset:8192
  buffer_load_dwordx4 v9, s[24:27], s88 offen offset:1024 lds
  v_mfma_f32_16x16x32_bf16 v[52:55], v[160:163], a[108:111], v[52:55]
  ds_read_b64_tr_b16 v[190:191], v29 offset:9216
  v_mfma_f32_16x16x32_bf16 v[56:59], v[164:167], a[104:107], v[56:59]
  ds_read_b64_tr_b16 v[160:161], v20 offset:16384
  v_mfma_f32_16x16x32_bf16 v[60:63], v[164:167], a[108:111], v[60:63]
  ds_read_b64_tr_b16 v[162:163], v20 offset:17408
  s_waitcnt lgkmcnt(10)
  v_mfma_f32_16x16x32_bf16 v[64:67], v[168:171], a[104:107], v[64:67]
  ds_read_b64_tr_b16 v[164:165], v21 offset:16384
  buffer_load_dwordx4 v10, s[24:27], s88 offen offset:2048 lds
  v_mfma_f32_16x16x32_bf16 v[68:71], v[168:171], a[108:111], v[68:71]
  ds_read_b64_tr_b16 v[166:167], v21 offset:17408
  v_mfma_f32_16x16x32_bf16 v[72:75], v[172:175], a[104:107], v[72:75]
  ds_read_b64_tr_b16 v[168:169], v22 offset:16384
  v_mfma_f32_16x16x32_bf16 v[76:79], v[172:175], a[108:111], v[76:79]
  ds_read_b64_tr_b16 v[170:171], v22 offset:17408
  s_waitcnt lgkmcnt(10)
  v_mfma_f32_16x16x32_bf16 v[80:83], v[176:179], a[104:107], v[80:83]
  ds_read_b64_tr_b16 v[172:173], v23 offset:16384
  buffer_load_dwordx4 v11, s[24:27], s88 offen offset:3072 lds
  v_mfma_f32_16x16x32_bf16 v[84:87], v[176:179], a[108:111], v[84:87]
  ds_read_b64_tr_b16 v[174:175], v23 offset:17408
  s_add_u32 s87, s87, 262144
  v_mfma_f32_16x16x32_bf16 v[88:91], v[180:183], a[104:107], v[88:91]
  ds_read_b64_tr_b16 v[176:177], v26 offset:16384
  s_add_u32 s88, s88, 262144
  v_mfma_f32_16x16x32_bf16 v[92:95], v[180:183], a[108:111], v[92:95]
  ds_read_b64_tr_b16 v[178:179], v26 offset:17408
  s_waitcnt lgkmcnt(10)
  v_mfma_f32_16x16x32_bf16 v[96:99], v[184:187], a[104:107], v[96:99]
  ds_read_b64_tr_b16 v[180:181], v27 offset:16384
  buffer_load_dwordx4 a[4:7], v30, s[20:23], s90 offen offset:2304 sc1
  v_mfma_f32_16x16x32_bf16 v[100:103], v[184:187], a[108:111], v[100:103]
  ds_read_b64_tr_b16 v[182:183], v27 offset:17408
  s_add_u32 s90, s90, 4096
  v_mfma_f32_16x16x32_bf16 v[104:107], v[188:191], a[104:107], v[104:107]
  ds_read_b64_tr_b16 v[184:185], v28 offset:16384
  v_mfma_f32_16x16x32_bf16 v[108:111], v[188:191], a[108:111], v[108:111]
  ds_read_b64_tr_b16 v[186:187], v28 offset:17408
  s_waitcnt lgkmcnt(10)
  v_mfma_f32_16x16x32_bf16 v[48:51], v[160:163], a[112:115], v[48:51]
  ds_read_b64_tr_b16 v[188:189], v29 offset:16384
  buffer_load_dwordx4 a[8:11], v30, s[20:23], s90 offen offset:0 sc1
  v_mfma_f32_16x16x32_bf16 v[52:55], v[160:163], a[116:119], v[52:55]
  ds_read_b64_tr_b16 v[190:191], v29 offset:17408
  v_mfma_f32_16x16x32_bf16 v[56:59], v[164:167], a[112:115], v[56:59]
  ds_read_b64_tr_b16 v[160:161], v20 offset:24576
  v_mfma_f32_16x16x32_bf16 v[60:63], v[164:167], a[116:119], v[60:63]
  ds_read_b64_tr_b16 v[162:163], v20 offset:25600
  s_waitcnt lgkmcnt(10)
  v_mfma_f32_16x16x32_bf16 v[64:67], v[168:171], a[112:115], v[64:67]
  ds_read_b64_tr_b16 v[164:165], v21 offset:24576
  v_add_u32 v20, 32768, v20
  v_mfma_f32_16x16x32_bf16 v[68:71], v[168:171], a[116:119], v[68:71]
  ds_read_b64_tr_b16 v[166:167], v21 offset:25600
  v_add_u32 v21, 32768, v21
  v_mfma_f32_16x16x32_bf16 v[72:75], v[172:175], a[112:115], v[72:75]
  ds_read_b64_tr_b16 v[168:169], v22 offset:24576
  buffer_load_dwordx4 a[12:15], v30, s[20:23], s90 offen offset:256 sc1
  v_mfma_f32_16x16x32_bf16 v[76:79], v[172:175], a[116:119], v[76:79]
  ds_read_b64_tr_b16 v[170:171], v22 offset:25600
  s_waitcnt lgkmcnt(10)
  v_mfma_f32_16x16x32_bf16 v[80:83], v[176:179], a[112:115], v[80:83]
  ds_read_b64_tr_b16 v[172:173], v23 offset:24576
  v_add_u32 v22, 32768, v22
  v_mfma_f32_16x16x32_bf16 v[84:87], v[176:179], a[116:119], v[84:87]
  ds_read_b64_tr_b16 v[174:175], v23 offset:25600
  v_add_u32 v23, 32768, v23
  v_mfma_f32_16x16x32_bf16 v[88:91], v[180:183], a[112:115], v[88:91]
  ds_read_b64_tr_b16 v[176:177], v26 offset:24576
  v_mfma_f32_16x16x32_bf16 v[92:95], v[180:183], a[116:119], v[92:95]
  ds_read_b64_tr_b16 v[178:179], v26 offset:25600
  s_waitcnt lgkmcnt(10)
  v_mfma_f32_16x16x32_bf16 v[96:99], v[184:187], a[112:115], v[96:99]
  ds_read_b64_tr_b16 v[180:181], v27 offset:24576
  v_add_u32 v26, 32768, v26
  v_mfma_f32_16x16x32_bf16 v[100:103], v[184:187], a[116:119], v[100:103]
  ds_read_b64_tr_b16 v[182:183], v27 offset:25600
  buffer_load_dwordx4 a[16:19], v30, s[20:23], s90 offen offset:2048 sc1
  v_mfma_f32_16x16x32_bf16 v[104:107], v[188:191], a[112:115], v[104:107]
  ds_read_b64_tr_b16 v[184:185], v28 offset:24576
  v_add_u32 v27, 32768, v27
  v_mfma_f32_16x16x32_bf16 v[108:111], v[188:191], a[116:119], v[108:111]
  ds_read_b64_tr_b16 v[186:187], v28 offset:25600
  s_waitcnt lgkmcnt(10)
  v_mfma_f32_16x16x32_bf16 v[48:51], v[160:163], a[120:123], v[48:51]
  ds_read_b64_tr_b16 v[188:189], v29 offset:24576
  v_add_u32 v28, 32768, v28
  v_mfma_f32_16x16x32_bf16 v[52:55], v[160:163], a[124:127], v[52:55]
  ds_read_b64_tr_b16 v[190:191], v29 offset:25600
  buffer_load_dwordx4 a[20:23], v30, s[20:23], s90 offen offset:2304 sc1
  v_mfma_f32_16x16x32_bf16 v[56:59], v[164:167], a[120:123], v[56:59]
  s_add_u32 s90, s90, 4096
  v_add_u32 v29, 32768, v29
  v_mfma_f32_16x16x32_bf16 v[60:63], v[164:167], a[124:127], v[60:63]
  s_waitcnt lgkmcnt(8)
  buffer_load_dwordx4 a[24:27], v30, s[20:23], s90 offen offset:0 sc1
  v_mfma_f32_16x16x32_bf16 v[64:67], v[168:171], a[120:123], v[64:67]
  v_mfma_f32_16x16x32_bf16 v[68:71], v[168:171], a[124:127], v[68:71]
  s_waitcnt vmcnt(31) lgkmcnt(0)
  s_barrier
  v_mfma_f32_16x16x32_bf16 v[72:75], v[172:175], a[120:123], v[72:75]
  ds_read_b64_tr_b16 v[160:161], v20 offset:0
  ds_read_b64_tr_b16 v[162:163], v20 offset:1024
  buffer_load_dwordx4 a[28:31], v30, s[20:23], s90 offen offset:256 sc1
  v_mfma_f32_16x16x32_bf16 v[76:79], v[172:175], a[124:127], v[76:79]
  ds_read_b64_tr_b16 v[164:165], v21 offset:0
  ds_read_b64_tr_b16 v[166:167], v21 offset:1024
  v_mfma_f32_16x16x32_bf16 v[80:83], v[176:179], a[120:123], v[80:83]
  ds_read_b64_tr_b16 v[168:169], v22 offset:0
  ds_read_b64_tr_b16 v[170:171], v22 offset:1024
  s_add_u32 m0, s89, 0
  v_mfma_f32_16x16x32_bf16 v[84:87], v[176:179], a[124:127], v[84:87]
  ds_read_b64_tr_b16 v[172:173], v23 offset:0
  ds_read_b64_tr_b16 v[174:175], v23 offset:1024
  v_mfma_f32_16x16x32_bf16 v[88:91], v[180:183], a[120:123], v[88:91]
  ds_read_b64_tr_b16 v[176:177], v26 offset:0
  buffer_load_dwordx4 v8, s[24:27], s87 offen offset:0 lds
  v_mfma_f32_16x16x32_bf16 v[92:95], v[180:183], a[124:127], v[92:95]
  ds_read_b64_tr_b16 v[178:179], v26 offset:1024
  v_mfma_f32_16x16x32_bf16 v[96:99], v[184:187], a[120:123], v[96:99]
  ds_read_b64_tr_b16 v[180:181], v27 offset:0
  v_mfma_f32_16x16x32_bf16 v[100:103], v[184:187], a[124:127], v[100:103]
  ds_read_b64_tr_b16 v[182:183], v27 offset:1024
  v_mfma_f32_16x16x32_bf16 v[104:107], v[188:191], a[120:123], v[104:107]
  ds_read_b64_tr_b16 v[184:185], v28 offset:0
  buffer_load_dwordx4 v9, s[24:27], s87 offen offset:1024 lds
  v_mfma_f32_16x16x32_bf16 v[108:111], v[188:191], a[124:127], v[108:111]
  ds_read_b64_tr_b16 v[186:187], v28 offset:1024
  s_waitcnt lgkmcnt(10)
  v_mfma_f32_16x16x32_bf16 v[48:51], v[160:163], a[128:131], v[48:51]
  ds_read_b64_tr_b16 v[188:189], v29 offset:0
  v_mfma_f32_16x16x32_bf16 v[52:55], v[160:163], a[132:135], v[52:55]
  ds_read_b64_tr_b16 v[190:191], v29 offset:1024
  v_mfma_f32_16x16x32_bf16 v[56:59], v[164:167], a[128:131], v[56:59]
  ds_read_b64_tr_b16 v[160:161], v20 offset:8192
  v_mfma_f32_16x16x32_bf16 v[60:63], v[164:167], a[132:135], v[60:63]
  ds_read_b64_tr_b16 v[162:163], v20 offset:9216
  s_waitcnt lgkmcnt(10)
  v_mfma_f32_16x16x32_bf16 v[64:67], v[168:171], a[128:131], v[64:67]
  ds_read_b64_tr_b16 v[164:165], v21 offset:8192
  buffer_load_dwordx4 v10, s[24:27], s87 offen offset:2048 lds
  v_mfma_f32_16x16x32_bf16 v[68:71], v[168:171], a[132:135], v[68:71]
  ds_read_b64_tr_b16 v[166:167], v21 offset:9216
  v_mfma_f32_16x16x32_bf16 v[72:75], v[172:175], a[128:131], v[72:75]
  ds_read_b64_tr_b16 v[168:169], v22 offset:8192
  v_mfma_f32_16x16x32_bf16 v[76:79], v[172:175], a[132:135], v[76:79]
  ds_read_b64_tr_b16 v[170:171], v22 offset:9216
  s_waitcnt lgkmcnt(10)
  v_mfma_f32_16x16x32_bf16 v[80:83], v[176:179], a[128:131], v[80:83]
  ds_read_b64_tr_b16 v[172:173], v23 offset:8192
  buffer_load_dwordx4 v11, s[24:27], s87 offen offset:3072 lds
  v_mfma_f32_16x16x32_bf16 v[84:87], v[176:179], a[132:135], v[84:87]
  ds_read_b64_tr_b16 v[174:175], v23 offset:9216
  v_mfma_f32_16x16x32_bf16 v[88:91], v[180:183], a[128:131], v[88:91]
  ds_read_b64_tr_b16 v[176:177], v26 offset:8192
  s_add_u32 m0, s89, 4096
  v_mfma_f32_16x16x32_bf16 v[92:95], v[180:183], a[132:135], v[92:95]
  ds_read_b64_tr_b16 v[178:179], v26 offset:9216
  s_waitcnt lgkmcnt(10)
  v_mfma_f32_16x16x32_bf16 v[96:99], v[184:187], a[128:131], v[96:99]
  ds_read_b64_tr_b16 v[180:181], v27 offset:8192
  buffer_load_dwordx4 v8, s[24:27], s88 offen offset:0 lds
  v_mfma_f32_16x16x32_bf16 v[100:103], v[184:187], a[132:135], v[100:103]
  ds_read_b64_tr_b16 v[182:183], v27 offset:9216
  v_mfma_f32_16x16x32_bf16 v[104:107], v[188:191], a[128:131], v[104:107]
  ds_read_b64_tr_b16 v[184:185], v28 offset:8192
  v_mfma_f32_16x16x32_bf16 v[108:111], v[188:191], a[132:135], v[108:111]
  ds_read_b64_tr_b16 v[186:187], v28 offset:9216
  s_waitcnt lgkmcnt(10)
  v_mfma_f32_16x16x32_bf16 v[48:51], v[160:163], a[136:139], v[48:51]
  ds_read_b64_tr_b16 v[188:189], v29 offset:8192
  buffer_load_dwordx4 v9, s[24:27], s88 offen offset:1024 lds
  v_mfma_f32_16x16x32_bf16 v[52:55], v[160:163], a[140:143], v[52:55]
  ds_read_b64_tr_b16 v[190:191], v29 offset:9216
  v_mfma_f32_16x16x32_bf16 v[56:59], v[164:167], a[136:139], v[56:59]
  ds_read_b64_tr_b16 v[160:161], v20 offset:16384
  v_mfma_f32_16x16x32_bf16 v[60:63], v[164:167], a[140:143], v[60:63]
  ds_read_b64_tr_b16 v[162:163], v20 offset:17408
  s_waitcnt lgkmcnt(10)
  v_mfma_f32_16x16x32_bf16 v[64:67], v[168:171], a[136:139], v[64:67]
  ds_read_b64_tr_b16 v[164:165], v21 offset:16384
  buffer_load_dwordx4 v10, s[24:27], s88 offen offset:2048 lds
  v_mfma_f32_16x16x32_bf16 v[68:71], v[168:171], a[140:143], v[68:71]
  ds_read_b64_tr_b16 v[166:167], v21 offset:17408
L_touch15:
  s_cbranch_execz L_tback
  v_mfma_f32_16x16x32_bf16 v[72:75], v[172:175], a[136:139], v[72:75]
  ds_read_b64_tr_b16 v[168:169], v22 offset:16384
  v_mfma_f32_16x16x32_bf16 v[76:79], v[172:175], a[140:143], v[76:79]
  ds_read_b64_tr_b16 v[170:171], v22 offset:17408
  s_waitcnt lgkmcnt(10)
  v_mfma_f32_16x16x32_bf16 v[80:83], v[176:179], a[136:139], v[80:83]
  ds_read_b64_tr_b16 v[172:173], v23 offset:16384
  buffer_load_dwordx4 v11, s[24:27], s88 offen offset:3072 lds
  v_mfma_f32_16x16x32_bf16 v[84:87], v[176:179], a[140:143], v[84:87]
  ds_read_b64_tr_b16 v[174:175], v23 offset:17408
  s_add_u32 s87, s87, 262144
  v_mfma_f32_16x16x32_bf16 v[88:91], v[180:183], a[136:139], v[88:91]
  ds_read_b64_tr_b16 v[176:177], v26 offset:16384
  s_add_u32 s88, s88, 262144
  v_mfma_f32_16x16x32_bf16 v[92:95], v[180:183], a[140:143], v[92:95]
  ds_read_b64_tr_b16 v[178:179], v26 offset:17408
  s_waitcnt lgkmcnt(10)
  v_mfma_f32_16x16x32_bf16 v[96:99], v[184:187], a[136:139], v[96:99]
  ds_read_b64_tr_b16 v[180:181], v27 offset:16384
  buffer_load_dwordx4 a[32:35], v30, s[20:23], s90 offen offset:2048 sc1
  v_mfma_f32_16x16x32_bf16 v[100:103], v[184:187], a[140:143], v[100:103]
  ds_read_b64_tr_b16 v[182:183], v27 offset:17408
  v_mfma_f32_16x16x32_bf16 v[104:107], v[188:191], a[136:139], v[104:107]
  ds_read_b64_tr_b16 v[184:185], v28 offset:16384
  v_mfma_f32_16x16x32_bf16 v[108:111], v[188:191], a[140:143], v[108:111]
  ds_read_b64_tr_b16 v[186:187], v28 offset:17408
  s_waitcnt lgkmcnt(10)
  v_mfma_f32_16x16x32_bf16 v[48:51], v[160:163], a[144:147], v[48:51]
  ds_read_b64_tr_b16 v[188:189], v29 offset:16384
  v_mfma_f32_16x16x32_bf16 v[52:55], v[160:163], a[148:151], v[52:55]
  ds_read_b64_tr_b16 v[190:191], v29 offset:17408
  v_mfma_f32_16x16x32_bf16 v[56:59], v[164:167], a[144:147], v[56:59]
  ds_read_b64_tr_b16 v[160:161], v20 offset:24576
  v_mfma_f32_16x16x32_bf16 v[60:63], v[164:167], a[148:151], v[60:63]
  ds_read_b64_tr_b16 v[162:163], v20 offset:25600
  s_waitcnt lgkmcnt(10)
  v_mfma_f32_16x16x32_bf16 v[64:67], v[168:171], a[144:147], v[64:67]
  ds_read_b64_tr_b16 v[164:165], v21 offset:24576
  v_add_u32 v20, 32768, v20
  v_mfma_f32_16x16x32_bf16 v[68:71], v[168:171], a[148:151], v[68:71]
  ds_read_b64_tr_b16 v[166:167], v21 offset:25600
  buffer_load_dwordx4 a[36:39], v30, s[20:23], s90 offen offset:2304 sc1
  v_mfma_f32_16x16x32_bf16 v[72:75], v[172:175], a[144:147], v[72:75]
  ds_read_b64_tr_b16 v[168:169], v22 offset:24576
  s_add_u32 s90, s90, 4096
  v_add_u32 v21, 32768, v21
  v_mfma_f32_16x16x32_bf16 v[76:79], v[172:175], a[148:151], v[76:79]
  ds_read_b64_tr_b16 v[170:171], v22 offset:25600
  s_waitcnt lgkmcnt(10)
  v_mfma_f32_16x16x32_bf16 v[80:83], v[176:179], a[144:147], v[80:83]
  ds_read_b64_tr_b16 v[172:173], v23 offset:24576
  v_add_u32 v22, 32768, v22
  v_mfma_f32_16x16x32_bf16 v[84:87], v[176:179], a[148:151], v[84:87]
  ds_read_b64_tr_b16 v[174:175], v23 offset:25600
  buffer_load_dwordx4 a[40:43], v30, s[20:23], s90 offen offset:0 sc1
  v_mfma_f32_16x16x32_bf16 v[88:91], v[180:183], a[144:147], v[88:91]
  ds_read_b64_tr_b16 v[176:177], v26 offset:24576
  v_add_u32 v23, 32768, v23
  v_mfma_f32_16x16x32_bf16 v[92:95], v[180:183], a[148:151], v[92:95]
  ds_read_b64_tr_b16 v[178:179], v26 offset:25600
  s_waitcnt lgkmcnt(10)
  v_mfma_f32_16x16x32_bf16 v[96:99], v[184:187], a[144:147], v[96:99]
  ds_read_b64_tr_b16 v[180:181], v27 offset:24576
  v_add_u32 v26, 32768, v26
  v_mfma_f32_16x16x32_bf16 v[100:103], v[184:187], a[148:151], v[100:103]
  ds_read_b64_tr_b16 v[182:183], v27 offset:25600
  buffer_load_dwordx4 a[44:47], v30, s[20:23], s90 offen offset:256 sc1
  v_mfma_f32_16x16x32_bf16 v[104:107], v[188:191], a[144:147], v[104:107]
  ds_read_b64_tr_b16 v[184:185], v28 offset:24576
  v_add_u32 v27, 32768, v27
  v_mfma_f32_16x16x32_bf16 v[108:111], v[188:191], a[148:151], v[108:111]
  ds_read_b64_tr_b16 v[186:187], v28 offset:25600
  s_waitcnt lgkmcnt(10)
  v_mfma_f32_16x16x32_bf16 v[48:51], v[160:163], a[152:155], v[48:51]
  ds_read_b64_tr_b16 v[188:189], v29 offset:24576
  v_add_u32 v28, 32768, v28
  v_mfma_f32_16x16x32_bf16 v[52:55], v[160:163], a[156:159], v[52:55]
  ds_read_b64_tr_b16 v[190:191], v29 offset:25600
  buffer_load_dwordx4 a[48:51], v30, s[20:23], s90 offen offset:2048 sc1
  v_mfma_f32_16x16x32_bf16 v[56:59], v[164:167], a[152:155], v[56:59]
  v_add_u32 v29, 32768, v29
  v_mfma_f32_16x16x32_bf16 v[60:63], v[164:167], a[156:159], v[60:63]
  s_waitcnt lgkmcnt(8)
  buffer_load_dwordx4 a[52:55], v30, s[20:23], s90 offen offset:2304 sc1
  v_mfma_f32_16x16x32_bf16 v[64:67], v[168:171], a[152:155], v[64:67]
  s_add_u32 s90, s90, 4096
  v_mfma_f32_16x16x32_bf16 v[68:71], v[168:171], a[156:159], v[68:71]
  s_waitcnt vmcnt(38) lgkmcnt(0)
  s_barrier
  v_mfma_f32_16x16x32_bf16 v[72:75], v[172:175], a[152:155], v[72:75]
  ds_read_b64_tr_b16 v[160:161], v20 offset:0
  ds_read_b64_tr_b16 v[162:163], v20 offset:1024
  buffer_load_dwordx4 a[56:59], v30, s[20:23], s90 offen offset:0 sc1
  v_mfma_f32_16x16x32_bf16 v[76:79], v[172:175], a[156:159], v[76:79]
  ds_read_b64_tr_b16 v[164:165], v21 offset:0
  ds_read_b64_tr_b16 v[166:167], v21 offset:1024
  v_mfma_f32_16x16x32_bf16 v[80:83], v[176:179], a[152:155], v[80:83]
  ds_read_b64_tr_b16 v[168:169], v22 offset:0
  ds_read_b64_tr_b16 v[170:171], v22 offset:1024
  s_add_u32 m0, s89, 32768
  v_mfma_f32_16x16x32_bf16 v[84:87], v[176:179], a[156:159], v[84:87]
  ds_read_b64_tr_b16 v[172:173], v23 offset:0
  ds_read_b64_tr_b16 v[174:175], v23 offset:1024
  v_mfma_f32_16x16x32_bf16 v[88:91], v[180:183], a[152:155], v[88:91]
  ds_read_b64_tr_b16 v[176:177], v26 offset:0
  buffer_load_dwordx4 v8, s[24:27], s87 offen offset:0 lds
  v_mfma_f32_16x16x32_bf16 v[92:95], v[180:183], a[156:159], v[92:95]
  ds_read_b64_tr_b16 v[178:179], v26 offset:1024
  v_mfma_f32_16x16x32_bf16 v[96:99], v[184:187], a[152:155], v[96:99]
  ds_read_b64_tr_b16 v[180:181], v27 offset:0
  v_mfma_f32_16x16x32_bf16 v[100:103], v[184:187], a[156:159], v[100:103]
  ds_read_b64_tr_b16 v[182:183], v27 offset:1024
  v_mfma_f32_16x16x32_bf16 v[104:107], v[188:191], a[152:155], v[104:107]
  ds_read_b64_tr_b16 v[184:185], v28 offset:0
  v_mfma_f32_16x16x32_bf16 v[108:111], v[188:191], a[156:159], v[108:111]
  ds_read_b64_tr_b16 v[186:187], v28 offset:1024
  s_waitcnt lgkmcnt(10)
  v_mfma_f32_16x16x32_bf16 v[48:51], v[160:163], a[160:163], v[48:51]
  ds_read_b64_tr_b16 v[188:189], v29 offset:0
  buffer_load_dwordx4 v9, s[24:27], s87 offen offset:1024 lds
  v_mfma_f32_16x16x32_bf16 v[52:55], v[160:163], a[164:167], v[52:55]
  ds_read_b64_tr_b16 v[190:191], v29 offset:1024
  v_mfma_f32_16x16x32_bf16 v[56:59], v[164:167], a[160:163], v[56:59]
  ds_read_b64_tr_b16 v[160:161], v20 offset:8192
  v_mfma_f32_16x16x32_bf16 v[60:63], v[164:167], a[164:167], v[60:63]
  ds_read_b64_tr_b16 v[162:163], v20 offset:9216
  s_waitcnt lgkmcnt(10)
  v_mfma_f32_16x16x32_bf16 v[64:67], v[168:171], a[160:163], v[64:67]
  ds_read_b64_tr_b16 v[164:165], v21 offset:8192
  buffer_load_dwordx4 v10, s[24:27], s87 offen offset:2048 lds
  v_mfma_f32_16x16x32_bf16 v[68:71], v[168:171], a[164:167], v[68:71]
  ds_read_b64_tr_b16 v[166:167], v21 offset:9216
  v_mfma_f32_16x16x32_bf16 v[72:75], v[172:175], a[160:163], v[72:75]
  ds_read_b64_tr_b16 v[168:169], v22 offset:8192
  v_mfma_f32_16x16x32_bf16 v[76:79], v[172:175], a[164:167], v[76:79]
  ds_read_b64_tr_b16 v[170:171], v22 offset:9216
  s_waitcnt lgkmcnt(10)
  v_mfma_f32_16x16x32_bf16 v[80:83], v[176:179], a[160:163], v[80:83]
  ds_read_b64_tr_b16 v[172:173], v23 offset:8192
  buffer_load_dwordx4 v11, s[24:27], s87 offen offset:3072 lds
  v_mfma_f32_16x16x32_bf16 v[84:87], v[176:179], a[164:167], v[84:87]
  ds_read_b64_tr_b16 v[174:175], v23 offset:9216
  v_mfma_f32_16x16x32_bf16 v[88:91], v[180:183], a[160:163], v[88:91]
  ds_read_b64_tr_b16 v[176:177], v26 offset:8192
  s_add_u32 m0, s89, 36864
  v_mfma_f32_16x16x32_bf16 v[92:95], v[180:183], a[164:167], v[92:95]
  ds_read_b64_tr_b16 v[178:179], v26 offset:9216
  s_waitcnt lgkmcnt(10)
  v_mfma_f32_16x16x32_bf16 v[96:99], v[184:187], a[160:163], v[96:99]
  ds_read_b64_tr_b16 v[180:181], v27 offset:8192
  buffer_load_dwordx4 v8, s[24:27], s88 offen offset:0 lds
  v_mfma_f32_16x16x32_bf16 v[100:103], v[184:187], a[164:167], v[100:103]
  ds_read_b64_tr_b16 v[182:183], v27 offset:9216
  v_mfma_f32_16x16x32_bf16 v[104:107], v[188:191], a[160:163], v[104:107]
  ds_read_b64_tr_b16 v[184:185], v28 offset:8192
  v_mfma_f32_16x16x32_bf16 v[108:111], v[188:191], a[164:167], v[108:111]
  ds_read_b64_tr_b16 v[186:187], v28 offset:9216
  s_waitcnt lgkmcnt(10)
  v_mfma_f32_16x16x32_bf16 v[48:51], v[160:163], a[168:171], v[48:51]
  ds_read_b64_tr_b16 v[188:189], v29 offset:8192
  buffer_load_dwordx4 v9, s[24:27], s88 offen offset:1024 lds
  v_mfma_f32_16x16x32_bf16 v[52:55], v[160:163], a[172:175], v[52:55]
  ds_read_b64_tr_b16 v[190:191], v29 offset:9216
  v_mfma_f32_16x16x32_bf16 v[56:59], v[164:167], a[168:171], v[56:59]
  ds_read_b64_tr_b16 v[160:161], v20 offset:16384
  v_mfma_f32_16x16x32_bf16 v[60:63], v[164:167], a[172:175], v[60:63]
  ds_read_b64_tr_b16 v[162:163], v20 offset:17408
  s_waitcnt lgkmcnt(10)
  v_mfma_f32_16x16x32_bf16 v[64:67], v[168:171], a[168:171], v[64:67]
  ds_read_b64_tr_b16 v[164:165], v21 offset:16384
  buffer_load_dwordx4 v10, s[24:27], s88 offen offset:2048 lds
  v_mfma_f32_16x16x32_bf16 v[68:71], v[168:171], a[172:175], v[68:71]
  ds_read_b64_tr_b16 v[166:167], v21 offset:17408
  v_mfma_f32_16x16x32_bf16 v[72:75], v[172:175], a[168:171], v[72:75]
  ds_read_b64_tr_b16 v[168:169], v22 offset:16384
  v_mfma_f32_16x16x32_bf16 v[76:79], v[172:175], a[172:175], v[76:79]
  ds_read_b64_tr_b16 v[170:171], v22 offset:17408
  s_waitcnt lgkmcnt(10)
  v_mfma_f32_16x16x32_bf16 v[80:83], v[176:179], a[168:171], v[80:83]
  ds_read_b64_tr_b16 v[172:173], v23 offset:16384
  v_mfma_f32_16x16x32_bf16 v[84:87], v[176:179], a[172:175], v[84:87]
  ds_read_b64_tr_b16 v[174:175], v23 offset:17408
  v_mfma_f32_16x16x32_bf16 v[88:91], v[180:183], a[168:171], v[88:91]
  ds_read_b64_tr_b16 v[176:177], v26 offset:16384
  buffer_load_dwordx4 v11, s[24:27], s88 offen offset:3072 lds
  v_mfma_f32_16x16x32_bf16 v[92:95], v[180:183], a[172:175], v[92:95]
  ds_read_b64_tr_b16 v[178:179], v26 offset:17408
  s_waitcnt lgkmcnt(10)
  v_mfma_f32_16x16x32_bf16 v[96:99], v[184:187], a[168:171], v[96:99]
  ds_read_b64_tr_b16 v[180:181], v27 offset:16384
  s_add_u32 s87, s87, 262144
  v_mfma_f32_16x16x32_bf16 v[100:103], v[184:187], a[172:175], v[100:103]
  ds_read_b64_tr_b16 v[182:183], v27 offset:17408
  s_add_u32 s88, s88, 262144
  v_mfma_f32_16x16x32_bf16 v[104:107], v[188:191], a[168:171], v[104:107]
  ds_read_b64_tr_b16 v[184:185], v28 offset:16384
  buffer_load_dwordx4 a[60:63], v30, s[20:23], s90 offen offset:256 sc1
  v_mfma_f32_16x16x32_bf16 v[108:111], v[188:191], a[172:175], v[108:111]
  ds_read_b64_tr_b16 v[186:187], v28 offset:17408
  s_waitcnt lgkmcnt(10)
  v_mfma_f32_16x16x32_bf16 v[48:51], v[160:163], a[176:179], v[48:51]
  ds_read_b64_tr_b16 v[188:189], v29 offset:16384
  v_mfma_f32_16x16x32_bf16 v[52:55], v[160:163], a[180:183], v[52:55]
  ds_read_b64_tr_b16 v[190:191], v29 offset:17408
  v_mfma_f32_16x16x32_bf16 v[56:59], v[164:167], a[176:179], v[56:59]
  ds_read_b64_tr_b16 v[160:161], v20 offset:24576
  v_mfma_f32_16x16x32_bf16 v[60:63], v[164:167], a[180:183], v[60:63]
  ds_read_b64_tr_b16 v[162:163], v20 offset:25600
  s_waitcnt lgkmcnt(10)
  v_mfma_f32_16x16x32_bf16 v[64:67], v[168:171], a[176:179], v[64:67]
  ds_read_b64_tr_b16 v[164:165], v21 offset:24576
  v_add_u32 v20, 32768, v20
  v_mfma_f32_16x16x32_bf16 v[68:71], v[168:171], a[180:183], v[68:71]
  ds_read_b64_tr_b16 v[166:167], v21 offset:25600
  buffer_load_dwordx4 a[64:67], v30, s[20:23], s90 offen offset:2048 sc1
  v_mfma_f32_16x16x32_bf16 v[72:75], v[172:175], a[176:179], v[72:75]
  ds_read_b64_tr_b16 v[168:169], v22 offset:24576
  v_add_u32 v21, 32768, v21
  v_mfma_f32_16x16x32_bf16 v[76:79], v[172:175], a[180:183], v[76:79]
  ds_read_b64_tr_b16 v[170:171], v22 offset:25600
  s_waitcnt lgkmcnt(10)
  v_mfma_f32_16x16x32_bf16 v[80:83], v[176:179], a[176:179], v[80:83]
  ds_read_b64_tr_b16 v[172:173], v23 offset:24576
  v_add_u32 v22, 32768, v22
  v_mfma_f32_16x16x32_bf16 v[84:87], v[176:179], a[180:183], v[84:87]
  ds_read_b64_tr_b16 v[174:175], v23 offset:25600
  buffer_load_dwordx4 a[68:71], v30, s[20:23], s90 offen offset:2304 sc1
  v_mfma_f32_16x16x32_bf16 v[88:91], v[180:183], a[176:179], v[88:91]
  ds_read_b64_tr_b16 v[176:177], v26 offset:24576
  s_add_u32 s90, s90, 4096
  v_add_u32 v23, 32768, v23
  v_mfma_f32_16x16x32_bf16 v[92:95], v[180:183], a[180:183], v[92:95]
  ds_read_b64_tr_b16 v[178:179], v26 offset:25600
  s_waitcnt lgkmcnt(10)
  v_mfma_f32_16x16x32_bf16 v[96:99], v[184:187], a[176:179], v[96:99]
  ds_read_b64_tr_b16 v[180:181], v27 offset:24576
  v_add_u32 v26, 32768, v26
  v_mfma_f32_16x16x32_bf16 v[100:103], v[184:187], a[180:183], v[100:103]
  ds_read_b64_tr_b16 v[182:183], v27 offset:25600
  buffer_load_dwordx4 a[72:75], v30, s[20:23], s90 offen offset:0 sc1
  v_mfma_f32_16x16x32_bf16 v[104:107], v[188:191], a[176:179], v[104:107]
  ds_read_b64_tr_b16 v[184:185], v28 offset:24576
  v_add_u32 v27, 32768, v27
  v_mfma_f32_16x16x32_bf16 v[108:111], v[188:191], a[180:183], v[108:111]
  ds_read_b64_tr_b16 v[186:187], v28 offset:25600
  s_waitcnt lgkmcnt(10)
  v_mfma_f32_16x16x32_bf16 v[48:51], v[160:163], a[184:187], v[48:51]
  ds_read_b64_tr_b16 v[188:189], v29 offset:24576
  v_add_u32 v28, 32768, v28
  v_mfma_f32_16x16x32_bf16 v[52:55], v[160:163], a[188:191], v[52:55]
  ds_read_b64_tr_b16 v[190:191], v29 offset:25600
  buffer_load_dwordx4 a[76:79], v30, s[20:23], s90 offen offset:256 sc1
  v_mfma_f32_16x16x32_bf16 v[56:59], v[164:167], a[184:187], v[56:59]
  v_add_u32 v29, 32768, v29
  v_mfma_f32_16x16x32_bf16 v[60:63], v[164:167], a[188:191], v[60:63]
  s_waitcnt lgkmcnt(8)
  buffer_load_dwordx4 a[80:83], v30, s[20:23], s90 offen offset:2048 sc1
  v_mfma_f32_16x16x32_bf16 v[64:67], v[168:171], a[184:187], v[64:67]
  v_mfma_f32_16x16x32_bf16 v[68:71], v[168:171], a[188:191], v[68:71]
  s_waitcnt vmcnt(45) lgkmcnt(0)
  s_barrier
  v_mfma_f32_16x16x32_bf16 v[72:75], v[172:175], a[184:187], v[72:75]
  ds_read_b64_tr_b16 v[160:161], v20 offset:0
  ds_read_b64_tr_b16 v[162:163], v20 offset:1024
  s_add_u32 m0, s89, 65536
  v_mfma_f32_16x16x32_bf16 v[76:79], v[172:175], a[188:191], v[76:79]
  ds_read_b64_tr_b16 v[164:165], v21 offset:0
  ds_read_b64_tr_b16 v[166:167], v21 offset:1024
  v_mfma_f32_16x16x32_bf16 v[80:83], v[176:179], a[184:187], v[80:83]
  ds_read_b64_tr_b16 v[168:169], v22 offset:0
  ds_read_b64_tr_b16 v[170:171], v22 offset:1024
  buffer_load_dwordx4 v8, s[24:27], s87 offen offset:0 lds
  v_mfma_f32_16x16x32_bf16 v[84:87], v[176:179], a[188:191], v[84:87]
  ds_read_b64_tr_b16 v[172:173], v23 offset:0
  ds_read_b64_tr_b16 v[174:175], v23 offset:1024
  v_mfma_f32_16x16x32_bf16 v[88:91], v[180:183], a[184:187], v[88:91]
  ds_read_b64_tr_b16 v[176:177], v26 offset:0
  v_mfma_f32_16x16x32_bf16 v[92:95], v[180:183], a[188:191], v[92:95]
  ds_read_b64_tr_b16 v[178:179], v26 offset:1024
  v_mfma_f32_16x16x32_bf16 v[96:99], v[184:187], a[184:187], v[96:99]
  ds_read_b64_tr_b16 v[180:181], v27 offset:0
  buffer_load_dwordx4 v9, s[24:27], s87 offen offset:1024 lds
  v_mfma_f32_16x16x32_bf16 v[100:103], v[184:187], a[188:191], v[100:103]
  ds_read_b64_tr_b16 v[182:183], v27 offset:1024
  v_mfma_f32_16x16x32_bf16 v[104:107], v[188:191], a[184:187], v[104:107]
  ds_read_b64_tr_b16 v[184:185], v28 offset:0
  v_mfma_f32_16x16x32_bf16 v[108:111], v[188:191], a[188:191], v[108:111]
  ds_read_b64_tr_b16 v[186:187], v28 offset:1024
  s_waitcnt lgkmcnt(10)
  v_mfma_f32_16x16x32_bf16 v[48:51], v[160:163], a[192:195], v[48:51]
  ds_read_b64_tr_b16 v[188:189], v29 offset:0
  buffer_load_dwordx4 v10, s[24:27], s87 offen offset:2048 lds
  v_mfma_f32_16x16x32_bf16 v[52:55], v[160:163], a[196:199], v[52:55]
  ds_read_b64_tr_b16 v[190:191], v29 offset:1024
  v_mfma_f32_16x16x32_bf16 v[56:59], v[164:167], a[192:195], v[56:59]
  ds_read_b64_tr_b16 v[160:161], v20 offset:8192
  v_mfma_f32_16x16x32_bf16 v[60:63], v[164:167], a[196:199], v[60:63]
  ds_read_b64_tr_b16 v[162:163], v20 offset:9216
  s_waitcnt lgkmcnt(10)
  v_mfma_f32_16x16x32_bf16 v[64:67], v[168:171], a[192:195], v[64:67]
  ds_read_b64_tr_b16 v[164:165], v21 offset:8192
  buffer_load_dwordx4 v11, s[24:27], s87 offen offset:3072 lds
  v_mfma_f32_16x16x32_bf16 v[68:71], v[168:171], a[196:199], v[68:71]
  ds_read_b64_tr_b16 v[166:167], v21 offset:9216
  v_mfma_f32_16x16x32_bf16 v[72:75], v[172:175], a[192:195], v[72:75]
  ds_read_b64_tr_b16 v[168:169], v22 offset:8192
  s_add_u32 m0, s89, 69632
  v_mfma_f32_16x16x32_bf16 v[76:79], v[172:175], a[196:199], v[76:79]
  ds_read_b64_tr_b16 v[170:171], v22 offset:9216
  s_waitcnt lgkmcnt(10)
  v_mfma_f32_16x16x32_bf16 v[80:83], v[176:179], a[192:195], v[80:83]
  ds_read_b64_tr_b16 v[172:173], v23 offset:8192
  buffer_load_dwordx4 v8, s[24:27], s88 offen offset:0 lds
  v_mfma_f32_16x16x32_bf16 v[84:87], v[176:179], a[196:199], v[84:87]
  ds_read_b64_tr_b16 v[174:175], v23 offset:9216
  v_mfma_f32_16x16x32_bf16 v[88:91], v[180:183], a[192:195], v[88:91]
  ds_read_b64_tr_b16 v[176:177], v26 offset:8192
  v_mfma_f32_16x16x32_bf16 v[92:95], v[180:183], a[196:199], v[92:95]
  ds_read_b64_tr_b16 v[178:179], v26 offset:9216
  s_waitcnt lgkmcnt(10)
  v_mfma_f32_16x16x32_bf16 v[96:99], v[184:187], a[192:195], v[96:99]
  ds_read_b64_tr_b16 v[180:181], v27 offset:8192
  buffer_load_dwordx4 v9, s[24:27], s88 offen offset:1024 lds
  v_mfma_f32_16x16x32_bf16 v[100:103], v[184:187], a[196:199], v[100:103]
  ds_read_b64_tr_b16 v[182:183], v27 offset:9216
  v_mfma_f32_16x16x32_bf16 v[104:107], v[188:191], a[192:195], v[104:107]
  ds_read_b64_tr_b16 v[184:185], v28 offset:8192
  v_mfma_f32_16x16x32_bf16 v[108:111], v[188:191], a[196:199], v[108:111]
  ds_read_b64_tr_b16 v[186:187], v28 offset:9216
  s_waitcnt lgkmcnt(10)
  v_mfma_f32_16x16x32_bf16 v[48:51], v[160:163], a[200:203], v[48:51]
  ds_read_b64_tr_b16 v[188:189], v29 offset:8192
  buffer_load_dwordx4 v10, s[24:27], s88 offen offset:2048 lds
  v_mfma_f32_16x16x32_bf16 v[52:55], v[160:163], a[204:207], v[52:55]
  ds_read_b64_tr_b16 v[190:191], v29 offset:9216
  v_mfma_f32_16x16x32_bf16 v[56:59], v[164:167], a[200:203], v[56:59]
  ds_read_b64_tr_b16 v[160:161], v20 offset:16384
  v_mfma_f32_16x16x32_bf16 v[60:63], v[164:167], a[204:207], v[60:63]
  ds_read_b64_tr_b16 v[162:163], v20 offset:17408
  s_waitcnt lgkmcnt(10)
  v_mfma_f32_16x16x32_bf16 v[64:67], v[168:171], a[200:203], v[64:67]
  ds_read_b64_tr_b16 v[164:165], v21 offset:16384
  v_mfma_f32_16x16x32_bf16 v[68:71], v[168:171], a[204:207], v[68:71]
  ds_read_b64_tr_b16 v[166:167], v21 offset:17408
  v_mfma_f32_16x16x32_bf16 v[72:75], v[172:175], a[200:203], v[72:75]
  ds_read_b64_tr_b16 v[168:169], v22 offset:16384
  buffer_load_dwordx4 v11, s[24:27], s88 offen offset:3072 lds
  v_mfma_f32_16x16x32_bf16 v[76:79], v[172:175], a[204:207], v[76:79]
  ds_read_b64_tr_b16 v[170:171], v22 offset:17408
  s_waitcnt lgkmcnt(10)
  v_mfma_f32_16x16x32_bf16 v[80:83], v[176:179], a[200:203], v[80:83]
  ds_read_b64_tr_b16 v[172:173], v23 offset:16384
  s_add_u32 s87, s87, 262144
  v_mfma_f32_16x16x32_bf16 v[84:87], v[176:179], a[204:207], v[84:87]
  ds_read_b64_tr_b16 v[174:175], v23 offset:17408
  s_add_u32 s88, s88, 262144
  v_mfma_f32_16x16x32_bf16 v[88:91], v[180:183], a[200:203], v[88:91]
  ds_read_b64_tr_b16 v[176:177], v26 offset:16384
  buffer_load_dwordx4 a[84:87], v30, s[20:23], s90 offen offset:2304 sc1
  v_mfma_f32_16x16x32_bf16 v[92:95], v[180:183], a[204:207], v[92:95]
  ds_read_b64_tr_b16 v[178:179], v26 offset:17408
  s_waitcnt lgkmcnt(10)
  v_mfma_f32_16x16x32_bf16 v[96:99], v[184:187], a[200:203], v[96:99]
  ds_read_b64_tr_b16 v[180:181], v27 offset:16384
  s_add_u32 s90, s90, 4096
  v_mfma_f32_16x16x32_bf16 v[100:103], v[184:187], a[204:207], v[100:103]
  ds_read_b64_tr_b16 v[182:183], v27 offset:17408
  v_mfma_f32_16x16x32_bf16 v[104:107], v[188:191], a[200:203], v[104:107]
  ds_read_b64_tr_b16 v[184:185], v28 offset:16384
  buffer_load_dwordx4 a[88:91], v30, s[20:23], s90 offen offset:0 sc1
  v_mfma_f32_16x16x32_bf16 v[108:111], v[188:191], a[204:207], v[108:111]
  ds_read_b64_tr_b16 v[186:187], v28 offset:17408
  s_waitcnt lgkmcnt(10)
  v_mfma_f32_16x16x32_bf16 v[48:51], v[160:163], a[208:211], v[48:51]
  ds_read_b64_tr_b16 v[188:189], v29 offset:16384
  v_mfma_f32_16x16x32_bf16 v[52:55], v[160:163], a[212:215], v[52:55]
  ds_read_b64_tr_b16 v[190:191], v29 offset:17408
  v_mfma_f32_16x16x32_bf16 v[56:59], v[164:167], a[208:211], v[56:59]
  ds_read_b64_tr_b16 v[160:161], v20 offset:24576
  v_mfma_f32_16x16x32_bf16 v[60:63], v[164:167], a[212:215], v[60:63]
  ds_read_b64_tr_b16 v[162:163], v20 offset:25600
  s_waitcnt lgkmcnt(10)
  v_mfma_f32_16x16x32_bf16 v[64:67], v[168:171], a[208:211], v[64:67]
  ds_read_b64_tr_b16 v[164:165], v21 offset:24576
  v_add_u32 v20, 32768, v20
  v_mfma_f32_16x16x32_bf16 v[68:71], v[168:171], a[212:215], v[68:71]
  ds_read_b64_tr_b16 v[166:167], v21 offset:25600
  buffer_load_dwordx4 a[92:95], v30, s[20:23], s90 offen offset:256 sc1
  v_mfma_f32_16x16x32_bf16 v[72:75], v[172:175], a[208:211], v[72:75]
  ds_read_b64_tr_b16 v[168:169], v22 offset:24576
  v_add_u32 v21, 32768, v21
  v_mfma_f32_16x16x32_bf16 v[76:79], v[172:175], a[212:215], v[76:79]
  ds_read_b64_tr_b16 v[170:171], v22 offset:25600
  s_waitcnt lgkmcnt(10)
  v_mfma_f32_16x16x32_bf16 v[80:83], v[176:179], a[208:211], v[80:83]
  ds_read_b64_tr_b16 v[172:173], v23 offset:24576
  v_add_u32 v22, 32768, v22
  v_mfma_f32_16x16x32_bf16 v[84:87], v[176:179], a[212:215], v[84:87]
  ds_read_b64_tr_b16 v[174:175], v23 offset:25600
  buffer_load_dwordx4 a[96:99], v30, s[20:23], s90 offen offset:2048 sc1
  v_mfma_f32_16x16x32_bf16 v[88:91], v[180:183], a[208:211], v[88:91]
  ds_read_b64_tr_b16 v[176:177], v26 offset:24576
  v_add_u32 v23, 32768, v23
  v_mfma_f32_16x16x32_bf16 v[92:95], v[180:183], a[212:215], v[92:95]
  ds_read_b64_tr_b16 v[178:179], v26 offset:25600
  s_waitcnt lgkmcnt(10)
  v_mfma_f32_16x16x32_bf16 v[96:99], v[184:187], a[208:211], v[96:99]
  ds_read_b64_tr_b16 v[180:181], v27 offset:24576
  v_add_u32 v26, 32768, v26
  v_mfma_f32_16x16x32_bf16 v[100:103], v[184:187], a[212:215], v[100:103]
  ds_read_b64_tr_b16 v[182:183], v27 offset:25600
  buffer_load_dwordx4 a[100:103], v30, s[20:23], s90 offen offset:2304 sc1
  v_mfma_f32_16x16x32_bf16 v[104:107], v[188:191], a[208:211], v[104:107]
  ds_read_b64_tr_b16 v[184:185], v28 offset:24576
  s_add_u32 s90, s90, 4096
  v_mfma_f32_16x16x32_bf16 v[108:111], v[188:191], a[212:215], v[108:111]
  ds_read_b64_tr_b16 v[186:187], v28 offset:25600
  s_waitcnt lgkmcnt(10)
  v_mfma_f32_16x16x32_bf16 v[48:51], v[160:163], a[216:219], v[48:51]
  ds_read_b64_tr_b16 v[188:189], v29 offset:24576
  v_add_u32 v27, 32768, v27
  v_mfma_f32_16x16x32_bf16 v[52:55], v[160:163], a[220:223], v[52:55]
  ds_read_b64_tr_b16 v[190:191], v29 offset:25600
  v_add_u32 v28, 32768, v28
  v_mfma_f32_16x16x32_bf16 v[56:59], v[164:167], a[216:219], v[56:59]
  v_add_u32 v29, 32768, v29
  v_mfma_f32_16x16x32_bf16 v[60:63], v[164:167], a[220:223], v[60:63]
  s_waitcnt lgkmcnt(8)
  v_mfma_f32_16x16x32_bf16 v[64:67], v[168:171], a[216:219], v[64:67]
  v_mfma_f32_16x16x32_bf16 v[68:71], v[168:171], a[220:223], v[68:71]
  s_waitcnt vmcnt(49) lgkmcnt(0)
  s_barrier
  v_mfma_f32_16x16x32_bf16 v[72:75], v[172:175], a[216:219], v[72:75]
  ds_read_b64_tr_b16 v[160:161], v20 offset:0
  ds_read_b64_tr_b16 v[162:163], v20 offset:1024
  s_add_u32 m0, s89, 98304
  v_mfma_f32_16x16x32_bf16 v[76:79], v[172:175], a[220:223], v[76:79]
  ds_read_b64_tr_b16 v[164:165], v21 offset:0
  ds_read_b64_tr_b16 v[166:167], v21 offset:1024
  v_mfma_f32_16x16x32_bf16 v[80:83], v[176:179], a[216:219], v[80:83]
  ds_read_b64_tr_b16 v[168:169], v22 offset:0
  ds_read_b64_tr_b16 v[170:171], v22 offset:1024
  buffer_load_dwordx4 v8, s[24:27], s87 offen offset:0 lds
  v_mfma_f32_16x16x32_bf16 v[84:87], v[176:179], a[220:223], v[84:87]
  ds_read_b64_tr_b16 v[172:173], v23 offset:0
  ds_read_b64_tr_b16 v[174:175], v23 offset:1024
  buffer_load_dword v25, v24, s[20:23], s94 offen sc1
  v_mfma_f32_16x16x32_bf16 v[88:91], v[180:183], a[216:219], v[88:91]
  ds_read_b64_tr_b16 v[176:177], v26 offset:0
  buffer_load_dwordx4 v9, s[24:27], s87 offen offset:1024 lds
  v_mfma_f32_16x16x32_bf16 v[92:95], v[180:183], a[220:223], v[92:95]
  ds_read_b64_tr_b16 v[178:179], v26 offset:1024
  v_mfma_f32_16x16x32_bf16 v[96:99], v[184:187], a[216:219], v[96:99]
  ds_read_b64_tr_b16 v[180:181], v27 offset:0
  v_mfma_f32_16x16x32_bf16 v[100:103], v[184:187], a[220:223], v[100:103]
  ds_read_b64_tr_b16 v[182:183], v27 offset:1024
  v_mfma_f32_16x16x32_bf16 v[104:107], v[188:191], a[216:219], v[104:107]
  ds_read_b64_tr_b16 v[184:185], v28 offset:0
  buffer_load_dwordx4 v10, s[24:27], s87 offen offset:2048 lds
  v_mfma_f32_16x16x32_bf16 v[108:111], v[188:191], a[220:223], v[108:111]
  ds_read_b64_tr_b16 v[186:187], v28 offset:1024
  s_waitcnt lgkmcnt(10)
  v_mfma_f32_16x16x32_bf16 v[48:51], v[160:163], v[200:203], v[48:51]
  ds_read_b64_tr_b16 v[188:189], v29 offset:0
  v_mfma_f32_16x16x32_bf16 v[52:55], v[160:163], v[204:207], v[52:55]
  ds_read_b64_tr_b16 v[190:191], v29 offset:1024
  v_mfma_f32_16x16x32_bf16 v[56:59], v[164:167], v[200:203], v[56:59]
  ds_read_b64_tr_b16 v[160:161], v20 offset:8192
  buffer_load_dwordx4 v11, s[24:27], s87 offen offset:3072 lds
  v_mfma_f32_16x16x32_bf16 v[60:63], v[164:167], v[204:207], v[60:63]
  ds_read_b64_tr_b16 v[162:163], v20 offset:9216
  s_waitcnt lgkmcnt(10)
  v_mfma_f32_16x16x32_bf16 v[64:67], v[168:171], v[200:203], v[64:67]
  ds_read_b64_tr_b16 v[164:165], v21 offset:8192
  s_add_u32 m0, s89, 102400
  v_mfma_f32_16x16x32_bf16 v[68:71], v[168:171], v[204:207], v[68:71]
  ds_read_b64_tr_b16 v[166:167], v21 offset:9216
  v_mfma_f32_16x16x32_bf16 v[72:75], v[172:175], v[200:203], v[72:75]
  ds_read_b64_tr_b16 v[168:169], v22 offset:8192
  buffer_load_dwordx4 v8, s[24:27], s88 offen offset:0 lds
  v_mfma_f32_16x16x32_bf16 v[76:79], v[172:175], v[204:207], v[76:79]
  ds_read_b64_tr_b16 v[170:171], v22 offset:9216
  s_waitcnt lgkmcnt(10)
  v_mfma_f32_16x16x32_bf16 v[80:83], v[176:179], v[200:203], v[80:83]
  ds_read_b64_tr_b16 v[172:173], v23 offset:8192
  v_mfma_f32_16x16x32_bf16 v[84:87], v[176:179], v[204:207], v[84:87]
  ds_read_b64_tr_b16 v[174:175], v23 offset:9216
  v_mfma_f32_16x16x32_bf16 v[88:91], v[180:183], v[200:203], v[88:91]
  ds_read_b64_tr_b16 v[176:177], v26 offset:8192
  buffer_load_dwordx4 v9, s[24:27], s88 offen offset:1024 lds
  v_mfma_f32_16x16x32_bf16 v[92:95], v[180:183], v[204:207], v[92:95]
  ds_read_b64_tr_b16 v[178:179], v26 offset:9216
  s_waitcnt lgkmcnt(10)
  v_mfma_f32_16x16x32_bf16 v[96:99], v[184:187], v[200:203], v[96:99]
  ds_read_b64_tr_b16 v[180:181], v27 offset:8192
  v_mfma_f32_16x16x32_bf16 v[100:103], v[184:187], v[204:207], v[100:103]
  ds_read_b64_tr_b16 v[182:183], v27 offset:9216
  v_mfma_f32_16x16x32_bf16 v[104:107], v[188:191], v[200:203], v[104:107]
  ds_read_b64_tr_b16 v[184:185], v28 offset:8192
  buffer_load_dwordx4 v10, s[24:27], s88 offen offset:2048 lds
  v_mfma_f32_16x16x32_bf16 v[108:111], v[188:191], v[204:207], v[108:111]
  ds_read_b64_tr_b16 v[186:187], v28 offset:9216
  s_waitcnt lgkmcnt(10)
  v_mfma_f32_16x16x32_bf16 v[48:51], v[160:163], v[208:211], v[48:51]
  ds_read_b64_tr_b16 v[188:189], v29 offset:8192
  v_mfma_f32_16x16x32_bf16 v[52:55], v[160:163], v[212:215], v[52:55]
  ds_read_b64_tr_b16 v[190:191], v29 offset:9216
  v_mfma_f32_16x16x32_bf16 v[56:59], v[164:167], v[208:211], v[56:59]
  ds_read_b64_tr_b16 v[160:161], v20 offset:16384
  buffer_load_dwordx4 v11, s[24:27], s88 offen offset:3072 lds
  v_mfma_f32_16x16x32_bf16 v[60:63], v[164:167], v[212:215], v[60:63]
  ds_read_b64_tr_b16 v[162:163], v20 offset:17408
  s_waitcnt lgkmcnt(10)
  v_mfma_f32_16x16x32_bf16 v[64:67], v[168:171], v[208:211], v[64:67]
  ds_read_b64_tr_b16 v[164:165], v21 offset:16384
  s_add_u32 s87, s87, 262144
  v_mfma_f32_16x16x32_bf16 v[68:71], v[168:171], v[212:215], v[68:71]
  ds_read_b64_tr_b16 v[166:167], v21 offset:17408
  s_add_u32 s88, s88, 262144
  v_mfma_f32_16x16x32_bf16 v[72:75], v[172:175], v[208:211], v[72:75]
  ds_read_b64_tr_b16 v[168:169], v22 offset:16384
  v_mfma_f32_16x16x32_bf16 v[76:79], v[172:175], v[212:215], v[76:79]
  ds_read_b64_tr_b16 v[170:171], v22 offset:17408
  s_waitcnt lgkmcnt(10)
  v_mfma_f32_16x16x32_bf16 v[80:83], v[176:179], v[208:211], v[80:83]
  ds_read_b64_tr_b16 v[172:173], v23 offset:16384
  v_mfma_f32_16x16x32_bf16 v[84:87], v[176:179], v[212:215], v[84:87]
  ds_read_b64_tr_b16 v[174:175], v23 offset:17408
  v_mfma_f32_16x16x32_bf16 v[88:91], v[180:183], v[208:211], v[88:91]
  ds_read_b64_tr_b16 v[176:177], v26 offset:16384
  v_mfma_f32_16x16x32_bf16 v[92:95], v[180:183], v[212:215], v[92:95]
  ds_read_b64_tr_b16 v[178:179], v26 offset:17408
  s_waitcnt lgkmcnt(10)
  v_mfma_f32_16x16x32_bf16 v[96:99], v[184:187], v[208:211], v[96:99]
  ds_read_b64_tr_b16 v[180:181], v27 offset:16384
  v_mfma_f32_16x16x32_bf16 v[100:103], v[184:187], v[212:215], v[100:103]
  ds_read_b64_tr_b16 v[182:183], v27 offset:17408
L_touch16:
  s_cbranch_execz L_tback
  v_mfma_f32_16x16x32_bf16 v[104:107], v[188:191], v[208:211], v[104:107]
  ds_read_b64_tr_b16 v[184:185], v28 offset:16384
  v_mfma_f32_16x16x32_bf16 v[108:111], v[188:191], v[212:215], v[108:111]
  ds_read_b64_tr_b16 v[186:187], v28 offset:17408
  s_waitcnt lgkmcnt(10)
  v_mfma_f32_16x16x32_bf16 v[48:51], v[160:163], v[216:219], v[48:51]
  ds_read_b64_tr_b16 v[188:189], v29 offset:16384
  v_mfma_f32_16x16x32_bf16 v[52:55], v[160:163], v[220:223], v[52:55]
  ds_read_b64_tr_b16 v[190:191], v29 offset:17408
  v_mfma_f32_16x16x32_bf16 v[56:59], v[164:167], v[216:219], v[56:59]
  ds_read_b64_tr_b16 v[160:161], v20 offset:24576
  v_mfma_f32_16x16x32_bf16 v[60:63], v[164:167], v[220:223], v[60:63]
  ds_read_b64_tr_b16 v[162:163], v20 offset:25600
  s_waitcnt lgkmcnt(10)
  v_mfma_f32_16x16x32_bf16 v[64:67], v[168:171], v[216:219], v[64:67]
  ds_read_b64_tr_b16 v[164:165], v21 offset:24576
  v_add_u32 v20, 4294836224, v20
  v_mfma_f32_16x16x32_bf16 v[68:71], v[168:171], v[220:223], v[68:71]
  ds_read_b64_tr_b16 v[166:167], v21 offset:25600
  v_add_u32 v21, 4294836224, v21
  v_mfma_f32_16x16x32_bf16 v[72:75], v[172:175], v[216:219], v[72:75]
  ds_read_b64_tr_b16 v[168:169], v22 offset:24576
  v_mfma_f32_16x16x32_bf16 v[76:79], v[172:175], v[220:223], v[76:79]
  ds_read_b64_tr_b16 v[170:171], v22 offset:25600
  s_waitcnt lgkmcnt(10)
  v_mfma_f32_16x16x32_bf16 v[80:83], v[176:179], v[216:219], v[80:83]
  ds_read_b64_tr_b16 v[172:173], v23 offset:24576
  v_add_u32 v22, 4294836224, v22
  v_mfma_f32_16x16x32_bf16 v[84:87], v[176:179], v[220:223], v[84:87]
  ds_read_b64_tr_b16 v[174:175], v23 offset:25600
  v_add_u32 v23, 4294836224, v23
  v_mfma_f32_16x16x32_bf16 v[88:91], v[180:183], v[216:219], v[88:91]
  ds_read_b64_tr_b16 v[176:177], v26 offset:24576
  v_mfma_f32_16x16x32_bf16 v[92:95], v[180:183], v[220:223], v[92:95]
  ds_read_b64_tr_b16 v[178:179], v26 offset:25600
  s_waitcnt lgkmcnt(10)
  v_mfma_f32_16x16x32_bf16 v[96:99], v[184:187], v[216:219], v[96:99]
  ds_read_b64_tr_b16 v[180:181], v27 offset:24576
  v_add_u32 v26, 4294836224, v26
  v_mfma_f32_16x16x32_bf16 v[100:103], v[184:187], v[220:223], v[100:103]
  ds_read_b64_tr_b16 v[182:183], v27 offset:25600
  v_add_u32 v27, 4294836224, v27
  v_mfma_f32_16x16x32_bf16 v[104:107], v[188:191], v[216:219], v[104:107]
  ds_read_b64_tr_b16 v[184:185], v28 offset:24576
  v_mfma_f32_16x16x32_bf16 v[108:111], v[188:191], v[220:223], v[108:111]
  ds_read_b64_tr_b16 v[186:187], v28 offset:25600
  s_waitcnt lgkmcnt(10)
  v_mfma_f32_16x16x32_bf16 v[48:51], v[160:163], v[224:227], v[48:51]
  ds_read_b64_tr_b16 v[188:189], v29 offset:24576
  v_add_u32 v28, 4294836224, v28
  v_mfma_f32_16x16x32_bf16 v[52:55], v[160:163], v[228:231], v[52:55]
  ds_read_b64_tr_b16 v[190:191], v29 offset:25600
  v_add_u32 v29, 4294836224, v29
  v_mfma_f32_16x16x32_bf16 v[56:59], v[164:167], v[224:227], v[56:59]
  v_mfma_f32_16x16x32_bf16 v[60:63], v[164:167], v[228:231], v[60:63]
  s_waitcnt lgkmcnt(8)
  v_mfma_f32_16x16x32_bf16 v[64:67], v[168:171], v[224:227], v[64:67]
  v_mfma_f32_16x16x32_bf16 v[68:71], v[168:171], v[228:231], v[68:71]
  s_waitcnt vmcnt(43) lgkmcnt(0)
  s_barrier
  v_mfma_f32_16x16x32_bf16 v[72:75], v[172:175], v[224:227], v[72:75]
  ds_read_b64_tr_b16 v[160:161], v20 offset:0
  ds_read_b64_tr_b16 v[162:163], v20 offset:1024
  s_mov_b32 s87, s100
  v_mfma_f32_16x16x32_bf16 v[76:79], v[172:175], v[228:231], v[76:79]
  ds_read_b64_tr_b16 v[164:165], v21 offset:0
  ds_read_b64_tr_b16 v[166:167], v21 offset:1024
  v_mfma_f32_16x16x32_bf16 v[80:83], v[176:179], v[224:227], v[80:83]
  ds_read_b64_tr_b16 v[168:169], v22 offset:0
  ds_read_b64_tr_b16 v[170:171], v22 offset:1024
  s_add_u32 s88, s87, 65536
  v_mfma_f32_16x16x32_bf16 v[84:87], v[176:179], v[228:231], v[84:87]
  ds_read_b64_tr_b16 v[172:173], v23 offset:0
  ds_read_b64_tr_b16 v[174:175], v23 offset:1024
  s_add_u32 m0, s89, 131072
  v_mfma_f32_16x16x32_bf16 v[88:91], v[180:183], v[224:227], v[88:91]
  ds_read_b64_tr_b16 v[176:177], v26 offset:0
  buffer_load_dwordx4 v32, s[28:31], s87 offen offset:0 lds
  v_mfma_f32_16x16x32_bf16 v[92:95], v[180:183], v[228:231], v[92:95]
  ds_read_b64_tr_b16 v[178:179], v26 offset:1024
  v_mfma_f32_16x16x32_bf16 v[96:99], v[184:187], v[224:227], v[96:99]
  ds_read_b64_tr_b16 v[180:181], v27 offset:0
  buffer_load_dwordx4 v33, s[28:31], s87 offen offset:1024 lds
  v_mfma_f32_16x16x32_bf16 v[100:103], v[184:187], v[228:231], v[100:103]
  ds_read_b64_tr_b16 v[182:183], v27 offset:1024
  v_mfma_f32_16x16x32_bf16 v[104:107], v[188:191], v[224:227], v[104:107]
  ds_read_b64_tr_b16 v[184:185], v28 offset:0
  buffer_load_dwordx4 v34, s[28:31], s87 offen offset:2048 lds
  v_mfma_f32_16x16x32_bf16 v[108:111], v[188:191], v[228:231], v[108:111]
  ds_read_b64_tr_b16 v[186:187], v28 offset:1024
  s_waitcnt lgkmcnt(10)
  v_mfma_f32_16x16x32_bf16 v[48:51], v[160:163], v[232:235], v[48:51]
  ds_read_b64_tr_b16 v[188:189], v29 offset:0
  v_mfma_f32_16x16x32_bf16 v[52:55], v[160:163], v[236:239], v[52:55]
  ds_read_b64_tr_b16 v[190:191], v29 offset:1024
  v_mfma_f32_16x16x32_bf16 v[56:59], v[164:167], v[232:235], v[56:59]
  ds_read_b64_tr_b16 v[160:161], v20 offset:8192
  buffer_load_dwordx4 v35, s[28:31], s87 offen offset:3072 lds
  v_mfma_f32_16x16x32_bf16 v[60:63], v[164:167], v[236:239], v[60:63]
  ds_read_b64_tr_b16 v[162:163], v20 offset:9216
  s_waitcnt lgkmcnt(10)
  v_mfma_f32_16x16x32_bf16 v[64:67], v[168:171], v[232:235], v[64:67]
  ds_read_b64_tr_b16 v[164:165], v21 offset:8192
  s_add_u32 m0, s89, 135168
  v_mfma_f32_16x16x32_bf16 v[68:71], v[168:171], v[236:239], v[68:71]
  ds_read_b64_tr_b16 v[166:167], v21 offset:9216
  v_mfma_f32_16x16x32_bf16 v[72:75], v[172:175], v[232:235], v[72:75]
  ds_read_b64_tr_b16 v[168:169], v22 offset:8192
  buffer_load_dwordx4 v32, s[28:31], s88 offen offset:0 lds
  v_mfma_f32_16x16x32_bf16 v[76:79], v[172:175], v[236:239], v[76:79]
  ds_read_b64_tr_b16 v[170:171], v22 offset:9216
  s_waitcnt lgkmcnt(10)
  v_mfma_f32_16x16x32_bf16 v[80:83], v[176:179], v[232:235], v[80:83]
  ds_read_b64_tr_b16 v[172:173], v23 offset:8192
  v_mfma_f32_16x16x32_bf16 v[84:87], v[176:179], v[236:239], v[84:87]
  ds_read_b64_tr_b16 v[174:175], v23 offset:9216
  v_mfma_f32_16x16x32_bf16 v[88:91], v[180:183], v[232:235], v[88:91]
  ds_read_b64_tr_b16 v[176:177], v26 offset:8192
  buffer_load_dwordx4 v33, s[28:31], s88 offen offset:1024 lds
  v_mfma_f32_16x16x32_bf16 v[92:95], v[180:183], v[236:239], v[92:95]
  ds_read_b64_tr_b16 v[178:179], v26 offset:9216
  s_waitcnt lgkmcnt(10)
  v_mfma_f32_16x16x32_bf16 v[96:99], v[184:187], v[232:235], v[96:99]
  ds_read_b64_tr_b16 v[180:181], v27 offset:8192
  v_mfma_f32_16x16x32_bf16 v[100:103], v[184:187], v[236:239], v[100:103]
  ds_read_b64_tr_b16 v[182:183], v27 offset:9216
  v_mfma_f32_16x16x32_bf16 v[104:107], v[188:191], v[232:235], v[104:107]
  ds_read_b64_tr_b16 v[184:185], v28 offset:8192
  buffer_load_dwordx4 v34, s[28:31], s88 offen offset:2048 lds
  v_mfma_f32_16x16x32_bf16 v[108:111], v[188:191], v[236:239], v[108:111]
  ds_read_b64_tr_b16 v[186:187], v28 offset:9216
  s_waitcnt lgkmcnt(10)
  s_waitcnt vmcnt(14)
  v_cmp_gt_u32 vcc, 7, v25
  s_nop 0
  s_cbranch_vccnz L_retry5
L_cont5:
  v_mfma_f32_16x16x32_bf16 v[48:51], v[160:163], v[240:243], v[48:51]
  ds_read_b64_tr_b16 v[188:189], v29 offset:8192
  v_mfma_f32_16x16x32_bf16 v[52:55], v[160:163], v[244:247], v[52:55]
  ds_read_b64_tr_b16 v[190:191], v29 offset:9216
  v_mfma_f32_16x16x32_bf16 v[56:59], v[164:167], v[240:243], v[56:59]
  ds_read_b64_tr_b16 v[160:161], v20 offset:16384
  buffer_load_dwordx4 v35, s[28:31], s88 offen offset:3072 lds
  s_add_u32 s87, s87, 524288
  v_mfma_f32_16x16x32_bf16 v[60:63], v[164:167], v[244:247], v[60:63]
  ds_read_b64_tr_b16 v[162:163], v20 offset:17408
  s_waitcnt lgkmcnt(10)
  v_mfma_f32_16x16x32_bf16 v[64:67], v[168:171], v[240:243], v[64:67]
  ds_read_b64_tr_b16 v[164:165], v21 offset:16384
  s_and_b32 s87, s87, 0x1fffff
  v_mfma_f32_16x16x32_bf16 v[68:71], v[168:171], v[244:247], v[68:71]
  ds_read_b64_tr_b16 v[166:167], v21 offset:17408
  s_add_u32 s88, s87, 65536
  v_mfma_f32_16x16x32_bf16 v[72:75], v[172:175], v[240:243], v[72:75]
  ds_read_b64_tr_b16 v[168:169], v22 offset:16384
  s_lshl_b32 s63, s67, 13
  v_mfma_f32_16x16x32_bf16 v[76:79], v[172:175], v[244:247], v[76:79]
  ds_read_b64_tr_b16 v[170:171], v22 offset:17408
  s_waitcnt lgkmcnt(10)
  v_mfma_f32_16x16x32_bf16 v[80:83], v[176:179], v[240:243], v[80:83]
  ds_read_b64_tr_b16 v[172:173], v23 offset:16384
  s_and_b32 s63, s63, 0xffff
  v_mfma_f32_16x16x32_bf16 v[84:87], v[176:179], v[244:247], v[84:87]
  ds_read_b64_tr_b16 v[174:175], v23 offset:17408
  s_add_u32 s90, s96, s63
  v_mfma_f32_16x16x32_bf16 v[88:91], v[180:183], v[240:243], v[88:91]
  ds_read_b64_tr_b16 v[176:177], v26 offset:16384
  buffer_load_dwordx4 a[104:107], v30, s[20:23], s90 offen offset:0 sc1
  v_mfma_f32_16x16x32_bf16 v[92:95], v[180:183], v[244:247], v[92:95]
  ds_read_b64_tr_b16 v[178:179], v26 offset:17408
  s_waitcnt lgkmcnt(10)
  v_mfma_f32_16x16x32_bf16 v[96:99], v[184:187], v[240:243], v[96:99]
  ds_read_b64_tr_b16 v[180:181], v27 offset:16384
  buffer_load_dwordx4 a[108:111], v30, s[20:23], s90 offen offset:256 sc1
  v_mfma_f32_16x16x32_bf16 v[100:103], v[184:187], v[244:247], v[100:103]
  ds_read_b64_tr_b16 v[182:183], v27 offset:17408
  v_mfma_f32_16x16x32_bf16 v[104:107], v[188:191], v[240:243], v[104:107]
  ds_read_b64_tr_b16 v[184:185], v28 offset:16384
  v_mfma_f32_16x16x32_bf16 v[108:111], v[188:191], v[244:247], v[108:111]
  ds_read_b64_tr_b16 v[186:187], v28 offset:17408
  s_waitcnt lgkmcnt(10)
  v_mfma_f32_16x16x32_bf16 v[48:51], v[160:163], v[248:251], v[48:51]
  ds_read_b64_tr_b16 v[188:189], v29 offset:16384
  buffer_load_dwordx4 a[112:115], v30, s[20:23], s90 offen offset:2048 sc1
  v_mfma_f32_16x16x32_bf16 v[52:55], v[160:163], v[252:255], v[52:55]
  ds_read_b64_tr_b16 v[190:191], v29 offset:17408
  v_mfma_f32_16x16x32_bf16 v[56:59], v[164:167], v[248:251], v[56:59]
  ds_read_b64_tr_b16 v[160:161], v20 offset:24576
  v_mfma_f32_16x16x32_bf16 v[60:63], v[164:167], v[252:255], v[60:63]
  ds_read_b64_tr_b16 v[162:163], v20 offset:25600
  s_waitcnt lgkmcnt(10)
  v_mfma_f32_16x16x32_bf16 v[64:67], v[168:171], v[248:251], v[64:67]
  ds_read_b64_tr_b16 v[164:165], v21 offset:24576
  v_add_u32 v20, 32768, v20
  v_mfma_f32_16x16x32_bf16 v[68:71], v[168:171], v[252:255], v[68:71]
  ds_read_b64_tr_b16 v[166:167], v21 offset:25600
  v_add_u32 v21, 32768, v21
  v_mfma_f32_16x16x32_bf16 v[72:75], v[172:175], v[248:251], v[72:75]
  ds_read_b64_tr_b16 v[168:169], v22 offset:24576
  buffer_load_dwordx4 a[116:119], v30, s[20:23], s90 offen offset:2304 sc1
  s_add_u32 s63, s63, 4096
  v_mfma_f32_16x16x32_bf16 v[76:79], v[172:175], v[252:255], v[76:79]
  ds_read_b64_tr_b16 v[170:171], v22 offset:25600
  s_waitcnt lgkmcnt(10)
  v_mfma_f32_16x16x32_bf16 v[80:83], v[176:179], v[248:251], v[80:83]
  ds_read_b64_tr_b16 v[172:173], v23 offset:24576
  s_and_b32 s63, s63, 0xffff
  s_add_u32 s90, s96, s63
  v_mfma_f32_16x16x32_bf16 v[84:87], v[176:179], v[252:255], v[84:87]
  ds_read_b64_tr_b16 v[174:175], v23 offset:25600
  v_add_u32 v22, 32768, v22
  v_mfma_f32_16x16x32_bf16 v[88:91], v[180:183], v[248:251], v[88:91]
  ds_read_b64_tr_b16 v[176:177], v26 offset:24576
  v_add_u32 v23, 32768, v23
  v_mfma_f32_16x16x32_bf16 v[92:95], v[180:183], v[252:255], v[92:95]
  ds_read_b64_tr_b16 v[178:179], v26 offset:25600
  s_waitcnt lgkmcnt(10)
  v_mfma_f32_16x16x32_bf16 v[96:99], v[184:187], v[248:251], v[96:99]
  ds_read_b64_tr_b16 v[180:181], v27 offset:24576
  buffer_load_dwordx4 a[120:123], v30, s[20:23], s90 offen offset:0 sc1
  v_add_u32 v26, 32768, v26
  v_mfma_f32_16x16x32_bf16 v[100:103], v[184:187], v[252:255], v[100:103]
  ds_read_b64_tr_b16 v[182:183], v27 offset:25600
  v_add_u32 v27, 32768, v27
  v_mfma_f32_16x16x32_bf16 v[104:107], v[188:191], v[248:251], v[104:107]
  ds_read_b64_tr_b16 v[184:185], v28 offset:24576
  buffer_load_dwordx4 a[124:127], v30, s[20:23], s90 offen offset:256 sc1
  v_mfma_f32_16x16x32_bf16 v[108:111], v[188:191], v[252:255], v[108:111]
  ds_read_b64_tr_b16 v[186:187], v28 offset:25600
  s_waitcnt lgkmcnt(10)
  v_mfma_f32_16x16x32_bf16 v[48:51], v[160:163], a[0:3], v[48:51]
  ds_read_b64_tr_b16 v[188:189], v29 offset:24576
  v_add_u32 v28, 32768, v28
  v_mfma_f32_16x16x32_bf16 v[52:55], v[160:163], a[4:7], v[52:55]
  ds_read_b64_tr_b16 v[190:191], v29 offset:25600
  v_add_u32 v29, 32768, v29
  v_mfma_f32_16x16x32_bf16 v[56:59], v[164:167], a[0:3], v[56:59]
  buffer_load_dwordx4 a[128:131], v30, s[20:23], s90 offen offset:2048 sc1
  v_mfma_f32_16x16x32_bf16 v[60:63], v[164:167], a[4:7], v[60:63]
  s_waitcnt lgkmcnt(8)
  v_mfma_f32_16x16x32_bf16 v[64:67], v[168:171], a[0:3], v[64:67]
  v_mfma_f32_16x16x32_bf16 v[68:71], v[168:171], a[4:7], v[68:71]
  s_waitcnt lgkmcnt(0)
  s_barrier
  v_mfma_f32_16x16x32_bf16 v[72:75], v[172:175], a[0:3], v[72:75]
  ds_read_b64_tr_b16 v[160:161], v20 offset:0
  ds_read_b64_tr_b16 v[162:163], v20 offset:1024
  buffer_load_dwordx4 a[132:135], v30, s[20:23], s90 offen offset:2304 sc1
  s_add_u32 s63, s63, 4096
  v_mfma_f32_16x16x32_bf16 v[76:79], v[172:175], a[4:7], v[76:79]
  ds_read_b64_tr_b16 v[164:165], v21 offset:0
  ds_read_b64_tr_b16 v[166:167], v21 offset:1024
  v_mfma_f32_16x16x32_bf16 v[80:83], v[176:179], a[0:3], v[80:83]
  ds_read_b64_tr_b16 v[168:169], v22 offset:0
  ds_read_b64_tr_b16 v[170:171], v22 offset:1024
  s_and_b32 s63, s63, 0xffff
  v_mfma_f32_16x16x32_bf16 v[84:87], v[176:179], a[4:7], v[84:87]
  ds_read_b64_tr_b16 v[172:173], v23 offset:0
  ds_read_b64_tr_b16 v[174:175], v23 offset:1024
  s_add_u32 s90, s96, s63
  v_mfma_f32_16x16x32_bf16 v[88:91], v[180:183], a[0:3], v[88:91]
  ds_read_b64_tr_b16 v[176:177], v26 offset:0
  buffer_load_dwordx4 a[136:139], v30, s[20:23], s90 offen offset:0 sc1
  v_mfma_f32_16x16x32_bf16 v[92:95], v[180:183], a[4:7], v[92:95]
  ds_read_b64_tr_b16 v[178:179], v26 offset:1024
  v_mfma_f32_16x16x32_bf16 v[96:99], v[184:187], a[0:3], v[96:99]
  ds_read_b64_tr_b16 v[180:181], v27 offset:0
  v_mfma_f32_16x16x32_bf16 v[100:103], v[184:187], a[4:7], v[100:103]
  ds_read_b64_tr_b16 v[182:183], v27 offset:1024
  v_mfma_f32_16x16x32_bf16 v[104:107], v[188:191], a[0:3], v[104:107]
  ds_read_b64_tr_b16 v[184:185], v28 offset:0
  buffer_load_dwordx4 a[140:143], v30, s[20:23], s90 offen offset:256 sc1
  v_mfma_f32_16x16x32_bf16 v[108:111], v[188:191], a[4:7], v[108:111]
  ds_read_b64_tr_b16 v[186:187], v28 offset:1024
  s_waitcnt lgkmcnt(10)
  v_mfma_f32_16x16x32_bf16 v[48:51], v[160:163], a[8:11], v[48:51]
  ds_read_b64_tr_b16 v[188:189], v29 offset:0
  v_mfma_f32_16x16x32_bf16 v[52:55], v[160:163], a[12:15], v[52:55]
  ds_read_b64_tr_b16 v[190:191], v29 offset:1024
  v_mfma_f32_16x16x32_bf16 v[56:59], v[164:167], a[8:11], v[56:59]
  ds_read_b64_tr_b16 v[160:161], v20 offset:8192
  buffer_load_dwordx4 a[144:147], v30, s[20:23], s90 offen offset:2048 sc1
  v_mfma_f32_16x16x32_bf16 v[60:63], v[164:167], a[12:15], v[60:63]
  ds_read_b64_tr_b16 v[162:163], v20 offset:9216
  s_waitcnt lgkmcnt(10)
  v_mfma_f32_16x16x32_bf16 v[64:67], v[168:171], a[8:11], v[64:67]
  ds_read_b64_tr_b16 v[164:165], v21 offset:8192
  v_mfma_f32_16x16x32_bf16 v[68:71], v[168:171], a[12:15], v[68:71]
  ds_read_b64_tr_b16 v[166:167], v21 offset:9216
  v_mfma_f32_16x16x32_bf16 v[72:75], v[172:175], a[8:11], v[72:75]
  ds_read_b64_tr_b16 v[168:169], v22 offset:8192
  buffer_load_dwordx4 a[148:151], v30, s[20:23], s90 offen offset:2304 sc1
  s_add_u32 s63, s63, 4096
  v_mfma_f32_16x16x32_bf16 v[76:79], v[172:175], a[12:15], v[76:79]
  ds_read_b64_tr_b16 v[170:171], v22 offset:9216
  s_waitcnt lgkmcnt(10)
  v_mfma_f32_16x16x32_bf16 v[80:83], v[176:179], a[8:11], v[80:83]
  ds_read_b64_tr_b16 v[172:173], v23 offset:8192
  s_and_b32 s63, s63, 0xffff
  v_mfma_f32_16x16x32_bf16 v[84:87], v[176:179], a[12:15], v[84:87]
  ds_read_b64_tr_b16 v[174:175], v23 offset:9216
  s_add_u32 s90, s96, s63
  v_mfma_f32_16x16x32_bf16 v[88:91], v[180:183], a[8:11], v[88:91]
  ds_read_b64_tr_b16 v[176:177], v26 offset:8192
  buffer_load_dwordx4 a[152:155], v30, s[20:23], s90 offen offset:0 sc1
  v_mfma_f32_16x16x32_bf16 v[92:95], v[180:183], a[12:15], v[92:95]
  ds_read_b64_tr_b16 v[178:179], v26 offset:9216
  s_waitcnt lgkmcnt(10)
  v_mfma_f32_16x16x32_bf16 v[96:99], v[184:187], a[8:11], v[96:99]
  ds_read_b64_tr_b16 v[180:181], v27 offset:8192
  v_mfma_f32_16x16x32_bf16 v[100:103], v[184:187], a[12:15], v[100:103]
  ds_read_b64_tr_b16 v[182:183], v27 offset:9216
  v_mfma_f32_16x16x32_bf16 v[104:107], v[188:191], a[8:11], v[104:107]
  ds_read_b64_tr_b16 v[184:185], v28 offset:8192
  v_mfma_f32_16x16x32_bf16 v[108:111], v[188:191], a[12:15], v[108:111]
  ds_read_b64_tr_b16 v[186:187], v28 offset:9216
  s_waitcnt lgkmcnt(10)
  v_mfma_f32_16x16x32_bf16 v[48:51], v[160:163], a[16:19], v[48:51]
  ds_read_b64_tr_b16 v[188:189], v29 offset:8192
  buffer_load_dwordx4 a[156:159], v30, s[20:23], s90 offen offset:256 sc1
  v_mfma_f32_16x16x32_bf16 v[52:55], v[160:163], a[20:23], v[52:55]
  ds_read_b64_tr_b16 v[190:191], v29 offset:9216
  v_mfma_f32_16x16x32_bf16 v[56:59], v[164:167], a[16:19], v[56:59]
  ds_read_b64_tr_b16 v[160:161], v20 offset:16384
  s_add_u32 m0, s89, 0
  v_mfma_f32_16x16x32_bf16 v[60:63], v[164:167], a[20:23], v[60:63]
  ds_read_b64_tr_b16 v[162:163], v20 offset:17408
  s_waitcnt lgkmcnt(10)
  v_mfma_f32_16x16x32_bf16 v[64:67], v[168:171], a[16:19], v[64:67]
  ds_read_b64_tr_b16 v[164:165], v21 offset:16384
  buffer_load_dwordx4 v32, s[28:31], s87 offen offset:0 lds
  v_mfma_f32_16x16x32_bf16 v[68:71], v[168:171], a[20:23], v[68:71]
  ds_read_b64_tr_b16 v[166:167], v21 offset:17408
  v_mfma_f32_16x16x32_bf16 v[72:75], v[172:175], a[16:19], v[72:75]
  ds_read_b64_tr_b16 v[168:169], v22 offset:16384
  v_mfma_f32_16x16x32_bf16 v[76:79], v[172:175], a[20:23], v[76:79]
  ds_read_b64_tr_b16 v[170:171], v22 offset:17408
  s_waitcnt lgkmcnt(10)
  v_mfma_f32_16x16x32_bf16 v[80:83], v[176:179], a[16:19], v[80:83]
  ds_read_b64_tr_b16 v[172:173], v23 offset:16384
  buffer_load_dwordx4 v33, s[28:31], s87 offen offset:1024 lds
  v_mfma_f32_16x16x32_bf16 v[84:87], v[176:179], a[20:23], v[84:87]
  ds_read_b64_tr_b16 v[174:175], v23 offset:17408
  v_mfma_f32_16x16x32_bf16 v[88:91], v[180:183], a[16:19], v[88:91]
  ds_read_b64_tr_b16 v[176:177], v26 offset:16384
  v_mfma_f32_16x16x32_bf16 v[92:95], v[180:183], a[20:23], v[92:95]
  ds_read_b64_tr_b16 v[178:179], v26 offset:17408
  s_waitcnt lgkmcnt(10)
  v_mfma_f32_16x16x32_bf16 v[96:99], v[184:187], a[16:19], v[96:99]
  ds_read_b64_tr_b16 v[180:181], v27 offset:16384
  buffer_load_dwordx4 v34, s[28:31], s87 offen offset:2048 lds
  v_mfma_f32_16x16x32_bf16 v[100:103], v[184:187], a[20:23], v[100:103]
  ds_read_b64_tr_b16 v[182:183], v27 offset:17408
  v_mfma_f32_16x16x32_bf16 v[104:107], v[188:191], a[16:19], v[104:107]
  ds_read_b64_tr_b16 v[184:185], v28 offset:16384
  v_mfma_f32_16x16x32_bf16 v[108:111], v[188:191], a[20:23], v[108:111]
  ds_read_b64_tr_b16 v[186:187], v28 offset:17408
  s_waitcnt lgkmcnt(10)
  v_mfma_f32_16x16x32_bf16 v[48:51], v[160:163], a[24:27], v[48:51]
  ds_read_b64_tr_b16 v[188:189], v29 offset:16384
  buffer_load_dwordx4 v35, s[28:31], s87 offen offset:3072 lds
  v_mfma_f32_16x16x32_bf16 v[52:55], v[160:163], a[28:31], v[52:55]
  ds_read_b64_tr_b16 v[190:191], v29 offset:17408
  v_mfma_f32_16x16x32_bf16 v[56:59], v[164:167], a[24:27], v[56:59]
  ds_read_b64_tr_b16 v[160:161], v20 offset:24576
  v_mfma_f32_16x16x32_bf16 v[60:63], v[164:167], a[28:31], v[60:63]
  ds_read_b64_tr_b16 v[162:163], v20 offset:25600
  s_waitcnt lgkmcnt(10)
  v_mfma_f32_16x16x32_bf16 v[64:67], v[168:171], a[24:27], v[64:67]
  ds_read_b64_tr_b16 v[164:165], v21 offset:24576
  v_add_u32 v20, 32768, v20
  s_add_u32 m0, s89, 4096
  v_mfma_f32_16x16x32_bf16 v[68:71], v[168:171], a[28:31], v[68:71]
  ds_read_b64_tr_b16 v[166:167], v21 offset:25600
  v_add_u32 v21, 32768, v21
  v_mfma_f32_16x16x32_bf16 v[72:75], v[172:175], a[24:27], v[72:75]
  ds_read_b64_tr_b16 v[168:169], v22 offset:24576
  buffer_load_dwordx4 v32, s[28:31], s88 offen offset:0 lds
  v_mfma_f32_16x16x32_bf16 v[76:79], v[172:175], a[28:31], v[76:79]
  ds_read_b64_tr_b16 v[170:171], v22 offset:25600
  s_waitcnt lgkmcnt(10)
  v_mfma_f32_16x16x32_bf16 v[80:83], v[176:179], a[24:27], v[80:83]
  ds_read_b64_tr_b16 v[172:173], v23 offset:24576
  v_add_u32 v22, 32768, v22
  v_mfma_f32_16x16x32_bf16 v[84:87], v[176:179], a[28:31], v[84:87]
  ds_read_b64_tr_b16 v[174:175], v23 offset:25600
  v_add_u32 v23, 32768, v23
  v_mfma_f32_16x16x32_bf16 v[88:91], v[180:183], a[24:27], v[88:91]
  ds_read_b64_tr_b16 v[176:177], v26 offset:24576
  buffer_load_dwordx4 v33, s[28:31], s88 offen offset:1024 lds
  v_mfma_f32_16x16x32_bf16 v[92:95], v[180:183], a[28:31], v[92:95]
  ds_read_b64_tr_b16 v[178:179], v26 offset:25600
  s_waitcnt lgkmcnt(10)
  v_mfma_f32_16x16x32_bf16 v[96:99], v[184:187], a[24:27], v[96:99]
  ds_read_b64_tr_b16 v[180:181], v27 offset:24576
  v_add_u32 v26, 32768, v26
  v_mfma_f32_16x16x32_bf16 v[100:103], v[184:187], a[28:31], v[100:103]
  ds_read_b64_tr_b16 v[182:183], v27 offset:25600
  v_add_u32 v27, 32768, v27
  v_mfma_f32_16x16x32_bf16 v[104:107], v[188:191], a[24:27], v[104:107]
  ds_read_b64_tr_b16 v[184:185], v28 offset:24576
  v_mfma_f32_16x16x32_bf16 v[108:111], v[188:191], a[28:31], v[108:111]
  ds_read_b64_tr_b16 v[186:187], v28 offset:25600
  s_waitcnt lgkmcnt(10)
  v_mfma_f32_16x16x32_bf16 v[48:51], v[160:163], a[32:35], v[48:51]
  ds_read_b64_tr_b16 v[188:189], v29 offset:24576
  v_add_u32 v28, 32768, v28
  v_mfma_f32_16x16x32_bf16 v[52:55], v[160:163], a[36:39], v[52:55]
  ds_read_b64_tr_b16 v[190:191], v29 offset:25600
  buffer_load_dwordx4 v34, s[28:31], s88 offen offset:2048 lds
  v_mfma_f32_16x16x32_bf16 v[56:59], v[164:167], a[32:35], v[56:59]
  v_add_u32 v29, 32768, v29
  v_mfma_f32_16x16x32_bf16 v[60:63], v[164:167], a[36:39], v[60:63]
  s_waitcnt lgkmcnt(8)
  buffer_load_dwordx4 v35, s[28:31], s88 offen offset:3072 lds
  s_add_u32 s87, s87, 524288
  v_mfma_f32_16x16x32_bf16 v[64:67], v[168:171], a[32:35], v[64:67]
  s_and_b32 s87, s87, 0x1fffff
  s_add_u32 s88, s87, 65536
  v_mfma_f32_16x16x32_bf16 v[68:71], v[168:171], a[36:39], v[68:71]
  s_waitcnt vmcnt(30) lgkmcnt(0)
  s_barrier
  v_mfma_f32_16x16x32_bf16 v[72:75], v[172:175], a[32:35], v[72:75]
  ds_read_b64_tr_b16 v[160:161], v20 offset:0
  ds_read_b64_tr_b16 v[162:163], v20 offset:1024
  buffer_load_dwordx4 a[160:163], v30, s[20:23], s90 offen offset:2048 sc1
  v_mfma_f32_16x16x32_bf16 v[76:79], v[172:175], a[36:39], v[76:79]
  ds_read_b64_tr_b16 v[164:165], v21 offset:0
  ds_read_b64_tr_b16 v[166:167], v21 offset:1024
  v_mfma_f32_16x16x32_bf16 v[80:83], v[176:179], a[32:35], v[80:83]
  ds_read_b64_tr_b16 v[168:169], v22 offset:0
  ds_read_b64_tr_b16 v[170:171], v22 offset:1024
  v_mfma_f32_16x16x32_bf16 v[84:87], v[176:179], a[36:39], v[84:87]
  ds_read_b64_tr_b16 v[172:173], v23 offset:0
  ds_read_b64_tr_b16 v[174:175], v23 offset:1024
  v_mfma_f32_16x16x32_bf16 v[88:91], v[180:183], a[32:35], v[88:91]
  ds_read_b64_tr_b16 v[176:177], v20 offset:8192
  buffer_load_dwordx4 a[164:167], v30, s[20:23], s90 offen offset:2304 sc1
  s_add_u32 s63, s63, 4096
  v_mfma_f32_16x16x32_bf16 v[92:95], v[180:183], a[36:39], v[92:95]
  ds_read_b64_tr_b16 v[178:179], v20 offset:9216
  v_mfma_f32_16x16x32_bf16 v[96:99], v[184:187], a[32:35], v[96:99]
  ds_read_b64_tr_b16 v[180:181], v21 offset:8192
  s_and_b32 s63, s63, 0xffff
  v_mfma_f32_16x16x32_bf16 v[100:103], v[184:187], a[36:39], v[100:103]
  ds_read_b64_tr_b16 v[182:183], v21 offset:9216
  s_add_u32 s90, s96, s63
  v_mfma_f32_16x16x32_bf16 v[104:107], v[188:191], a[32:35], v[104:107]
  ds_read_b64_tr_b16 v[184:185], v22 offset:8192
  buffer_load_dwordx4 a[168:171], v30, s[20:23], s90 offen offset:0 sc1
  v_mfma_f32_16x16x32_bf16 v[108:111], v[188:191], a[36:39], v[108:111]
  ds_read_b64_tr_b16 v[186:187], v22 offset:9216
  s_waitcnt lgkmcnt(10)
  v_mfma_f32_16x16x32_bf16 v[48:51], v[160:163], a[40:43], v[48:51]
  ds_read_b64_tr_b16 v[188:189], v23 offset:8192
  v_mfma_f32_16x16x32_bf16 v[52:55], v[160:163], a[44:47], v[52:55]
  ds_read_b64_tr_b16 v[190:191], v23 offset:9216
  v_mfma_f32_16x16x32_bf16 v[56:59], v[164:167], a[40:43], v[56:59]
  ds_read_b64_tr_b16 v[160:161], v20 offset:16384
  buffer_load_dwordx4 a[172:175], v30, s[20:23], s90 offen offset:256 sc1
  v_mfma_f32_16x16x32_bf16 v[60:63], v[164:167], a[44:47], v[60:63]
  ds_read_b64_tr_b16 v[162:163], v20 offset:17408
  s_waitcnt lgkmcnt(10)
  v_mfma_f32_16x16x32_bf16 v[64:67], v[168:171], a[40:43], v[64:67]
  ds_read_b64_tr_b16 v[164:165], v21 offset:16384
  v_mfma_f32_16x16x32_bf16 v[68:71], v[168:171], a[44:47], v[68:71]
  ds_read_b64_tr_b16 v[166:167], v21 offset:17408
  v_mfma_f32_16x16x32_bf16 v[72:75], v[172:175], a[40:43], v[72:75]
  ds_read_b64_tr_b16 v[168:169], v22 offset:16384
  buffer_load_dwordx4 a[176:179], v30, s[20:23], s90 offen offset:2048 sc1
  v_mfma_f32_16x16x32_bf16 v[76:79], v[172:175], a[44:47], v[76:79]
  ds_read_b64_tr_b16 v[170:171], v22 offset:17408
  s_waitcnt lgkmcnt(10)
  v_mfma_f32_16x16x32_bf16 v[48:51], v[176:179], a[48:51], v[48:51]
  ds_read_b64_tr_b16 v[172:173], v23 offset:16384
  v_mfma_f32_16x16x32_bf16 v[52:55], v[176:179], a[52:55], v[52:55]
  ds_read_b64_tr_b16 v[174:175], v23 offset:17408
  v_mfma_f32_16x16x32_bf16 v[56:59], v[180:183], a[48:51], v[56:59]
  ds_read_b64_tr_b16 v[176:177], v20 offset:24576
  v_mfma_f32_16x16x32_bf16 v[60:63], v[180:183], a[52:55], v[60:63]
  ds_read_b64_tr_b16 v[178:179], v20 offset:25600
  s_waitcnt lgkmcnt(10)
  v_mfma_f32_16x16x32_bf16 v[64:67], v[184:187], a[48:51], v[64:67]
  ds_read_b64_tr_b16 v[180:181], v21 offset:24576
  v_add_u32 v20, 32768, v20
  v_mfma_f32_16x16x32_bf16 v[68:71], v[184:187], a[52:55], v[68:71]
  ds_read_b64_tr_b16 v[182:183], v21 offset:25600
  v_add_u32 v21, 32768, v21
  v_mfma_f32_16x16x32_bf16 v[72:75], v[188:191], a[48:51], v[72:75]
  ds_read_b64_tr_b16 v[184:185], v22 offset:24576
  buffer_load_dwordx4 a[180:183], v30, s[20:23], s90 offen offset:2304 sc1
  s_add_u32 s63, s63, 4096
  v_mfma_f32_16x16x32_bf16 v[76:79], v[188:191], a[52:55], v[76:79]
  ds_read_b64_tr_b16 v[186:187], v22 offset:25600
  s_waitcnt lgkmcnt(10)
  v_mfma_f32_16x16x32_bf16 v[48:51], v[160:163], a[56:59], v[48:51]
  ds_read_b64_tr_b16 v[188:189], v23 offset:24576
  s_and_b32 s63, s63, 0xffff
  s_add_u32 s90, s96, s63
  v_mfma_f32_16x16x32_bf16 v[52:55], v[160:163], a[60:63], v[52:55]
  ds_read_b64_tr_b16 v[190:191], v23 offset:25600
  v_add_u32 v22, 32768, v22
  v_mfma_f32_16x16x32_bf16 v[56:59], v[164:167], a[56:59], v[56:59]
  ds_read_b64_tr_b16 v[160:161], v20 offset:0
  v_add_u32 v23, 32768, v23
  v_mfma_f32_16x16x32_bf16 v[60:63], v[164:167], a[60:63], v[60:63]
  ds_read_b64_tr_b16 v[162:163], v20 offset:1024
  s_waitcnt lgkmcnt(10)
  v_mfma_f32_16x16x32_bf16 v[64:67], v[168:171], a[56:59], v[64:67]
  ds_read_b64_tr_b16 v[164:165], v21 offset:0
  buffer_load_dwordx4 a[184:187], v30, s[20:23], s90 offen offset:0 sc1
  v_mfma_f32_16x16x32_bf16 v[68:71], v[168:171], a[60:63], v[68:71]
  ds_read_b64_tr_b16 v[166:167], v21 offset:1024
  buffer_load_dwordx4 a[188:191], v30, s[20:23], s90 offen offset:256 sc1
  v_mfma_f32_16x16x32_bf16 v[72:75], v[172:175], a[56:59], v[72:75]
  ds_read_b64_tr_b16 v[168:169], v22 offset:0
  v_mfma_f32_16x16x32_bf16 v[76:79], v[172:175], a[60:63], v[76:79]
  ds_read_b64_tr_b16 v[170:171], v22 offset:1024
  s_waitcnt lgkmcnt(10)
  v_mfma_f32_16x16x32_bf16 v[48:51], v[176:179], a[64:67], v[48:51]
  ds_read_b64_tr_b16 v[172:173], v23 offset:0
  buffer_load_dwordx4 a[192:195], v30, s[20:23], s90 offen offset:2048 sc1
  v_mfma_f32_16x16x32_bf16 v[52:55], v[176:179], a[68:71], v[52:55]
  ds_read_b64_tr_b16 v[174:175], v23 offset:1024
  v_mfma_f32_16x16x32_bf16 v[56:59], v[180:183], a[64:67], v[56:59]
  ds_read_b64_tr_b16 v[176:177], v20 offset:8192
  v_mfma_f32_16x16x32_bf16 v[60:63], v[180:183], a[68:71], v[60:63]
  ds_read_b64_tr_b16 v[178:179], v20 offset:9216
  s_waitcnt lgkmcnt(10)
  v_mfma_f32_16x16x32_bf16 v[64:67], v[184:187], a[64:67], v[64:67]
  ds_read_b64_tr_b16 v[180:181], v21 offset:8192
  buffer_load_dwordx4 a[196:199], v30, s[20:23], s90 offen offset:2304 sc1
  s_add_u32 s63, s63, 4096
  v_mfma_f32_16x16x32_bf16 v[68:71], v[184:187], a[68:71], v[68:71]
  ds_read_b64_tr_b16 v[182:183], v21 offset:9216
  s_and_b32 s63, s63, 0xffff
  v_mfma_f32_16x16x32_bf16 v[72:75], v[188:191], a[64:67], v[72:75]
  ds_read_b64_tr_b16 v[184:185], v22 offset:8192
  s_add_u32 s90, s96, s63
  v_mfma_f32_16x16x32_bf16 v[76:79], v[188:191], a[68:71], v[76:79]
  ds_read_b64_tr_b16 v[186:187], v22 offset:9216
  s_waitcnt lgkmcnt(10)
  v_mfma_f32_16x16x32_bf16 v[48:51], v[160:163], a[72:75], v[48:51]
L_touch17:
  s_cbranch_execz L_tback
  ds_read_b64_tr_b16 v[188:189], v23 offset:8192
  buffer_load_dwordx4 a[200:203], v30, s[20:23], s90 offen offset:0 sc1
  v_mfma_f32_16x16x32_bf16 v[52:55], v[160:163], a[76:79], v[52:55]
  ds_read_b64_tr_b16 v[190:191], v23 offset:9216
  v_mfma_f32_16x16x32_bf16 v[56:59], v[164:167], a[72:75], v[56:59]
  ds_read_b64_tr_b16 v[160:161], v20 offset:16384
  v_mfma_f32_16x16x32_bf16 v[60:63], v[164:167], a[76:79], v[60:63]
  ds_read_b64_tr_b16 v[162:163], v20 offset:17408
  s_waitcnt lgkmcnt(10)
  v_mfma_f32_16x16x32_bf16 v[64:67], v[168:171], a[72:75], v[64:67]
  ds_read_b64_tr_b16 v[164:165], v21 offset:16384
  v_mfma_f32_16x16x32_bf16 v[68:71], v[168:171], a[76:79], v[68:71]
  ds_read_b64_tr_b16 v[166:167], v21 offset:17408
  v_mfma_f32_16x16x32_bf16 v[72:75], v[172:175], a[72:75], v[72:75]
  ds_read_b64_tr_b16 v[168:169], v22 offset:16384
  buffer_load_dwordx4 a[204:207], v30, s[20:23], s90 offen offset:256 sc1
  v_mfma_f32_16x16x32_bf16 v[76:79], v[172:175], a[76:79], v[76:79]
  ds_read_b64_tr_b16 v[170:171], v22 offset:17408
  s_waitcnt lgkmcnt(10)
  v_mfma_f32_16x16x32_bf16 v[48:51], v[176:179], a[80:83], v[48:51]
  ds_read_b64_tr_b16 v[172:173], v23 offset:16384
  v_mfma_f32_16x16x32_bf16 v[52:55], v[176:179], a[84:87], v[52:55]
  ds_read_b64_tr_b16 v[174:175], v23 offset:17408
  v_mfma_f32_16x16x32_bf16 v[56:59], v[180:183], a[80:83], v[56:59]
  ds_read_b64_tr_b16 v[176:177], v20 offset:24576
  buffer_load_dwordx4 a[208:211], v30, s[20:23], s90 offen offset:2048 sc1
  v_mfma_f32_16x16x32_bf16 v[60:63], v[180:183], a[84:87], v[60:63]
  ds_read_b64_tr_b16 v[178:179], v20 offset:25600
  s_waitcnt lgkmcnt(10)
  v_mfma_f32_16x16x32_bf16 v[64:67], v[184:187], a[80:83], v[64:67]
  ds_read_b64_tr_b16 v[180:181], v21 offset:24576
  v_mfma_f32_16x16x32_bf16 v[68:71], v[184:187], a[84:87], v[68:71]
  ds_read_b64_tr_b16 v[182:183], v21 offset:25600
  v_mfma_f32_16x16x32_bf16 v[72:75], v[188:191], a[80:83], v[72:75]
  ds_read_b64_tr_b16 v[184:185], v22 offset:24576
  buffer_load_dwordx4 a[212:215], v30, s[20:23], s90 offen offset:2304 sc1
  s_add_u32 s63, s63, 4096
  v_mfma_f32_16x16x32_bf16 v[76:79], v[188:191], a[84:87], v[76:79]
  ds_read_b64_tr_b16 v[186:187], v22 offset:25600
  s_waitcnt lgkmcnt(10)
  v_mfma_f32_16x16x32_bf16 v[48:51], v[160:163], a[88:91], v[48:51]
  ds_read_b64_tr_b16 v[188:189], v23 offset:24576
  s_and_b32 s63, s63, 0xffff
  v_mfma_f32_16x16x32_bf16 v[52:55], v[160:163], a[92:95], v[52:55]
  ds_read_b64_tr_b16 v[190:191], v23 offset:25600
  s_add_u32 s90, s96, s63
  v_mfma_f32_16x16x32_bf16 v[56:59], v[164:167], a[88:91], v[56:59]
  ds_read_b64_tr_b16 v[160:161], v26 offset:0
  buffer_load_dwordx4 a[216:219], v30, s[20:23], s90 offen offset:0 sc1
  v_mfma_f32_16x16x32_bf16 v[60:63], v[164:167], a[92:95], v[60:63]
  ds_read_b64_tr_b16 v[162:163], v26 offset:1024
  s_waitcnt lgkmcnt(10)
  v_mfma_f32_16x16x32_bf16 v[64:67], v[168:171], a[88:91], v[64:67]
  ds_read_b64_tr_b16 v[164:165], v27 offset:0
  v_mfma_f32_16x16x32_bf16 v[68:71], v[168:171], a[92:95], v[68:71]
  ds_read_b64_tr_b16 v[166:167], v27 offset:1024
  v_mfma_f32_16x16x32_bf16 v[72:75], v[172:175], a[88:91], v[72:75]
  ds_read_b64_tr_b16 v[168:169], v28 offset:0
  buffer_load_dwordx4 a[220:223], v30, s[20:23], s90 offen offset:256 sc1
  v_mfma_f32_16x16x32_bf16 v[76:79], v[172:175], a[92:95], v[76:79]
  ds_read_b64_tr_b16 v[170:171], v28 offset:1024
  s_waitcnt lgkmcnt(10)
  v_mfma_f32_16x16x32_bf16 v[48:51], v[176:179], a[96:99], v[48:51]
  ds_read_b64_tr_b16 v[172:173], v29 offset:0
  s_add_u32 m0, s89, 32768
  v_mfma_f32_16x16x32_bf16 v[52:55], v[176:179], a[100:103], v[52:55]
  ds_read_b64_tr_b16 v[174:175], v29 offset:1024
  v_mfma_f32_16x16x32_bf16 v[56:59], v[180:183], a[96:99], v[56:59]
  ds_read_b64_tr_b16 v[176:177], v26 offset:8192
  buffer_load_dwordx4 v32, s[28:31], s87 offen offset:0 lds
  v_mfma_f32_16x16x32_bf16 v[60:63], v[180:183], a[100:103], v[60:63]
  ds_read_b64_tr_b16 v[178:179], v26 offset:9216
  s_waitcnt lgkmcnt(10)
  v_mfma_f32_16x16x32_bf16 v[64:67], v[184:187], a[96:99], v[64:67]
  ds_read_b64_tr_b16 v[180:181], v27 offset:8192
  v_mfma_f32_16x16x32_bf16 v[68:71], v[184:187], a[100:103], v[68:71]
  ds_read_b64_tr_b16 v[182:183], v27 offset:9216
  v_mfma_f32_16x16x32_bf16 v[72:75], v[188:191], a[96:99], v[72:75]
  ds_read_b64_tr_b16 v[184:185], v28 offset:8192
  buffer_load_dwordx4 v33, s[28:31], s87 offen offset:1024 lds
  v_mfma_f32_16x16x32_bf16 v[76:79], v[188:191], a[100:103], v[76:79]
  ds_read_b64_tr_b16 v[186:187], v28 offset:9216
  s_waitcnt lgkmcnt(10)
  v_mfma_f32_16x16x32_bf16 v[80:83], v[160:163], a[40:43], v[80:83]
  ds_read_b64_tr_b16 v[188:189], v29 offset:8192
  v_mfma_f32_16x16x32_bf16 v[84:87], v[160:163], a[44:47], v[84:87]
  ds_read_b64_tr_b16 v[190:191], v29 offset:9216
  v_mfma_f32_16x16x32_bf16 v[88:91], v[164:167], a[40:43], v[88:91]
  ds_read_b64_tr_b16 v[160:161], v26 offset:16384
  v_mfma_f32_16x16x32_bf16 v[92:95], v[164:167], a[44:47], v[92:95]
  ds_read_b64_tr_b16 v[162:163], v26 offset:17408
  s_waitcnt lgkmcnt(10)
  v_mfma_f32_16x16x32_bf16 v[96:99], v[168:171], a[40:43], v[96:99]
  ds_read_b64_tr_b16 v[164:165], v27 offset:16384
  buffer_load_dwordx4 v34, s[28:31], s87 offen offset:2048 lds
  v_mfma_f32_16x16x32_bf16 v[100:103], v[168:171], a[44:47], v[100:103]
  ds_read_b64_tr_b16 v[166:167], v27 offset:17408
  v_mfma_f32_16x16x32_bf16 v[104:107], v[172:175], a[40:43], v[104:107]
  ds_read_b64_tr_b16 v[168:169], v28 offset:16384
  v_cvt_pk_bf16_f32 v144, v48, v49
  v_mfma_f32_16x16x32_bf16 v[108:111], v[172:175], a[44:47], v[108:111]
  ds_read_b64_tr_b16 v[170:171], v28 offset:17408
  s_waitcnt lgkmcnt(10)
  v_mfma_f32_16x16x32_bf16 v[80:83], v[176:179], a[48:51], v[80:83]
  ds_read_b64_tr_b16 v[172:173], v29 offset:16384
  v_cvt_pk_bf16_f32 v145, v50, v51
  v_cvt_pk_bf16_f32 v146, v52, v53
  v_mfma_f32_16x16x32_bf16 v[84:87], v[176:179], a[52:55], v[84:87]
  ds_read_b64_tr_b16 v[174:175], v29 offset:17408
  v_cvt_pk_bf16_f32 v147, v54, v55
  v_mfma_f32_16x16x32_bf16 v[88:91], v[180:183], a[48:51], v[88:91]
  ds_read_b64_tr_b16 v[176:177], v26 offset:24576
  buffer_load_dwordx4 v35, s[28:31], s87 offen offset:3072 lds
  v_mfma_f32_16x16x32_bf16 v[92:95], v[180:183], a[52:55], v[92:95]
  ds_read_b64_tr_b16 v[178:179], v26 offset:25600
  s_waitcnt lgkmcnt(10)
  v_add_u32 v26, 32768, v26
  v_mfma_f32_16x16x32_bf16 v[96:99], v[184:187], a[48:51], v[96:99]
  ds_read_b64_tr_b16 v[180:181], v27 offset:24576
  v_cvt_pk_bf16_f32 v148, v56, v57
  v_cvt_pk_bf16_f32 v149, v58, v59
  v_mfma_f32_16x16x32_bf16 v[100:103], v[184:187], a[52:55], v[100:103]
  ds_read_b64_tr_b16 v[182:183], v27 offset:25600
  buffer_store_dwordx4 v[144:147], v4, s[20:23], s93 offen offset:0 sc1
  v_add_u32 v27, 32768, v27
  v_mfma_f32_16x16x32_bf16 v[104:107], v[188:191], a[48:51], v[104:107]
  ds_read_b64_tr_b16 v[184:185], v28 offset:24576
  v_cvt_pk_bf16_f32 v150, v60, v61
  v_cvt_pk_bf16_f32 v151, v62, v63
  v_mfma_f32_16x16x32_bf16 v[108:111], v[188:191], a[52:55], v[108:111]
  ds_read_b64_tr_b16 v[186:187], v28 offset:25600
  s_waitcnt lgkmcnt(10)
  v_add_u32 v28, 32768, v28
  v_mfma_f32_16x16x32_bf16 v[80:83], v[160:163], a[56:59], v[80:83]
  ds_read_b64_tr_b16 v[188:189], v29 offset:24576
  v_cvt_pk_bf16_f32 v152, v64, v65
  v_cvt_pk_bf16_f32 v153, v66, v67
  v_mfma_f32_16x16x32_bf16 v[84:87], v[160:163], a[60:63], v[84:87]
  ds_read_b64_tr_b16 v[190:191], v29 offset:25600
  buffer_store_dwordx4 v[148:151], v4, s[20:23], s93 offen offset:1024 sc1
  v_add_u32 v29, 32768, v29
  v_mfma_f32_16x16x32_bf16 v[88:91], v[164:167], a[56:59], v[88:91]
  ds_read_b64_tr_b16 v[160:161], v26 offset:0
  v_cvt_pk_bf16_f32 v154, v68, v69
  v_cvt_pk_bf16_f32 v155, v70, v71
  v_mfma_f32_16x16x32_bf16 v[92:95], v[164:167], a[60:63], v[92:95]
  ds_read_b64_tr_b16 v[162:163], v26 offset:1024
  s_waitcnt lgkmcnt(10)
  v_mfma_f32_16x16x32_bf16 v[96:99], v[168:171], a[56:59], v[96:99]
  ds_read_b64_tr_b16 v[164:165], v27 offset:0
  v_cvt_pk_bf16_f32 v156, v72, v73
  v_cvt_pk_bf16_f32 v157, v74, v75
  v_mfma_f32_16x16x32_bf16 v[100:103], v[168:171], a[60:63], v[100:103]
  ds_read_b64_tr_b16 v[166:167], v27 offset:1024
  buffer_store_dwordx4 v[152:155], v4, s[20:23], s93 offen offset:2048 sc1
  v_mfma_f32_16x16x32_bf16 v[104:107], v[172:175], a[56:59], v[104:107]
  ds_read_b64_tr_b16 v[168:169], v28 offset:0
  v_cvt_pk_bf16_f32 v158, v76, v77
  v_mfma_f32_16x16x32_bf16 v[108:111], v[172:175], a[60:63], v[108:111]
  ds_read_b64_tr_b16 v[170:171], v28 offset:1024
  s_waitcnt lgkmcnt(10)
  v_mfma_f32_16x16x32_bf16 v[80:83], v[176:179], a[64:67], v[80:83]
  ds_read_b64_tr_b16 v[172:173], v29 offset:0
  v_cvt_pk_bf16_f32 v159, v78, v79
  v_mfma_f32_16x16x32_bf16 v[84:87], v[176:179], a[68:71], v[84:87]
  ds_read_b64_tr_b16 v[174:175], v29 offset:1024
  buffer_store_dwordx4 v[156:159], v4, s[20:23], s93 offen offset:3072 sc1
  v_mfma_f32_16x16x32_bf16 v[88:91], v[180:183], a[64:67], v[88:91]
  ds_read_b64_tr_b16 v[176:177], v26 offset:8192
  s_xor_b32 s93, s93, 32768
  v_mfma_f32_16x16x32_bf16 v[92:95], v[180:183], a[68:71], v[92:95]
  ds_read_b64_tr_b16 v[178:179], v26 offset:9216
  s_waitcnt lgkmcnt(10)
  v_mfma_f32_16x16x32_bf16 v[96:99], v[184:187], a[64:67], v[96:99]
  ds_read_b64_tr_b16 v[180:181], v27 offset:8192
  s_xor_b32 s62, s65, 32
  v_mfma_f32_16x16x32_bf16 v[100:103], v[184:187], a[68:71], v[100:103]
  ds_read_b64_tr_b16 v[182:183], v27 offset:9216
  v_mfma_f32_16x16x32_bf16 v[104:107], v[188:191], a[64:67], v[104:107]
  ds_read_b64_tr_b16 v[184:185], v28 offset:8192
  s_lshl_b32 s62, s62, 7
  v_mfma_f32_16x16x32_bf16 v[108:111], v[188:191], a[68:71], v[108:111]
  ds_read_b64_tr_b16 v[186:187], v28 offset:9216
  s_waitcnt lgkmcnt(10)
  v_mfma_f32_16x16x32_bf16 v[80:83], v[160:163], a[72:75], v[80:83]
  ds_read_b64_tr_b16 v[188:189], v29 offset:8192
  v_mov_b32 v24, s62
  v_mfma_f32_16x16x32_bf16 v[84:87], v[160:163], a[76:79], v[84:87]
  ds_read_b64_tr_b16 v[190:191], v29 offset:9216
  v_mfma_f32_16x16x32_bf16 v[88:91], v[164:167], a[72:75], v[88:91]
  ds_read_b64_tr_b16 v[160:161], v26 offset:16384
  v_mfma_f32_16x16x32_bf16 v[92:95], v[164:167], a[76:79], v[92:95]
  ds_read_b64_tr_b16 v[162:163], v26 offset:17408
  s_waitcnt lgkmcnt(10)
  v_mfma_f32_16x16x32_bf16 v[96:99], v[168:171], a[72:75], v[96:99]
  ds_read_b64_tr_b16 v[164:165], v27 offset:16384
  v_mfma_f32_16x16x32_bf16 v[100:103], v[168:171], a[76:79], v[100:103]
  ds_read_b64_tr_b16 v[166:167], v27 offset:17408
  v_mfma_f32_16x16x32_bf16 v[104:107], v[172:175], a[72:75], v[104:107]
  ds_read_b64_tr_b16 v[168:169], v28 offset:16384
  v_mfma_f32_16x16x32_bf16 v[108:111], v[172:175], a[76:79], v[108:111]
  ds_read_b64_tr_b16 v[170:171], v28 offset:17408
  s_waitcnt lgkmcnt(10)
  v_mfma_f32_16x16x32_bf16 v[80:83], v[176:179], a[80:83], v[80:83]
  ds_read_b64_tr_b16 v[172:173], v29 offset:16384
  v_mfma_f32_16x16x32_bf16 v[84:87], v[176:179], a[84:87], v[84:87]
  ds_read_b64_tr_b16 v[174:175], v29 offset:17408
  v_mfma_f32_16x16x32_bf16 v[88:91], v[180:183], a[80:83], v[88:91]
  ds_read_b64_tr_b16 v[176:177], v26 offset:24576
  v_mfma_f32_16x16x32_bf16 v[92:95], v[180:183], a[84:87], v[92:95]
  ds_read_b64_tr_b16 v[178:179], v26 offset:25600
  s_waitcnt lgkmcnt(10)
  v_mfma_f32_16x16x32_bf16 v[96:99], v[184:187], a[80:83], v[96:99]
  ds_read_b64_tr_b16 v[180:181], v27 offset:24576
  v_mfma_f32_16x16x32_bf16 v[100:103], v[184:187], a[84:87], v[100:103]
  ds_read_b64_tr_b16 v[182:183], v27 offset:25600
  v_mfma_f32_16x16x32_bf16 v[104:107], v[188:191], a[80:83], v[104:107]
  ds_read_b64_tr_b16 v[184:185], v28 offset:24576
  v_mfma_f32_16x16x32_bf16 v[108:111], v[188:191], a[84:87], v[108:111]
  ds_read_b64_tr_b16 v[186:187], v28 offset:25600
  s_waitcnt lgkmcnt(10)
  v_mfma_f32_16x16x32_bf16 v[80:83], v[160:163], a[88:91], v[80:83]
  ds_read_b64_tr_b16 v[188:189], v29 offset:24576
  v_mfma_f32_16x16x32_bf16 v[84:87], v[160:163], a[92:95], v[84:87]
  ds_read_b64_tr_b16 v[190:191], v29 offset:25600
  v_mfma_f32_16x16x32_bf16 v[88:91], v[164:167], a[88:91], v[88:91]
  v_mfma_f32_16x16x32_bf16 v[92:95], v[164:167], a[92:95], v[92:95]
  s_waitcnt lgkmcnt(8)
  v_mfma_f32_16x16x32_bf16 v[96:99], v[168:171], a[88:91], v[96:99]
  v_mfma_f32_16x16x32_bf16 v[100:103], v[168:171], a[92:95], v[100:103]
  s_waitcnt vmcnt(46) lgkmcnt(0)
  s_barrier
  v_mfma_f32_16x16x32_bf16 v[104:107], v[172:175], a[88:91], v[104:107]
  ds_read_b64_tr_b16 v[160:161], v36 offset:0
  ds_read_b64_tr_b16 v[162:163], v36 offset:512
  v_mfma_f32_16x16x32_bf16 v[108:111], v[172:175], a[92:95], v[108:111]
  ds_read_b64_tr_b16 v[164:165], v37 offset:0
  ds_read_b64_tr_b16 v[166:167], v37 offset:512
  v_mfma_f32_16x16x32_bf16 v[80:83], v[176:179], a[96:99], v[80:83]
  ds_read_b64_tr_b16 v[168:169], v38 offset:0
  ds_read_b64_tr_b16 v[170:171], v38 offset:512
  v_mfma_f32_16x16x32_bf16 v[84:87], v[176:179], a[100:103], v[84:87]
  ds_read_b64_tr_b16 v[172:173], v39 offset:0
  ds_read_b64_tr_b16 v[174:175], v39 offset:512
  v_mfma_f32_16x16x32_bf16 v[88:91], v[180:183], a[96:99], v[88:91]
  ds_read_b64_tr_b16 v[176:177], v36 offset:4096
  v_mfma_f32_16x16x32_bf16 v[92:95], v[180:183], a[100:103], v[92:95]
  ds_read_b64_tr_b16 v[178:179], v36 offset:4608
  v_mfma_f32_16x16x32_bf16 v[96:99], v[184:187], a[96:99], v[96:99]
  ds_read_b64_tr_b16 v[180:181], v37 offset:4096
  v_mfma_f32_16x16x32_bf16 v[100:103], v[184:187], a[100:103], v[100:103]
  ds_read_b64_tr_b16 v[182:183], v37 offset:4608
  v_mfma_f32_16x16x32_bf16 v[104:107], v[188:191], a[96:99], v[104:107]
  ds_read_b64_tr_b16 v[184:185], v38 offset:4096
  v_mfma_f32_16x16x32_bf16 v[108:111], v[188:191], a[100:103], v[108:111]
  ds_read_b64_tr_b16 v[186:187], v38 offset:4608
  s_waitcnt lgkmcnt(10)
  s_waitcnt vmcnt(45)
  v_mfma_f32_16x16x32_bf16 v[112:115], v[160:163], a[104:107], 0
  ds_read_b64_tr_b16 v[188:189], v39 offset:4096
  s_waitcnt vmcnt(44)
  v_mfma_f32_16x16x32_bf16 v[116:119], v[160:163], a[108:111], 0
  ds_read_b64_tr_b16 v[190:191], v39 offset:4608
  v_mfma_f32_16x16x32_bf16 v[120:123], v[164:167], a[104:107], 0
  ds_read_b64_tr_b16 v[160:161], v36 offset:8192
  v_mfma_f32_16x16x32_bf16 v[124:127], v[164:167], a[108:111], 0
  ds_read_b64_tr_b16 v[162:163], v36 offset:8704
  s_waitcnt lgkmcnt(10)
  v_mfma_f32_16x16x32_bf16 v[128:131], v[168:171], a[104:107], 0
  ds_read_b64_tr_b16 v[164:165], v37 offset:8192
  v_mul_f32 v80, v41, v80
  v_mfma_f32_16x16x32_bf16 v[132:135], v[168:171], a[108:111], 0
  ds_read_b64_tr_b16 v[166:167], v37 offset:8704
  v_mfma_f32_16x16x32_bf16 v[136:139], v[172:175], a[104:107], 0
  ds_read_b64_tr_b16 v[168:169], v38 offset:8192
  s_add_u32 m0, s89, 36864
  v_mfma_f32_16x16x32_bf16 v[140:143], v[172:175], a[108:111], 0
  ds_read_b64_tr_b16 v[170:171], v38 offset:8704
  s_waitcnt lgkmcnt(10)
  s_waitcnt vmcnt(43)
  v_mfma_f32_16x16x32_bf16 v[112:115], v[176:179], a[112:115], v[112:115]
  ds_read_b64_tr_b16 v[172:173], v39 offset:8192
  v_mul_f32 v81, v41, v81
  s_waitcnt vmcnt(42)
  v_mfma_f32_16x16x32_bf16 v[116:119], v[176:179], a[116:119], v[116:119]
  ds_read_b64_tr_b16 v[174:175], v39 offset:8704
  buffer_load_dwordx4 v32, s[28:31], s88 offen offset:0 lds
  v_mfma_f32_16x16x32_bf16 v[120:123], v[180:183], a[112:115], v[120:123]
  ds_read_b64_tr_b16 v[176:177], v36 offset:12288
  v_mul_f32 v82, v41, v82
  v_mfma_f32_16x16x32_bf16 v[124:127], v[180:183], a[116:119], v[124:127]
  ds_read_b64_tr_b16 v[178:179], v36 offset:12800
  s_waitcnt lgkmcnt(10)
  v_mfma_f32_16x16x32_bf16 v[128:131], v[184:187], a[112:115], v[128:131]
  ds_read_b64_tr_b16 v[180:181], v37 offset:12288
  v_mul_f32 v83, v41, v83
  v_mfma_f32_16x16x32_bf16 v[132:135], v[184:187], a[116:119], v[132:135]
  ds_read_b64_tr_b16 v[182:183], v37 offset:12800
  buffer_load_dwordx4 v33, s[28:31], s88 offen offset:1024 lds
  v_mfma_f32_16x16x32_bf16 v[136:139], v[188:191], a[112:115], v[136:139]
  ds_read_b64_tr_b16 v[184:185], v38 offset:12288
  v_mul_f32 v84, v43, v84
  v_mfma_f32_16x16x32_bf16 v[140:143], v[188:191], a[116:119], v[140:143]
  ds_read_b64_tr_b16 v[186:187], v38 offset:12800
  s_waitcnt lgkmcnt(10)
  s_waitcnt vmcnt(43)
  v_mfma_f32_16x16x32_bf16 v[112:115], v[160:163], a[120:123], v[112:115]
  ds_read_b64_tr_b16 v[188:189], v39 offset:12288
  v_mul_f32 v85, v43, v85
  s_waitcnt vmcnt(42)
  v_mfma_f32_16x16x32_bf16 v[116:119], v[160:163], a[124:127], v[116:119]
  ds_read_b64_tr_b16 v[190:191], v39 offset:12800
  buffer_load_dwordx4 v34, s[28:31], s88 offen offset:2048 lds
  v_mfma_f32_16x16x32_bf16 v[120:123], v[164:167], a[120:123], v[120:123]
  ds_read_b64_tr_b16 v[160:161], v36 offset:16384
  v_mul_f32 v86, v43, v86
  v_mfma_f32_16x16x32_bf16 v[124:127], v[164:167], a[124:127], v[124:127]
  ds_read_b64_tr_b16 v[162:163], v36 offset:16896
  s_waitcnt lgkmcnt(10)
  v_mfma_f32_16x16x32_bf16 v[128:131], v[168:171], a[120:123], v[128:131]
  ds_read_b64_tr_b16 v[164:165], v37 offset:16384
  v_mul_f32 v87, v43, v87
  v_mfma_f32_16x16x32_bf16 v[132:135], v[168:171], a[124:127], v[132:135]
  ds_read_b64_tr_b16 v[166:167], v37 offset:16896
  buffer_load_dwordx4 v35, s[28:31], s88 offen offset:3072 lds
  s_add_u32 s87, s87, 524288
  v_mfma_f32_16x16x32_bf16 v[136:139], v[172:175], a[120:123], v[136:139]
  ds_read_b64_tr_b16 v[168:169], v38 offset:16384
  s_and_b32 s87, s87, 0x1fffff
  s_add_u32 s88, s87, 65536
  v_mfma_f32_16x16x32_bf16 v[140:143], v[172:175], a[124:127], v[140:143]
  ds_read_b64_tr_b16 v[170:171], v38 offset:16896
  s_waitcnt lgkmcnt(10)
  s_waitcnt vmcnt(43)
  v_mfma_f32_16x16x32_bf16 v[112:115], v[176:179], a[128:131], v[112:115]
  ds_read_b64_tr_b16 v[172:173], v39 offset:16384
  v_mul_f32 v88, v41, v88
  s_waitcnt vmcnt(42)
  v_mfma_f32_16x16x32_bf16 v[116:119], v[176:179], a[132:135], v[116:119]
  ds_read_b64_tr_b16 v[174:175], v39 offset:16896
  v_mul_f32 v89, v41, v89
  v_mfma_f32_16x16x32_bf16 v[120:123], v[180:183], a[128:131], v[120:123]
  ds_read_b64_tr_b16 v[176:177], v36 offset:20480
  v_mul_f32 v90, v41, v90
  v_mfma_f32_16x16x32_bf16 v[124:127], v[180:183], a[132:135], v[124:127]
  ds_read_b64_tr_b16 v[178:179], v36 offset:20992
  s_waitcnt lgkmcnt(10)
  v_mfma_f32_16x16x32_bf16 v[128:131], v[184:187], a[128:131], v[128:131]
  ds_read_b64_tr_b16 v[180:181], v37 offset:20480
  buffer_load_dwordx4 v[200:203], v30, s[20:23], s90 offen offset:2048 sc1
  v_mfma_f32_16x16x32_bf16 v[132:135], v[184:187], a[132:135], v[132:135]
  ds_read_b64_tr_b16 v[182:183], v37 offset:20992
  v_mul_f32 v91, v41, v91
  v_mfma_f32_16x16x32_bf16 v[136:139], v[188:191], a[128:131], v[136:139]
  ds_read_b64_tr_b16 v[184:185], v38 offset:20480
  v_mul_f32 v92, v43, v92
  v_mfma_f32_16x16x32_bf16 v[140:143], v[188:191], a[132:135], v[140:143]
  ds_read_b64_tr_b16 v[186:187], v38 offset:20992
  s_waitcnt lgkmcnt(10)
  buffer_load_dwordx4 v[204:207], v30, s[20:23], s90 offen offset:2304 sc1
  s_waitcnt vmcnt(43)
  v_mfma_f32_16x16x32_bf16 v[112:115], v[160:163], a[136:139], v[112:115]
  ds_read_b64_tr_b16 v[188:189], v39 offset:20480
  s_add_u32 s63, s63, 4096
  s_and_b32 s63, s63, 0xffff
  s_waitcnt vmcnt(42)
  v_mfma_f32_16x16x32_bf16 v[116:119], v[160:163], a[140:143], v[116:119]
  ds_read_b64_tr_b16 v[190:191], v39 offset:20992
  s_add_u32 s90, s96, s63
  v_mfma_f32_16x16x32_bf16 v[120:123], v[164:167], a[136:139], v[120:123]
  ds_read_b64_tr_b16 v[160:161], v36 offset:24576
  v_mul_f32 v93, v43, v93
  v_mul_f32 v94, v43, v94
  v_mfma_f32_16x16x32_bf16 v[124:127], v[164:167], a[140:143], v[124:127]
  ds_read_b64_tr_b16 v[162:163], v36 offset:25088
  s_waitcnt lgkmcnt(10)
  v_mfma_f32_16x16x32_bf16 v[128:131], v[168:171], a[136:139], v[128:131]
  ds_read_b64_tr_b16 v[164:165], v37 offset:24576
  buffer_load_dwordx4 v[208:211], v30, s[20:23], s90 offen offset:0 sc1
  v_mfma_f32_16x16x32_bf16 v[132:135], v[168:171], a[140:143], v[132:135]
  ds_read_b64_tr_b16 v[166:167], v37 offset:25088
  v_mul_f32 v95, v43, v95
  v_mfma_f32_16x16x32_bf16 v[136:139], v[172:175], a[136:139], v[136:139]
  ds_read_b64_tr_b16 v[168:169], v38 offset:24576
  v_mul_f32 v96, v41, v96
  v_mfma_f32_16x16x32_bf16 v[140:143], v[172:175], a[140:143], v[140:143]
  ds_read_b64_tr_b16 v[170:171], v38 offset:25088
  s_waitcnt lgkmcnt(10)
  s_waitcnt vmcnt(42)
  v_mfma_f32_16x16x32_bf16 v[112:115], v[176:179], a[144:147], v[112:115]
  ds_read_b64_tr_b16 v[172:173], v39 offset:24576
  buffer_load_dwordx4 v[212:215], v30, s[20:23], s90 offen offset:256 sc1
  s_waitcnt vmcnt(42)
  v_mfma_f32_16x16x32_bf16 v[116:119], v[176:179], a[148:151], v[116:119]
  ds_read_b64_tr_b16 v[174:175], v39 offset:25088
  v_mul_f32 v97, v41, v97
  v_mfma_f32_16x16x32_bf16 v[120:123], v[180:183], a[144:147], v[120:123]
  ds_read_b64_tr_b16 v[176:177], v36 offset:28672
  v_mul_f32 v98, v41, v98
  v_mfma_f32_16x16x32_bf16 v[124:127], v[180:183], a[148:151], v[124:127]
  ds_read_b64_tr_b16 v[178:179], v36 offset:29184
  s_waitcnt lgkmcnt(10)
  v_mfma_f32_16x16x32_bf16 v[128:131], v[184:187], a[144:147], v[128:131]
  ds_read_b64_tr_b16 v[180:181], v37 offset:28672
  v_add_u32 v36, 4294836224, v36
  v_mfma_f32_16x16x32_bf16 v[132:135], v[184:187], a[148:151], v[132:135]
  ds_read_b64_tr_b16 v[182:183], v37 offset:29184
  buffer_load_dwordx4 v[216:219], v30, s[20:23], s90 offen offset:2048 sc1
  v_mul_f32 v99, v41, v99
  v_mfma_f32_16x16x32_bf16 v[136:139], v[188:191], a[144:147], v[136:139]
  ds_read_b64_tr_b16 v[184:185], v38 offset:28672
  v_add_u32 v37, 4294836224, v37
  v_mul_f32 v100, v43, v100
  v_mfma_f32_16x16x32_bf16 v[140:143], v[188:191], a[148:151], v[140:143]
  ds_read_b64_tr_b16 v[186:187], v38 offset:29184
  s_waitcnt lgkmcnt(10)
  v_add_u32 v38, 4294836224, v38
  s_waitcnt vmcnt(42)
  v_mfma_f32_16x16x32_bf16 v[112:115], v[160:163], a[152:155], v[112:115]
  ds_read_b64_tr_b16 v[188:189], v39 offset:28672
  buffer_load_dwordx4 v[220:223], v30, s[20:23], s90 offen offset:2304 sc1
  s_add_u32 s63, s63, 4096
  s_waitcnt vmcnt(42)
  v_mfma_f32_16x16x32_bf16 v[116:119], v[160:163], a[156:159], v[116:119]
  ds_read_b64_tr_b16 v[190:191], v39 offset:29184
  s_and_b32 s63, s63, 0xffff
  s_add_u32 s90, s96, s63
  v_mfma_f32_16x16x32_bf16 v[120:123], v[164:167], a[152:155], v[120:123]
  v_mul_f32 v101, v43, v101
  v_add_u32 v39, 4294836224, v39
  v_mul_f32 v102, v43, v102
  v_mfma_f32_16x16x32_bf16 v[124:127], v[164:167], a[156:159], v[124:127]
  s_waitcnt lgkmcnt(8)
  buffer_load_dwordx4 v[224:227], v30, s[20:23], s90 offen offset:0 sc1
  v_mfma_f32_16x16x32_bf16 v[128:131], v[168:171], a[152:155], v[128:131]
  v_mul_f32 v103, v43, v103
  v_mul_f32 v104, v41, v104
  v_mfma_f32_16x16x32_bf16 v[132:135], v[168:171], a[156:159], v[132:135]
  s_waitcnt vmcnt(11) lgkmcnt(0)
  s_barrier
  s_cmp_lg_u32 s3, 0
  s_cbranch_scc1 L_sig28
  s_mov_b64 exec, 1
  v_mov_b32 v5, 15
  buffer_store_dword v5, off, s[20:23], s69 sc1
  s_mov_b64 exec, -1
L_sig28:
  v_mfma_f32_16x16x32_bf16 v[136:139], v[172:175], a[152:155], v[136:139]
  ds_read_b64_tr_b16 v[160:161], v36 offset:0
  ds_read_b64_tr_b16 v[162:163], v36 offset:512
  v_mul_f32 v105, v41, v105
  v_mfma_f32_16x16x32_bf16 v[140:143], v[172:175], a[156:159], v[140:143]
  ds_read_b64_tr_b16 v[164:165], v37 offset:0
  ds_read_b64_tr_b16 v[166:167], v37 offset:512
  v_mfma_f32_16x16x32_bf16 v[112:115], v[176:179], a[160:163], v[112:115]
  ds_read_b64_tr_b16 v[168:169], v38 offset:0
  ds_read_b64_tr_b16 v[170:171], v38 offset:512
  buffer_load_dwordx4 v[228:231], v30, s[20:23], s90 offen offset:256 sc1
  v_mfma_f32_16x16x32_bf16 v[116:119], v[176:179], a[164:167], v[116:119]
  ds_read_b64_tr_b16 v[172:173], v39 offset:0
  ds_read_b64_tr_b16 v[174:175], v39 offset:512
  v_mul_f32 v106, v41, v106
  v_mfma_f32_16x16x32_bf16 v[120:123], v[180:183], a[160:163], v[120:123]
  ds_read_b64_tr_b16 v[176:177], v36 offset:4096
  v_mul_f32 v107, v41, v107
  v_mfma_f32_16x16x32_bf16 v[124:127], v[180:183], a[164:167], v[124:127]
  ds_read_b64_tr_b16 v[178:179], v36 offset:4608
  v_mfma_f32_16x16x32_bf16 v[128:131], v[184:187], a[160:163], v[128:131]
  ds_read_b64_tr_b16 v[180:181], v37 offset:4096
  buffer_load_dwordx4 v[232:235], v30, s[20:23], s90 offen offset:2048 sc1
  v_mfma_f32_16x16x32_bf16 v[132:135], v[184:187], a[164:167], v[132:135]
  ds_read_b64_tr_b16 v[182:183], v37 offset:4608
  v_mul_f32 v108, v43, v108
  v_mfma_f32_16x16x32_bf16 v[136:139], v[188:191], a[160:163], v[136:139]
  ds_read_b64_tr_b16 v[184:185], v38 offset:4096
  v_mul_f32 v109, v43, v109
  v_mfma_f32_16x16x32_bf16 v[140:143], v[188:191], a[164:167], v[140:143]
  ds_read_b64_tr_b16 v[186:187], v38 offset:4608
  s_waitcnt lgkmcnt(10)
  v_mfma_f32_16x16x32_bf16 v[112:115], v[160:163], a[168:171], v[112:115]
  ds_read_b64_tr_b16 v[188:189], v39 offset:4096
  buffer_load_dwordx4 v[236:239], v30, s[20:23], s90 offen offset:2304 sc1
  s_add_u32 s63, s63, 4096
  v_mfma_f32_16x16x32_bf16 v[116:119], v[160:163], a[172:175], v[116:119]
  ds_read_b64_tr_b16 v[190:191], v39 offset:4608
  s_and_b32 s63, s63, 0xffff
  v_mfma_f32_16x16x32_bf16 v[120:123], v[164:167], a[168:171], v[120:123]
  ds_read_b64_tr_b16 v[160:161], v36 offset:8192
  s_add_u32 s90, s96, s63
  v_mfma_f32_16x16x32_bf16 v[124:127], v[164:167], a[172:175], v[124:127]
  ds_read_b64_tr_b16 v[162:163], v36 offset:8704
  s_waitcnt lgkmcnt(10)
  v_mfma_f32_16x16x32_bf16 v[128:131], v[168:171], a[168:171], v[128:131]
  ds_read_b64_tr_b16 v[164:165], v37 offset:8192
  v_mul_f32 v110, v43, v110
  v_mfma_f32_16x16x32_bf16 v[132:135], v[168:171], a[172:175], v[132:135]
  ds_read_b64_tr_b16 v[166:167], v37 offset:8704
  v_mul_f32_e64 v111, v43, v111
  v_mfma_f32_16x16x32_bf16 v[136:139], v[172:175], a[168:171], v[136:139]
  ds_read_b64_tr_b16 v[168:169], v38 offset:8192
  buffer_load_dwordx4 v[240:243], v30, s[20:23], s90 offen offset:0 sc1
  v_mfma_f32_16x16x32_bf16 v[140:143], v[172:175], a[172:175], v[140:143]
  ds_read_b64_tr_b16 v[170:171], v38 offset:8704
  s_waitcnt lgkmcnt(10)
  v_mfma_f32_16x16x32_bf16 v[112:115], v[176:179], a[176:179], v[112:115]
  ds_read_b64_tr_b16 v[172:173], v39 offset:8192
  buffer_load_dwordx4 v[244:247], v30, s[20:23], s90 offen offset:256 sc1
  v_mfma_f32_16x16x32_bf16 v[116:119], v[176:179], a[180:183], v[116:119]
  ds_read_b64_tr_b16 v[174:175], v39 offset:8704
  v_mfma_f32_16x16x32_bf16 v[120:123], v[180:183], a[176:179], v[120:123]
  ds_read_b64_tr_b16 v[176:177], v36 offset:12288
  v_mfma_f32_16x16x32_bf16 v[124:127], v[180:183], a[180:183], v[124:127]
  ds_read_b64_tr_b16 v[178:179], v36 offset:12800
  s_waitcnt lgkmcnt(10)
  v_mfma_f32_16x16x32_bf16 v[128:131], v[184:187], a[176:179], v[128:131]
  ds_read_b64_tr_b16 v[180:181], v37 offset:12288
  buffer_load_dwordx4 v[248:251], v30, s[20:23], s90 offen offset:2048 sc1
  v_mfma_f32_16x16x32_bf16 v[132:135], v[184:187], a[180:183], v[132:135]
  ds_read_b64_tr_b16 v[182:183], v37 offset:12800
  v_mfma_f32_16x16x32_bf16 v[136:139], v[188:191], a[176:179], v[136:139]
  ds_read_b64_tr_b16 v[184:185], v38 offset:12288
  v_mfma_f32_16x16x32_bf16 v[140:143], v[188:191], a[180:183], v[140:143]
  ds_read_b64_tr_b16 v[186:187], v38 offset:12800
  s_waitcnt lgkmcnt(10)
  v_mfma_f32_16x16x32_bf16 v[112:115], v[160:163], a[184:187], v[112:115]
  ds_read_b64_tr_b16 v[188:189], v39 offset:12288
  v_mfma_f32_16x16x32_bf16 v[116:119], v[160:163], a[188:191], v[116:119]
  ds_read_b64_tr_b16 v[190:191], v39 offset:12800
  v_mfma_f32_16x16x32_bf16 v[120:123], v[164:167], a[184:187], v[120:123]
  ds_read_b64_tr_b16 v[160:161], v36 offset:16384
  buffer_load_dwordx4 v[252:255], v30, s[20:23], s90 offen offset:2304 sc1
  s_add_u32 s63, s63, 4096
  v_mfma_f32_16x16x32_bf16 v[124:127], v[164:167], a[188:191], v[124:127]
  ds_read_b64_tr_b16 v[162:163], v36 offset:16896
  s_waitcnt lgkmcnt(10)
  v_mfma_f32_16x16x32_bf16 v[128:131], v[168:171], a[184:187], v[128:131]
  ds_read_b64_tr_b16 v[164:165], v37 offset:16384
  s_and_b32 s63, s63, 0xffff
  v_mfma_f32_16x16x32_bf16 v[132:135], v[168:171], a[188:191], v[132:135]
  ds_read_b64_tr_b16 v[166:167], v37 offset:16896
  s_add_u32 s90, s96, s63
  v_mfma_f32_16x16x32_bf16 v[136:139], v[172:175], a[184:187], v[136:139]
  ds_read_b64_tr_b16 v[168:169], v38 offset:16384
  buffer_load_dwordx4 a[0:3], v30, s[20:23], s90 offen offset:0 sc1
  v_mfma_f32_16x16x32_bf16 v[140:143], v[172:175], a[188:191], v[140:143]
  ds_read_b64_tr_b16 v[170:171], v38 offset:16896
  s_waitcnt lgkmcnt(10)
  v_mfma_f32_16x16x32_bf16 v[112:115], v[176:179], a[192:195], v[112:115]
  ds_read_b64_tr_b16 v[172:173], v39 offset:16384
  v_mfma_f32_16x16x32_bf16 v[116:119], v[176:179], a[196:199], v[116:119]
  ds_read_b64_tr_b16 v[174:175], v39 offset:16896
  v_mfma_f32_16x16x32_bf16 v[120:123], v[180:183], a[192:195], v[120:123]
  ds_read_b64_tr_b16 v[176:177], v36 offset:20480
  buffer_load_dwordx4 a[4:7], v30, s[20:23], s90 offen offset:256 sc1
  v_mfma_f32_16x16x32_bf16 v[124:127], v[180:183], a[196:199], v[124:127]
  ds_read_b64_tr_b16 v[178:179], v36 offset:20992
  s_waitcnt lgkmcnt(10)
  v_mfma_f32_16x16x32_bf16 v[128:131], v[184:187], a[192:195], v[128:131]
  ds_read_b64_tr_b16 v[180:181], v37 offset:20480
  s_add_u32 m0, s89, 65536
  v_mfma_f32_16x16x32_bf16 v[132:135], v[184:187], a[196:199], v[132:135]
  ds_read_b64_tr_b16 v[182:183], v37 offset:20992
  buffer_load_dword v25, v24, s[20:23], s94 offen sc1
  v_mfma_f32_16x16x32_bf16 v[136:139], v[188:191], a[192:195], v[136:139]
  ds_read_b64_tr_b16 v[184:185], v38 offset:20480
L_touch18:
  s_cbranch_execz L_tback
  buffer_load_dwordx4 v32, s[28:31], s87 offen offset:0 lds
  v_mfma_f32_16x16x32_bf16 v[140:143], v[188:191], a[196:199], v[140:143]
  ds_read_b64_tr_b16 v[186:187], v38 offset:20992
  s_waitcnt lgkmcnt(10)
  v_mfma_f32_16x16x32_bf16 v[112:115], v[160:163], a[200:203], v[112:115]
  ds_read_b64_tr_b16 v[188:189], v39 offset:20480
  v_mfma_f32_16x16x32_bf16 v[116:119], v[160:163], a[204:207], v[116:119]
  ds_read_b64_tr_b16 v[190:191], v39 offset:20992
  v_mfma_f32_16x16x32_bf16 v[120:123], v[164:167], a[200:203], v[120:123]
  ds_read_b64_tr_b16 v[160:161], v36 offset:24576
  buffer_load_dwordx4 v33, s[28:31], s87 offen offset:1024 lds
  v_mfma_f32_16x16x32_bf16 v[124:127], v[164:167], a[204:207], v[124:127]
  ds_read_b64_tr_b16 v[162:163], v36 offset:25088
  s_waitcnt lgkmcnt(10)
  v_mfma_f32_16x16x32_bf16 v[128:131], v[168:171], a[200:203], v[128:131]
  ds_read_b64_tr_b16 v[164:165], v37 offset:24576
  v_mfma_f32_16x16x32_bf16 v[132:135], v[168:171], a[204:207], v[132:135]
  ds_read_b64_tr_b16 v[166:167], v37 offset:25088
  v_mfma_f32_16x16x32_bf16 v[136:139], v[172:175], a[200:203], v[136:139]
  ds_read_b64_tr_b16 v[168:169], v38 offset:24576
  buffer_load_dwordx4 v34, s[28:31], s87 offen offset:2048 lds
  v_mfma_f32_16x16x32_bf16 v[140:143], v[172:175], a[204:207], v[140:143]
  ds_read_b64_tr_b16 v[170:171], v38 offset:25088
  s_waitcnt lgkmcnt(10)
  v_mfma_f32_16x16x32_bf16 v[112:115], v[176:179], a[208:211], v[112:115]
  ds_read_b64_tr_b16 v[172:173], v39 offset:24576
  buffer_load_dwordx4 v35, s[28:31], s87 offen offset:3072 lds
  v_mfma_f32_16x16x32_bf16 v[116:119], v[176:179], a[212:215], v[116:119]
  ds_read_b64_tr_b16 v[174:175], v39 offset:25088
  s_add_u32 m0, s89, 69632
  v_mfma_f32_16x16x32_bf16 v[120:123], v[180:183], a[208:211], v[120:123]
  ds_read_b64_tr_b16 v[176:177], v36 offset:28672
  v_mfma_f32_16x16x32_bf16 v[124:127], v[180:183], a[212:215], v[124:127]
  ds_read_b64_tr_b16 v[178:179], v36 offset:29184
  s_waitcnt lgkmcnt(10)
  v_mfma_f32_16x16x32_bf16 v[128:131], v[184:187], a[208:211], v[128:131]
  ds_read_b64_tr_b16 v[180:181], v37 offset:28672
  v_add_u32 v36, 32768, v36
  v_mfma_f32_16x16x32_bf16 v[132:135], v[184:187], a[212:215], v[132:135]
  ds_read_b64_tr_b16 v[182:183], v37 offset:29184
  buffer_load_dwordx4 v32, s[28:31], s88 offen offset:0 lds
  v_mfma_f32_16x16x32_bf16 v[136:139], v[188:191], a[208:211], v[136:139]
  ds_read_b64_tr_b16 v[184:185], v38 offset:28672
  v_add_u32 v37, 32768, v37
  v_mfma_f32_16x16x32_bf16 v[140:143], v[188:191], a[212:215], v[140:143]
  ds_read_b64_tr_b16 v[186:187], v38 offset:29184
  s_waitcnt lgkmcnt(10)
  v_mfma_f32_16x16x32_bf16 v[112:115], v[160:163], a[216:219], v[112:115]
  ds_read_b64_tr_b16 v[188:189], v39 offset:28672
  buffer_load_dwordx4 v33, s[28:31], s88 offen offset:1024 lds
  v_add_u32 v38, 32768, v38
  v_mfma_f32_16x16x32_bf16 v[116:119], v[160:163], a[220:223], v[116:119]
  ds_read_b64_tr_b16 v[190:191], v39 offset:29184
  buffer_load_dwordx4 v34, s[28:31], s88 offen offset:2048 lds
  v_add_u32 v39, 32768, v39
  v_mfma_f32_16x16x32_bf16 v[120:123], v[164:167], a[216:219], v[120:123]
  buffer_load_dwordx4 v35, s[28:31], s88 offen offset:3072 lds
  s_add_u32 s87, s87, 524288
  s_and_b32 s87, s87, 0x1fffff
  v_mfma_f32_16x16x32_bf16 v[124:127], v[164:167], a[220:223], v[124:127]
  s_waitcnt lgkmcnt(8)
  s_add_u32 s88, s87, 65536
  v_mfma_f32_16x16x32_bf16 v[128:131], v[168:171], a[216:219], v[128:131]
  buffer_load_dwordx4 a[8:11], v30, s[20:23], s90 offen offset:2048 sc1
  buffer_load_dwordx4 a[12:15], v30, s[20:23], s90 offen offset:2304 sc1
  s_add_u32 s63, s63, 4096
  v_mfma_f32_16x16x32_bf16 v[132:135], v[168:171], a[220:223], v[132:135]
  s_and_b32 s63, s63, 0xffff
  s_add_u32 s90, s96, s63
  s_waitcnt vmcnt(27) lgkmcnt(0)
  s_barrier
  v_mfma_f32_16x16x32_bf16 v[136:139], v[172:175], a[216:219], v[136:139]
  ds_read_b64_tr_b16 v[160:161], v36 offset:0
  ds_read_b64_tr_b16 v[162:163], v36 offset:512
  buffer_load_dwordx4 a[16:19], v30, s[20:23], s90 offen offset:0 sc1
  v_mfma_f32_16x16x32_bf16 v[140:143], v[172:175], a[220:223], v[140:143]
  ds_read_b64_tr_b16 v[164:165], v37 offset:0
  ds_read_b64_tr_b16 v[166:167], v37 offset:512
  s_waitcnt vmcnt(27)
  v_mfma_f32_16x16x32_bf16 v[112:115], v[176:179], v[200:203], v[112:115]
  ds_read_b64_tr_b16 v[168:169], v38 offset:0
  ds_read_b64_tr_b16 v[170:171], v38 offset:512
  buffer_load_dwordx4 a[20:23], v30, s[20:23], s90 offen offset:256 sc1
  s_waitcnt vmcnt(27)
  v_mfma_f32_16x16x32_bf16 v[116:119], v[176:179], v[204:207], v[116:119]
  ds_read_b64_tr_b16 v[172:173], v39 offset:0
  ds_read_b64_tr_b16 v[174:175], v39 offset:512
  v_mfma_f32_16x16x32_bf16 v[120:123], v[180:183], v[200:203], v[120:123]
  ds_read_b64_tr_b16 v[176:177], v36 offset:4096
  buffer_load_dwordx4 a[24:27], v30, s[20:23], s90 offen offset:2048 sc1
  v_mfma_f32_16x16x32_bf16 v[124:127], v[180:183], v[204:207], v[124:127]
  ds_read_b64_tr_b16 v[178:179], v36 offset:4608
  v_mfma_f32_16x16x32_bf16 v[128:131], v[184:187], v[200:203], v[128:131]
  ds_read_b64_tr_b16 v[180:181], v37 offset:4096
  buffer_load_dwordx4 a[28:31], v30, s[20:23], s90 offen offset:2304 sc1
  s_add_u32 s63, s63, 4096
  v_mfma_f32_16x16x32_bf16 v[132:135], v[184:187], v[204:207], v[132:135]
  ds_read_b64_tr_b16 v[182:183], v37 offset:4608
  s_and_b32 s63, s63, 0xffff
  v_mfma_f32_16x16x32_bf16 v[136:139], v[188:191], v[200:203], v[136:139]
  ds_read_b64_tr_b16 v[184:185], v38 offset:4096
  s_add_u32 s90, s96, s63
  v_mfma_f32_16x16x32_bf16 v[140:143], v[188:191], v[204:207], v[140:143]
  ds_read_b64_tr_b16 v[186:187], v38 offset:4608
  s_waitcnt lgkmcnt(10)
  s_waitcnt vmcnt(28)
  v_mfma_f32_16x16x32_bf16 v[112:115], v[160:163], v[208:211], v[112:115]
  ds_read_b64_tr_b16 v[188:189], v39 offset:4096
  buffer_load_dwordx4 a[32:35], v30, s[20:23], s90 offen offset:0 sc1
  s_waitcnt vmcnt(28)
  v_mfma_f32_16x16x32_bf16 v[116:119], v[160:163], v[212:215], v[116:119]
  ds_read_b64_tr_b16 v[190:191], v39 offset:4608
  buffer_load_dwordx4 a[36:39], v30, s[20:23], s90 offen offset:256 sc1
  v_mfma_f32_16x16x32_bf16 v[120:123], v[164:167], v[208:211], v[120:123]
  ds_read_b64_tr_b16 v[160:161], v36 offset:8192
  buffer_load_dwordx4 a[40:43], v30, s[20:23], s90 offen offset:2048 sc1
  v_mfma_f32_16x16x32_bf16 v[124:127], v[164:167], v[212:215], v[124:127]
  ds_read_b64_tr_b16 v[162:163], v36 offset:8704
  s_waitcnt lgkmcnt(10)
  v_mfma_f32_16x16x32_bf16 v[128:131], v[168:171], v[208:211], v[128:131]
  ds_read_b64_tr_b16 v[164:165], v37 offset:8192
  buffer_load_dwordx4 a[44:47], v30, s[20:23], s90 offen offset:2304 sc1
  s_add_u32 s63, s63, 4096
  v_mfma_f32_16x16x32_bf16 v[132:135], v[168:171], v[212:215], v[132:135]
  ds_read_b64_tr_b16 v[166:167], v37 offset:8704
  s_and_b32 s63, s63, 0xffff
  v_mfma_f32_16x16x32_bf16 v[136:139], v[172:175], v[208:211], v[136:139]
  ds_read_b64_tr_b16 v[168:169], v38 offset:8192
  s_add_u32 s90, s96, s63
  v_mfma_f32_16x16x32_bf16 v[140:143], v[172:175], v[212:215], v[140:143]
  ds_read_b64_tr_b16 v[170:171], v38 offset:8704
  s_waitcnt lgkmcnt(10)
  s_waitcnt vmcnt(30)
  v_mfma_f32_16x16x32_bf16 v[112:115], v[176:179], v[216:219], v[112:115]
  ds_read_b64_tr_b16 v[172:173], v39 offset:8192
  buffer_load_dwordx4 a[48:51], v30, s[20:23], s90 offen offset:0 sc1
  s_waitcnt vmcnt(30)
  v_mfma_f32_16x16x32_bf16 v[116:119], v[176:179], v[220:223], v[116:119]
  ds_read_b64_tr_b16 v[174:175], v39 offset:8704
  buffer_load_dwordx4 a[52:55], v30, s[20:23], s90 offen offset:256 sc1
  v_mfma_f32_16x16x32_bf16 v[120:123], v[180:183], v[216:219], v[120:123]
  ds_read_b64_tr_b16 v[176:177], v36 offset:12288
  buffer_load_dwordx4 a[56:59], v30, s[20:23], s90 offen offset:2048 sc1
  v_mfma_f32_16x16x32_bf16 v[124:127], v[180:183], v[220:223], v[124:127]
  ds_read_b64_tr_b16 v[178:179], v36 offset:12800
  s_waitcnt lgkmcnt(10)
  v_mfma_f32_16x16x32_bf16 v[128:131], v[184:187], v[216:219], v[128:131]
  ds_read_b64_tr_b16 v[180:181], v37 offset:12288
  buffer_load_dwordx4 a[60:63], v30, s[20:23], s90 offen offset:2304 sc1
  s_add_u32 s63, s63, 4096
  v_mfma_f32_16x16x32_bf16 v[132:135], v[184:187], v[220:223], v[132:135]
  ds_read_b64_tr_b16 v[182:183], v37 offset:12800
  s_and_b32 s63, s63, 0xffff
  v_mfma_f32_16x16x32_bf16 v[136:139], v[188:191], v[216:219], v[136:139]
  ds_read_b64_tr_b16 v[184:185], v38 offset:12288
  s_add_u32 s90, s96, s63
  v_mfma_f32_16x16x32_bf16 v[140:143], v[188:191], v[220:223], v[140:143]
  ds_read_b64_tr_b16 v[186:187], v38 offset:12800
  s_waitcnt lgkmcnt(10)
  s_waitcnt vmcnt(32)
  v_mfma_f32_16x16x32_bf16 v[112:115], v[160:163], v[224:227], v[112:115]
  ds_read_b64_tr_b16 v[188:189], v39 offset:12288
  buffer_load_dwordx4 a[64:67], v30, s[20:23], s90 offen offset:0 sc1
  s_waitcnt vmcnt(32)
  v_mfma_f32_16x16x32_bf16 v[116:119], v[160:163], v[228:231], v[116:119]
  ds_read_b64_tr_b16 v[190:191], v39 offset:12800
  buffer_load_dwordx4 a[68:71], v30, s[20:23], s90 offen offset:256 sc1
  v_mfma_f32_16x16x32_bf16 v[120:123], v[164:167], v[224:227], v[120:123]
  ds_read_b64_tr_b16 v[160:161], v36 offset:16384
  buffer_load_dwordx4 a[72:75], v30, s[20:23], s90 offen offset:2048 sc1
  v_mfma_f32_16x16x32_bf16 v[124:127], v[164:167], v[228:231], v[124:127]
  ds_read_b64_tr_b16 v[162:163], v36 offset:16896
  s_waitcnt lgkmcnt(10)
  v_mfma_f32_16x16x32_bf16 v[128:131], v[168:171], v[224:227], v[128:131]
  ds_read_b64_tr_b16 v[164:165], v37 offset:16384
  buffer_load_dwordx4 a[76:79], v30, s[20:23], s90 offen offset:2304 sc1
  s_add_u32 s63, s63, 4096
  v_mfma_f32_16x16x32_bf16 v[132:135], v[168:171], v[228:231], v[132:135]
  ds_read_b64_tr_b16 v[166:167], v37 offset:16896
  s_and_b32 s63, s63, 0xffff
  v_mfma_f32_16x16x32_bf16 v[136:139], v[172:175], v[224:227], v[136:139]
  ds_read_b64_tr_b16 v[168:169], v38 offset:16384
  s_add_u32 s90, s96, s63
  v_mfma_f32_16x16x32_bf16 v[140:143], v[172:175], v[228:231], v[140:143]
  ds_read_b64_tr_b16 v[170:171], v38 offset:16896
  s_waitcnt lgkmcnt(10)
  s_waitcnt vmcnt(26)
  v_cmp_gt_u32 vcc, 15, v25
  s_nop 0
  s_cbranch_vccnz L_retry6
L_cont6:
  v_mfma_f32_16x16x32_bf16 v[112:115], v[176:179], v[232:235], v[112:115]
  ds_read_b64_tr_b16 v[172:173], v39 offset:16384
  buffer_load_dwordx4 v[144:147], v4, s[20:23], s93 offen offset:0 sc1
  v_mfma_f32_16x16x32_bf16 v[116:119], v[176:179], v[236:239], v[116:119]
  ds_read_b64_tr_b16 v[174:175], v39 offset:16896
  v_mfma_f32_16x16x32_bf16 v[120:123], v[180:183], v[232:235], v[120:123]
  ds_read_b64_tr_b16 v[176:177], v36 offset:20480
  buffer_load_dwordx4 v[148:151], v4, s[20:23], s93 offen offset:1024 sc1
  v_mfma_f32_16x16x32_bf16 v[124:127], v[180:183], v[236:239], v[124:127]
  ds_read_b64_tr_b16 v[178:179], v36 offset:20992
  s_waitcnt lgkmcnt(10)
  v_mfma_f32_16x16x32_bf16 v[128:131], v[184:187], v[232:235], v[128:131]
  ds_read_b64_tr_b16 v[180:181], v37 offset:20480
  buffer_load_dwordx4 v[152:155], v4, s[20:23], s93 offen offset:2048 sc1
  v_mfma_f32_16x16x32_bf16 v[132:135], v[184:187], v[236:239], v[132:135]
  ds_read_b64_tr_b16 v[182:183], v37 offset:20992
  v_mfma_f32_16x16x32_bf16 v[136:139], v[188:191], v[232:235], v[136:139]
  ds_read_b64_tr_b16 v[184:185], v38 offset:20480
  buffer_load_dwordx4 v[156:159], v4, s[20:23], s93 offen offset:3072 sc1
  v_mfma_f32_16x16x32_bf16 v[140:143], v[188:191], v[236:239], v[140:143]
  ds_read_b64_tr_b16 v[186:187], v38 offset:20992
  s_waitcnt lgkmcnt(10)
  v_mfma_f32_16x16x32_bf16 v[112:115], v[160:163], v[240:243], v[112:115]
  ds_read_b64_tr_b16 v[188:189], v39 offset:20480
  v_mfma_f32_16x16x32_bf16 v[116:119], v[160:163], v[244:247], v[116:119]
  ds_read_b64_tr_b16 v[190:191], v39 offset:20992
  v_mfma_f32_16x16x32_bf16 v[120:123], v[164:167], v[240:243], v[120:123]
  ds_read_b64_tr_b16 v[160:161], v36 offset:24576
  v_mfma_f32_16x16x32_bf16 v[124:127], v[164:167], v[244:247], v[124:127]
  ds_read_b64_tr_b16 v[162:163], v36 offset:25088
  s_waitcnt lgkmcnt(10)
  v_mfma_f32_16x16x32_bf16 v[128:131], v[168:171], v[240:243], v[128:131]
  ds_read_b64_tr_b16 v[164:165], v37 offset:24576
  v_mfma_f32_16x16x32_bf16 v[132:135], v[168:171], v[244:247], v[132:135]
  ds_read_b64_tr_b16 v[166:167], v37 offset:25088
  v_mfma_f32_16x16x32_bf16 v[136:139], v[172:175], v[240:243], v[136:139]
  ds_read_b64_tr_b16 v[168:169], v38 offset:24576
  v_mfma_f32_16x16x32_bf16 v[140:143], v[172:175], v[244:247], v[140:143]
  ds_read_b64_tr_b16 v[170:171], v38 offset:25088
  s_waitcnt lgkmcnt(10)
  v_mfma_f32_16x16x32_bf16 v[112:115], v[176:179], v[248:251], v[112:115]
  ds_read_b64_tr_b16 v[172:173], v39 offset:24576
  v_mfma_f32_16x16x32_bf16 v[116:119], v[176:179], v[252:255], v[116:119]
  ds_read_b64_tr_b16 v[174:175], v39 offset:25088
  v_mfma_f32_16x16x32_bf16 v[120:123], v[180:183], v[248:251], v[120:123]
  ds_read_b64_tr_b16 v[176:177], v36 offset:28672
  v_mfma_f32_16x16x32_bf16 v[124:127], v[180:183], v[252:255], v[124:127]
  ds_read_b64_tr_b16 v[178:179], v36 offset:29184
  s_waitcnt lgkmcnt(10)
  v_mfma_f32_16x16x32_bf16 v[128:131], v[184:187], v[248:251], v[128:131]
  ds_read_b64_tr_b16 v[180:181], v37 offset:28672
  v_add_u32 v36, 32768, v36
  v_mfma_f32_16x16x32_bf16 v[132:135], v[184:187], v[252:255], v[132:135]
  ds_read_b64_tr_b16 v[182:183], v37 offset:29184
  v_add_u32 v37, 32768, v37
  v_mfma_f32_16x16x32_bf16 v[136:139], v[188:191], v[248:251], v[136:139]
  ds_read_b64_tr_b16 v[184:185], v38 offset:28672
  v_mfma_f32_16x16x32_bf16 v[140:143], v[188:191], v[252:255], v[140:143]
  ds_read_b64_tr_b16 v[186:187], v38 offset:29184
  s_waitcnt lgkmcnt(10)
  v_mfma_f32_16x16x32_bf16 v[112:115], v[160:163], a[0:3], v[112:115]
  ds_read_b64_tr_b16 v[188:189], v39 offset:28672
  v_add_u32 v38, 32768, v38
  v_mfma_f32_16x16x32_bf16 v[116:119], v[160:163], a[4:7], v[116:119]
  ds_read_b64_tr_b16 v[190:191], v39 offset:29184
  v_add_u32 v39, 32768, v39
  v_mfma_f32_16x16x32_bf16 v[120:123], v[164:167], a[0:3], v[120:123]
  v_mfma_f32_16x16x32_bf16 v[124:127], v[164:167], a[4:7], v[124:127]
  s_waitcnt lgkmcnt(8)
  v_mfma_f32_16x16x32_bf16 v[128:131], v[168:171], a[0:3], v[128:131]
  v_mfma_f32_16x16x32_bf16 v[132:135], v[168:171], a[4:7], v[132:135]
  s_waitcnt vmcnt(22) lgkmcnt(0)
  s_barrier
  v_mfma_f32_16x16x32_bf16 v[136:139], v[172:175], a[0:3], v[136:139]
  ds_read_b64_tr_b16 v[160:161], v36 offset:0
  ds_read_b64_tr_b16 v[162:163], v36 offset:512
  v_mfma_f32_16x16x32_bf16 v[140:143], v[172:175], a[4:7], v[140:143]
  ds_read_b64_tr_b16 v[164:165], v37 offset:0
  ds_read_b64_tr_b16 v[166:167], v37 offset:512
  s_waitcnt vmcnt(21)
  v_mfma_f32_16x16x32_bf16 v[112:115], v[176:179], a[8:11], v[112:115]
  ds_read_b64_tr_b16 v[168:169], v36 offset:4096
  ds_read_b64_tr_b16 v[170:171], v36 offset:4608
  s_waitcnt vmcnt(20)
  v_mfma_f32_16x16x32_bf16 v[116:119], v[176:179], a[12:15], v[116:119]
  ds_read_b64_tr_b16 v[172:173], v37 offset:4096
  ds_read_b64_tr_b16 v[174:175], v37 offset:4608
  v_mfma_f32_16x16x32_bf16 v[120:123], v[180:183], a[8:11], v[120:123]
  ds_read_b64_tr_b16 v[176:177], v36 offset:8192
  v_mfma_f32_16x16x32_bf16 v[124:127], v[180:183], a[12:15], v[124:127]
  ds_read_b64_tr_b16 v[178:179], v36 offset:8704
  v_mfma_f32_16x16x32_bf16 v[128:131], v[184:187], a[8:11], v[128:131]
  ds_read_b64_tr_b16 v[180:181], v37 offset:8192
  v_mfma_f32_16x16x32_bf16 v[132:135], v[184:187], a[12:15], v[132:135]
  ds_read_b64_tr_b16 v[182:183], v37 offset:8704
  v_mfma_f32_16x16x32_bf16 v[136:139], v[188:191], a[8:11], v[136:139]
  ds_read_b64_tr_b16 v[184:185], v36 offset:12288
  v_mfma_f32_16x16x32_bf16 v[140:143], v[188:191], a[12:15], v[140:143]
  ds_read_b64_tr_b16 v[186:187], v36 offset:12800
  s_waitcnt lgkmcnt(10)
  s_waitcnt vmcnt(19)
  v_mfma_f32_16x16x32_bf16 v[112:115], v[160:163], a[16:19], v[112:115]
  ds_read_b64_tr_b16 v[188:189], v37 offset:12288
  s_waitcnt vmcnt(18)
  v_mfma_f32_16x16x32_bf16 v[116:119], v[160:163], a[20:23], v[116:119]
  ds_read_b64_tr_b16 v[190:191], v37 offset:12800
  v_mfma_f32_16x16x32_bf16 v[120:123], v[164:167], a[16:19], v[120:123]
  ds_read_b64_tr_b16 v[160:161], v36 offset:16384
  v_mfma_f32_16x16x32_bf16 v[124:127], v[164:167], a[20:23], v[124:127]
  ds_read_b64_tr_b16 v[162:163], v36 offset:16896
  s_waitcnt lgkmcnt(10)
  s_waitcnt vmcnt(17)
  v_mfma_f32_16x16x32_bf16 v[112:115], v[168:171], a[24:27], v[112:115]
  ds_read_b64_tr_b16 v[164:165], v37 offset:16384
  s_waitcnt vmcnt(16)
  v_mfma_f32_16x16x32_bf16 v[116:119], v[168:171], a[28:31], v[116:119]
  ds_read_b64_tr_b16 v[166:167], v37 offset:16896
  v_mfma_f32_16x16x32_bf16 v[120:123], v[172:175], a[24:27], v[120:123]
  ds_read_b64_tr_b16 v[168:169], v36 offset:20480
  v_mfma_f32_16x16x32_bf16 v[124:127], v[172:175], a[28:31], v[124:127]
  ds_read_b64_tr_b16 v[170:171], v36 offset:20992
  s_waitcnt lgkmcnt(10)
  s_waitcnt vmcnt(15)
  v_mfma_f32_16x16x32_bf16 v[112:115], v[176:179], a[32:35], v[112:115]
  ds_read_b64_tr_b16 v[172:173], v37 offset:20480
  s_waitcnt vmcnt(14)
  v_mfma_f32_16x16x32_bf16 v[116:119], v[176:179], a[36:39], v[116:119]
  ds_read_b64_tr_b16 v[174:175], v37 offset:20992
  v_mfma_f32_16x16x32_bf16 v[120:123], v[180:183], a[32:35], v[120:123]
  ds_read_b64_tr_b16 v[176:177], v36 offset:24576
  v_mfma_f32_16x16x32_bf16 v[124:127], v[180:183], a[36:39], v[124:127]
  ds_read_b64_tr_b16 v[178:179], v36 offset:25088
  s_waitcnt lgkmcnt(10)
  s_waitcnt vmcnt(13)
  v_mfma_f32_16x16x32_bf16 v[112:115], v[184:187], a[40:43], v[112:115]
  ds_read_b64_tr_b16 v[180:181], v37 offset:24576
  s_waitcnt vmcnt(12)
  v_mfma_f32_16x16x32_bf16 v[116:119], v[184:187], a[44:47], v[116:119]
  ds_read_b64_tr_b16 v[182:183], v37 offset:25088
  v_mfma_f32_16x16x32_bf16 v[120:123], v[188:191], a[40:43], v[120:123]
  ds_read_b64_tr_b16 v[184:185], v36 offset:28672
  v_mfma_f32_16x16x32_bf16 v[124:127], v[188:191], a[44:47], v[124:127]
  ds_read_b64_tr_b16 v[186:187], v36 offset:29184
  s_waitcnt lgkmcnt(10)
  s_waitcnt vmcnt(11)
  v_mfma_f32_16x16x32_bf16 v[112:115], v[160:163], a[48:51], v[112:115]
  ds_read_b64_tr_b16 v[188:189], v37 offset:28672
  s_waitcnt vmcnt(10)
  v_mfma_f32_16x16x32_bf16 v[116:119], v[160:163], a[52:55], v[116:119]
  ds_read_b64_tr_b16 v[190:191], v37 offset:29184
  v_mfma_f32_16x16x32_bf16 v[120:123], v[164:167], a[48:51], v[120:123]
  ds_read_b64_tr_b16 v[160:161], v38 offset:0
  v_mfma_f32_16x16x32_bf16 v[124:127], v[164:167], a[52:55], v[124:127]
  ds_read_b64_tr_b16 v[162:163], v38 offset:512
  s_waitcnt lgkmcnt(10)
  s_waitcnt vmcnt(9)
  v_mfma_f32_16x16x32_bf16 v[112:115], v[168:171], a[56:59], v[112:115]
  ds_read_b64_tr_b16 v[164:165], v39 offset:0
  s_waitcnt vmcnt(8)
  v_mfma_f32_16x16x32_bf16 v[116:119], v[168:171], a[60:63], v[116:119]
  ds_read_b64_tr_b16 v[166:167], v39 offset:512
  v_mfma_f32_16x16x32_bf16 v[120:123], v[172:175], a[56:59], v[120:123]
  ds_read_b64_tr_b16 v[168:169], v38 offset:4096
  v_mfma_f32_16x16x32_bf16 v[124:127], v[172:175], a[60:63], v[124:127]
  ds_read_b64_tr_b16 v[170:171], v38 offset:4608
  s_waitcnt lgkmcnt(10)
  s_waitcnt vmcnt(7)
  v_mfma_f32_16x16x32_bf16 v[112:115], v[176:179], a[64:67], v[112:115]
  ds_read_b64_tr_b16 v[172:173], v39 offset:4096
  s_waitcnt vmcnt(6)
  v_mfma_f32_16x16x32_bf16 v[116:119], v[176:179], a[68:71], v[116:119]
  ds_read_b64_tr_b16 v[174:175], v39 offset:4608
  v_mfma_f32_16x16x32_bf16 v[120:123], v[180:183], a[64:67], v[120:123]
  ds_read_b64_tr_b16 v[176:177], v38 offset:8192
  v_mfma_f32_16x16x32_bf16 v[124:127], v[180:183], a[68:71], v[124:127]
  ds_read_b64_tr_b16 v[178:179], v38 offset:8704
  s_waitcnt lgkmcnt(10)
  s_waitcnt vmcnt(5)
  v_mfma_f32_16x16x32_bf16 v[112:115], v[184:187], a[72:75], v[112:115]
  ds_read_b64_tr_b16 v[180:181], v39 offset:8192
  s_waitcnt vmcnt(4)
  v_mfma_f32_16x16x32_bf16 v[116:119], v[184:187], a[76:79], v[116:119]
  ds_read_b64_tr_b16 v[182:183], v39 offset:8704
  v_mfma_f32_16x16x32_bf16 v[120:123], v[188:191], a[72:75], v[120:123]
  ds_read_b64_tr_b16 v[184:185], v38 offset:12288
  v_mfma_f32_16x16x32_bf16 v[124:127], v[188:191], a[76:79], v[124:127]
  ds_read_b64_tr_b16 v[186:187], v38 offset:12800
  s_waitcnt lgkmcnt(10)
  v_mfma_f32_16x16x32_bf16 v[128:131], v[160:163], a[16:19], v[128:131]
  ds_read_b64_tr_b16 v[188:189], v39 offset:12288
  s_waitcnt vmcnt(3)
  v_dot2_f32_bf16 v80, v144, v40, v80
  v_mfma_f32_16x16x32_bf16 v[132:135], v[160:163], a[20:23], v[132:135]
  ds_read_b64_tr_b16 v[190:191], v39 offset:12800
  v_dot2_f32_bf16 v81, v144, v41, v81
  v_mfma_f32_16x16x32_bf16 v[136:139], v[164:167], a[16:19], v[136:139]
  ds_read_b64_tr_b16 v[160:161], v38 offset:16384
  v_dot2_f32_bf16 v82, v145, v40, v82
  v_mfma_f32_16x16x32_bf16 v[140:143], v[164:167], a[20:23], v[140:143]
  ds_read_b64_tr_b16 v[162:163], v38 offset:16896
  s_waitcnt lgkmcnt(10)
  v_mfma_f32_16x16x32_bf16 v[128:131], v[168:171], a[24:27], v[128:131]
  ds_read_b64_tr_b16 v[164:165], v39 offset:16384
  v_dot2_f32_bf16 v83, v145, v41, v83
  v_mfma_f32_16x16x32_bf16 v[132:135], v[168:171], a[28:31], v[132:135]
  ds_read_b64_tr_b16 v[166:167], v39 offset:16896
  v_dot2_f32_bf16 v84, v146, v42, v84
  v_mfma_f32_16x16x32_bf16 v[136:139], v[172:175], a[24:27], v[136:139]
  ds_read_b64_tr_b16 v[168:169], v38 offset:20480
  v_dot2_f32_bf16 v85, v146, v43, v85
  v_mfma_f32_16x16x32_bf16 v[140:143], v[172:175], a[28:31], v[140:143]
  ds_read_b64_tr_b16 v[170:171], v38 offset:20992
  s_waitcnt lgkmcnt(10)
  v_mfma_f32_16x16x32_bf16 v[128:131], v[176:179], a[32:35], v[128:131]
  ds_read_b64_tr_b16 v[172:173], v39 offset:20480
  v_dot2_f32_bf16 v86, v147, v42, v86
  v_dot2_f32_bf16 v87, v147, v43, v87
  v_mfma_f32_16x16x32_bf16 v[132:135], v[176:179], a[36:39], v[132:135]
  ds_read_b64_tr_b16 v[174:175], v39 offset:20992
  s_waitcnt vmcnt(2)
  v_dot2_f32_bf16 v88, v148, v40, v88
  v_mfma_f32_16x16x32_bf16 v[136:139], v[180:183], a[32:35], v[136:139]
  ds_read_b64_tr_b16 v[176:177], v38 offset:24576
  v_dot2_f32_bf16 v89, v148, v41, v89
  v_mfma_f32_16x16x32_bf16 v[140:143], v[180:183], a[36:39], v[140:143]
  ds_read_b64_tr_b16 v[178:179], v38 offset:25088
  s_waitcnt lgkmcnt(10)
  v_mfma_f32_16x16x32_bf16 v[128:131], v[184:187], a[40:43], v[128:131]
  ds_read_b64_tr_b16 v[180:181], v39 offset:24576
  v_dot2_f32_bf16 v90, v149, v40, v90
  v_dot2_f32_bf16 v91, v149, v41, v91
  v_mfma_f32_16x16x32_bf16 v[132:135], v[184:187], a[44:47], v[132:135]
  ds_read_b64_tr_b16 v[182:183], v39 offset:25088
  v_dot2_f32_bf16 v92, v150, v42, v92
  v_mfma_f32_16x16x32_bf16 v[136:139], v[188:191], a[40:43], v[136:139]
  ds_read_b64_tr_b16 v[184:185], v38 offset:28672
  v_dot2_f32_bf16 v93, v150, v43, v93
  v_mfma_f32_16x16x32_bf16 v[140:143], v[188:191], a[44:47], v[140:143]
  ds_read_b64_tr_b16 v[186:187], v38 offset:29184
  s_waitcnt lgkmcnt(10)
  v_mfma_f32_16x16x32_bf16 v[128:131], v[160:163], a[48:51], v[128:131]
  ds_read_b64_tr_b16 v[188:189], v39 offset:28672
  v_dot2_f32_bf16 v94, v151, v42, v94
  v_dot2_f32_bf16 v95, v151, v43, v95
  v_mfma_f32_16x16x32_bf16 v[132:135], v[160:163], a[52:55], v[132:135]
  ds_read_b64_tr_b16 v[190:191], v39 offset:29184
  s_waitcnt vmcnt(1)
  v_dot2_f32_bf16 v96, v152, v40, v96
  v_mfma_f32_16x16x32_bf16 v[136:139], v[164:167], a[48:51], v[136:139]
  v_dot2_f32_bf16 v97, v152, v41, v97
  v_dot2_f32_bf16 v98, v153, v40, v98
  v_dot2_f32_bf16 v99, v153, v41, v99
  v_mfma_f32_16x16x32_bf16 v[140:143], v[164:167], a[52:55], v[140:143]
  s_waitcnt lgkmcnt(8)
  v_fma_f32 v80, v112, v6, v80
  v_mfma_f32_16x16x32_bf16 v[128:131], v[168:171], a[56:59], v[128:131]
  v_fma_f32 v81, v113, v6, v81
  v_fma_f32 v82, v114, v6, v82
  v_fma_f32 v83, v115, v6, v83
  v_mfma_f32_16x16x32_bf16 v[132:135], v[168:171], a[60:63], v[132:135]
  v_cvt_pk_bf16_f32 v48, v80, v81
  v_cvt_pk_bf16_f32 v49, v82, v83
  v_mfma_f32_16x16x32_bf16 v[136:139], v[172:175], a[56:59], v[136:139]
  v_fma_f32 v88, v120, v6, v88
  v_fma_f32 v89, v121, v6, v89
  v_fma_f32 v90, v122, v6, v90
  v_mfma_f32_16x16x32_bf16 v[140:143], v[172:175], a[60:63], v[140:143]
  s_waitcnt lgkmcnt(4)
  v_fma_f32 v91, v123, v6, v91
  v_mfma_f32_16x16x32_bf16 v[128:131], v[176:179], a[64:67], v[128:131]
  v_cvt_pk_bf16_f32 v50, v88, v89
  v_cvt_pk_bf16_f32 v51, v90, v91
  v_fma_f32 v84, v116, v31, v84
  v_mfma_f32_16x16x32_bf16 v[132:135], v[176:179], a[68:71], v[132:135]
  v_fma_f32 v85, v117, v31, v85
  v_mfma_f32_16x16x32_bf16 v[136:139], v[180:183], a[64:67], v[136:139]
  v_fma_f32 v86, v118, v31, v86
  v_fma_f32 v87, v119, v31, v87
  v_cvt_pk_bf16_f32 v52, v84, v85
  v_mfma_f32_16x16x32_bf16 v[140:143], v[180:183], a[68:71], v[140:143]
  s_waitcnt lgkmcnt(0)
  v_cvt_pk_bf16_f32 v53, v86, v87
  v_mfma_f32_16x16x32_bf16 v[128:131], v[184:187], a[72:75], v[128:131]
  v_fma_f32 v92, v124, v31, v92
  v_fma_f32 v93, v125, v31, v93
  v_fma_f32 v94, v126, v31, v94
  v_mfma_f32_16x16x32_bf16 v[132:135], v[184:187], a[76:79], v[132:135]
  v_fma_f32 v95, v127, v31, v95
  v_mfma_f32_16x16x32_bf16 v[136:139], v[188:191], a[72:75], v[136:139]
  v_cvt_pk_bf16_f32 v54, v92, v93
  v_cvt_pk_bf16_f32 v55, v94, v95
  v_permlane16_swap_b32 v48, v50
  v_mfma_f32_16x16x32_bf16 v[140:143], v[188:191], a[76:79], v[140:143]
  v_permlane16_swap_b32 v49, v51
  v_permlane16_swap_b32 v52, v54
  v_permlane16_swap_b32_e64 v53, v55
  buffer_store_dwordx4 v[48:51], v44, s[32:35], s73 offen offset:0
  buffer_store_dwordx4 v[52:55], v45, s[32:35], s73 offen offset:0
  v_dot2_f32_bf16 v100, v154, v42, v100
  v_dot2_f32_bf16 v101, v154, v43, v101
  v_dot2_f32_bf16 v102, v155, v42, v102
  v_dot2_f32_bf16 v103, v155, v43, v103
  s_nop 0
  s_waitcnt vmcnt(2)
  v_dot2_f32_bf16 v104, v156, v40, v104
  v_dot2_f32_bf16 v105, v156, v41, v105
  v_dot2_f32_bf16 v106, v157, v40, v106
  v_dot2_f32_bf16 v107, v157, v41, v107
  v_dot2_f32_bf16 v108, v158, v42, v108
  v_dot2_f32_bf16 v109, v158, v43, v109
  v_dot2_f32_bf16 v110, v159, v42, v110
  v_dot2_f32_bf16 v111, v159, v43, v111
  v_fma_f32 v96, v128, v6, v96
  v_fma_f32 v97, v129, v6, v97
  v_fma_f32 v98, v130, v6, v98
  v_fma_f32 v99, v131, v6, v99
  v_cvt_pk_bf16_f32 v56, v96, v97
  v_cvt_pk_bf16_f32 v57, v98, v99
  v_fma_f32 v104, v136, v6, v104
  v_fma_f32 v105, v137, v6, v105
  v_fma_f32 v106, v138, v6, v106
  v_fma_f32 v107, v139, v6, v107
  v_cvt_pk_bf16_f32 v58, v104, v105
  v_cvt_pk_bf16_f32 v59, v106, v107
  v_fma_f32 v100, v132, v31, v100
  v_fma_f32 v101, v133, v31, v101
  v_fma_f32 v102, v134, v31, v102
  v_fma_f32 v103, v135, v31, v103
  v_cvt_pk_bf16_f32 v60, v100, v101
  v_cvt_pk_bf16_f32 v61, v102, v103
  v_fma_f32 v108, v140, v31, v108
  v_fma_f32 v109, v141, v31, v109
  v_fma_f32 v110, v142, v31, v110
  v_fma_f32 v111, v143, v31, v111
  v_cvt_pk_bf16_f32 v62, v108, v109
  v_cvt_pk_bf16_f32 v63, v110, v111
  v_permlane16_swap_b32 v56, v58
  v_permlane16_swap_b32 v57, v59
  v_permlane16_swap_b32 v60, v62
  v_permlane16_swap_b32 v61, v63
  buffer_store_dwordx4 v[56:59], v44, s[32:35], s73 offen offset:64
  buffer_store_dwordx4 v[60:63], v45, s[32:35], s73 offen offset:64
L_fin:
L_end:
  s_endpgm
L_fallback:
  s_mov_b32 s83, s81
  s_mov_b32 s86, 64
  v_mov_b32 v48, 0xff800000
  v_mov_b32 v50, 0
  v_mov_b32 v112, 0
  v_mov_b32 v113, 0
  v_mov_b32 v114, 0
  v_mov_b32 v115, 0
  v_mov_b32 v116, 0
  v_mov_b32 v117, 0
  v_mov_b32 v118, 0
  v_mov_b32 v119, 0
  v_mov_b32 v120, 0
  v_mov_b32 v121, 0
  v_mov_b32 v122, 0
  v_mov_b32 v123, 0
  v_mov_b32 v124, 0
  v_mov_b32 v125, 0
  v_mov_b32 v126, 0
  v_mov_b32 v127, 0
  v_mov_b32 v49, 0xff800000
  v_mov_b32 v51, 0
  v_mov_b32 v128, 0
  v_mov_b32 v129, 0
  v_mov_b32 v130, 0
  v_mov_b32 v131, 0
  v_mov_b32 v132, 0
  v_mov_b32 v133, 0
  v_mov_b32 v134, 0
  v_mov_b32 v135, 0
  v_mov_b32 v136, 0
  v_mov_b32 v137, 0
  v_mov_b32 v138, 0
  v_mov_b32 v139, 0
  v_mov_b32 v140, 0
  v_mov_b32 v141, 0
  v_mov_b32 v142, 0
  v_mov_b32 v143, 0
L_fb_loop:
  buffer_load_dwordx4 v[160:163], v4, s[20:23], s83 offen offset:0 sc1
  buffer_load_dwordx4 v[164:167], v4, s[20:23], s83 offen offset:1024 sc1
  buffer_load_dwordx4 v[176:179], v4, s[20:23], s83 offen offset:2048 sc1
  buffer_load_dwordx4 v[180:183], v4, s[20:23], s83 offen offset:3072 sc1
  s_waitcnt vmcnt(3)
  v_mfma_f32_32x32x16_bf16 v[80:95], v[160:163], v[32:35], 0
  s_waitcnt vmcnt(2)
  v_mfma_f32_32x32x16_bf16 v[80:95], v[164:167], v[36:39], v[80:95]
  v_mfma_f32_32x32x16_bf16 v[96:111], v[160:163], v[40:43], 0
  v_mfma_f32_32x32x16_bf16 v[96:111], v[164:167], v[44:47], v[96:111]
  s_nop 9
  v_max3_f32 v12, v80, v81, v48
  v_max3_f32 v12, v82, v83, v12
  v_max3_f32 v12, v84, v85, v12
  v_max3_f32 v12, v86, v87, v12
  v_max3_f32 v12, v88, v89, v12
  v_max3_f32 v12, v90, v91, v12
  v_max3_f32 v12, v92, v93, v12
  v_max3_f32 v12, v94, v95, v12
  v_mov_b32 v13, v12
  s_nop 1
  v_permlane32_swap_b32 v12, v13
  v_max_f32 v12, v12, v13
  v_sub_f32 v13, v48, v12
  v_exp_f32 v13, v13
  v_mov_b32 v48, v12
  v_mul_f32 v50, v13, v50
  v_mul_f32 v112, v13, v112
  v_mul_f32 v113, v13, v113
  v_mul_f32 v114, v13, v114
  v_mul_f32 v115, v13, v115
  v_mul_f32 v116, v13, v116
  v_mul_f32 v117, v13, v117
  v_mul_f32 v118, v13, v118
  v_mul_f32 v119, v13, v119
  v_mul_f32 v120, v13, v120
  v_mul_f32 v121, v13, v121
  v_mul_f32 v122, v13, v122
  v_mul_f32 v123, v13, v123
  v_mul_f32 v124, v13, v124
  v_mul_f32 v125, v13, v125
  v_mul_f32 v126, v13, v126
  v_mul_f32 v127, v13, v127
  v_sub_f32 v80, v80, v12
  v_sub_f32 v81, v81, v12
  v_sub_f32 v82, v82, v12
  v_sub_f32 v83, v83, v12
  v_sub_f32 v84, v84, v12
  v_sub_f32 v85, v85, v12
  v_sub_f32 v86, v86, v12
  v_sub_f32 v87, v87, v12
  v_sub_f32 v88, v88, v12
  v_sub_f32 v89, v89, v12
  v_sub_f32 v90, v90, v12
  v_sub_f32 v91, v91, v12
  v_sub_f32 v92, v92, v12
  v_sub_f32 v93, v93, v12
  v_sub_f32 v94, v94, v12
  v_sub_f32 v95, v95, v12
  v_exp_f32 v80, v80
  v_exp_f32 v81, v81
  v_exp_f32 v82, v82
  v_exp_f32 v83, v83
  v_exp_f32 v84, v84
  v_exp_f32 v85, v85
  v_exp_f32 v86, v86
  v_exp_f32 v87, v87
  v_exp_f32 v88, v88
  v_exp_f32 v89, v89
  v_exp_f32 v90, v90
  v_exp_f32 v91, v91
  v_exp_f32 v92, v92
  v_exp_f32 v93, v93
  v_exp_f32 v94, v94
  v_exp_f32 v95, v95
  v_add_f32 v50, v50, v80
  v_add_f32 v50, v50, v81
  v_add_f32 v50, v50, v82
  v_add_f32 v50, v50, v83
  v_add_f32 v50, v50, v84
  v_add_f32 v50, v50, v85
  v_add_f32 v50, v50, v86
  v_add_f32 v50, v50, v87
  v_add_f32 v50, v50, v88
  v_add_f32 v50, v50, v89
  v_add_f32 v50, v50, v90
  v_add_f32 v50, v50, v91
  v_add_f32 v50, v50, v92
  v_add_f32 v50, v50, v93
  v_add_f32 v50, v50, v94
  v_add_f32 v50, v50, v95
  v_cvt_pk_bf16_f32 v144, v80, v81
  v_cvt_pk_bf16_f32 v145, v82, v83
  v_cvt_pk_bf16_f32 v146, v84, v85
  v_cvt_pk_bf16_f32 v147, v86, v87
  v_cvt_pk_bf16_f32 v148, v88, v89
  v_cvt_pk_bf16_f32 v149, v90, v91
  v_cvt_pk_bf16_f32 v150, v92, v93
  v_cvt_pk_bf16_f32 v151, v94, v95
  s_waitcnt vmcnt(1)
  v_mfma_f32_32x32x16_bf16 v[112:127], v[176:179], v[144:147], v[112:127]
  s_waitcnt vmcnt(0)
  v_mfma_f32_32x32x16_bf16 v[112:127], v[180:183], v[148:151], v[112:127]
  v_max3_f32 v12, v96, v97, v49
  v_max3_f32 v12, v98, v99, v12
  v_max3_f32 v12, v100, v101, v12
  v_max3_f32 v12, v102, v103, v12
  v_max3_f32 v12, v104, v105, v12
  v_max3_f32 v12, v106, v107, v12
  v_max3_f32 v12, v108, v109, v12
  v_max3_f32 v12, v110, v111, v12
  v_mov_b32 v13, v12
  s_nop 1
  v_permlane32_swap_b32 v12, v13
  v_max_f32 v12, v12, v13
  v_sub_f32 v13, v49, v12
  v_exp_f32 v13, v13
  v_mov_b32 v49, v12
  v_mul_f32 v51, v13, v51
  v_mul_f32 v128, v13, v128
  v_mul_f32 v129, v13, v129
  v_mul_f32 v130, v13, v130
  v_mul_f32 v131, v13, v131
  v_mul_f32 v132, v13, v132
  v_mul_f32 v133, v13, v133
  v_mul_f32 v134, v13, v134
  v_mul_f32 v135, v13, v135
  v_mul_f32 v136, v13, v136
  v_mul_f32 v137, v13, v137
  v_mul_f32 v138, v13, v138
  v_mul_f32 v139, v13, v139
  v_mul_f32 v140, v13, v140
  v_mul_f32 v141, v13, v141
  v_mul_f32 v142, v13, v142
  v_mul_f32 v143, v13, v143
  v_sub_f32 v96, v96, v12
  v_sub_f32 v97, v97, v12
  v_sub_f32 v98, v98, v12
  v_sub_f32 v99, v99, v12
  v_sub_f32 v100, v100, v12
  v_sub_f32 v101, v101, v12
  v_sub_f32 v102, v102, v12
  v_sub_f32 v103, v103, v12
  v_sub_f32 v104, v104, v12
  v_sub_f32 v105, v105, v12
  v_sub_f32 v106, v106, v12
  v_sub_f32 v107, v107, v12
  v_sub_f32 v108, v108, v12
  v_sub_f32 v109, v109, v12
  v_sub_f32 v110, v110, v12
  v_sub_f32 v111, v111, v12
  v_exp_f32 v96, v96
  v_exp_f32 v97, v97
  v_exp_f32 v98, v98
  v_exp_f32 v99, v99
  v_exp_f32 v100, v100
  v_exp_f32 v101, v101
  v_exp_f32 v102, v102
  v_exp_f32 v103, v103
  v_exp_f32 v104, v104
  v_exp_f32 v105, v105
  v_exp_f32 v106, v106
  v_exp_f32 v107, v107
  v_exp_f32 v108, v108
  v_exp_f32 v109, v109
  v_exp_f32 v110, v110
  v_exp_f32 v111, v111
  v_add_f32 v51, v51, v96
  v_add_f32 v51, v51, v97
  v_add_f32 v51, v51, v98
  v_add_f32 v51, v51, v99
  v_add_f32 v51, v51, v100
  v_add_f32 v51, v51, v101
  v_add_f32 v51, v51, v102
  v_add_f32 v51, v51, v103
  v_add_f32 v51, v51, v104
  v_add_f32 v51, v51, v105
  v_add_f32 v51, v51, v106
  v_add_f32 v51, v51, v107
  v_add_f32 v51, v51, v108
  v_add_f32 v51, v51, v109
  v_add_f32 v51, v51, v110
  v_add_f32 v51, v51, v111
  v_cvt_pk_bf16_f32 v152, v96, v97
  v_cvt_pk_bf16_f32 v153, v98, v99
  v_cvt_pk_bf16_f32 v154, v100, v101
  v_cvt_pk_bf16_f32 v155, v102, v103
  v_cvt_pk_bf16_f32 v156, v104, v105
  v_cvt_pk_bf16_f32 v157, v106, v107
  v_cvt_pk_bf16_f32 v158, v108, v109
  v_cvt_pk_bf16_f32 v159, v110, v111
  v_mfma_f32_32x32x16_bf16 v[128:143], v[176:179], v[152:155], v[128:143]
  s_nop 0
  v_mfma_f32_32x32x16_bf16 v[128:143], v[180:183], v[156:159], v[128:143]
  s_add_u32 s83, s83, 4096
  s_sub_u32 s86, s86, 1
  s_cmp_lg_u32 s86, 0
  s_cbranch_scc1 L_fb_loop
  v_mov_b32 v13, v50
  s_nop 1
  v_permlane32_swap_b32 v50, v13
  v_add_f32 v192, v50, v13
  v_mov_b32 v13, v51
  s_nop 1
  v_permlane32_swap_b32 v51, v13
  v_add_f32 v196, v51, v13
  s_branch L_norm
L_ann:
  s_mov_b64 exec, 1
  v_mov_b32 v31, 1
  buffer_atomic_add v31, off, s[36:39], 0 offset:252 sc1
  s_mov_b64 exec, -1
  s_nop 3
  s_branch L_annret
L_retry0:
  s_mov_b32 s64, 0
L_spin0:
  s_add_u32 s64, s64, 1
  s_cmp_gt_u32 s64, 32768
  s_cbranch_scc1 L_end
  s_sleep 2
  buffer_load_dword v5, off, s[36:39], 0 offset:252 sc1
  s_waitcnt vmcnt(0)
  v_cmp_gt_u32 vcc, 0x100, v5
  s_nop 0
  s_cbranch_vccnz L_spin0
  s_branch L_cont0
L_retry1:
  s_mov_b32 s64, 0
L_spin1:
  s_add_u32 s64, s64, 1
  s_cmp_gt_u32 s64, 32768
  s_cbranch_scc1 L_end
  s_sleep 2
  buffer_load_dword v25, v24, s[20:23], s94 offen sc1
  s_waitcnt vmcnt(0)
  v_cmp_gt_u32 vcc, 1, v25
  s_nop 0
  s_cbranch_vccnz L_spin1
  s_branch L_cont1
L_retry2:
  s_mov_b32 s64, 0
L_spin2:
  s_add_u32 s64, s64, 1
  s_cmp_gt_u32 s64, 32768
  s_cbranch_scc1 L_end
  s_sleep 2
  buffer_load_dword v25, v24, s[20:23], s94 offen sc1
  s_waitcnt vmcnt(0)
  v_cmp_gt_u32 vcc, 3, v25
  s_nop 0
  s_cbranch_vccnz L_spin2
  s_branch L_cont2
L_retry3:
  s_mov_b32 s64, 0
L_spin3:
  s_add_u32 s64, s64, 1
  s_cmp_gt_u32 s64, 32768
  s_cbranch_scc1 L_end
  s_sleep 2
  buffer_load_dword v25, v24, s[20:23], s94 offen sc1
  s_waitcnt vmcnt(0)
  v_cmp_gt_u32 vcc, 7, v25
  s_nop 0
  s_cbranch_vccnz L_spin3
  s_branch L_cont3
L_retry4:
  s_mov_b32 s64, 0
L_spin4:
  s_add_u32 s64, s64, 1
  s_cmp_gt_u32 s64, 32768
  s_cbranch_scc1 L_end
  s_sleep 2
  buffer_load_dword v25, v24, s[20:23], s94 offen sc1
  s_waitcnt vmcnt(0)
  v_cmp_gt_u32 vcc, 15, v25
  s_nop 0
  s_cbranch_vccnz L_spin4
  s_branch L_cont4
L_retry5:
  s_mov_b32 s64, 0
L_spin5:
  s_add_u32 s64, s64, 1
  s_cmp_gt_u32 s64, 32768
  s_cbranch_scc1 L_end
  s_sleep 2
  buffer_load_dword v25, v24, s[20:23], s94 offen sc1
  s_waitcnt vmcnt(0)
  v_cmp_gt_u32 vcc, 7, v25
  s_nop 0
  s_cbranch_vccnz L_spin5
  s_branch L_cont5
L_retry6:
  s_mov_b32 s64, 0
L_spin6:
  s_add_u32 s64, s64, 1
  s_cmp_gt_u32 s64, 32768
  s_cbranch_scc1 L_end
  s_sleep 2
  buffer_load_dword v25, v24, s[20:23], s94 offen sc1
  s_waitcnt vmcnt(0)
  v_cmp_gt_u32 vcc, 15, v25
  s_nop 0
  s_cbranch_vccnz L_spin6
  s_branch L_cont6
L_codeend:
.section .rodata,"a"
.p2align 6
.amdhsa_kernel gated_mix__softmax_full_mha__glu_gated_geglu__prompt_kernel
  .amdhsa_next_free_vgpr 512
  .amdhsa_next_free_sgpr 102
  .amdhsa_accum_offset 256
  .amdhsa_group_segment_fixed_size 0
  .amdhsa_kernarg_size 88
  .amdhsa_user_sgpr_count 2
  .amdhsa_user_sgpr_kernarg_segment_ptr 1
  .amdhsa_system_sgpr_workgroup_id_x 1
.end_amdhsa_kernel
```
